```python
import torch

def _softmax(x, axis=-1):
    return torch.softmax(x, dim=axis)
def _gelu(x):
    return torch.nn.functional.gelu(x, approximate="tanh")
def _silu(x):
    return torch.nn.functional.silu(x)
def _sigmoid(x):
    return torch.sigmoid(x)
def _layernorm(x, axis=-1, eps=1e-5):
    m = x.mean(dim=axis, keepdim=True)
    v = x.var(dim=axis, keepdim=True, unbiased=False)
    return (x - m) / torch.sqrt(v + eps)
def _scatter_add(tgt, idx, src, axis=0):
    return tgt.clone().index_add_(axis, idx, src)
def _segment_sum(src, seg, n):
    out = torch.zeros((n,) + src.shape[1:], dtype=src.dtype)
    return out.index_add_(0, seg, src)
def _pad(x, pw):
    flat = tuple(v for pair in reversed(pw) for v in pair)
    return torch.nn.functional.pad(x, flat)

kernel_name = 'sequential_preLN__compressed_kv_cla__geglu_ffn__prompt'

def setup_inputs():

    _w = (lambda a: (lambda t: t.to(torch.bfloat16) if t.is_floating_point() else t)(torch.as_tensor(a)))
    def _A_setup():
        B, H, Sq, Sk, D, M = 1, 32, 2048, 2048, 128, 512
        Dc = 4 * D
        return {
            "x": _w((lambda *s: torch.randn(*s, dtype=torch.bfloat16) * 0.05)(B, Sq, M)),
            "c_kv": _w((lambda *s: torch.randn(*s, dtype=torch.bfloat16) * 0.4)(B, Sk, Dc)),
            "w_q": _w((lambda *s: torch.randn(*s, dtype=torch.bfloat16) * 1.6)(M, H, D) * (M ** -0.5)),
            "w_uk": _w((lambda *s: torch.randn(*s, dtype=torch.bfloat16) * 1.6)(Dc, H, D) * (Dc ** -0.5)),
            "w_uv": _w((lambda *s: torch.randn(*s, dtype=torch.bfloat16) * 0.4)(Dc, H, D) * (Dc ** -0.5)),
            "w_o": _w((lambda *s: torch.randn(*s, dtype=torch.bfloat16) * 0.4)(H, D, M) * ((H * D) ** -0.5)),
        }
    _A_in = _A_setup()

    def _B_setup():
        B, S, D, F = 1, 2048, 512, 1792
        return {
            "x": _w((lambda *s: torch.randn(*s, dtype=torch.bfloat16) * 0.05)(B, S, D)),
            "w_gate": _w((lambda *s: torch.randn(*s, dtype=torch.bfloat16) * 0.05)(D, F)),
            "w_up": _w((lambda *s: torch.randn(*s, dtype=torch.bfloat16) * 0.05)(D, F)),
            "w_down": _w((lambda *s: torch.randn(*s, dtype=torch.bfloat16) * 0.05)(F, D)),
        }
    _B_in = _B_setup()

    return {
        "A_x": _A_in["x"],
        "A_c_kv": _A_in["c_kv"],
        "A_w_q": _A_in["w_q"],
        "A_w_uk": _A_in["w_uk"],
        "A_w_uv": _A_in["w_uv"],
        "A_w_o": _A_in["w_o"],
        "B_x": _B_in["x"],
        "B_w_gate": _B_in["w_gate"],
        "B_w_up": _B_in["w_up"],
        "B_w_down": _B_in["w_down"],
    }

def reference(A_x, A_c_kv, A_w_q, A_w_uk, A_w_uv, A_w_o, B_x, B_w_gate, B_w_up, B_w_down):
    def _A_ref(x, c_kv, w_q, w_uk, w_uv, w_o):
        B, Sq, M = x.shape[0], x.shape[1], x.shape[2]
        Sk = c_kv.shape[1]
        H, D = w_q.shape[1], w_q.shape[2]
        q = torch.einsum("bqm,mhd->bhqd", x, w_q)
        k = torch.einsum("bkc,chd->bhkd", c_kv, w_uk)
        v = torch.einsum("bkc,chd->bhkd", c_kv, w_uv)
        scores = torch.einsum("bhqd,bhkd->bhqk", q, k) * (D ** -0.5)
        off = Sk - Sq
        qi = torch.arange(Sq)[:, None]
        kj = torch.arange(Sk)[None, :]
        cmask = kj <= (qi + off)
        scores = torch.where(cmask[None, None], scores, -1e9)
        p = _softmax(scores, axis=-1)
        ctx = torch.einsum("bhqk,bhkd->bhqd", p, v)
        return torch.einsum("bhqd,hdm->bqm", ctx, w_o)

    def _B_ref(x, w_gate, w_up, w_down):
        return (_gelu(x @ w_gate) * (x @ w_up)) @ w_down

    x = A_x
    h = x + _A_ref(_layernorm(x, axis=-1), A_c_kv, A_w_q, A_w_uk, A_w_uv, A_w_o)
    h2 = h + _B_ref(_layernorm(h, axis=-1), B_w_gate, B_w_up, B_w_down)
    return h2
```

```asm
; @launch grid=(256,1,1) block=(256,1,1) lds=163840
.amdgcn_target "amdgcn-amd-amdhsa--gfx950"
.text
.globl sequential_preLN__compressed_kv_cla__geglu_ffn__prompt_kernel
.p2align 8
.type sequential_preLN__compressed_kv_cla__geglu_ffn__prompt_kernel,@function
sequential_preLN__compressed_kv_cla__geglu_ffn__prompt_kernel:
    s_cmp_ge_u32 s2, 256
    s_cbranch_scc1 L_end
    s_mov_b32 s38, 0
L_restart:
    s_load_dwordx8 s[64:71], s[0:1], 0
    s_load_dwordx2 s[72:73], s[0:1], 32
    s_load_dwordx2 s[78:79], s[0:1], 96
    s_load_dwordx2 s[74:75], s[0:1], 56
    s_load_dwordx2 s[76:77], s[0:1], 64
    s_load_dwordx2 s[28:29], s[0:1], 88
    v_lshrrev_b32 v1, 6, v0
    s_and_b32 s26, s2, 7
    s_lshr_b32 s39, s2, 3
    v_readfirstlane_b32 s3, v1
    s_and_b32 s37, s39, 3
    s_lshl_b32 s24, s26, 2
    s_add_u32 s24, s24, s37
    s_lshr_b32 s25, s39, 2
    v_and_b32 v27, 63, v0
    v_lshlrev_b32 v1, 4, v27
    s_lshl_b32 s26, s25, 18
    s_lshl_b32 s39, s3, 16
    s_add_u32 s26, s26, s39
    v_lshrrev_b32 v16, 3, v27
    v_and_b32 v17, 7, v27
    v_lshrrev_b32 v18, 4, v27
    v_xor_b32 v17, v17, v18
    v_lshlrev_b32 v16, 10, v16
    v_lshl_add_u32 v16, v17, 4, v16
    v_add_u32 v240, s26, v16
    v_xor_b32 v19, 64, v240
    v_add_u32 v241, 7168, v19
    v_add_u32 v242, 14336, v240
    v_add_u32 v243, 21504, v19
    s_lshl_b32 s26, s3, 17
    s_lshl_b32 s39, s24, 8
    s_add_u32 s26, s26, s39
    v_and_b32 v20, 15, v27
    v_lshlrev_b32 v21, 1, v18
    v_xor_b32 v21, v20, v21
    v_lshlrev_b32 v22, 13, v18
    v_lshl_add_u32 v22, v21, 4, v22
    v_add_u32 v244, s26, v22
    v_xor_b32 v19, 128, v244
    v_add_u32 v245, 31744, v244
    v_add_u32 v246, 63488, v19
    v_add_u32 v247, 95232, v19
    s_lshl_b32 s35, s3, 13
    s_add_u32 s35, s35, 32768
    s_lshl_b32 s36, s3, 12
    s_add_u32 s36, s36, 65536
    s_lshr_b32 s26, s2, 3
    s_lshr_b32 s26, 0x993366cc, s26
    s_and_b32 s26, s26, 1
    s_mul_i32 s26, s26, 4
    s_add_u32 s26, s26, 0
    s_and_b32 s26, s26, 7
    s_lshl_b32 s32, s26, 7
    s_lshl_b32 s34, s26, 19
    s_waitcnt lgkmcnt(0)
    s_add_u32 s78, s78, 184549376
    s_addc_u32 s79, s79, 0
    s_mov_b32 s4, s66
    s_mov_b32 s5, s67
    s_mov_b32 s6, 0x200000
    s_mov_b32 s7, 0x00020000
    s_mov_b32 s8, s70
    s_mov_b32 s9, s71
    s_mov_b32 s10, 0x400000
    s_mov_b32 s11, 0x00020000
    s_mov_b32 s20, s72
    s_mov_b32 s21, s73
    s_mov_b32 s22, 0x400000
    s_mov_b32 s23, 0x00020000
    s_add_u32 m0, s35, 0
    s_add_u32 s33, s32, 32768
    buffer_load_dwordx4 v240, s[4:7], s32 offen offset:0  lds
    buffer_load_dwordx4 v241, s[4:7], s32 offen offset:1024  lds
    buffer_load_dwordx4 v242, s[4:7], s32 offen offset:2048  lds
    buffer_load_dwordx4 v243, s[4:7], s32 offen offset:3072  lds
    s_add_u32 m0, s35, 4096
    s_add_u32 s32, s32, 128
    buffer_load_dwordx4 v240, s[4:7], s33 offen offset:0  lds
    buffer_load_dwordx4 v241, s[4:7], s33 offen offset:1024  lds
    buffer_load_dwordx4 v242, s[4:7], s33 offen offset:2048  lds
    buffer_load_dwordx4 v243, s[4:7], s33 offen offset:3072  lds
    s_add_u32 m0, s36, 0
    s_and_b32 s32, s32, 1023
    buffer_load_dwordx4 v244, s[8:11], s34 offen offset:0  lds
    buffer_load_dwordx4 v245, s[8:11], s34 offen offset:1024  lds
    buffer_load_dwordx4 v246, s[8:11], s34 offen offset:2048  lds
    buffer_load_dwordx4 v247, s[8:11], s34 offen offset:3072  lds
    s_add_u32 m0, s36, 16384
    s_nop 0
    buffer_load_dwordx4 v244, s[20:23], s34 offen offset:0  lds
    buffer_load_dwordx4 v245, s[20:23], s34 offen offset:1024  lds
    buffer_load_dwordx4 v246, s[20:23], s34 offen offset:2048  lds
    buffer_load_dwordx4 v247, s[20:23], s34 offen offset:3072  lds
    s_add_u32 s34, s34, 524288
    s_and_b32 s34, s34, 4194303
    s_getpc_b64 s[48:49]
L_pc:
    s_mov_b32 s50, L_text_end-L_pc
    s_mov_b32 s51, 0x00020000
    s_lshr_b32 s26, s2, 3
    s_lshl_b32 s26, s26, 12
    s_lshl_b32 s39, s3, 10
    s_add_u32 s26, s26, s39
    v_and_b32 v24, 7, v27
    v_lshl_add_u32 v24, v24, 7, s26
    buffer_load_dword v226, v24, s[48:51], 0 offen
    s_lshl_b32 s26, s3, 14
    s_and_b32 s26, s26, 0x4000
    s_add_u32 s26, s26, 32768
    v_lshrrev_b32 v24, 1, v20
    v_xor_b32 v24, v24, v18
    v_lshlrev_b32 v25, 7, v20
    v_lshl_add_u32 v25, v24, 4, v25
    v_add_u32 v248, s26, v25
    v_xor_b32 v249, 64, v248
    v_lshrrev_b32 v24, 2, v20
    v_lshl_add_u32 v25, v18, 3, v24
    v_lshlrev_b32 v25, 8, v25
    v_and_b32 v26, 1, v18
    v_lshl_add_u32 v26, v26, 2, v24
    v_lshl_add_u32 v25, v26, 5, v25
    v_and_b32 v26, 3, v20
    v_lshl_add_u32 v25, v26, 3, v25
    v_add_u32 v2, 32768, v25
    v_add_u32 v25, 65536, v25
    s_lshr_b32 s26, s3, 1
    s_lshl_b32 s26, s26, 7
    v_xor_b32 v250, s26, v25
    v_xor_b32 v251, 32, v250
    v_xor_b32 v252, 64, v250
    v_xor_b32 v253, 96, v250
    s_add_u32 s60, s78, 0x480000
    s_addc_u32 s61, s79, 0
    s_mov_b32 s62, 0x16000
    s_mov_b32 s63, 0x00020000
    s_mov_b32 s40, s64
    s_mov_b32 s41, s65
    s_mov_b32 s42, 0x200000
    s_mov_b32 s43, 0x00020000
    s_or_b32 s66, s2, s38
    s_min_u32 s66, s66, 1
    s_lshl_b32 s66, s66, 28
    s_mul_i32 s67, s3, 22528
    s_add_u32 s66, s66, s67
    v_lshrrev_b32 v24, 3, v27
    v_lshlrev_b32 v24, 8, v24
    v_and_b32 v224, 112, v1
    v_add3_u32 v224, v224, v24, s66
    v_mov_b64 v[232:233], 0
    v_mov_b64 v[234:235], 0
    s_lshl_b32 s26, s2, 13
    s_lshl_b32 s39, s3, 11
    s_add_u32 s26, s26, s39
    v_add_u32 v231, s26, v1
    s_lshl_b32 s72, s3, 13
    s_sub_u32 s16, s2, 32
    s_and_b32 s16, s16, 255
    s_sub_u32 s17, s2, 96
    s_and_b32 s17, s17, 255
    s_barrier
    s_add_u32 m0, s35, 65536
    s_add_u32 s33, s32, 32768
    buffer_load_dwordx4 v240, s[4:7], s32 offen offset:0  lds
    buffer_load_dwordx4 v241, s[4:7], s32 offen offset:1024  lds
    buffer_load_dwordx4 v242, s[4:7], s32 offen offset:2048  lds
    buffer_load_dwordx4 v243, s[4:7], s32 offen offset:3072  lds
    s_add_u32 m0, s35, 69632
    s_add_u32 s32, s32, 128
    buffer_load_dwordx4 v240, s[4:7], s33 offen offset:0  lds
    buffer_load_dwordx4 v241, s[4:7], s33 offen offset:1024  lds
    buffer_load_dwordx4 v242, s[4:7], s33 offen offset:2048  lds
    buffer_load_dwordx4 v243, s[4:7], s33 offen offset:3072  lds
    s_add_u32 m0, s36, 65536
    s_and_b32 s32, s32, 1023
    buffer_load_dwordx4 v244, s[8:11], s34 offen offset:0  lds
    buffer_load_dwordx4 v245, s[8:11], s34 offen offset:1024  lds
    buffer_load_dwordx4 v246, s[8:11], s34 offen offset:2048  lds
    buffer_load_dwordx4 v247, s[8:11], s34 offen offset:3072  lds
    s_add_u32 m0, s36, 81920
    s_nop 0
    s_or_b32 s66, s2, s38
    s_cmp_eq_u32 s66, 0
    s_cbranch_scc0 L_noclr
    s_mov_b32 s66, 0
    buffer_store_dwordx4 v[232:235], v224, s[60:63], s66 offen sc1
    s_mov_b32 s66, 2048
    buffer_store_dwordx4 v[232:235], v224, s[60:63], s66 offen sc1
    s_mov_b32 s66, 4096
    buffer_store_dwordx4 v[232:235], v224, s[60:63], s66 offen sc1
    s_mov_b32 s66, 6144
    buffer_store_dwordx4 v[232:235], v224, s[60:63], s66 offen sc1
    s_mov_b32 s66, 8192
    buffer_store_dwordx4 v[232:235], v224, s[60:63], s66 offen sc1
    s_mov_b32 s66, 10240
    buffer_store_dwordx4 v[232:235], v224, s[60:63], s66 offen sc1
    s_mov_b32 s66, 12288
    buffer_store_dwordx4 v[232:235], v224, s[60:63], s66 offen sc1
    s_mov_b32 s66, 14336
    buffer_store_dwordx4 v[232:235], v224, s[60:63], s66 offen sc1
    s_mov_b32 s66, 16384
    buffer_store_dwordx4 v[232:235], v224, s[60:63], s66 offen sc1
    s_mov_b32 s66, 18432
    buffer_store_dwordx4 v[232:235], v224, s[60:63], s66 offen sc1
    s_mov_b32 s66, 20480
    buffer_store_dwordx4 v[232:235], v224, s[60:63], s66 offen sc1
L_noclr:
    s_waitcnt vmcnt(13)
    s_barrier
    ds_read_b128 v[16:19], v248 offset:0
    ds_read_b128 v[20:23], v248 offset:2048
    ds_read_b128 v[24:27], v248 offset:4096
    ds_read_b128 v[28:31], v248 offset:6144
    ds_read_b64_tr_b16 v[48:49], v250 offset:0
    ds_read_b64_tr_b16 v[50:51], v250 offset:1024
    ds_read_b64_tr_b16 v[52:53], v251 offset:0
    ds_read_b64_tr_b16 v[54:55], v251 offset:1024
    ds_read_b64_tr_b16 v[56:57], v252 offset:0
    ds_read_b64_tr_b16 v[58:59], v252 offset:1024
    ds_read_b64_tr_b16 v[60:61], v253 offset:0
    ds_read_b64_tr_b16 v[62:63], v253 offset:1024
    ds_read_b128 v[32:35], v248 offset:8192
    ds_read_b128 v[36:39], v248 offset:10240
    ds_read_b128 v[40:43], v248 offset:12288
    ds_read_b128 v[44:47], v248 offset:14336
    ds_read_b64_tr_b16 v[64:65], v250 offset:16384
    ds_read_b64_tr_b16 v[66:67], v250 offset:17408
    ds_read_b64_tr_b16 v[68:69], v251 offset:16384
    ds_read_b64_tr_b16 v[70:71], v251 offset:17408
    ds_read_b64_tr_b16 v[72:73], v252 offset:16384
    ds_read_b64_tr_b16 v[74:75], v252 offset:17408
    ds_read_b64_tr_b16 v[76:77], v253 offset:16384
    ds_read_b64_tr_b16 v[78:79], v253 offset:17408
    s_waitcnt lgkmcnt(0)
    v_mfma_f32_16x16x32_bf16 a[0:3], v[48:51], v[16:19], 0
    buffer_load_dwordx4 v244, s[20:23], s34 offen offset:0  lds
    v_mfma_f32_16x16x32_bf16 a[4:7], v[48:51], v[20:23], 0
    buffer_load_dwordx4 v245, s[20:23], s34 offen offset:1024  lds
    v_mfma_f32_16x16x32_bf16 a[8:11], v[48:51], v[24:27], 0
    buffer_load_dwordx4 v246, s[20:23], s34 offen offset:2048  lds
    v_mfma_f32_16x16x32_bf16 a[12:15], v[48:51], v[28:31], 0
    buffer_load_dwordx4 v247, s[20:23], s34 offen offset:3072  lds
    v_mfma_f32_16x16x32_bf16 a[16:19], v[48:51], v[32:35], 0
    s_add_u32 s34, s34, 524288
    v_mfma_f32_16x16x32_bf16 a[20:23], v[48:51], v[36:39], 0
    s_and_b32 s34, s34, 4194303
    v_mfma_f32_16x16x32_bf16 a[24:27], v[48:51], v[40:43], 0
    buffer_load_dwordx4 v[144:147], v231, s[40:43], 0 offen offset:0
    v_mfma_f32_16x16x32_bf16 a[28:31], v[48:51], v[44:47], 0
    buffer_load_dwordx4 v[148:151], v231, s[40:43], 0 offen offset:1024
    v_mfma_f32_16x16x32_bf16 a[32:35], v[52:55], v[16:19], 0
    s_mov_b32 s44, s78
    v_mfma_f32_16x16x32_bf16 a[36:39], v[52:55], v[20:23], 0
    s_mov_b32 s45, s79
    v_mfma_f32_16x16x32_bf16 a[40:43], v[52:55], v[24:27], 0
    s_mov_b32 s46, 0x200000
    v_mfma_f32_16x16x32_bf16 a[44:47], v[52:55], v[28:31], 0
    s_mov_b32 s47, 0x00020000
    v_mfma_f32_16x16x32_bf16 a[48:51], v[52:55], v[32:35], 0
    ds_read_b128 v[80:83], v249 offset:0
    v_add_u32 v173, s72, v1
    v_mfma_f32_16x16x32_bf16 a[52:55], v[52:55], v[36:39], 0
    ds_read_b128 v[84:87], v249 offset:2048
    v_mfma_f32_16x16x32_bf16 a[56:59], v[52:55], v[40:43], 0
    ds_read_b128 v[88:91], v249 offset:4096
    v_bfe_u32 v224, v1, 5, 2
    v_mfma_f32_16x16x32_bf16 a[60:63], v[52:55], v[44:47], 0
    ds_read_b128 v[92:95], v249 offset:6144
    v_mfma_f32_16x16x32_bf16 a[64:67], v[56:59], v[16:19], 0
    ds_read_b64_tr_b16 v[112:113], v250 offset:8192
    v_lshlrev_b32 v174, 13, v224
    v_mfma_f32_16x16x32_bf16 a[68:71], v[56:59], v[20:23], 0
    ds_read_b64_tr_b16 v[114:115], v250 offset:9216
    v_mfma_f32_16x16x32_bf16 a[72:75], v[56:59], v[24:27], 0
    ds_read_b64_tr_b16 v[116:117], v251 offset:8192
    v_bfe_u32 v224, v1, 4, 1
    v_mfma_f32_16x16x32_bf16 a[76:79], v[56:59], v[28:31], 0
    ds_read_b64_tr_b16 v[118:119], v251 offset:9216
    v_mfma_f32_16x16x32_bf16 a[80:83], v[56:59], v[32:35], 0
    ds_read_b64_tr_b16 v[120:121], v252 offset:8192
    v_mul_u32_u24 v224, 1040, v224
    v_mfma_f32_16x16x32_bf16 a[84:87], v[56:59], v[36:39], 0
    ds_read_b64_tr_b16 v[122:123], v252 offset:9216
    v_mfma_f32_16x16x32_bf16 a[88:91], v[56:59], v[40:43], 0
    ds_read_b64_tr_b16 v[124:125], v253 offset:8192
    v_lshrrev_b32 v225, 7, v1
    v_mfma_f32_16x16x32_bf16 a[92:95], v[56:59], v[44:47], 0
    ds_read_b64_tr_b16 v[126:127], v253 offset:9216
    v_mfma_f32_16x16x32_bf16 a[96:99], v[60:63], v[16:19], 0
    ds_read_b128 v[96:99], v249 offset:8192
    v_lshl_add_u32 v224, v225, 4, v224
    v_mfma_f32_16x16x32_bf16 a[100:103], v[60:63], v[20:23], 0
    ds_read_b128 v[100:103], v249 offset:10240
    v_mfma_f32_16x16x32_bf16 a[104:107], v[60:63], v[24:27], 0
    s_lshl_b32 s26, s3, 8
    v_mfma_f32_16x16x32_bf16 a[108:111], v[60:63], v[28:31], 0
    ds_read_b128 v[104:107], v249 offset:12288
    v_mfma_f32_16x16x32_bf16 a[112:115], v[60:63], v[32:35], 0
    s_add_u32 s26, s26, 4096
    v_mfma_f32_16x16x32_bf16 a[116:119], v[60:63], v[36:39], 0
    ds_read_b128 v[108:111], v249 offset:14336
    v_mfma_f32_16x16x32_bf16 a[120:123], v[60:63], v[40:43], 0
    ds_read_b64_tr_b16 v[128:129], v250 offset:24576
    v_add3_u32 v174, v174, v224, s26
    v_mfma_f32_16x16x32_bf16 a[124:127], v[60:63], v[44:47], 0
    ds_read_b64_tr_b16 v[130:131], v250 offset:25600
    v_mfma_f32_16x16x32_bf16 a[128:131], v[16:19], v[64:67], 0
    s_lshr_b32 s26, s2, 3
    v_mfma_f32_16x16x32_bf16 a[144:147], v[20:23], v[64:67], 0
    ds_read_b64_tr_b16 v[132:133], v251 offset:24576
    v_mfma_f32_16x16x32_bf16 a[160:163], v[24:27], v[64:67], 0
    s_lshl_b32 s26, s26, 16
    v_mfma_f32_16x16x32_bf16 a[176:179], v[28:31], v[64:67], 0
    ds_read_b64_tr_b16 v[134:135], v251 offset:25600
    v_mfma_f32_16x16x32_bf16 a[192:195], v[32:35], v[64:67], 0
    ds_read_b64_tr_b16 v[136:137], v252 offset:24576
    v_mfma_f32_16x16x32_bf16 a[208:211], v[36:39], v[64:67], 0
    ds_read_b64_tr_b16 v[138:139], v252 offset:25600
    v_mfma_f32_16x16x32_bf16 a[224:227], v[40:43], v[64:67], 0
    ds_read_b64_tr_b16 v[140:141], v253 offset:24576
    v_mfma_f32_16x16x32_bf16 a[240:243], v[44:47], v[64:67], 0
    ds_read_b64_tr_b16 v[142:143], v253 offset:25600
    v_mfma_f32_16x16x32_bf16 a[132:135], v[16:19], v[68:71], 0
    s_bfe_u32 s39, s2, 0x20001
    v_mfma_f32_16x16x32_bf16 a[148:151], v[20:23], v[68:71], 0
    s_lshl_b32 s39, s39, 10
    v_mfma_f32_16x16x32_bf16 a[164:167], v[24:27], v[68:71], 0
    s_add_u32 s26, s26, s39
    v_mfma_f32_16x16x32_bf16 a[180:183], v[28:31], v[68:71], 0
    s_and_b32 s39, s2, 1
    v_mfma_f32_16x16x32_bf16 a[196:199], v[32:35], v[68:71], 0
    s_lshl_b32 s39, s39, 7
    v_mfma_f32_16x16x32_bf16 a[212:215], v[36:39], v[68:71], 0
    v_mfma_f32_16x16x32_bf16 a[228:231], v[40:43], v[68:71], 0
    s_add_u32 s26, s26, s39
    v_add_u32 v248, 0x10000, v248
    v_add_u32 v249, 0x10000, v249
    v_mfma_f32_16x16x32_bf16 a[244:247], v[44:47], v[68:71], 0
    v_add_u32 v250, 0x10000, v250
    v_add_u32 v251, 0x10000, v251
    v_mfma_f32_16x16x32_bf16 a[136:139], v[16:19], v[72:75], 0
    s_lshl_b32 s39, s3, 14
    v_add_u32 v252, 0x10000, v252
    v_add_u32 v253, 0x10000, v253
    v_mfma_f32_16x16x32_bf16 a[152:155], v[20:23], v[72:75], 0
    v_mfma_f32_16x16x32_bf16 a[168:171], v[24:27], v[72:75], 0
    s_add_u32 s26, s26, s39
    v_mfma_f32_16x16x32_bf16 a[184:187], v[28:31], v[72:75], 0
    v_mfma_f32_16x16x32_bf16 a[200:203], v[32:35], v[72:75], 0
    v_lshrrev_b32 v224, 2, v225
    v_mfma_f32_16x16x32_bf16 a[216:219], v[36:39], v[72:75], 0
    v_mfma_f32_16x16x32_bf16 a[232:235], v[40:43], v[72:75], 0
    v_and_b32 v225, 3, v225
    v_mfma_f32_16x16x32_bf16 a[248:251], v[44:47], v[72:75], 0
    v_mfma_f32_16x16x32_bf16 a[140:143], v[16:19], v[76:79], 0
    v_lshlrev_b32 v224, 12, v224
    v_mfma_f32_16x16x32_bf16 a[156:159], v[20:23], v[76:79], 0
    v_mfma_f32_16x16x32_bf16 a[172:175], v[24:27], v[76:79], 0
    v_lshl_add_u32 v224, v225, 8, v224
    v_mfma_f32_16x16x32_bf16 a[188:191], v[28:31], v[76:79], 0
    v_mfma_f32_16x16x32_bf16 a[204:207], v[32:35], v[76:79], 0
    v_and_b32 v225, 0x70, v1
    v_mfma_f32_16x16x32_bf16 a[220:223], v[36:39], v[76:79], 0
    v_mfma_f32_16x16x32_bf16 a[236:239], v[40:43], v[76:79], 0
    v_add3_u32 v172, v224, v225, s26
    v_mfma_f32_16x16x32_bf16 a[252:255], v[44:47], v[76:79], 0
    s_waitcnt vmcnt(2) lgkmcnt(0)
    s_barrier
    v_mfma_f32_16x16x32_bf16 a[0:3], v[112:115], v[80:83], a[0:3]
    s_add_u32 m0, s35, 0
    v_mfma_f32_16x16x32_bf16 a[4:7], v[112:115], v[84:87], a[4:7]
    s_mov_b32 s30, 256
    v_mfma_f32_16x16x32_bf16 a[8:11], v[112:115], v[88:91], a[8:11]
    s_add_u32 s33, s32, 32768
    v_mfma_f32_16x16x32_bf16 a[12:15], v[112:115], v[92:95], a[12:15]
    s_mov_b32 s31, 0x00020000
    v_mfma_f32_16x16x32_bf16 a[16:19], v[112:115], v[96:99], a[16:19]
    buffer_load_dwordx4 v240, s[4:7], s32 offen offset:0  lds
    v_mfma_f32_16x16x32_bf16 a[20:23], v[112:115], v[100:103], a[20:23]
    ds_read_b128 v[16:19], v248 offset:0
    v_min_u32 v255, 1, v0
    v_mfma_f32_16x16x32_bf16 a[24:27], v[112:115], v[104:107], a[24:27]
    buffer_load_dwordx4 v241, s[4:7], s32 offen offset:1024  lds
    v_mfma_f32_16x16x32_bf16 a[28:31], v[112:115], v[108:111], a[28:31]
    ds_read_b128 v[20:23], v248 offset:2048
    v_sub_u32 v229, 1, v255
    v_mfma_f32_16x16x32_bf16 a[32:35], v[116:119], v[80:83], a[32:35]
    buffer_load_dwordx4 v242, s[4:7], s32 offen offset:2048  lds
    v_mfma_f32_16x16x32_bf16 a[36:39], v[116:119], v[84:87], a[36:39]
    ds_read_b128 v[24:27], v248 offset:4096
    v_lshlrev_b32 v255, 28, v255
    v_mfma_f32_16x16x32_bf16 a[40:43], v[116:119], v[88:91], a[40:43]
    buffer_load_dwordx4 v243, s[4:7], s32 offen offset:3072  lds
    v_mfma_f32_16x16x32_bf16 a[44:47], v[116:119], v[92:95], a[44:47]
    s_min_u32 s26, s2, 1
    v_mfma_f32_16x16x32_bf16 a[48:51], v[116:119], v[96:99], a[48:51]
    s_add_u32 m0, s35, 4096
    v_mfma_f32_16x16x32_bf16 a[52:55], v[116:119], v[100:103], a[52:55]
    s_lshl_b32 s26, s26, 28
    v_mfma_f32_16x16x32_bf16 a[56:59], v[116:119], v[104:107], a[56:59]
    ds_read_b128 v[28:31], v248 offset:6144
    v_add_u32 v224, s26, v255
    v_mfma_f32_16x16x32_bf16 a[60:63], v[116:119], v[108:111], a[60:63]
    s_add_u32 s32, s32, 128
    v_mfma_f32_16x16x32_bf16 a[64:67], v[120:123], v[80:83], a[64:67]
    s_movk_i32 s27, 8192
    v_mfma_f32_16x16x32_bf16 a[68:71], v[120:123], v[84:87], a[68:71]
    buffer_load_dwordx4 v240, s[4:7], s33 offen offset:0  lds
    v_mfma_f32_16x16x32_bf16 a[72:75], v[120:123], v[88:91], a[72:75]
    ds_read_b64_tr_b16 v[48:49], v250 offset:0
    v_mfma_f32_16x16x32_bf16 a[76:79], v[120:123], v[92:95], a[76:79]
    buffer_load_dwordx4 v241, s[4:7], s33 offen offset:1024  lds
    v_mfma_f32_16x16x32_bf16 a[80:83], v[120:123], v[96:99], a[80:83]
    ds_read_b64_tr_b16 v[50:51], v250 offset:1024
    v_mfma_f32_16x16x32_bf16 a[84:87], v[120:123], v[100:103], a[84:87]
    buffer_load_dwordx4 v242, s[4:7], s33 offen offset:2048  lds
    v_mfma_f32_16x16x32_bf16 a[88:91], v[120:123], v[104:107], a[88:91]
    ds_read_b64_tr_b16 v[52:53], v251 offset:0
    v_mfma_f32_16x16x32_bf16 a[92:95], v[120:123], v[108:111], a[92:95]
    buffer_load_dwordx4 v243, s[4:7], s33 offen offset:3072  lds
    v_mfma_f32_16x16x32_bf16 a[96:99], v[124:127], v[80:83], a[96:99]
    ds_read_b64_tr_b16 v[54:55], v251 offset:1024
    v_mfma_f32_16x16x32_bf16 a[100:103], v[124:127], v[84:87], a[100:103]
    s_add_u32 m0, s36, 0
    v_mfma_f32_16x16x32_bf16 a[104:107], v[124:127], v[88:91], a[104:107]
    ds_read_b64_tr_b16 v[56:57], v252 offset:0
    v_mfma_f32_16x16x32_bf16 a[108:111], v[124:127], v[92:95], a[108:111]
    ds_read_b64_tr_b16 v[58:59], v252 offset:1024
    v_mfma_f32_16x16x32_bf16 a[112:115], v[124:127], v[96:99], a[112:115]
    s_and_b32 s32, s32, 1023
    v_mfma_f32_16x16x32_bf16 a[116:119], v[124:127], v[100:103], a[116:119]
    ds_read_b64_tr_b16 v[60:61], v253 offset:0
    v_mfma_f32_16x16x32_bf16 a[120:123], v[124:127], v[104:107], a[120:123]
    buffer_load_dwordx4 v244, s[8:11], s34 offen offset:0  lds
    v_mfma_f32_16x16x32_bf16 a[124:127], v[124:127], v[108:111], a[124:127]
    ds_read_b64_tr_b16 v[62:63], v253 offset:1024
    v_mfma_f32_16x16x32_bf16 a[128:131], v[80:83], v[128:131], a[128:131]
    buffer_load_dwordx4 v245, s[8:11], s34 offen offset:1024  lds
    v_mfma_f32_16x16x32_bf16 a[144:147], v[84:87], v[128:131], a[144:147]
    ds_read_b128 v[32:35], v248 offset:8192
    v_mfma_f32_16x16x32_bf16 a[160:163], v[88:91], v[128:131], a[160:163]
    buffer_load_dwordx4 v246, s[8:11], s34 offen offset:2048  lds
    v_mfma_f32_16x16x32_bf16 a[176:179], v[92:95], v[128:131], a[176:179]
    ds_read_b128 v[36:39], v248 offset:10240
    v_mfma_f32_16x16x32_bf16 a[192:195], v[96:99], v[128:131], a[192:195]
    buffer_load_dwordx4 v247, s[8:11], s34 offen offset:3072  lds
    v_mfma_f32_16x16x32_bf16 a[208:211], v[100:103], v[128:131], a[208:211]
    ds_read_b128 v[40:43], v248 offset:12288
    v_mfma_f32_16x16x32_bf16 a[224:227], v[104:107], v[128:131], a[224:227]
    s_add_u32 m0, s36, 16384
    v_mfma_f32_16x16x32_bf16 a[240:243], v[108:111], v[128:131], a[240:243]
    ds_read_b128 v[44:47], v248 offset:14336
    v_mfma_f32_16x16x32_bf16 a[132:135], v[80:83], v[132:135], a[132:135]
    s_nop 0
    v_mfma_f32_16x16x32_bf16 a[148:151], v[84:87], v[132:135], a[148:151]
    ds_read_b64_tr_b16 v[64:65], v250 offset:16384
    v_mfma_f32_16x16x32_bf16 a[164:167], v[88:91], v[132:135], a[164:167]
    ds_read_b64_tr_b16 v[66:67], v250 offset:17408
    v_mfma_f32_16x16x32_bf16 a[180:183], v[92:95], v[132:135], a[180:183]
    buffer_load_dwordx4 v244, s[20:23], s34 offen offset:0  lds
    v_mfma_f32_16x16x32_bf16 a[196:199], v[96:99], v[132:135], a[196:199]
    ds_read_b64_tr_b16 v[68:69], v251 offset:16384
    v_mfma_f32_16x16x32_bf16 a[212:215], v[100:103], v[132:135], a[212:215]
    buffer_load_dwordx4 v245, s[20:23], s34 offen offset:1024  lds
    v_mfma_f32_16x16x32_bf16 a[228:231], v[104:107], v[132:135], a[228:231]
    s_waitcnt vmcnt(14)
    v_mfma_f32_16x16x32_bf16 a[244:247], v[108:111], v[132:135], a[244:247]
    buffer_load_dwordx4 v246, s[20:23], s34 offen offset:2048  lds
    v_mfma_f32_16x16x32_bf16 a[136:139], v[80:83], v[136:139], a[136:139]
    ds_read_b64_tr_b16 v[70:71], v251 offset:17408
    v_lshlrev_b32 v152, 16, v144
    v_mfma_f32_16x16x32_bf16 a[152:155], v[84:87], v[136:139], a[152:155]
    buffer_load_dwordx4 v247, s[20:23], s34 offen offset:3072  lds
    v_mfma_f32_16x16x32_bf16 a[168:171], v[88:91], v[136:139], a[168:171]
    ds_read_b64_tr_b16 v[72:73], v252 offset:16384
    v_and_b32 v153, 0xffff0000, v144
    v_mfma_f32_16x16x32_bf16 a[184:187], v[92:95], v[136:139], a[184:187]
    ds_read_b64_tr_b16 v[74:75], v252 offset:17408
    v_lshlrev_b32 v154, 16, v145
    v_mfma_f32_16x16x32_bf16 a[200:203], v[96:99], v[136:139], a[200:203]
    ds_read_b64_tr_b16 v[76:77], v253 offset:16384
    v_and_b32 v155, 0xffff0000, v145
    v_mfma_f32_16x16x32_bf16 a[216:219], v[100:103], v[136:139], a[216:219]
    ds_read_b64_tr_b16 v[78:79], v253 offset:17408
    v_lshlrev_b32 v156, 16, v146
    v_mfma_f32_16x16x32_bf16 a[232:235], v[104:107], v[136:139], a[232:235]
    s_add_u32 s34, s34, 524288
    v_and_b32 v157, 0xffff0000, v146
    v_lshlrev_b32 v160, 16, v148
    v_mfma_f32_16x16x32_bf16 a[248:251], v[108:111], v[136:139], a[248:251]
    s_and_b32 s34, s34, 4194303
    v_lshlrev_b32 v158, 16, v147
    v_and_b32 v161, 0xffff0000, v148
    v_mfma_f32_16x16x32_bf16 a[140:143], v[80:83], v[140:143], a[140:143]
    v_and_b32 v159, 0xffff0000, v147
    v_lshlrev_b32 v162, 16, v149
    v_mfma_f32_16x16x32_bf16 a[156:159], v[84:87], v[140:143], a[156:159]
    v_add_f32 v168, v152, v153
    v_and_b32 v163, 0xffff0000, v149
    v_mfma_f32_16x16x32_bf16 a[172:175], v[88:91], v[140:143], a[172:175]
    buffer_store_dword v229, v224, s[28:31], 0 offen sc1
    v_mfma_f32_16x16x32_bf16 a[188:191], v[92:95], v[140:143], a[188:191]
    v_add_f32 v168, v168, v154
    v_lshlrev_b32 v164, 16, v150
    v_mfma_f32_16x16x32_bf16 a[204:207], v[96:99], v[140:143], a[204:207]
    v_add_f32 v168, v168, v155
    v_and_b32 v165, 0xffff0000, v150
    v_mfma_f32_16x16x32_bf16 a[220:223], v[100:103], v[140:143], a[220:223]
    v_add_f32 v168, v168, v156
    v_lshlrev_b32 v166, 16, v151
    v_mfma_f32_16x16x32_bf16 a[236:239], v[104:107], v[140:143], a[236:239]
    v_add_f32 v168, v168, v157
    v_and_b32 v167, 0xffff0000, v151
    v_mfma_f32_16x16x32_bf16 a[252:255], v[108:111], v[140:143], a[252:255]
    s_waitcnt lgkmcnt(0)
    v_add_f32 v168, v168, v158
    v_add_f32 v170, v160, v161
    v_mfma_f32_16x16x32_bf16 a[0:3], v[48:51], v[16:19], a[0:3]
    ds_read_b128 v[80:83], v249 offset:0
    v_add_f32 v168, v168, v159
    v_mfma_f32_16x16x32_bf16 a[4:7], v[48:51], v[20:23], a[4:7]
    ds_read_b128 v[84:87], v249 offset:2048
    v_add_f32 v170, v170, v162
    v_mfma_f32_16x16x32_bf16 a[8:11], v[48:51], v[24:27], a[8:11]
    s_bitcmp1_b32 s16, 2
    s_cselect_b32 s48, s76, s74
    s_cselect_b32 s49, s77, s75
    s_cselect_b32 s70, 1, 0
    v_mfma_f32_16x16x32_bf16 a[12:15], v[48:51], v[28:31], a[12:15]
    s_add_u32 s52, s78, 0x500000
    s_addc_u32 s53, s79, 0
    v_add_f32_dpp v168, v168, v168 row_ror:8 row_mask:0xf bank_mask:0xf
    v_mfma_f32_16x16x32_bf16 a[16:19], v[48:51], v[32:35], a[16:19]
    ds_read_b128 v[88:91], v249 offset:4096
    v_add_f32 v170, v170, v163
    v_mfma_f32_16x16x32_bf16 a[20:23], v[48:51], v[36:39], a[20:23]
    s_mov_b32 s54, 0x380000
    v_add_f32_dpp v168, v168, v168 row_ror:4 row_mask:0xf bank_mask:0xf
    v_add_f32 v170, v170, v164
    v_mfma_f32_16x16x32_bf16 a[24:27], v[48:51], v[40:43], a[24:27]
    s_mov_b32 s55, 0x00020000
    v_add_f32 v170, v170, v165
    v_mfma_f32_16x16x32_bf16 a[28:31], v[48:51], v[44:47], a[28:31]
    ds_read_b128 v[92:95], v249 offset:6144
    v_add_f32_dpp v168, v168, v168 row_ror:2 row_mask:0xf bank_mask:0xf
    v_mfma_f32_16x16x32_bf16 a[32:35], v[52:55], v[16:19], a[32:35]
    s_add_u32 s56, s78, 0x420000
    s_addc_u32 s57, s79, 0
    v_add_f32 v170, v170, v166
    v_mfma_f32_16x16x32_bf16 a[36:39], v[52:55], v[20:23], a[36:39]
    ds_read_b64_tr_b16 v[112:113], v250 offset:8192
    v_add_f32_dpp v168, v168, v168 row_ror:1 row_mask:0xf bank_mask:0xf
    v_mfma_f32_16x16x32_bf16 a[40:43], v[52:55], v[24:27], a[40:43]
    s_mov_b32 s58, 0xe000
    v_mov_b32 v169, v168
    v_add_f32 v170, v170, v167
    v_mfma_f32_16x16x32_bf16 a[44:47], v[52:55], v[28:31], a[44:47]
    s_mov_b32 s59, 0x00020000
    v_mfma_f32_16x16x32_bf16 a[48:51], v[52:55], v[32:35], a[48:51]
    ds_read_b64_tr_b16 v[114:115], v250 offset:9216
    v_permlane32_swap_b32 v168, v169
    v_mfma_f32_16x16x32_bf16 a[52:55], v[52:55], v[36:39], a[52:55]
    s_cmp_lt_u32 s16, 224
    s_cselect_b32 s50, 1835008, 0
    s_cselect_b32 s54, 3670016, 0
    s_cselect_b32 s58, 57344, 0
    v_mfma_f32_16x16x32_bf16 a[56:59], v[52:55], v[40:43], a[56:59]
    s_and_b32 s66, s16, 3
    v_add_f32 v168, v168, v169
    v_add_f32_dpp v170, v170, v170 row_ror:8 row_mask:0xf bank_mask:0xf
    v_mfma_f32_16x16x32_bf16 a[60:63], v[52:55], v[44:47], a[60:63]
    ds_read_b64_tr_b16 v[116:117], v251 offset:8192
    v_mov_b32 v169, v168
    v_mfma_f32_16x16x32_bf16 a[64:67], v[56:59], v[16:19], a[64:67]
    s_lshl_b32 s66, s66, 2
    v_add_f32_dpp v170, v170, v170 row_ror:4 row_mask:0xf bank_mask:0xf
    v_mfma_f32_16x16x32_bf16 a[68:71], v[56:59], v[20:23], a[68:71]
    ds_read_b64_tr_b16 v[118:119], v251 offset:9216
    v_permlane16_swap_b32 v168, v169
    v_mfma_f32_16x16x32_bf16 a[72:75], v[56:59], v[24:27], a[72:75]
    s_add_u32 s66, s66, s3
    v_add_f32 v168, v168, v169
    v_add_f32_dpp v170, v170, v170 row_ror:2 row_mask:0xf bank_mask:0xf
    v_mfma_f32_16x16x32_bf16 a[76:79], v[56:59], v[28:31], a[76:79]
    s_mul_i32 s67, s66, 114688
    v_mul_f32 v168, 0x3b000000, v168
    v_mfma_f32_16x16x32_bf16 a[80:83], v[56:59], v[32:35], a[80:83]
    ds_read_b64_tr_b16 v[120:121], v252 offset:8192
    v_sub_f32 v152, v152, v168
    v_mfma_f32_16x16x32_bf16 a[84:87], v[56:59], v[36:39], a[84:87]
    s_lshr_b32 s71, s16, 3
    v_sub_f32 v153, v153, v168
    v_add_f32_dpp v170, v170, v170 row_ror:1 row_mask:0xf bank_mask:0xf
    v_mfma_f32_16x16x32_bf16 a[88:91], v[56:59], v[40:43], a[88:91]
    s_lshl_b32 s71, s71, 7
    v_sub_f32 v154, v154, v168
    v_mov_b32 v171, v170
    v_mfma_f32_16x16x32_bf16 a[92:95], v[56:59], v[44:47], a[92:95]
    ds_read_b64_tr_b16 v[122:123], v252 offset:9216
    v_sub_f32 v155, v155, v168
    v_mfma_f32_16x16x32_bf16 a[96:99], v[60:63], v[16:19], a[96:99]
    s_add_u32 s67, s67, s71
    v_sub_f32 v156, v156, v168
    v_permlane32_swap_b32 v170, v171
    v_mfma_f32_16x16x32_bf16 a[100:103], v[60:63], v[20:23], a[100:103]
    ds_read_b64_tr_b16 v[124:125], v253 offset:8192
    v_sub_f32 v157, v157, v168
    v_mfma_f32_16x16x32_bf16 a[104:107], v[60:63], v[24:27], a[104:107]
    ds_read_b64_tr_b16 v[126:127], v253 offset:9216
    v_lshrrev_b32 v204, 7, v1
    v_mfma_f32_16x16x32_bf16 a[108:111], v[60:63], v[28:31], a[108:111]
    ds_read_b128 v[96:99], v249 offset:8192
    v_mul_u32_u24 v204, 3584, v204
    v_mfma_f32_16x16x32_bf16 a[112:115], v[60:63], v[32:35], a[112:115]
    ds_read_b128 v[100:103], v249 offset:10240
    v_sub_f32 v158, v158, v168
    v_mfma_f32_16x16x32_bf16 a[116:119], v[60:63], v[36:39], a[116:119]
    ds_read_b128 v[104:107], v249 offset:12288
    v_lshrrev_b32 v201, 3, v1
    v_mfma_f32_16x16x32_bf16 a[120:123], v[60:63], v[40:43], a[120:123]
    ds_read_b128 v[108:111], v249 offset:14336
    v_and_b32 v201, 0x60, v201
    v_mfma_f32_16x16x32_bf16 a[124:127], v[60:63], v[44:47], a[124:127]
    ds_read_b64_tr_b16 v[128:129], v250 offset:24576
    v_sub_f32 v159, v159, v168
    v_mfma_f32_16x16x32_bf16 a[128:131], v[16:19], v[64:67], a[128:131]
    ds_read_b64_tr_b16 v[130:131], v250 offset:25600
    v_and_b32 v200, 0x70, v1
    v_mfma_f32_16x16x32_bf16 a[144:147], v[20:23], v[64:67], a[144:147]
    ds_read_b64_tr_b16 v[132:133], v251 offset:24576
    v_mul_f32 v168, v152, v152
    v_mfma_f32_16x16x32_bf16 a[160:163], v[24:27], v[64:67], a[160:163]
    ds_read_b64_tr_b16 v[134:135], v251 offset:25600
    v_xor_b32 v201, v201, v200
    v_mfma_f32_16x16x32_bf16 a[176:179], v[28:31], v[64:67], a[176:179]
    ds_read_b64_tr_b16 v[136:137], v252 offset:24576
    v_add3_u32 v204, v204, v201, s67
    v_mfma_f32_16x16x32_bf16 a[192:195], v[32:35], v[64:67], a[192:195]
    ds_read_b64_tr_b16 v[138:139], v252 offset:25600
    v_fmac_f32 v168, v153, v153
    v_mfma_f32_16x16x32_bf16 a[208:211], v[36:39], v[64:67], a[208:211]
    ds_read_b64_tr_b16 v[140:141], v253 offset:24576
    v_fmac_f32 v168, v154, v154
    v_mfma_f32_16x16x32_bf16 a[224:227], v[40:43], v[64:67], a[224:227]
    ds_read_b64_tr_b16 v[142:143], v253 offset:25600
    v_fmac_f32 v168, v155, v155
    v_mfma_f32_16x16x32_bf16 a[240:243], v[44:47], v[64:67], a[240:243]
    s_lshl_b32 s67, s71, 10
    v_fmac_f32 v168, v156, v156
    v_add_f32 v170, v170, v171
    v_mfma_f32_16x16x32_bf16 a[132:135], v[16:19], v[68:71], a[132:135]
    s_lshl_b32 s66, s66, 11
    v_fmac_f32 v168, v157, v157
    v_mov_b32 v171, v170
    v_mfma_f32_16x16x32_bf16 a[148:151], v[20:23], v[68:71], a[148:151]
    s_add_u32 s67, s67, s66
    v_fmac_f32 v168, v158, v158
    v_mfma_f32_16x16x32_bf16 a[164:167], v[24:27], v[68:71], a[164:167]
    s_lshl_b32 s66, s70, 10
    v_fmac_f32 v168, v159, v159
    v_permlane16_swap_b32 v170, v171
    v_mfma_f32_16x16x32_bf16 a[180:183], v[28:31], v[68:71], a[180:183]
    s_add_u32 s67, s67, s66
    v_add_f32 v170, v170, v171
    v_mfma_f32_16x16x32_bf16 a[196:199], v[32:35], v[68:71], a[196:199]
    v_add_f32_dpp v168, v168, v168 row_ror:8 row_mask:0xf bank_mask:0xf
    v_mul_f32 v170, 0x3b000000, v170
    v_mfma_f32_16x16x32_bf16 a[212:215], v[36:39], v[68:71], a[212:215]
    v_add_u32 v201, s67, v1
    v_sub_f32 v160, v160, v170
    v_mfma_f32_16x16x32_bf16 a[228:231], v[40:43], v[68:71], a[228:231]
    s_and_b32 s66, s16, 3
    v_add_u32 v248, 0xffff0000, v248
    v_add_u32 v249, 0xffff0000, v249
    v_mfma_f32_16x16x32_bf16 a[244:247], v[44:47], v[68:71], a[244:247]
    v_add_u32 v250, 0xffff0000, v250
    v_add_u32 v251, 0xffff0000, v251
    v_mfma_f32_16x16x32_bf16 a[136:139], v[16:19], v[72:75], a[136:139]
    s_lshl_b32 s66, s66, 1
    v_add_u32 v252, 0xffff0000, v252
    v_add_u32 v253, 0xffff0000, v253
    v_mfma_f32_16x16x32_bf16 a[152:155], v[20:23], v[72:75], a[152:155]
    v_add_f32_dpp v168, v168, v168 row_ror:4 row_mask:0xf bank_mask:0xf
    v_sub_f32 v161, v161, v170
    v_mfma_f32_16x16x32_bf16 a[168:171], v[24:27], v[72:75], a[168:171]
    s_add_u32 s66, s66, s70
    v_sub_f32 v162, v162, v170
    v_mfma_f32_16x16x32_bf16 a[184:187], v[28:31], v[72:75], a[184:187]
    s_mul_i32 s66, s66, 7168
    v_add_f32_dpp v168, v168, v168 row_ror:2 row_mask:0xf bank_mask:0xf
    v_sub_f32 v163, v163, v170
    v_mfma_f32_16x16x32_bf16 a[200:203], v[32:35], v[72:75], a[200:203]
    v_sub_f32 v164, v164, v170
    v_mfma_f32_16x16x32_bf16 a[216:219], v[36:39], v[72:75], a[216:219]
    s_lshl_b32 s71, s71, 1
    v_add_f32_dpp v168, v168, v168 row_ror:1 row_mask:0xf bank_mask:0xf
    v_sub_f32 v165, v165, v170
    v_mfma_f32_16x16x32_bf16 a[232:235], v[40:43], v[72:75], a[232:235]
    s_add_u32 s66, s66, s71
    v_mov_b32 v169, v168
    v_sub_f32 v166, v166, v170
    v_mfma_f32_16x16x32_bf16 a[248:251], v[44:47], v[72:75], a[248:251]
    v_sub_f32 v167, v167, v170
    v_mfma_f32_16x16x32_bf16 a[140:143], v[16:19], v[76:79], a[140:143]
    s_min_u32 s71, s3, 1
    v_permlane32_swap_b32 v168, v169
    v_mul_f32 v170, v160, v160
    v_mfma_f32_16x16x32_bf16 a[156:159], v[20:23], v[76:79], a[156:159]
    v_add_f32 v168, v168, v169
    v_fmac_f32 v170, v161, v161
    v_mfma_f32_16x16x32_bf16 a[172:175], v[24:27], v[76:79], a[172:175]
    s_lshl_b32 s71, s71, 28
    v_mov_b32 v169, v168
    v_fmac_f32 v170, v162, v162
    v_mfma_f32_16x16x32_bf16 a[188:191], v[28:31], v[76:79], a[188:191]
    s_add_u32 s66, s66, s71
    v_fmac_f32 v170, v163, v163
    v_mfma_f32_16x16x32_bf16 a[204:207], v[32:35], v[76:79], a[204:207]
    v_permlane16_swap_b32 v168, v169
    v_fmac_f32 v170, v164, v164
    v_mfma_f32_16x16x32_bf16 a[220:223], v[36:39], v[76:79], a[220:223]
    v_bfe_u32 v200, v1, 4, 2
    v_add_f32 v168, v168, v169
    v_mfma_f32_16x16x32_bf16 a[236:239], v[40:43], v[76:79], a[236:239]
    v_lshrrev_b32 v203, 8, v1
    v_mov_b32 v169, 0x3727c5ac
    v_mfma_f32_16x16x32_bf16 a[252:255], v[44:47], v[76:79], a[252:255]
    s_waitcnt vmcnt(1) lgkmcnt(0)
    s_barrier
    v_fmac_f32 v169, 0x3b000000, v168
    v_mfma_f32_16x16x32_bf16 a[0:3], v[112:115], v[80:83], a[0:3]
    s_add_u32 m0, s35, 65536
    v_lshlrev_b32 v203, 4, v203
    v_fmac_f32 v170, v165, v165
    v_mfma_f32_16x16x32_bf16 a[4:7], v[112:115], v[84:87], a[4:7]
    ds_read_b128 v[16:19], v248 offset:0
    v_fmac_f32 v170, v166, v166
    v_mfma_f32_16x16x32_bf16 a[8:11], v[112:115], v[88:91], a[8:11]
    s_add_u32 s33, s32, 32768
    v_lshl_add_u32 v203, v200, 6, v203
    v_fmac_f32 v170, v167, v167
    v_mfma_f32_16x16x32_bf16 a[12:15], v[112:115], v[92:95], a[12:15]
    ds_read_b128 v[20:23], v248 offset:2048
    v_bfe_u32 v202, v1, 6, 2
    v_mfma_f32_16x16x32_bf16 a[16:19], v[112:115], v[96:99], a[16:19]
    buffer_load_dwordx4 v240, s[4:7], s32 offen offset:0  lds
    v_mfma_f32_16x16x32_bf16 a[20:23], v[112:115], v[100:103], a[20:23]
    ds_read_b128 v[24:27], v248 offset:4096
    v_lshl_add_u32 v203, v202, 24, v203
    v_mfma_f32_16x16x32_bf16 a[24:27], v[112:115], v[104:107], a[24:27]
    buffer_load_dwordx4 v241, s[4:7], s32 offen offset:1024  lds
    v_mfma_f32_16x16x32_bf16 a[28:31], v[112:115], v[108:111], a[28:31]
    ds_read_b128 v[28:31], v248 offset:6144
    v_add_u32 v203, s66, v203
    v_mfma_f32_16x16x32_bf16 a[32:35], v[116:119], v[80:83], a[32:35]
    buffer_load_dwordx4 v242, s[4:7], s32 offen offset:2048  lds
    v_mfma_f32_16x16x32_bf16 a[36:39], v[116:119], v[84:87], a[36:39]
    ds_read_b64_tr_b16 v[48:49], v250 offset:0
    v_add_u32 v202, 4096, v1
    v_mfma_f32_16x16x32_bf16 a[40:43], v[116:119], v[88:91], a[40:43]
    buffer_load_dwordx4 v243, s[4:7], s32 offen offset:3072  lds
    v_mfma_f32_16x16x32_bf16 a[44:47], v[116:119], v[92:95], a[44:47]
    v_add_u32 v205, s72, v202
    v_lshl_add_u32 v202, v200, 10, v202
    v_mfma_f32_16x16x32_bf16 a[48:51], v[116:119], v[96:99], a[48:51]
    s_add_u32 m0, s35, 69632
    v_rsq_f32 v168, v169
    v_mfma_f32_16x16x32_bf16 a[52:55], v[116:119], v[100:103], a[52:55]
    ds_read_b64_tr_b16 v[50:51], v250 offset:1024
    v_mov_b32 v192, 0x3f803f80
    v_mfma_f32_16x16x32_bf16 a[56:59], v[116:119], v[104:107], a[56:59]
    ds_read_b64_tr_b16 v[52:53], v251 offset:0
    v_mov_b32 v193, 0x3f803f80
    v_mfma_f32_16x16x32_bf16 a[60:63], v[116:119], v[108:111], a[60:63]
    s_add_u32 s32, s32, 128
    v_mul_f32 v168, 0x3e0293ee, v168
    v_add_f32_dpp v170, v170, v170 row_ror:8 row_mask:0xf bank_mask:0xf
    v_mfma_f32_16x16x32_bf16 a[64:67], v[120:123], v[80:83], a[64:67]
    ds_read_b64_tr_b16 v[54:55], v251 offset:1024
    v_mov_b32 v194, 0x3f803f80
    v_mfma_f32_16x16x32_bf16 a[68:71], v[120:123], v[84:87], a[68:71]
    buffer_load_dwordx4 v240, s[4:7], s33 offen offset:0  lds
    v_mfma_f32_16x16x32_bf16 a[72:75], v[120:123], v[88:91], a[72:75]
    ds_read_b64_tr_b16 v[56:57], v252 offset:0
    v_mov_b32 v195, 0x3f803f80
    v_mfma_f32_16x16x32_bf16 a[76:79], v[120:123], v[92:95], a[76:79]
    buffer_load_dwordx4 v241, s[4:7], s33 offen offset:1024  lds
    v_mfma_f32_16x16x32_bf16 a[80:83], v[120:123], v[96:99], a[80:83]
    ds_read_b64_tr_b16 v[58:59], v252 offset:1024
    v_mul_f32 v152, v152, v168
    v_mfma_f32_16x16x32_bf16 a[84:87], v[120:123], v[100:103], a[84:87]
    buffer_load_dwordx4 v242, s[4:7], s33 offen offset:2048  lds
    v_mfma_f32_16x16x32_bf16 a[88:91], v[120:123], v[104:107], a[88:91]
    ds_read_b64_tr_b16 v[60:61], v253 offset:0
    v_mul_f32 v153, v153, v168
    v_mfma_f32_16x16x32_bf16 a[92:95], v[120:123], v[108:111], a[92:95]
    buffer_load_dwordx4 v243, s[4:7], s33 offen offset:3072  lds
    v_mfma_f32_16x16x32_bf16 a[96:99], v[124:127], v[80:83], a[96:99]
    ds_read_b64_tr_b16 v[62:63], v253 offset:1024
    v_mul_f32 v154, v154, v168
    v_mfma_f32_16x16x32_bf16 a[100:103], v[124:127], v[84:87], a[100:103]
    s_add_u32 m0, s36, 65536
    v_mul_f32 v155, v155, v168
    v_add_f32_dpp v170, v170, v170 row_ror:4 row_mask:0xf bank_mask:0xf
    v_mfma_f32_16x16x32_bf16 a[104:107], v[124:127], v[88:91], a[104:107]
    ds_read_b128 v[32:35], v248 offset:8192
    v_mul_f32 v156, v156, v168
    v_mfma_f32_16x16x32_bf16 a[108:111], v[124:127], v[92:95], a[108:111]
    ds_read_b128 v[36:39], v248 offset:10240
    v_mul_f32 v157, v157, v168
    v_mfma_f32_16x16x32_bf16 a[112:115], v[124:127], v[96:99], a[112:115]
    s_and_b32 s32, s32, 1023
    v_mul_f32 v158, v158, v168
    v_add_f32_dpp v170, v170, v170 row_ror:2 row_mask:0xf bank_mask:0xf
    v_mfma_f32_16x16x32_bf16 a[116:119], v[124:127], v[100:103], a[116:119]
    ds_read_b128 v[40:43], v248 offset:12288
    v_mul_f32 v159, v159, v168
    v_mfma_f32_16x16x32_bf16 a[120:123], v[124:127], v[104:107], a[120:123]
    buffer_load_dwordx4 v244, s[8:11], s34 offen offset:0  lds
    v_mfma_f32_16x16x32_bf16 a[124:127], v[124:127], v[108:111], a[124:127]
    ds_read_b128 v[44:47], v248 offset:14336
    v_cvt_pk_bf16_f32 v144, v152, v153
    v_mfma_f32_16x16x32_bf16 a[128:131], v[80:83], v[128:131], a[128:131]
    buffer_load_dwordx4 v245, s[8:11], s34 offen offset:1024  lds
    v_mfma_f32_16x16x32_bf16 a[144:147], v[84:87], v[128:131], a[144:147]
    ds_read_b64_tr_b16 v[64:65], v250 offset:16384
    v_cvt_pk_bf16_f32 v145, v154, v155
    v_mfma_f32_16x16x32_bf16 a[160:163], v[88:91], v[128:131], a[160:163]
    buffer_load_dwordx4 v246, s[8:11], s34 offen offset:2048  lds
    v_mfma_f32_16x16x32_bf16 a[176:179], v[92:95], v[128:131], a[176:179]
    ds_read_b64_tr_b16 v[66:67], v250 offset:17408
    v_cvt_pk_bf16_f32 v146, v156, v157
    v_mfma_f32_16x16x32_bf16 a[192:195], v[96:99], v[128:131], a[192:195]
    buffer_load_dwordx4 v247, s[8:11], s34 offen offset:3072  lds
    v_mfma_f32_16x16x32_bf16 a[208:211], v[100:103], v[128:131], a[208:211]
    ds_read_b64_tr_b16 v[68:69], v251 offset:16384
    v_cvt_pk_bf16_f32 v147, v158, v159
    v_mfma_f32_16x16x32_bf16 a[224:227], v[104:107], v[128:131], a[224:227]
    s_add_u32 m0, s36, 81920
    v_add_f32_dpp v170, v170, v170 row_ror:1 row_mask:0xf bank_mask:0xf
    v_mfma_f32_16x16x32_bf16 a[240:243], v[108:111], v[128:131], a[240:243]
    ds_read_b64_tr_b16 v[70:71], v251 offset:17408
    v_mov_b32 v171, v170
    v_mfma_f32_16x16x32_bf16 a[132:135], v[80:83], v[132:135], a[132:135]
    s_nop 0
    v_mfma_f32_16x16x32_bf16 a[148:151], v[84:87], v[132:135], a[148:151]
    ds_read_b64_tr_b16 v[72:73], v252 offset:16384
    v_permlane32_swap_b32 v170, v171
    v_mfma_f32_16x16x32_bf16 a[164:167], v[88:91], v[132:135], a[164:167]
    ds_read_b64_tr_b16 v[74:75], v252 offset:17408
    v_add_f32 v170, v170, v171
    v_mfma_f32_16x16x32_bf16 a[180:183], v[92:95], v[132:135], a[180:183]
    buffer_load_dwordx4 v244, s[20:23], s34 offen offset:0  lds
    v_mfma_f32_16x16x32_bf16 a[196:199], v[96:99], v[132:135], a[196:199]
    ds_read_b64_tr_b16 v[76:77], v253 offset:16384
    v_mov_b32 v171, v170
    v_mfma_f32_16x16x32_bf16 a[212:215], v[100:103], v[132:135], a[212:215]
    buffer_load_dwordx4 v245, s[20:23], s34 offen offset:1024  lds
    v_mfma_f32_16x16x32_bf16 a[228:231], v[104:107], v[132:135], a[228:231]
    ds_read_b64_tr_b16 v[78:79], v253 offset:17408
    v_permlane16_swap_b32 v170, v171
    v_mfma_f32_16x16x32_bf16 a[244:247], v[108:111], v[132:135], a[244:247]
    buffer_load_dwordx4 v246, s[20:23], s34 offen offset:2048  lds
    v_mfma_f32_16x16x32_bf16 a[136:139], v[80:83], v[136:139], a[136:139]
    ds_write_b128 v173, v[144:147] offset:4096
    v_add_f32 v170, v170, v171
    v_mfma_f32_16x16x32_bf16 a[152:155], v[84:87], v[136:139], a[152:155]
    buffer_load_dwordx4 v247, s[20:23], s34 offen offset:3072  lds
    v_mfma_f32_16x16x32_bf16 a[168:171], v[88:91], v[136:139], a[168:171]
    v_mov_b32 v171, 0x3727c5ac
    v_mfma_f32_16x16x32_bf16 a[184:187], v[92:95], v[136:139], a[184:187]
    s_add_u32 s34, s34, 524288
    v_fmac_f32 v171, 0x3b000000, v170
    v_mfma_f32_16x16x32_bf16 a[200:203], v[96:99], v[136:139], a[200:203]
    v_rsq_f32 v170, v171
    v_mfma_f32_16x16x32_bf16 a[216:219], v[100:103], v[136:139], a[216:219]
    s_and_b32 s34, s34, 4194303
    v_mfma_f32_16x16x32_bf16 a[232:235], v[104:107], v[136:139], a[232:235]
    v_mul_f32 v170, 0x3e0293ee, v170
    v_mfma_f32_16x16x32_bf16 a[248:251], v[108:111], v[136:139], a[248:251]
    v_mul_f32 v160, v160, v170
    v_mfma_f32_16x16x32_bf16 a[140:143], v[80:83], v[140:143], a[140:143]
    v_mul_f32 v161, v161, v170
    v_mfma_f32_16x16x32_bf16 a[156:159], v[84:87], v[140:143], a[156:159]
    v_mul_f32 v162, v162, v170
    v_mfma_f32_16x16x32_bf16 a[172:175], v[88:91], v[140:143], a[172:175]
    buffer_load_dword v254, v255, s[28:31], 0 offen sc1
    v_mfma_f32_16x16x32_bf16 a[188:191], v[92:95], v[140:143], a[188:191]
    v_mul_f32 v163, v163, v170
    v_mfma_f32_16x16x32_bf16 a[204:207], v[96:99], v[140:143], a[204:207]
    s_add_u32 m0, s72, 0
    v_mul_f32 v164, v164, v170
    v_mfma_f32_16x16x32_bf16 a[220:223], v[100:103], v[140:143], a[220:223]
    s_nop 0
    v_mul_f32 v165, v165, v170
    v_mfma_f32_16x16x32_bf16 a[236:239], v[104:107], v[140:143], a[236:239]
    s_getreg_b32 s26, hwreg(HW_REG_XCC_ID, 0, 4)
    v_mul_f32 v166, v166, v170
    v_mfma_f32_16x16x32_bf16 a[252:255], v[108:111], v[140:143], a[252:255]
    s_waitcnt lgkmcnt(0)
    v_mul_f32 v167, v167, v170
    v_mfma_f32_16x16x32_bf16 a[0:3], v[48:51], v[16:19], a[0:3]
    buffer_load_dwordx4 v204, s[48:51], 0 offen offset:0 nt lds
    v_mfma_f32_16x16x32_bf16 a[4:7], v[48:51], v[20:23], a[4:7]
    s_mov_b32 s73, 27648
    v_cvt_pk_bf16_f32 v148, v160, v161
    v_mfma_f32_16x16x32_bf16 a[8:11], v[48:51], v[24:27], a[8:11]
    buffer_load_dwordx4 v204, s[48:51], s73 offen offset:1024 nt lds
    v_mfma_f32_16x16x32_bf16 a[12:15], v[48:51], v[28:31], a[12:15]
    s_add_u32 s98, s26, 1
    v_mov_b32 v225, s98
    v_cvt_pk_bf16_f32 v149, v162, v163
    v_mfma_f32_16x16x32_bf16 a[16:19], v[48:51], v[32:35], a[16:19]
    s_mov_b32 s73, 55296
    v_cvt_pk_bf16_f32 v150, v164, v165
    v_mfma_f32_16x16x32_bf16 a[20:23], v[48:51], v[36:39], a[20:23]
    buffer_load_dwordx4 v204, s[48:51], s73 offen offset:2048 nt lds
    v_mfma_f32_16x16x32_bf16 a[24:27], v[48:51], v[40:43], a[24:27]
    s_mov_b32 s73, 82944
    v_cvt_pk_bf16_f32 v151, v166, v167
    v_mfma_f32_16x16x32_bf16 a[28:31], v[48:51], v[44:47], a[28:31]
    s_lshr_b32 s26, s2, 3
    v_mfma_f32_16x16x32_bf16 a[32:35], v[52:55], v[16:19], a[32:35]
    buffer_load_dwordx4 v204, s[48:51], s73 offen offset:3072 nt lds
    v_mfma_f32_16x16x32_bf16 a[36:39], v[52:55], v[20:23], a[36:39]
    s_lshl_b32 s26, s26, 6
    v_mfma_f32_16x16x32_bf16 a[40:43], v[52:55], v[24:27], a[40:43]
    s_and_b32 s39, s2, 7
    v_mfma_f32_16x16x32_bf16 a[44:47], v[52:55], v[28:31], a[44:47]
    s_add_u32 s26, s26, s39
    v_mfma_f32_16x16x32_bf16 a[48:51], v[52:55], v[32:35], a[48:51]
    s_lshl_b32 s26, s26, 2
    v_mfma_f32_16x16x32_bf16 a[52:55], v[52:55], v[36:39], a[52:55]
    ds_read_b128 v[80:83], v249 offset:0
    v_add_u32 v224, s26, v255
    v_mfma_f32_16x16x32_bf16 a[56:59], v[52:55], v[40:43], a[56:59]
    ds_read_b128 v[84:87], v249 offset:2048
    v_mfma_f32_16x16x32_bf16 a[60:63], v[52:55], v[44:47], a[60:63]
    s_lshl_b32 s26, s25, 19
    v_mfma_f32_16x16x32_bf16 a[64:67], v[56:59], v[16:19], a[64:67]
    ds_read_b128 v[88:91], v249 offset:4096
    v_mfma_f32_16x16x32_bf16 a[68:71], v[56:59], v[20:23], a[68:71]
    ds_read_b128 v[92:95], v249 offset:6144
    v_mfma_f32_16x16x32_bf16 a[72:75], v[56:59], v[24:27], a[72:75]
    s_lshl_b32 s39, s24, 8
    v_mfma_f32_16x16x32_bf16 a[76:79], v[56:59], v[28:31], a[76:79]
    ds_read_b64_tr_b16 v[112:113], v250 offset:8192
    v_mfma_f32_16x16x32_bf16 a[80:83], v[56:59], v[32:35], a[80:83]
    s_add_u32 s26, s26, s39
    v_mfma_f32_16x16x32_bf16 a[84:87], v[56:59], v[36:39], a[84:87]
    ds_read_b64_tr_b16 v[114:115], v250 offset:9216
    v_mfma_f32_16x16x32_bf16 a[88:91], v[56:59], v[40:43], a[88:91]
    s_lshl_b32 s39, s3, 17
    v_mfma_f32_16x16x32_bf16 a[92:95], v[56:59], v[44:47], a[92:95]
    ds_read_b64_tr_b16 v[116:117], v251 offset:8192
    v_mfma_f32_16x16x32_bf16 a[96:99], v[60:63], v[16:19], a[96:99]
    s_add_u32 s26, s26, s39
    v_mfma_f32_16x16x32_bf16 a[100:103], v[60:63], v[20:23], a[100:103]
    ds_read_b64_tr_b16 v[118:119], v251 offset:9216
    v_mfma_f32_16x16x32_bf16 a[104:107], v[60:63], v[24:27], a[104:107]
    ds_read_b64_tr_b16 v[120:121], v252 offset:8192
    v_bfe_u32 v230, v1, 5, 4
    v_mfma_f32_16x16x32_bf16 a[108:111], v[60:63], v[28:31], a[108:111]
    ds_read_b64_tr_b16 v[122:123], v252 offset:9216
    v_mfma_f32_16x16x32_bf16 a[112:115], v[60:63], v[32:35], a[112:115]
    ds_read_b64_tr_b16 v[124:125], v253 offset:8192
    v_mfma_f32_16x16x32_bf16 a[116:119], v[60:63], v[36:39], a[116:119]
    ds_read_b64_tr_b16 v[126:127], v253 offset:9216
    v_lshlrev_b32 v230, 13, v230
    v_mfma_f32_16x16x32_bf16 a[120:123], v[60:63], v[40:43], a[120:123]
    ds_read_b128 v[96:99], v249 offset:8192
    v_mfma_f32_16x16x32_bf16 a[124:127], v[60:63], v[44:47], a[124:127]
    ds_read_b128 v[100:103], v249 offset:10240
    v_and_b32 v232, 16, v1
    v_mfma_f32_16x16x32_bf16 a[128:131], v[16:19], v[64:67], a[128:131]
    ds_read_b128 v[104:107], v249 offset:12288
    v_mfma_f32_16x16x32_bf16 a[144:147], v[20:23], v[64:67], a[144:147]
    ds_read_b128 v[108:111], v249 offset:14336
    v_lshl_add_u32 v230, v232, 3, v230
    v_mfma_f32_16x16x32_bf16 a[160:163], v[24:27], v[64:67], a[160:163]
    ds_read_b64_tr_b16 v[128:129], v250 offset:24576
    v_mfma_f32_16x16x32_bf16 a[176:179], v[28:31], v[64:67], a[176:179]
    ds_read_b64_tr_b16 v[130:131], v250 offset:25600
    v_add_u32 v230, s26, v230
    v_mfma_f32_16x16x32_bf16 a[192:195], v[32:35], v[64:67], a[192:195]
    ds_read_b64_tr_b16 v[132:133], v251 offset:24576
    v_mfma_f32_16x16x32_bf16 a[208:211], v[36:39], v[64:67], a[208:211]
    ds_read_b64_tr_b16 v[134:135], v251 offset:25600
    v_mfma_f32_16x16x32_bf16 a[224:227], v[40:43], v[64:67], a[224:227]
    ds_read_b64_tr_b16 v[136:137], v252 offset:24576
    v_mfma_f32_16x16x32_bf16 a[240:243], v[44:47], v[64:67], a[240:243]
    ds_read_b64_tr_b16 v[138:139], v252 offset:25600
    v_mfma_f32_16x16x32_bf16 a[132:135], v[16:19], v[68:71], a[132:135]
    ds_read_b64_tr_b16 v[140:141], v253 offset:24576
    v_mfma_f32_16x16x32_bf16 a[148:151], v[20:23], v[68:71], a[148:151]
    ds_read_b64_tr_b16 v[142:143], v253 offset:25600
    v_mfma_f32_16x16x32_bf16 a[164:167], v[24:27], v[68:71], a[164:167]
    s_mov_b32 s12, s68
    v_mfma_f32_16x16x32_bf16 a[180:183], v[28:31], v[68:71], a[180:183]
    s_mov_b32 s13, s69
    v_mfma_f32_16x16x32_bf16 a[196:199], v[32:35], v[68:71], a[196:199]
    s_mov_b32 s14, 0x400000
    v_mfma_f32_16x16x32_bf16 a[212:215], v[36:39], v[68:71], a[212:215]
    s_mov_b32 s15, 0x00020000
    v_mfma_f32_16x16x32_bf16 a[228:231], v[40:43], v[68:71], a[228:231]
    v_add_u32 v248, 0x10000, v248
    v_add_u32 v249, 0x10000, v249
    v_mfma_f32_16x16x32_bf16 a[244:247], v[44:47], v[68:71], a[244:247]
    v_add_u32 v250, 0x10000, v250
    v_add_u32 v251, 0x10000, v251
    v_mfma_f32_16x16x32_bf16 a[136:139], v[16:19], v[72:75], a[136:139]
    v_add_u32 v252, 0x10000, v252
    v_add_u32 v253, 0x10000, v253
    v_mfma_f32_16x16x32_bf16 a[152:155], v[20:23], v[72:75], a[152:155]
    ds_write_b128 v173, v[148:151] offset:5136
    v_mfma_f32_16x16x32_bf16 a[168:171], v[24:27], v[72:75], a[168:171]
    v_mfma_f32_16x16x32_bf16 a[184:187], v[28:31], v[72:75], a[184:187]
    v_mfma_f32_16x16x32_bf16 a[200:203], v[32:35], v[72:75], a[200:203]
    v_mfma_f32_16x16x32_bf16 a[216:219], v[36:39], v[72:75], a[216:219]
    v_mfma_f32_16x16x32_bf16 a[232:235], v[40:43], v[72:75], a[232:235]
    v_mfma_f32_16x16x32_bf16 a[248:251], v[44:47], v[72:75], a[248:251]
    v_mfma_f32_16x16x32_bf16 a[140:143], v[16:19], v[76:79], a[140:143]
    v_mfma_f32_16x16x32_bf16 a[156:159], v[20:23], v[76:79], a[156:159]
    v_mfma_f32_16x16x32_bf16 a[172:175], v[24:27], v[76:79], a[172:175]
    v_mfma_f32_16x16x32_bf16 a[188:191], v[28:31], v[76:79], a[188:191]
    v_mfma_f32_16x16x32_bf16 a[204:207], v[32:35], v[76:79], a[204:207]
    v_mfma_f32_16x16x32_bf16 a[220:223], v[36:39], v[76:79], a[220:223]
    v_mfma_f32_16x16x32_bf16 a[236:239], v[40:43], v[76:79], a[236:239]
    v_mfma_f32_16x16x32_bf16 a[252:255], v[44:47], v[76:79], a[252:255]
    s_waitcnt vmcnt(4) lgkmcnt(0)
    v_cmp_ne_u32 vcc, v229, v254
    s_nop 4
    s_cbranch_vccnz L_spin0
L_back0:
    s_barrier
    v_mfma_f32_16x16x32_bf16 a[0:3], v[112:115], v[80:83], a[0:3]
    ds_read_b128 v[144:147], v174 offset:0
    v_mfma_f32_16x16x32_bf16 a[4:7], v[112:115], v[84:87], a[4:7]
    ds_read_b128 v[148:151], v174 offset:128
    v_mfma_f32_16x16x32_bf16 a[8:11], v[112:115], v[88:91], a[8:11]
    s_add_u32 m0, s35, 0
    v_mfma_f32_16x16x32_bf16 a[12:15], v[112:115], v[92:95], a[12:15]
    s_add_u32 s33, s32, 32768
    v_mfma_f32_16x16x32_bf16 a[16:19], v[112:115], v[96:99], a[16:19]
    buffer_load_dwordx4 v240, s[4:7], s32 offen offset:0  lds
    v_mfma_f32_16x16x32_bf16 a[20:23], v[112:115], v[100:103], a[20:23]
    ds_read_b128 v[16:19], v248 offset:0
    v_mfma_f32_16x16x32_bf16 a[24:27], v[112:115], v[104:107], a[24:27]
    buffer_load_dwordx4 v241, s[4:7], s32 offen offset:1024  lds
    v_mfma_f32_16x16x32_bf16 a[28:31], v[112:115], v[108:111], a[28:31]
    ds_read_b128 v[20:23], v248 offset:2048
    v_mfma_f32_16x16x32_bf16 a[32:35], v[116:119], v[80:83], a[32:35]
    buffer_load_dwordx4 v242, s[4:7], s32 offen offset:2048  lds
    v_mfma_f32_16x16x32_bf16 a[36:39], v[116:119], v[84:87], a[36:39]
    ds_read_b128 v[24:27], v248 offset:4096
    v_mfma_f32_16x16x32_bf16 a[40:43], v[116:119], v[88:91], a[40:43]
    ds_read_b128 v[28:31], v248 offset:6144
    v_mfma_f32_16x16x32_bf16 a[44:47], v[116:119], v[92:95], a[44:47]
    ds_read_b64_tr_b16 v[48:49], v250 offset:0
    v_mfma_f32_16x16x32_bf16 a[48:51], v[116:119], v[96:99], a[48:51]
    ds_read_b64_tr_b16 v[50:51], v250 offset:1024
    v_mfma_f32_16x16x32_bf16 a[52:55], v[116:119], v[100:103], a[52:55]
    s_waitcnt lgkmcnt(6)
    v_mfma_f32_16x16x32_bf16 a[56:59], v[116:119], v[104:107], a[56:59]
    buffer_load_dwordx4 v243, s[4:7], s32 offen offset:3072  lds
    v_mfma_f32_16x16x32_bf16 a[60:63], v[116:119], v[108:111], a[60:63]
    s_add_u32 m0, s35, 4096
    v_mfma_f32_16x16x32_bf16 a[64:67], v[120:123], v[80:83], a[64:67]
    buffer_store_dwordx4 v[144:147], v172, s[44:47], 0 offen sc1
    v_mfma_f32_16x16x32_bf16 a[68:71], v[120:123], v[84:87], a[68:71]
    buffer_store_dwordx4 v[148:151], v172, s[44:47], s27 offen sc1
    v_mfma_f32_16x16x32_bf16 a[72:75], v[120:123], v[88:91], a[72:75]
    s_add_u32 s32, s32, 128
    v_mfma_f32_16x16x32_bf16 a[76:79], v[120:123], v[92:95], a[76:79]
    buffer_load_dwordx4 v240, s[4:7], s33 offen offset:0  lds
    v_mfma_f32_16x16x32_bf16 a[80:83], v[120:123], v[96:99], a[80:83]
    buffer_load_dwordx4 v241, s[4:7], s33 offen offset:1024  lds
    v_mfma_f32_16x16x32_bf16 a[84:87], v[120:123], v[100:103], a[84:87]
    buffer_load_dwordx4 v242, s[4:7], s33 offen offset:2048  lds
    v_mfma_f32_16x16x32_bf16 a[88:91], v[120:123], v[104:107], a[88:91]
    ds_read_b64_tr_b16 v[52:53], v251 offset:0
    v_mfma_f32_16x16x32_bf16 a[92:95], v[120:123], v[108:111], a[92:95]
    buffer_load_dwordx4 v243, s[4:7], s33 offen offset:3072  lds
    v_mfma_f32_16x16x32_bf16 a[96:99], v[124:127], v[80:83], a[96:99]
    s_load_dwordx2 s[40:41], s[0:1], 40
    v_mfma_f32_16x16x32_bf16 a[100:103], v[124:127], v[84:87], a[100:103]
    s_add_u32 m0, s36, 0
    v_mfma_f32_16x16x32_bf16 a[104:107], v[124:127], v[88:91], a[104:107]
    s_lshl_b32 s66, s17, 2
    v_mfma_f32_16x16x32_bf16 a[108:111], v[124:127], v[92:95], a[108:111]
    ds_read_b64_tr_b16 v[54:55], v251 offset:1024
    v_mfma_f32_16x16x32_bf16 a[112:115], v[124:127], v[96:99], a[112:115]
    s_and_b32 s32, s32, 1023
    v_mfma_f32_16x16x32_bf16 a[116:119], v[124:127], v[100:103], a[116:119]
    s_add_u32 s66, s66, s3
    v_mfma_f32_16x16x32_bf16 a[120:123], v[124:127], v[104:107], a[120:123]
    buffer_load_dwordx4 v244, s[8:11], s34 offen offset:0  lds
    v_mfma_f32_16x16x32_bf16 a[124:127], v[124:127], v[108:111], a[124:127]
    s_lshr_b32 s67, s66, 3
    v_mfma_f32_16x16x32_bf16 a[128:131], v[80:83], v[128:131], a[128:131]
    buffer_load_dwordx4 v245, s[8:11], s34 offen offset:1024  lds
    v_mfma_f32_16x16x32_bf16 a[144:147], v[84:87], v[128:131], a[144:147]
    s_and_b32 s70, s66, 7
    v_mfma_f32_16x16x32_bf16 a[160:163], v[88:91], v[128:131], a[160:163]
    buffer_load_dwordx4 v246, s[8:11], s34 offen offset:2048  lds
    v_mfma_f32_16x16x32_bf16 a[176:179], v[92:95], v[128:131], a[176:179]
    s_lshl_b32 s71, s67, 15
    v_mfma_f32_16x16x32_bf16 a[192:195], v[96:99], v[128:131], a[192:195]
    buffer_load_dwordx4 v247, s[8:11], s34 offen offset:3072  lds
    v_mfma_f32_16x16x32_bf16 a[208:211], v[100:103], v[128:131], a[208:211]
    ds_read_b64_tr_b16 v[56:57], v252 offset:0
    v_mfma_f32_16x16x32_bf16 a[224:227], v[104:107], v[128:131], a[224:227]
    s_add_u32 m0, s36, 16384
    v_mfma_f32_16x16x32_bf16 a[240:243], v[108:111], v[128:131], a[240:243]
    s_lshl_b32 s66, s70, 7
    v_mfma_f32_16x16x32_bf16 a[132:135], v[80:83], v[132:135], a[132:135]
    s_nop 0
    v_mfma_f32_16x16x32_bf16 a[148:151], v[84:87], v[132:135], a[148:151]
    s_add_u32 s71, s71, s66
    v_mfma_f32_16x16x32_bf16 a[164:167], v[88:91], v[132:135], a[164:167]
    ds_read_b64_tr_b16 v[58:59], v252 offset:1024
    v_mfma_f32_16x16x32_bf16 a[180:183], v[92:95], v[132:135], a[180:183]
    buffer_load_dwordx4 v244, s[20:23], s34 offen offset:0  lds
    v_mfma_f32_16x16x32_bf16 a[196:199], v[96:99], v[132:135], a[196:199]
    ds_read_b64_tr_b16 v[60:61], v253 offset:0
    v_lshrrev_b32 v153, 7, v1
    v_mfma_f32_16x16x32_bf16 a[212:215], v[100:103], v[132:135], a[212:215]
    buffer_load_dwordx4 v245, s[20:23], s34 offen offset:1024  lds
    v_mfma_f32_16x16x32_bf16 a[228:231], v[104:107], v[132:135], a[228:231]
    ds_read_b64_tr_b16 v[62:63], v253 offset:1024
    v_lshlrev_b32 v144, 10, v153
    v_mfma_f32_16x16x32_bf16 a[244:247], v[108:111], v[132:135], a[244:247]
    buffer_load_dwordx4 v246, s[20:23], s34 offen offset:2048  lds
    v_mfma_f32_16x16x32_bf16 a[136:139], v[80:83], v[136:139], a[136:139]
    ds_read_b128 v[32:35], v248 offset:8192
    v_lshrrev_b32 v153, 3, v1
    v_mfma_f32_16x16x32_bf16 a[152:155], v[84:87], v[136:139], a[152:155]
    buffer_load_dwordx4 v247, s[20:23], s34 offen offset:3072  lds
    v_mfma_f32_16x16x32_bf16 a[168:171], v[88:91], v[136:139], a[168:171]
    ds_read_b128 v[36:39], v248 offset:10240
    v_and_b32 v153, 0x60, v153
    v_mfma_f32_16x16x32_bf16 a[184:187], v[92:95], v[136:139], a[184:187]
    ds_read_b128 v[40:43], v248 offset:12288
    v_mfma_f32_16x16x32_bf16 a[200:203], v[96:99], v[136:139], a[200:203]
    ds_read_b128 v[44:47], v248 offset:14336
    v_mfma_f32_16x16x32_bf16 a[216:219], v[100:103], v[136:139], a[216:219]
    ds_read_b64_tr_b16 v[64:65], v250 offset:16384
    v_and_b32 v152, 0x70, v1
    v_mfma_f32_16x16x32_bf16 a[232:235], v[104:107], v[136:139], a[232:235]
    ds_read_b64_tr_b16 v[66:67], v250 offset:17408
    ds_read_b64_tr_b16 v[68:69], v251 offset:16384
    ds_read_b64_tr_b16 v[70:71], v251 offset:17408
    ds_read_b64_tr_b16 v[72:73], v252 offset:16384
    ds_read_b64_tr_b16 v[74:75], v252 offset:17408
    ds_read_b64_tr_b16 v[76:77], v253 offset:16384
    ds_read_b64_tr_b16 v[78:79], v253 offset:17408
    v_mfma_f32_16x16x32_bf16 a[248:251], v[108:111], v[136:139], a[248:251]
    s_add_u32 s34, s34, 524288
    v_xor_b32 v153, v153, v152
    v_mfma_f32_16x16x32_bf16 a[140:143], v[80:83], v[140:143], a[140:143]
    s_and_b32 s34, s34, 4194303
    v_mfma_f32_16x16x32_bf16 a[156:159], v[84:87], v[140:143], a[156:159]
    v_mfma_f32_16x16x32_bf16 a[172:175], v[88:91], v[140:143], a[172:175]
    buffer_load_dword v226, v230, s[12:15], 0 offen
    v_mfma_f32_16x16x32_bf16 a[188:191], v[92:95], v[140:143], a[188:191]
    v_add3_u32 v144, v144, v153, s71
    v_mfma_f32_16x16x32_bf16 a[204:207], v[96:99], v[140:143], a[204:207]
    v_add_u32 v145, 7168, v144
    v_mfma_f32_16x16x32_bf16 a[220:223], v[100:103], v[140:143], a[220:223]
    v_mfma_f32_16x16x32_bf16 a[236:239], v[104:107], v[140:143], a[236:239]
    v_mfma_f32_16x16x32_bf16 a[252:255], v[108:111], v[140:143], a[252:255]
    s_waitcnt lgkmcnt(0)
    v_add_u32 v146, 14336, v144
    v_mfma_f32_16x16x32_bf16 a[0:3], v[48:51], v[16:19], a[0:3]
    ds_read_b128 v[80:83], v249 offset:0
    v_mfma_f32_16x16x32_bf16 a[4:7], v[48:51], v[20:23], a[4:7]
    ds_read_b128 v[84:87], v249 offset:2048
    v_add_u32 v147, 21504, v144
    v_mfma_f32_16x16x32_bf16 a[8:11], v[48:51], v[24:27], a[8:11]
    ds_read_b128 v[88:91], v249 offset:4096
    v_mfma_f32_16x16x32_bf16 a[12:15], v[48:51], v[28:31], a[12:15]
    ds_read_b128 v[92:95], v249 offset:6144
    v_mfma_f32_16x16x32_bf16 a[16:19], v[48:51], v[32:35], a[16:19]
    ds_read_b64_tr_b16 v[112:113], v250 offset:8192
    v_lshrrev_b32 v153, 6, v1
    v_mfma_f32_16x16x32_bf16 a[20:23], v[48:51], v[36:39], a[20:23]
    ds_read_b64_tr_b16 v[114:115], v250 offset:9216
    v_mfma_f32_16x16x32_bf16 a[24:27], v[48:51], v[40:43], a[24:27]
    ds_read_b64_tr_b16 v[116:117], v251 offset:8192
    v_lshlrev_b32 v148, 7, v153
    v_mfma_f32_16x16x32_bf16 a[28:31], v[48:51], v[44:47], a[28:31]
    ds_read_b64_tr_b16 v[118:119], v251 offset:9216
    v_mfma_f32_16x16x32_bf16 a[32:35], v[52:55], v[16:19], a[32:35]
    ds_read_b64_tr_b16 v[120:121], v252 offset:8192
    v_mfma_f32_16x16x32_bf16 a[36:39], v[52:55], v[20:23], a[36:39]
    ds_read_b64_tr_b16 v[122:123], v252 offset:9216
    v_lshlrev_b32 v153, 4, v153
    v_mfma_f32_16x16x32_bf16 a[40:43], v[52:55], v[24:27], a[40:43]
    ds_read_b64_tr_b16 v[124:125], v253 offset:8192
    v_mfma_f32_16x16x32_bf16 a[44:47], v[52:55], v[28:31], a[44:47]
    ds_read_b64_tr_b16 v[126:127], v253 offset:9216
    v_and_b32 v153, 0x60, v153
    v_mfma_f32_16x16x32_bf16 a[48:51], v[52:55], v[32:35], a[48:51]
    ds_read_b128 v[96:99], v249 offset:8192
    v_mfma_f32_16x16x32_bf16 a[52:55], v[52:55], v[36:39], a[52:55]
    ds_read_b128 v[100:103], v249 offset:10240
    v_mfma_f32_16x16x32_bf16 a[56:59], v[52:55], v[40:43], a[56:59]
    ds_read_b128 v[104:107], v249 offset:12288
    v_add3_u32 v148, v148, v153, s72
    v_mfma_f32_16x16x32_bf16 a[60:63], v[52:55], v[44:47], a[60:63]
    ds_read_b128 v[108:111], v249 offset:14336
    v_mfma_f32_16x16x32_bf16 a[64:67], v[56:59], v[16:19], a[64:67]
    ds_read_b64_tr_b16 v[128:129], v250 offset:24576
    v_bfe_u32 v153, v1, 4, 2
    v_mfma_f32_16x16x32_bf16 a[68:71], v[56:59], v[20:23], a[68:71]
    ds_read_b64_tr_b16 v[130:131], v250 offset:25600
    v_mfma_f32_16x16x32_bf16 a[72:75], v[56:59], v[24:27], a[72:75]
    ds_read_b64_tr_b16 v[132:133], v251 offset:24576
    v_mfma_f32_16x16x32_bf16 a[76:79], v[56:59], v[28:31], a[76:79]
    ds_read_b64_tr_b16 v[134:135], v251 offset:25600
    v_lshl_add_u32 v148, v153, 3, v148
    v_mfma_f32_16x16x32_bf16 a[80:83], v[56:59], v[32:35], a[80:83]
    ds_read_b64_tr_b16 v[136:137], v252 offset:24576
    v_mfma_f32_16x16x32_bf16 a[84:87], v[56:59], v[36:39], a[84:87]
    ds_read_b64_tr_b16 v[138:139], v252 offset:25600
    v_xor_b32 v149, 32, v148
    v_mfma_f32_16x16x32_bf16 a[88:91], v[56:59], v[40:43], a[88:91]
    ds_read_b64_tr_b16 v[140:141], v253 offset:24576
    v_mfma_f32_16x16x32_bf16 a[92:95], v[56:59], v[44:47], a[92:95]
    ds_read_b64_tr_b16 v[142:143], v253 offset:25600
    v_mfma_f32_16x16x32_bf16 a[96:99], v[60:63], v[16:19], a[96:99]
    v_xor_b32 v150, 64, v148
    v_mfma_f32_16x16x32_bf16 a[100:103], v[60:63], v[20:23], a[100:103]
    v_mfma_f32_16x16x32_bf16 a[104:107], v[60:63], v[24:27], a[104:107]
    v_xor_b32 v151, 96, v148
    v_mfma_f32_16x16x32_bf16 a[108:111], v[60:63], v[28:31], a[108:111]
    v_mfma_f32_16x16x32_bf16 a[112:115], v[60:63], v[32:35], a[112:115]
    v_mfma_f32_16x16x32_bf16 a[116:119], v[60:63], v[36:39], a[116:119]
    s_mov_b32 s42, 4194304
    v_mfma_f32_16x16x32_bf16 a[120:123], v[60:63], v[40:43], a[120:123]
    v_mfma_f32_16x16x32_bf16 a[124:127], v[60:63], v[44:47], a[124:127]
    s_lshl_b32 s67, s67, 12
    v_mfma_f32_16x16x32_bf16 a[128:131], v[16:19], v[64:67], a[128:131]
    v_mfma_f32_16x16x32_bf16 a[144:147], v[20:23], v[64:67], a[144:147]
    v_mfma_f32_16x16x32_bf16 a[160:163], v[24:27], v[64:67], a[160:163]
    s_lshl_b32 s71, s70, 19
    v_mfma_f32_16x16x32_bf16 a[176:179], v[28:31], v[64:67], a[176:179]
    v_mfma_f32_16x16x32_bf16 a[192:195], v[32:35], v[64:67], a[192:195]
    s_add_u32 s71, s71, s67
    v_mfma_f32_16x16x32_bf16 a[208:211], v[36:39], v[64:67], a[208:211]
    v_mfma_f32_16x16x32_bf16 a[224:227], v[40:43], v[64:67], a[224:227]
    v_mfma_f32_16x16x32_bf16 a[240:243], v[44:47], v[64:67], a[240:243]
    v_add_u32 v152, s71, v1
    v_mfma_f32_16x16x32_bf16 a[132:135], v[16:19], v[68:71], a[132:135]
    v_mfma_f32_16x16x32_bf16 a[148:151], v[20:23], v[68:71], a[148:151]
    s_mul_i32 s71, s70, 229376
    v_mfma_f32_16x16x32_bf16 a[164:167], v[24:27], v[68:71], a[164:167]
    v_mfma_f32_16x16x32_bf16 a[180:183], v[28:31], v[68:71], a[180:183]
    v_mfma_f32_16x16x32_bf16 a[196:199], v[32:35], v[68:71], a[196:199]
    s_add_u32 s71, s71, s67
    v_mfma_f32_16x16x32_bf16 a[212:215], v[36:39], v[68:71], a[212:215]
    v_mfma_f32_16x16x32_bf16 a[228:231], v[40:43], v[68:71], a[228:231]
    v_add_u32 v153, s71, v1
    v_add_u32 v248, 0xffff0000, v248
    v_mfma_f32_16x16x32_bf16 a[244:247], v[44:47], v[68:71], a[244:247]
    v_add_u32 v249, 0xffff0000, v249
    v_add_u32 v250, 0xffff0000, v250
    v_mfma_f32_16x16x32_bf16 a[136:139], v[16:19], v[72:75], a[136:139]
    v_add_u32 v251, 0xffff0000, v251
    v_add_u32 v252, 0xffff0000, v252
    v_mfma_f32_16x16x32_bf16 a[152:155], v[20:23], v[72:75], a[152:155]
    s_add_u32 s44, s78, 0x4000000
    s_addc_u32 s45, s79, 0
    v_add_u32 v253, 0xffff0000, v253
    v_mfma_f32_16x16x32_bf16 a[168:171], v[24:27], v[72:75], a[168:171]
    v_mfma_f32_16x16x32_bf16 a[184:187], v[28:31], v[72:75], a[184:187]
    s_mov_b32 s46, 0x400000
    v_mfma_f32_16x16x32_bf16 a[200:203], v[32:35], v[72:75], a[200:203]
    v_mfma_f32_16x16x32_bf16 a[216:219], v[36:39], v[72:75], a[216:219]
    v_mfma_f32_16x16x32_bf16 a[232:235], v[40:43], v[72:75], a[232:235]
    s_mov_b32 s47, 0x00020000
    v_mfma_f32_16x16x32_bf16 a[248:251], v[44:47], v[72:75], a[248:251]
    v_mfma_f32_16x16x32_bf16 a[140:143], v[16:19], v[76:79], a[140:143]
    v_mfma_f32_16x16x32_bf16 a[156:159], v[20:23], v[76:79], a[156:159]
    v_mfma_f32_16x16x32_bf16 a[172:175], v[24:27], v[76:79], a[172:175]
    v_mfma_f32_16x16x32_bf16 a[188:191], v[28:31], v[76:79], a[188:191]
    v_mfma_f32_16x16x32_bf16 a[204:207], v[32:35], v[76:79], a[204:207]
    v_mfma_f32_16x16x32_bf16 a[220:223], v[36:39], v[76:79], a[220:223]
    v_mfma_f32_16x16x32_bf16 a[236:239], v[40:43], v[76:79], a[236:239]
    v_mfma_f32_16x16x32_bf16 a[252:255], v[44:47], v[76:79], a[252:255]
    s_waitcnt vmcnt(1) lgkmcnt(0)
    s_barrier
    v_mfma_f32_16x16x32_bf16 a[0:3], v[112:115], v[80:83], a[0:3]
    s_add_u32 m0, s35, 65536
    v_mfma_f32_16x16x32_bf16 a[4:7], v[112:115], v[84:87], a[4:7]
    ds_read_b128 v[16:19], v248 offset:0
    v_mfma_f32_16x16x32_bf16 a[8:11], v[112:115], v[88:91], a[8:11]
    s_add_u32 s33, s32, 32768
    v_mfma_f32_16x16x32_bf16 a[12:15], v[112:115], v[92:95], a[12:15]
    ds_read_b128 v[20:23], v248 offset:2048
    v_mfma_f32_16x16x32_bf16 a[16:19], v[112:115], v[96:99], a[16:19]
    buffer_load_dwordx4 v240, s[4:7], s32 offen offset:0  lds
    v_mfma_f32_16x16x32_bf16 a[20:23], v[112:115], v[100:103], a[20:23]
    ds_read_b128 v[24:27], v248 offset:4096
    v_mfma_f32_16x16x32_bf16 a[24:27], v[112:115], v[104:107], a[24:27]
    buffer_load_dwordx4 v241, s[4:7], s32 offen offset:1024  lds
    v_mfma_f32_16x16x32_bf16 a[28:31], v[112:115], v[108:111], a[28:31]
    ds_read_b128 v[28:31], v248 offset:6144
    v_mfma_f32_16x16x32_bf16 a[32:35], v[116:119], v[80:83], a[32:35]
    buffer_load_dwordx4 v242, s[4:7], s32 offen offset:2048  lds
    v_mfma_f32_16x16x32_bf16 a[36:39], v[116:119], v[84:87], a[36:39]
    ds_read_b64_tr_b16 v[48:49], v250 offset:0
    v_mfma_f32_16x16x32_bf16 a[40:43], v[116:119], v[88:91], a[40:43]
    buffer_load_dwordx4 v243, s[4:7], s32 offen offset:3072  lds
    v_mfma_f32_16x16x32_bf16 a[44:47], v[116:119], v[92:95], a[44:47]
    ds_read_b64_tr_b16 v[50:51], v250 offset:1024
    v_mfma_f32_16x16x32_bf16 a[48:51], v[116:119], v[96:99], a[48:51]
    s_add_u32 m0, s35, 69632
    v_mfma_f32_16x16x32_bf16 a[52:55], v[116:119], v[100:103], a[52:55]
    ds_read_b64_tr_b16 v[52:53], v251 offset:0
    v_mfma_f32_16x16x32_bf16 a[56:59], v[116:119], v[104:107], a[56:59]
    ds_read_b64_tr_b16 v[54:55], v251 offset:1024
    v_mfma_f32_16x16x32_bf16 a[60:63], v[116:119], v[108:111], a[60:63]
    s_add_u32 s32, s32, 128
    v_mfma_f32_16x16x32_bf16 a[64:67], v[120:123], v[80:83], a[64:67]
    ds_read_b64_tr_b16 v[56:57], v252 offset:0
    v_mfma_f32_16x16x32_bf16 a[68:71], v[120:123], v[84:87], a[68:71]
    buffer_load_dwordx4 v240, s[4:7], s33 offen offset:0  lds
    v_mfma_f32_16x16x32_bf16 a[72:75], v[120:123], v[88:91], a[72:75]
    ds_read_b64_tr_b16 v[58:59], v252 offset:1024
    v_mfma_f32_16x16x32_bf16 a[76:79], v[120:123], v[92:95], a[76:79]
    buffer_load_dwordx4 v241, s[4:7], s33 offen offset:1024  lds
    v_mfma_f32_16x16x32_bf16 a[80:83], v[120:123], v[96:99], a[80:83]
    ds_read_b64_tr_b16 v[60:61], v253 offset:0
    v_mfma_f32_16x16x32_bf16 a[84:87], v[120:123], v[100:103], a[84:87]
    buffer_load_dwordx4 v242, s[4:7], s33 offen offset:2048  lds
    v_mfma_f32_16x16x32_bf16 a[88:91], v[120:123], v[104:107], a[88:91]
    ds_read_b64_tr_b16 v[62:63], v253 offset:1024
    v_mfma_f32_16x16x32_bf16 a[92:95], v[120:123], v[108:111], a[92:95]
    buffer_load_dwordx4 v243, s[4:7], s33 offen offset:3072  lds
    v_mfma_f32_16x16x32_bf16 a[96:99], v[124:127], v[80:83], a[96:99]
    ds_read_b128 v[32:35], v248 offset:8192
    v_mfma_f32_16x16x32_bf16 a[100:103], v[124:127], v[84:87], a[100:103]
    s_add_u32 m0, s36, 65536
    v_mfma_f32_16x16x32_bf16 a[104:107], v[124:127], v[88:91], a[104:107]
    ds_read_b128 v[36:39], v248 offset:10240
    v_mfma_f32_16x16x32_bf16 a[108:111], v[124:127], v[92:95], a[108:111]
    v_mfma_f32_16x16x32_bf16 a[112:115], v[124:127], v[96:99], a[112:115]
    s_and_b32 s32, s32, 1023
    v_mfma_f32_16x16x32_bf16 a[116:119], v[124:127], v[100:103], a[116:119]
    ds_read_b128 v[40:43], v248 offset:12288
    v_mfma_f32_16x16x32_bf16 a[120:123], v[124:127], v[104:107], a[120:123]
    buffer_load_dwordx4 v244, s[8:11], s34 offen offset:0  lds
    v_mfma_f32_16x16x32_bf16 a[124:127], v[124:127], v[108:111], a[124:127]
    ds_read_b128 v[44:47], v248 offset:14336
    v_mfma_f32_16x16x32_bf16 a[128:131], v[80:83], v[128:131], a[128:131]
    buffer_load_dwordx4 v245, s[8:11], s34 offen offset:1024  lds
    v_mfma_f32_16x16x32_bf16 a[144:147], v[84:87], v[128:131], a[144:147]
    ds_read_b64_tr_b16 v[64:65], v250 offset:16384
    v_mfma_f32_16x16x32_bf16 a[160:163], v[88:91], v[128:131], a[160:163]
    buffer_load_dwordx4 v246, s[8:11], s34 offen offset:2048  lds
    v_mfma_f32_16x16x32_bf16 a[176:179], v[92:95], v[128:131], a[176:179]
    ds_read_b64_tr_b16 v[66:67], v250 offset:17408
    v_mfma_f32_16x16x32_bf16 a[192:195], v[96:99], v[128:131], a[192:195]
    buffer_load_dwordx4 v247, s[8:11], s34 offen offset:3072  lds
    v_mfma_f32_16x16x32_bf16 a[208:211], v[100:103], v[128:131], a[208:211]
    ds_read_b64_tr_b16 v[68:69], v251 offset:16384
    v_mfma_f32_16x16x32_bf16 a[224:227], v[104:107], v[128:131], a[224:227]
    s_add_u32 m0, s36, 81920
    v_mfma_f32_16x16x32_bf16 a[240:243], v[108:111], v[128:131], a[240:243]
    ds_read_b64_tr_b16 v[70:71], v251 offset:17408
    v_mfma_f32_16x16x32_bf16 a[132:135], v[80:83], v[132:135], a[132:135]
    s_nop 0
    v_mfma_f32_16x16x32_bf16 a[148:151], v[84:87], v[132:135], a[148:151]
    ds_read_b64_tr_b16 v[72:73], v252 offset:16384
    v_mfma_f32_16x16x32_bf16 a[164:167], v[88:91], v[132:135], a[164:167]
    ds_read_b64_tr_b16 v[74:75], v252 offset:17408
    v_mfma_f32_16x16x32_bf16 a[180:183], v[92:95], v[132:135], a[180:183]
    buffer_load_dwordx4 v244, s[20:23], s34 offen offset:0  lds
    v_mfma_f32_16x16x32_bf16 a[196:199], v[96:99], v[132:135], a[196:199]
    ds_read_b64_tr_b16 v[76:77], v253 offset:16384
    v_mfma_f32_16x16x32_bf16 a[212:215], v[100:103], v[132:135], a[212:215]
    buffer_load_dwordx4 v245, s[20:23], s34 offen offset:1024  lds
    v_mfma_f32_16x16x32_bf16 a[228:231], v[104:107], v[132:135], a[228:231]
    ds_read_b64_tr_b16 v[78:79], v253 offset:17408
    v_mfma_f32_16x16x32_bf16 a[244:247], v[108:111], v[132:135], a[244:247]
    buffer_load_dwordx4 v246, s[20:23], s34 offen offset:2048  lds
    v_mfma_f32_16x16x32_bf16 a[136:139], v[80:83], v[136:139], a[136:139]
    v_mfma_f32_16x16x32_bf16 a[152:155], v[84:87], v[136:139], a[152:155]
    buffer_load_dwordx4 v247, s[20:23], s34 offen offset:3072  lds
    v_mfma_f32_16x16x32_bf16 a[168:171], v[88:91], v[136:139], a[168:171]
    ds_read_b64_tr_b16 v[176:177], v148 offset:0
    v_mfma_f32_16x16x32_bf16 a[184:187], v[92:95], v[136:139], a[184:187]
    s_add_u32 s34, s34, 524288
    v_mfma_f32_16x16x32_bf16 a[200:203], v[96:99], v[136:139], a[200:203]
    ds_read_b64_tr_b16 v[178:179], v148 offset:2048
    v_mfma_f32_16x16x32_bf16 a[216:219], v[100:103], v[136:139], a[216:219]
    s_and_b32 s34, s34, 4194303
    v_mfma_f32_16x16x32_bf16 a[232:235], v[104:107], v[136:139], a[232:235]
    ds_read_b64_tr_b16 v[180:181], v149 offset:0
    v_mfma_f32_16x16x32_bf16 a[248:251], v[108:111], v[136:139], a[248:251]
    ds_read_b64_tr_b16 v[182:183], v149 offset:2048
    v_mfma_f32_16x16x32_bf16 a[140:143], v[80:83], v[140:143], a[140:143]
    ds_read_b64_tr_b16 v[184:185], v150 offset:0
    v_mfma_f32_16x16x32_bf16 a[156:159], v[84:87], v[140:143], a[156:159]
    buffer_store_dword v225, v224, s[60:63], 0 offen sc1
    v_mfma_f32_16x16x32_bf16 a[172:175], v[88:91], v[140:143], a[172:175]
    ds_read_b64_tr_b16 v[186:187], v150 offset:2048
    v_mfma_f32_16x16x32_bf16 a[188:191], v[92:95], v[140:143], a[188:191]
    ds_read_b64_tr_b16 v[188:189], v151 offset:0
    v_mfma_f32_16x16x32_bf16 a[204:207], v[96:99], v[140:143], a[204:207]
    ds_read_b64_tr_b16 v[190:191], v151 offset:2048
    v_mfma_f32_16x16x32_bf16 a[220:223], v[100:103], v[140:143], a[220:223]
    v_mfma_f32_16x16x32_bf16 a[236:239], v[104:107], v[140:143], a[236:239]
    v_mfma_f32_16x16x32_bf16 a[252:255], v[108:111], v[140:143], a[252:255]
    s_waitcnt lgkmcnt(0)
    v_mfma_f32_16x16x32_bf16 a[0:3], v[48:51], v[16:19], a[0:3]
    ds_read_b128 v[80:83], v249 offset:0
    v_mfma_f32_16x16x32_bf16 a[4:7], v[48:51], v[20:23], a[4:7]
    s_add_u32 m0, s72, 0
    v_mfma_f32_16x16x32_bf16 a[8:11], v[48:51], v[24:27], a[8:11]
    s_lshl_b32 s26, s25, 1
    v_mfma_f32_16x16x32_bf16 a[12:15], v[48:51], v[28:31], a[12:15]
    v_mfma_f32_16x16x32_bf16 v[208:211], v[176:179], v[192:195], 0
    s_nop 0
    v_mfma_f32_16x16x32_bf16 a[16:19], v[48:51], v[32:35], a[16:19]
    s_sub_u32 s39, 30, s26
    v_mfma_f32_16x16x32_bf16 a[20:23], v[48:51], v[36:39], a[20:23]
    v_mfma_f32_16x16x32_bf16 v[212:215], v[180:183], v[192:195], 0
    buffer_load_dwordx4 v144, s[40:43], 0 offen offset:0 nt lds
    v_mfma_f32_16x16x32_bf16 a[24:27], v[48:51], v[40:43], a[24:27]
    s_cmp_ge_u32 s3, 2
    s_cselect_b32 s27, s26, s39
    v_mfma_f32_16x16x32_bf16 a[28:31], v[48:51], v[44:47], a[28:31]
    v_mfma_f32_16x16x32_bf16 v[216:219], v[184:187], v[192:195], 0
    buffer_load_dwordx4 v145, s[40:43], 0 offen offset:1024 nt lds
    v_mfma_f32_16x16x32_bf16 a[32:35], v[52:55], v[16:19], a[32:35]
    s_and_b32 s26, s3, 1
    v_mfma_f32_16x16x32_bf16 a[36:39], v[52:55], v[20:23], a[36:39]
    v_mfma_f32_16x16x32_bf16 v[220:223], v[188:191], v[192:195], 0
    buffer_load_dwordx4 v146, s[40:43], 0 offen offset:2048 nt lds
    v_mfma_f32_16x16x32_bf16 a[40:43], v[52:55], v[24:27], a[40:43]
    s_add_u32 s27, s27, s26
    v_mfma_f32_16x16x32_bf16 a[44:47], v[52:55], v[28:31], a[44:47]
    buffer_load_dwordx4 v147, s[40:43], 0 offen offset:3072 nt lds
    v_mfma_f32_16x16x32_bf16 a[48:51], v[52:55], v[32:35], a[48:51]
    ds_read_b128 v[84:87], v249 offset:2048
    v_mfma_f32_16x16x32_bf16 a[52:55], v[52:55], v[36:39], a[52:55]
    ds_read_b128 v[88:91], v249 offset:4096
    v_mfma_f32_16x16x32_bf16 a[56:59], v[52:55], v[40:43], a[56:59]
    s_lshl_b32 s26, s25, 9
    v_mfma_f32_16x16x32_bf16 a[60:63], v[52:55], v[44:47], a[60:63]
    buffer_store_dwordx4 v[176:179], v201, s[52:55], 0 offen sc1
    v_mfma_f32_16x16x32_bf16 a[64:67], v[56:59], v[16:19], a[64:67]
    s_sub_u32 s39, 7680, s26
    v_mfma_f32_16x16x32_bf16 a[68:71], v[56:59], v[20:23], a[68:71]
    s_mov_b32 s73, 32768
    v_mfma_f32_16x16x32_bf16 a[72:75], v[56:59], v[24:27], a[72:75]
    ds_read_b128 v[92:95], v249 offset:6144
    v_mov_b32 v224, s39
    v_mfma_f32_16x16x32_bf16 a[76:79], v[56:59], v[28:31], a[76:79]
    buffer_store_dwordx4 v[180:183], v201, s[52:55], s73 offen sc1
    v_mfma_f32_16x16x32_bf16 a[80:83], v[56:59], v[32:35], a[80:83]
    ds_read_b64_tr_b16 v[112:113], v250 offset:8192
    v_mov_b32 v225, s26
    v_mfma_f32_16x16x32_bf16 a[84:87], v[56:59], v[36:39], a[84:87]
    s_mov_b32 s73, 65536
    v_mfma_f32_16x16x32_bf16 a[88:91], v[56:59], v[40:43], a[88:91]
    ds_read_b64_tr_b16 v[114:115], v250 offset:9216
    v_cmp_gt_u32 vcc, 16, v0
    v_mfma_f32_16x16x32_bf16 a[92:95], v[56:59], v[44:47], a[92:95]
    buffer_store_dwordx4 v[184:187], v201, s[52:55], s73 offen sc1
    v_mfma_f32_16x16x32_bf16 a[96:99], v[60:63], v[16:19], a[96:99]
    ds_read_b64_tr_b16 v[116:117], v251 offset:8192
    v_bfe_u32 v255, v0, 3, 1
    v_mfma_f32_16x16x32_bf16 a[100:103], v[60:63], v[20:23], a[100:103]
    s_mov_b32 s73, 98304
    v_mfma_f32_16x16x32_bf16 a[104:107], v[60:63], v[24:27], a[104:107]
    ds_read_b64_tr_b16 v[118:119], v251 offset:9216
    v_cndmask_b32 v224, v225, v224, vcc
    v_mfma_f32_16x16x32_bf16 a[108:111], v[60:63], v[28:31], a[108:111]
    buffer_store_dwordx4 v[188:191], v201, s[52:55], s73 offen sc1
    v_mfma_f32_16x16x32_bf16 a[112:115], v[60:63], v[32:35], a[112:115]
    ds_read_b64_tr_b16 v[120:121], v252 offset:8192
    v_lshl_add_u32 v224, v255, 8, v224
    v_mfma_f32_16x16x32_bf16 a[116:119], v[60:63], v[36:39], a[116:119]
    ds_read_b64_tr_b16 v[122:123], v252 offset:9216
    v_mfma_f32_16x16x32_bf16 a[120:123], v[60:63], v[40:43], a[120:123]
    ds_read_b64_tr_b16 v[124:125], v253 offset:8192
    v_and_b32 v225, 7, v0
    v_mfma_f32_16x16x32_bf16 a[124:127], v[60:63], v[44:47], a[124:127]
    ds_read_b64_tr_b16 v[126:127], v253 offset:9216
    v_mfma_f32_16x16x32_bf16 a[128:131], v[16:19], v[64:67], a[128:131]
    ds_read_b128 v[96:99], v249 offset:8192
    v_lshl_add_u32 v224, v225, 2, v224
    v_mfma_f32_16x16x32_bf16 a[144:147], v[20:23], v[64:67], a[144:147]
    ds_read_b128 v[100:103], v249 offset:10240
    v_mfma_f32_16x16x32_bf16 a[160:163], v[24:27], v[64:67], a[160:163]
    ds_read_b128 v[104:107], v249 offset:12288
    v_lshl_add_u32 v255, v225, 2, v255
    v_mfma_f32_16x16x32_bf16 a[176:179], v[28:31], v[64:67], a[176:179]
    ds_read_b128 v[108:111], v249 offset:14336
    v_mfma_f32_16x16x32_bf16 a[192:195], v[32:35], v[64:67], a[192:195]
    ds_read_b64_tr_b16 v[128:129], v250 offset:24576
    v_mfma_f32_16x16x32_bf16 a[208:211], v[36:39], v[64:67], a[208:211]
    ds_read_b64_tr_b16 v[130:131], v250 offset:25600
    v_mfma_f32_16x16x32_bf16 a[224:227], v[40:43], v[64:67], a[224:227]
    ds_read_b64_tr_b16 v[132:133], v251 offset:24576
    v_mfma_f32_16x16x32_bf16 a[240:243], v[44:47], v[64:67], a[240:243]
    ds_read_b64_tr_b16 v[134:135], v251 offset:25600
    v_mfma_f32_16x16x32_bf16 a[132:135], v[16:19], v[68:71], a[132:135]
    ds_read_b64_tr_b16 v[136:137], v252 offset:24576
    v_mfma_f32_16x16x32_bf16 a[148:151], v[20:23], v[68:71], a[148:151]
    ds_read_b64_tr_b16 v[138:139], v252 offset:25600
    v_mfma_f32_16x16x32_bf16 a[164:167], v[24:27], v[68:71], a[164:167]
    ds_read_b64_tr_b16 v[140:141], v253 offset:24576
    v_mfma_f32_16x16x32_bf16 a[180:183], v[28:31], v[68:71], a[180:183]
    ds_read_b64_tr_b16 v[142:143], v253 offset:25600
    v_mfma_f32_16x16x32_bf16 a[196:199], v[32:35], v[68:71], a[196:199]
    s_and_b32 s26, s24, 2
    v_mfma_f32_16x16x32_bf16 a[212:215], v[36:39], v[68:71], a[212:215]
    s_lshl_b32 s26, s26, 6
    v_mfma_f32_16x16x32_bf16 a[228:231], v[40:43], v[68:71], a[228:231]
    s_and_b32 s39, s2, 7
    v_add_u32 v248, 0x10000, v248
    v_add_u32 v249, 0x10000, v249
    v_mfma_f32_16x16x32_bf16 a[244:247], v[44:47], v[68:71], a[244:247]
    s_add_u32 s26, s26, s39
    v_add_u32 v250, 0x10000, v250
    v_add_u32 v251, 0x10000, v251
    v_mfma_f32_16x16x32_bf16 a[136:139], v[16:19], v[72:75], a[136:139]
    s_lshl_b32 s26, s26, 2
    v_lshl_add_u32 v255, v255, 8, s26
    v_cmp_gt_u32 vcc, 32, v0
    v_mfma_f32_16x16x32_bf16 a[152:155], v[20:23], v[72:75], a[152:155]
    v_add_u32 v252, 0x10000, v252
    v_add_u32 v253, 0x10000, v253
    v_mfma_f32_16x16x32_bf16 a[168:171], v[24:27], v[72:75], a[168:171]
    ds_write_b128 v205, v[208:211] offset:0
    v_mov_b32 v225, 47
    v_mfma_f32_16x16x32_bf16 a[184:187], v[28:31], v[72:75], a[184:187]
    ds_write_b128 v205, v[212:215] offset:1024
    v_mfma_f32_16x16x32_bf16 a[200:203], v[32:35], v[72:75], a[200:203]
    ds_write_b128 v205, v[216:219] offset:2048
    v_cndmask_b32 v255, v255, v224, vcc
    v_mfma_f32_16x16x32_bf16 a[216:219], v[36:39], v[72:75], a[216:219]
    ds_write_b128 v205, v[220:223] offset:3072
    v_mfma_f32_16x16x32_bf16 a[232:235], v[40:43], v[72:75], a[232:235]
    v_cmp_lt_u32 vcc, v225, v0
    v_mfma_f32_16x16x32_bf16 a[248:251], v[44:47], v[72:75], a[248:251]
    v_mfma_f32_16x16x32_bf16 a[140:143], v[16:19], v[76:79], a[140:143]
    s_nop 0
    v_mfma_f32_16x16x32_bf16 a[156:159], v[20:23], v[76:79], a[156:159]
    v_mfma_f32_16x16x32_bf16 a[172:175], v[24:27], v[76:79], a[172:175]
    v_cndmask_b32 v225, 0, 1, vcc
    v_mfma_f32_16x16x32_bf16 a[188:191], v[28:31], v[76:79], a[188:191]
    v_mfma_f32_16x16x32_bf16 a[204:207], v[32:35], v[76:79], a[204:207]
    v_lshl_add_u32 v255, v225, 28, v255
    v_mfma_f32_16x16x32_bf16 a[220:223], v[36:39], v[76:79], a[220:223]
    v_mfma_f32_16x16x32_bf16 a[236:239], v[40:43], v[76:79], a[236:239]
    v_mfma_f32_16x16x32_bf16 a[252:255], v[44:47], v[76:79], a[252:255]
    s_waitcnt vmcnt(9) lgkmcnt(0)
    s_barrier
    v_mfma_f32_16x16x32_bf16 a[0:3], v[112:115], v[80:83], a[0:3]
    s_add_u32 m0, s35, 0
    v_mfma_f32_16x16x32_bf16 a[4:7], v[112:115], v[84:87], a[4:7]
    ds_read_b128 v[16:19], v248 offset:0
    v_mfma_f32_16x16x32_bf16 a[8:11], v[112:115], v[88:91], a[8:11]
    s_add_u32 s33, s32, 32768
    v_mfma_f32_16x16x32_bf16 a[12:15], v[112:115], v[92:95], a[12:15]
    s_load_dwordx2 s[40:41], s[0:1], 72
    v_mfma_f32_16x16x32_bf16 a[16:19], v[112:115], v[96:99], a[16:19]
    buffer_load_dwordx4 v240, s[4:7], s32 offen offset:0  lds
    v_mfma_f32_16x16x32_bf16 a[20:23], v[112:115], v[100:103], a[20:23]
    s_cmp_lt_u32 s17, 112
    s_cselect_b32 s42, 1835008, 0
    s_cselect_b32 s66, 1835008, 0
    v_mfma_f32_16x16x32_bf16 a[24:27], v[112:115], v[104:107], a[24:27]
    buffer_load_dwordx4 v241, s[4:7], s32 offen offset:1024  lds
    v_mfma_f32_16x16x32_bf16 a[28:31], v[112:115], v[108:111], a[28:31]
    s_lshr_b32 s70, s67, 12
    v_mfma_f32_16x16x32_bf16 a[32:35], v[116:119], v[80:83], a[32:35]
    buffer_load_dwordx4 v242, s[4:7], s32 offen offset:2048  lds
    v_mfma_f32_16x16x32_bf16 a[36:39], v[116:119], v[84:87], a[36:39]
    s_mul_i32 s71, s70, 9363
    v_mfma_f32_16x16x32_bf16 a[40:43], v[116:119], v[88:91], a[40:43]
    buffer_load_dwordx4 v243, s[4:7], s32 offen offset:3072  lds
    v_mfma_f32_16x16x32_bf16 a[44:47], v[116:119], v[92:95], a[44:47]
    s_lshr_b32 s71, s71, 16
    v_mfma_f32_16x16x32_bf16 a[48:51], v[116:119], v[96:99], a[48:51]
    s_add_u32 m0, s35, 4096
    v_mfma_f32_16x16x32_bf16 a[52:55], v[116:119], v[100:103], a[52:55]
    s_mul_i32 s71, s71, 7
    v_mfma_f32_16x16x32_bf16 a[56:59], v[116:119], v[104:107], a[56:59]
    ds_read_b128 v[20:23], v248 offset:2048
    v_mfma_f32_16x16x32_bf16 a[60:63], v[116:119], v[108:111], a[60:63]
    s_add_u32 s32, s32, 128
    v_mfma_f32_16x16x32_bf16 a[64:67], v[120:123], v[80:83], a[64:67]
    s_sub_u32 s70, s70, s71
    v_mfma_f32_16x16x32_bf16 a[68:71], v[120:123], v[84:87], a[68:71]
    buffer_load_dwordx4 v240, s[4:7], s33 offen offset:0  lds
    v_mfma_f32_16x16x32_bf16 a[72:75], v[120:123], v[88:91], a[72:75]
    s_sub_u32 s71, s70, 1
    v_mfma_f32_16x16x32_bf16 a[76:79], v[120:123], v[92:95], a[76:79]
    buffer_load_dwordx4 v241, s[4:7], s33 offen offset:1024  lds
    v_mfma_f32_16x16x32_bf16 a[80:83], v[120:123], v[96:99], a[80:83]
    s_cmp_lt_u32 s71, 3
    s_cselect_b32 s71, -16384, 0
    v_mfma_f32_16x16x32_bf16 a[84:87], v[120:123], v[100:103], a[84:87]
    buffer_load_dwordx4 v242, s[4:7], s33 offen offset:2048  lds
    v_mfma_f32_16x16x32_bf16 a[88:91], v[120:123], v[104:107], a[88:91]
    s_cmp_eq_u32 s70, 0
    s_cselect_b32 s70, 98304, s71
    v_mfma_f32_16x16x32_bf16 a[92:95], v[120:123], v[108:111], a[92:95]
    buffer_load_dwordx4 v243, s[4:7], s33 offen offset:3072  lds
    v_mfma_f32_16x16x32_bf16 a[96:99], v[124:127], v[80:83], a[96:99]
    ds_read_b128 v[24:27], v248 offset:4096
    v_add_u32 v144, s71, v144
    v_mfma_f32_16x16x32_bf16 a[100:103], v[124:127], v[84:87], a[100:103]
    s_add_u32 m0, s36, 0
    v_add_u32 v145, s71, v145
    v_mfma_f32_16x16x32_bf16 a[104:107], v[124:127], v[88:91], a[104:107]
    ds_read_b128 v[28:31], v248 offset:6144
    v_mfma_f32_16x16x32_bf16 a[108:111], v[124:127], v[92:95], a[108:111]
    ds_read_b64_tr_b16 v[48:49], v250 offset:0
    v_add_u32 v146, s70, v146
    v_mfma_f32_16x16x32_bf16 a[112:115], v[124:127], v[96:99], a[112:115]
    s_and_b32 s32, s32, 1023
    v_mfma_f32_16x16x32_bf16 a[116:119], v[124:127], v[100:103], a[116:119]
    ds_read_b64_tr_b16 v[50:51], v250 offset:1024
    v_add_u32 v147, s70, v147
    v_mfma_f32_16x16x32_bf16 a[120:123], v[124:127], v[104:107], a[120:123]
    buffer_load_dwordx4 v244, s[8:11], s34 offen offset:0  lds
    v_mfma_f32_16x16x32_bf16 a[124:127], v[124:127], v[108:111], a[124:127]
    ds_read_b64_tr_b16 v[52:53], v251 offset:0
    v_mfma_f32_16x16x32_bf16 a[128:131], v[80:83], v[128:131], a[128:131]
    buffer_load_dwordx4 v245, s[8:11], s34 offen offset:1024  lds
    v_mfma_f32_16x16x32_bf16 a[144:147], v[84:87], v[128:131], a[144:147]
    ds_read_b64_tr_b16 v[54:55], v251 offset:1024
    v_mfma_f32_16x16x32_bf16 a[160:163], v[88:91], v[128:131], a[160:163]
    buffer_load_dwordx4 v246, s[8:11], s34 offen offset:2048  lds
    v_mfma_f32_16x16x32_bf16 a[176:179], v[92:95], v[128:131], a[176:179]
    ds_read_b64_tr_b16 v[56:57], v252 offset:0
    v_mfma_f32_16x16x32_bf16 a[192:195], v[96:99], v[128:131], a[192:195]
    buffer_load_dwordx4 v247, s[8:11], s34 offen offset:3072  lds
    v_mfma_f32_16x16x32_bf16 a[208:211], v[100:103], v[128:131], a[208:211]
    ds_read_b64_tr_b16 v[58:59], v252 offset:1024
    v_mfma_f32_16x16x32_bf16 a[224:227], v[104:107], v[128:131], a[224:227]
    s_add_u32 m0, s36, 16384
    v_mfma_f32_16x16x32_bf16 a[240:243], v[108:111], v[128:131], a[240:243]
    ds_read_b64_tr_b16 v[60:61], v253 offset:0
    v_mfma_f32_16x16x32_bf16 a[132:135], v[80:83], v[132:135], a[132:135]
    s_nop 0
    v_mfma_f32_16x16x32_bf16 a[148:151], v[84:87], v[132:135], a[148:151]
    s_add_u32 s12, s78, 0x2000000
    s_addc_u32 s13, s79, 0
    v_mfma_f32_16x16x32_bf16 a[164:167], v[88:91], v[132:135], a[164:167]
    s_mov_b32 s14, 0x2400000
    v_mfma_f32_16x16x32_bf16 a[180:183], v[92:95], v[132:135], a[180:183]
    buffer_load_dwordx4 v244, s[20:23], s34 offen offset:0  lds
    v_mfma_f32_16x16x32_bf16 a[196:199], v[96:99], v[132:135], a[196:199]
    s_mov_b32 s15, 0x00020000
    v_mfma_f32_16x16x32_bf16 a[212:215], v[100:103], v[132:135], a[212:215]
    buffer_load_dwordx4 v245, s[20:23], s34 offen offset:1024  lds
    v_mfma_f32_16x16x32_bf16 a[228:231], v[104:107], v[132:135], a[228:231]
    s_add_u32 s16, s78, 0x2004000
    s_addc_u32 s17, s79, 0
    v_mfma_f32_16x16x32_bf16 a[244:247], v[108:111], v[132:135], a[244:247]
    buffer_load_dwordx4 v246, s[20:23], s34 offen offset:2048  lds
    v_mfma_f32_16x16x32_bf16 a[136:139], v[80:83], v[136:139], a[136:139]
    s_mov_b32 s18, 0x1ffc000
    v_mfma_f32_16x16x32_bf16 a[152:155], v[84:87], v[136:139], a[152:155]
    buffer_load_dwordx4 v247, s[20:23], s34 offen offset:3072  lds
    v_mfma_f32_16x16x32_bf16 a[168:171], v[88:91], v[136:139], a[168:171]
    ds_read_b64_tr_b16 v[62:63], v253 offset:1024
    v_mfma_f32_16x16x32_bf16 a[184:187], v[92:95], v[136:139], a[184:187]
    ds_read_b128 v[32:35], v248 offset:8192
    v_mfma_f32_16x16x32_bf16 a[200:203], v[96:99], v[136:139], a[200:203]
    ds_read_b128 v[36:39], v248 offset:10240
    v_mfma_f32_16x16x32_bf16 a[216:219], v[100:103], v[136:139], a[216:219]
    ds_read_b128 v[40:43], v248 offset:12288
    v_mfma_f32_16x16x32_bf16 a[232:235], v[104:107], v[136:139], a[232:235]
    ds_read_b128 v[44:47], v248 offset:14336
    ds_read_b64_tr_b16 v[64:65], v250 offset:16384
    ds_read_b64_tr_b16 v[66:67], v250 offset:17408
    ds_read_b64_tr_b16 v[68:69], v251 offset:16384
    ds_read_b64_tr_b16 v[70:71], v251 offset:17408
    ds_read_b64_tr_b16 v[72:73], v252 offset:16384
    ds_read_b64_tr_b16 v[74:75], v252 offset:17408
    ds_read_b64_tr_b16 v[76:77], v253 offset:16384
    ds_read_b64_tr_b16 v[78:79], v253 offset:17408
    s_mov_b32 s19, 0x00020000
    v_mfma_f32_16x16x32_bf16 a[248:251], v[108:111], v[136:139], a[248:251]
    s_add_u32 s34, s34, 524288
    s_lshl_b32 s37, s3, 13
    v_mfma_f32_16x16x32_bf16 a[140:143], v[80:83], v[140:143], a[140:143]
    s_add_u32 s37, s37, 32768
    v_mfma_f32_16x16x32_bf16 a[156:159], v[84:87], v[140:143], a[156:159]
    s_and_b32 s34, s34, 4194303
    s_lshl_b32 s26, s3, 17
    v_add_u32 v12, s26, v244
    v_mfma_f32_16x16x32_bf16 a[172:175], v[88:91], v[140:143], a[172:175]
    v_add_u32 v13, s26, v245
    v_add_u32 v14, s26, v246
    v_mfma_f32_16x16x32_bf16 a[188:191], v[92:95], v[140:143], a[188:191]
    ds_read_b128 v[208:211], v202 offset:0
    v_add_u32 v15, s26, v247
    v_mfma_f32_16x16x32_bf16 a[204:207], v[96:99], v[140:143], a[204:207]
    ds_read_b128 v[212:215], v202 offset:8192
    v_xor_b32 v3, 32, v2
    v_mfma_f32_16x16x32_bf16 a[220:223], v[100:103], v[140:143], a[220:223]
    ds_read_b128 v[216:219], v202 offset:16384
    ds_read_b128 v[220:223], v202 offset:24576
    v_mfma_f32_16x16x32_bf16 a[236:239], v[104:107], v[140:143], a[236:239]
    v_xor_b32 v4, 64, v2
    v_xor_b32 v5, 96, v2
    v_mfma_f32_16x16x32_bf16 a[252:255], v[108:111], v[140:143], a[252:255]
    s_waitcnt lgkmcnt(0)
    v_xor_b32 v6, 128, v2
    v_xor_b32 v7, 160, v2
    v_mfma_f32_16x16x32_bf16 a[0:3], v[48:51], v[16:19], a[0:3]
    v_xor_b32 v8, 192, v2
    v_xor_b32 v9, 224, v2
    v_mfma_f32_16x16x32_bf16 a[4:7], v[48:51], v[20:23], a[4:7]
    s_lshl_b32 s26, s24, 20
    v_add_f32 v208, v208, v212
    v_add_f32 v216, v216, v220
    v_mfma_f32_16x16x32_bf16 a[8:11], v[48:51], v[24:27], a[8:11]
    s_lshl_b32 s39, s25, 17
    v_add_f32 v209, v209, v213
    v_add_f32 v217, v217, v221
    v_mfma_f32_16x16x32_bf16 a[12:15], v[48:51], v[28:31], a[12:15]
    s_add_u32 s26, s26, s39
    v_add_f32 v210, v210, v214
    v_add_f32 v218, v218, v222
    v_mfma_f32_16x16x32_bf16 a[16:19], v[48:51], v[32:35], a[16:19]
    s_and_b32 s39, s3, 1
    v_add_f32 v211, v211, v215
    v_add_f32 v219, v219, v223
    v_mfma_f32_16x16x32_bf16 a[20:23], v[48:51], v[36:39], a[20:23]
    s_lshl_b32 s39, s39, 16
    v_add_f32 v208, v208, v216
    v_add_f32 v209, v209, v217
    v_mfma_f32_16x16x32_bf16 a[24:27], v[48:51], v[40:43], a[24:27]
    s_add_u32 s26, s26, s39
    v_add_f32 v210, v210, v218
    v_add_f32 v211, v211, v219
    v_mfma_f32_16x16x32_bf16 a[28:31], v[48:51], v[44:47], a[28:31]
    s_lshr_b32 s39, s3, 1
    v_mfma_f32_16x16x32_bf16 a[32:35], v[52:55], v[16:19], a[32:35]
    s_lshl_b32 s39, s39, 11
    v_mfma_f32_16x16x32_bf16 a[36:39], v[52:55], v[20:23], a[36:39]
    s_add_u32 s26, s26, s39
    v_mfma_f32_16x16x32_bf16 a[40:43], v[52:55], v[24:27], a[40:43]
    ds_read_b128 v[80:83], v249 offset:0
    v_add_u32 v10, s26, v1
    v_mfma_f32_16x16x32_bf16 a[44:47], v[52:55], v[28:31], a[44:47]
    ds_read_b128 v[84:87], v249 offset:2048
    v_mfma_f32_16x16x32_bf16 a[48:51], v[52:55], v[32:35], a[48:51]
    s_mul_i32 s39, s39, 3
    v_mfma_f32_16x16x32_bf16 a[52:55], v[52:55], v[36:39], a[52:55]
    s_add_u32 s26, s26, s39
    v_mfma_f32_16x16x32_bf16 a[56:59], v[52:55], v[40:43], a[56:59]
    buffer_store_dwordx4 v[208:211], v203, s[56:59], 0 offen sc1
    v_mfma_f32_16x16x32_bf16 a[60:63], v[52:55], v[44:47], a[60:63]
    s_add_u32 s26, s26, 16384
    v_add_u32 v11, s26, v1
    v_mfma_f32_16x16x32_bf16 a[64:67], v[56:59], v[16:19], a[64:67]
    s_lshl_b32 s26, s27, 16
    v_mfma_f32_16x16x32_bf16 a[68:71], v[56:59], v[20:23], a[68:71]
    ds_read_b128 v[88:91], v249 offset:4096
    v_mfma_f32_16x16x32_bf16 a[72:75], v[56:59], v[24:27], a[72:75]
    ds_read_b128 v[92:95], v249 offset:6144
    v_add_u32 v173, s26, v1
    v_mfma_f32_16x16x32_bf16 a[76:79], v[56:59], v[28:31], a[76:79]
    ds_read_b64_tr_b16 v[112:113], v250 offset:8192
    v_mfma_f32_16x16x32_bf16 a[80:83], v[56:59], v[32:35], a[80:83]
    ds_read_b64_tr_b16 v[114:115], v250 offset:9216
    v_mfma_f32_16x16x32_bf16 a[84:87], v[56:59], v[36:39], a[84:87]
    ds_read_b64_tr_b16 v[116:117], v251 offset:8192
    v_mfma_f32_16x16x32_bf16 a[88:91], v[56:59], v[40:43], a[88:91]
    ds_read_b64_tr_b16 v[118:119], v251 offset:9216
    v_mfma_f32_16x16x32_bf16 a[92:95], v[56:59], v[44:47], a[92:95]
    ds_read_b64_tr_b16 v[120:121], v252 offset:8192
    v_mfma_f32_16x16x32_bf16 a[96:99], v[60:63], v[16:19], a[96:99]
    ds_read_b64_tr_b16 v[122:123], v252 offset:9216
    v_mfma_f32_16x16x32_bf16 a[100:103], v[60:63], v[20:23], a[100:103]
    ds_read_b64_tr_b16 v[124:125], v253 offset:8192
    v_mfma_f32_16x16x32_bf16 a[104:107], v[60:63], v[24:27], a[104:107]
    ds_read_b64_tr_b16 v[126:127], v253 offset:9216
    v_mfma_f32_16x16x32_bf16 a[108:111], v[60:63], v[28:31], a[108:111]
    ds_read_b128 v[96:99], v249 offset:8192
    v_mfma_f32_16x16x32_bf16 a[112:115], v[60:63], v[32:35], a[112:115]
    ds_read_b128 v[100:103], v249 offset:10240
    v_mfma_f32_16x16x32_bf16 a[116:119], v[60:63], v[36:39], a[116:119]
    ds_read_b128 v[104:107], v249 offset:12288
    v_mfma_f32_16x16x32_bf16 a[120:123], v[60:63], v[40:43], a[120:123]
    ds_read_b128 v[108:111], v249 offset:14336
    v_mfma_f32_16x16x32_bf16 a[124:127], v[60:63], v[44:47], a[124:127]
    ds_read_b64_tr_b16 v[128:129], v250 offset:24576
    v_mfma_f32_16x16x32_bf16 a[128:131], v[16:19], v[64:67], a[128:131]
    ds_read_b64_tr_b16 v[130:131], v250 offset:25600
    v_mfma_f32_16x16x32_bf16 a[144:147], v[20:23], v[64:67], a[144:147]
    ds_read_b64_tr_b16 v[132:133], v251 offset:24576
    v_mfma_f32_16x16x32_bf16 a[160:163], v[24:27], v[64:67], a[160:163]
    ds_read_b64_tr_b16 v[134:135], v251 offset:25600
    v_mfma_f32_16x16x32_bf16 a[176:179], v[28:31], v[64:67], a[176:179]
    ds_read_b64_tr_b16 v[136:137], v252 offset:24576
    v_mfma_f32_16x16x32_bf16 a[192:195], v[32:35], v[64:67], a[192:195]
    ds_read_b64_tr_b16 v[138:139], v252 offset:25600
    v_mfma_f32_16x16x32_bf16 a[208:211], v[36:39], v[64:67], a[208:211]
    ds_read_b64_tr_b16 v[140:141], v253 offset:24576
    v_mfma_f32_16x16x32_bf16 a[224:227], v[40:43], v[64:67], a[224:227]
    ds_read_b64_tr_b16 v[142:143], v253 offset:25600
    v_mfma_f32_16x16x32_bf16 a[240:243], v[44:47], v[64:67], a[240:243]
    v_mfma_f32_16x16x32_bf16 a[132:135], v[16:19], v[68:71], a[132:135]
    v_mfma_f32_16x16x32_bf16 a[148:151], v[20:23], v[68:71], a[148:151]
    v_mfma_f32_16x16x32_bf16 a[164:167], v[24:27], v[68:71], a[164:167]
    v_mfma_f32_16x16x32_bf16 a[180:183], v[28:31], v[68:71], a[180:183]
    v_mfma_f32_16x16x32_bf16 a[196:199], v[32:35], v[68:71], a[196:199]
    v_mfma_f32_16x16x32_bf16 a[212:215], v[36:39], v[68:71], a[212:215]
    v_mfma_f32_16x16x32_bf16 a[228:231], v[40:43], v[68:71], a[228:231]
    v_add_u32 v248, 0xffff0000, v248
    v_add_u32 v249, 0xffff0000, v249
    v_mfma_f32_16x16x32_bf16 a[244:247], v[44:47], v[68:71], a[244:247]
    v_add_u32 v250, 0xffff0000, v250
    v_add_u32 v251, 0xffff0000, v251
    v_mfma_f32_16x16x32_bf16 a[136:139], v[16:19], v[72:75], a[136:139]
    v_add_u32 v252, 0xffff0000, v252
    v_add_u32 v253, 0xffff0000, v253
    v_mfma_f32_16x16x32_bf16 a[152:155], v[20:23], v[72:75], a[152:155]
    v_mfma_f32_16x16x32_bf16 a[168:171], v[24:27], v[72:75], a[168:171]
    v_mfma_f32_16x16x32_bf16 a[184:187], v[28:31], v[72:75], a[184:187]
    v_mfma_f32_16x16x32_bf16 a[200:203], v[32:35], v[72:75], a[200:203]
    v_mfma_f32_16x16x32_bf16 a[216:219], v[36:39], v[72:75], a[216:219]
    v_mfma_f32_16x16x32_bf16 a[232:235], v[40:43], v[72:75], a[232:235]
    v_mfma_f32_16x16x32_bf16 a[248:251], v[44:47], v[72:75], a[248:251]
    v_mfma_f32_16x16x32_bf16 a[140:143], v[16:19], v[76:79], a[140:143]
    v_mfma_f32_16x16x32_bf16 a[156:159], v[20:23], v[76:79], a[156:159]
    v_mfma_f32_16x16x32_bf16 a[172:175], v[24:27], v[76:79], a[172:175]
    v_mfma_f32_16x16x32_bf16 a[188:191], v[28:31], v[76:79], a[188:191]
    v_mfma_f32_16x16x32_bf16 a[204:207], v[32:35], v[76:79], a[204:207]
    v_mfma_f32_16x16x32_bf16 a[220:223], v[36:39], v[76:79], a[220:223]
    v_mfma_f32_16x16x32_bf16 a[236:239], v[40:43], v[76:79], a[236:239]
    v_mfma_f32_16x16x32_bf16 a[252:255], v[44:47], v[76:79], a[252:255]
    s_waitcnt vmcnt(1) lgkmcnt(0)
    s_barrier
    v_mfma_f32_16x16x32_bf16 a[0:3], v[112:115], v[80:83], a[0:3]
    s_add_u32 m0, s35, 65536
    v_mfma_f32_16x16x32_bf16 a[4:7], v[112:115], v[84:87], a[4:7]
    ds_read_b128 v[16:19], v248 offset:0
    v_mfma_f32_16x16x32_bf16 a[8:11], v[112:115], v[88:91], a[8:11]
    s_add_u32 s33, s32, 32768
    v_mfma_f32_16x16x32_bf16 a[12:15], v[112:115], v[92:95], a[12:15]
    ds_read_b128 v[20:23], v248 offset:2048
    v_mfma_f32_16x16x32_bf16 a[16:19], v[112:115], v[96:99], a[16:19]
    buffer_load_dwordx4 v240, s[4:7], s32 offen offset:0  lds
    v_mfma_f32_16x16x32_bf16 a[20:23], v[112:115], v[100:103], a[20:23]
    ds_read_b128 v[24:27], v248 offset:4096
    v_mfma_f32_16x16x32_bf16 a[24:27], v[112:115], v[104:107], a[24:27]
    buffer_load_dwordx4 v241, s[4:7], s32 offen offset:1024  lds
    v_mfma_f32_16x16x32_bf16 a[28:31], v[112:115], v[108:111], a[28:31]
    ds_read_b128 v[28:31], v248 offset:6144
    v_mfma_f32_16x16x32_bf16 a[32:35], v[116:119], v[80:83], a[32:35]
    buffer_load_dwordx4 v242, s[4:7], s32 offen offset:2048  lds
    v_mfma_f32_16x16x32_bf16 a[36:39], v[116:119], v[84:87], a[36:39]
    ds_read_b64_tr_b16 v[48:49], v250 offset:0
    v_mfma_f32_16x16x32_bf16 a[40:43], v[116:119], v[88:91], a[40:43]
    buffer_load_dwordx4 v243, s[4:7], s32 offen offset:3072  lds
    v_mfma_f32_16x16x32_bf16 a[44:47], v[116:119], v[92:95], a[44:47]
    ds_read_b64_tr_b16 v[50:51], v250 offset:1024
    v_mfma_f32_16x16x32_bf16 a[48:51], v[116:119], v[96:99], a[48:51]
    s_add_u32 m0, s35, 69632
    v_mfma_f32_16x16x32_bf16 a[52:55], v[116:119], v[100:103], a[52:55]
    s_mov_b32 s26, 0
    v_mfma_f32_16x16x32_bf16 a[56:59], v[116:119], v[104:107], a[56:59]
    ds_read_b64_tr_b16 v[52:53], v251 offset:0
    v_mfma_f32_16x16x32_bf16 a[60:63], v[116:119], v[108:111], a[60:63]
    s_add_u32 s32, s32, 128
    v_mfma_f32_16x16x32_bf16 a[64:67], v[120:123], v[80:83], a[64:67]
    s_mov_b32 s56, -917504
    v_mfma_f32_16x16x32_bf16 a[68:71], v[120:123], v[84:87], a[68:71]
    buffer_load_dwordx4 v240, s[4:7], s33 offen offset:0  lds
    v_mfma_f32_16x16x32_bf16 a[72:75], v[120:123], v[88:91], a[72:75]
    ds_read_b64_tr_b16 v[54:55], v251 offset:1024
    v_mfma_f32_16x16x32_bf16 a[76:79], v[120:123], v[92:95], a[76:79]
    buffer_load_dwordx4 v241, s[4:7], s33 offen offset:1024  lds
    v_mfma_f32_16x16x32_bf16 a[80:83], v[120:123], v[96:99], a[80:83]
    ds_read_b64_tr_b16 v[56:57], v252 offset:0
    v_mfma_f32_16x16x32_bf16 a[84:87], v[120:123], v[100:103], a[84:87]
    buffer_load_dwordx4 v242, s[4:7], s33 offen offset:2048  lds
    v_mfma_f32_16x16x32_bf16 a[88:91], v[120:123], v[104:107], a[88:91]
    ds_read_b64_tr_b16 v[58:59], v252 offset:1024
    v_mfma_f32_16x16x32_bf16 a[92:95], v[120:123], v[108:111], a[92:95]
    buffer_load_dwordx4 v243, s[4:7], s33 offen offset:3072  lds
    v_mfma_f32_16x16x32_bf16 a[96:99], v[124:127], v[80:83], a[96:99]
    ds_read_b64_tr_b16 v[60:61], v253 offset:0
    v_mfma_f32_16x16x32_bf16 a[100:103], v[124:127], v[84:87], a[100:103]
    s_add_u32 m0, s36, 65536
    v_mfma_f32_16x16x32_bf16 a[104:107], v[124:127], v[88:91], a[104:107]
    ds_read_b64_tr_b16 v[62:63], v253 offset:1024
    v_mfma_f32_16x16x32_bf16 a[108:111], v[124:127], v[92:95], a[108:111]
    ds_read_b128 v[32:35], v248 offset:8192
    v_mfma_f32_16x16x32_bf16 a[112:115], v[124:127], v[96:99], a[112:115]
    s_and_b32 s32, s32, 1023
    v_mfma_f32_16x16x32_bf16 a[116:119], v[124:127], v[100:103], a[116:119]
    ds_read_b128 v[36:39], v248 offset:10240
    v_mfma_f32_16x16x32_bf16 a[120:123], v[124:127], v[104:107], a[120:123]
    buffer_load_dwordx4 v244, s[8:11], s34 offen offset:0  lds
    v_mfma_f32_16x16x32_bf16 a[124:127], v[124:127], v[108:111], a[124:127]
    ds_read_b128 v[40:43], v248 offset:12288
    v_mfma_f32_16x16x32_bf16 a[128:131], v[80:83], v[128:131], a[128:131]
    buffer_load_dwordx4 v245, s[8:11], s34 offen offset:1024  lds
    v_mfma_f32_16x16x32_bf16 a[144:147], v[84:87], v[128:131], a[144:147]
    ds_read_b128 v[44:47], v248 offset:14336
    v_mfma_f32_16x16x32_bf16 a[160:163], v[88:91], v[128:131], a[160:163]
    buffer_load_dwordx4 v246, s[8:11], s34 offen offset:2048  lds
    v_mfma_f32_16x16x32_bf16 a[176:179], v[92:95], v[128:131], a[176:179]
    ds_read_b64_tr_b16 v[64:65], v250 offset:16384
    v_mfma_f32_16x16x32_bf16 a[192:195], v[96:99], v[128:131], a[192:195]
    buffer_load_dwordx4 v247, s[8:11], s34 offen offset:3072  lds
    v_mfma_f32_16x16x32_bf16 a[208:211], v[100:103], v[128:131], a[208:211]
    ds_read_b64_tr_b16 v[66:67], v250 offset:17408
    v_mfma_f32_16x16x32_bf16 a[224:227], v[104:107], v[128:131], a[224:227]
    s_add_u32 m0, s36, 81920
    v_mfma_f32_16x16x32_bf16 a[240:243], v[108:111], v[128:131], a[240:243]
    ds_read_b64_tr_b16 v[68:69], v251 offset:16384
    v_mfma_f32_16x16x32_bf16 a[132:135], v[80:83], v[132:135], a[132:135]
    s_nop 0
    v_mfma_f32_16x16x32_bf16 a[148:151], v[84:87], v[132:135], a[148:151]
    ds_read_b64_tr_b16 v[70:71], v251 offset:17408
    v_mfma_f32_16x16x32_bf16 a[164:167], v[88:91], v[132:135], a[164:167]
    ds_read_b64_tr_b16 v[72:73], v252 offset:16384
    v_mfma_f32_16x16x32_bf16 a[180:183], v[92:95], v[132:135], a[180:183]
    buffer_load_dwordx4 v244, s[20:23], s34 offen offset:0  lds
    v_mfma_f32_16x16x32_bf16 a[196:199], v[96:99], v[132:135], a[196:199]
    ds_read_b64_tr_b16 v[74:75], v252 offset:17408
    v_mfma_f32_16x16x32_bf16 a[212:215], v[100:103], v[132:135], a[212:215]
    buffer_load_dwordx4 v245, s[20:23], s34 offen offset:1024  lds
    v_mfma_f32_16x16x32_bf16 a[228:231], v[104:107], v[132:135], a[228:231]
    ds_read_b64_tr_b16 v[76:77], v253 offset:16384
    v_mfma_f32_16x16x32_bf16 a[244:247], v[108:111], v[132:135], a[244:247]
    buffer_load_dwordx4 v246, s[20:23], s34 offen offset:2048  lds
    v_mfma_f32_16x16x32_bf16 a[136:139], v[80:83], v[136:139], a[136:139]
    ds_read_b64_tr_b16 v[78:79], v253 offset:17408
    v_mfma_f32_16x16x32_bf16 a[152:155], v[84:87], v[136:139], a[152:155]
    buffer_load_dwordx4 v247, s[20:23], s34 offen offset:3072  lds
    v_mfma_f32_16x16x32_bf16 a[168:171], v[88:91], v[136:139], a[168:171]
    ds_read_b64_tr_b16 v[176:177], v148 offset:0
    v_mfma_f32_16x16x32_bf16 a[184:187], v[92:95], v[136:139], a[184:187]
    s_add_u32 s34, s34, 524288
    v_mfma_f32_16x16x32_bf16 a[200:203], v[96:99], v[136:139], a[200:203]
    ds_read_b64_tr_b16 v[178:179], v148 offset:2048
    v_mfma_f32_16x16x32_bf16 a[216:219], v[100:103], v[136:139], a[216:219]
    s_and_b32 s34, s34, 4194303
    v_mfma_f32_16x16x32_bf16 a[232:235], v[104:107], v[136:139], a[232:235]
    s_lshl_b32 s73, s24, 8
    v_mfma_f32_16x16x32_bf16 a[248:251], v[108:111], v[136:139], a[248:251]
    s_add_u32 s73, s73, 81920
    v_mfma_f32_16x16x32_bf16 a[140:143], v[80:83], v[140:143], a[140:143]
    ds_read_b64_tr_b16 v[180:181], v149 offset:0
    v_mov_b32 v207, 0
    v_mfma_f32_16x16x32_bf16 a[156:159], v[84:87], v[140:143], a[156:159]
    buffer_load_dword v206, v207, s[60:63], s73 offen sc1
    v_mfma_f32_16x16x32_bf16 a[172:175], v[88:91], v[140:143], a[172:175]
    buffer_load_dword v254, v255, s[60:63], 0 offen sc1
    v_mfma_f32_16x16x32_bf16 a[188:191], v[92:95], v[140:143], a[188:191]
    ds_read_b64_tr_b16 v[182:183], v149 offset:2048
    v_mfma_f32_16x16x32_bf16 a[204:207], v[96:99], v[140:143], a[204:207]
    ds_read_b64_tr_b16 v[184:185], v150 offset:0
    v_mfma_f32_16x16x32_bf16 a[220:223], v[100:103], v[140:143], a[220:223]
    ds_read_b64_tr_b16 v[186:187], v150 offset:2048
    ds_read_b64_tr_b16 v[188:189], v151 offset:0
    ds_read_b64_tr_b16 v[190:191], v151 offset:2048
    v_mfma_f32_16x16x32_bf16 a[236:239], v[104:107], v[140:143], a[236:239]
    s_add_u32 m0, s72, 4096
    v_mfma_f32_16x16x32_bf16 a[252:255], v[108:111], v[140:143], a[252:255]
    s_waitcnt lgkmcnt(0)
    s_nop 0
    v_mfma_f32_16x16x32_bf16 a[0:3], v[48:51], v[16:19], a[0:3]
    buffer_load_dwordx4 v144, s[40:43], 0 offen offset:0 nt lds
    v_mfma_f32_16x16x32_bf16 a[4:7], v[48:51], v[20:23], a[4:7]
    buffer_load_dwordx4 v145, s[40:43], 0 offen offset:1024 nt lds
    v_mfma_f32_16x16x32_bf16 a[8:11], v[48:51], v[24:27], a[8:11]
    buffer_load_dwordx4 v146, s[40:43], 0 offen offset:2048 nt lds
    v_mfma_f32_16x16x32_bf16 a[12:15], v[48:51], v[28:31], a[12:15]
    buffer_load_dwordx4 v147, s[40:43], 0 offen offset:3072 nt lds
    v_mfma_f32_16x16x32_bf16 a[16:19], v[48:51], v[32:35], a[16:19]
    s_mov_b32 s8, s78
    v_mfma_f32_16x16x32_bf16 a[20:23], v[48:51], v[36:39], a[20:23]
    s_mov_b32 s9, s79
    v_mfma_f32_16x16x32_bf16 a[24:27], v[48:51], v[40:43], a[24:27]
    s_mov_b32 s4, s68
    v_mfma_f32_16x16x32_bf16 a[28:31], v[48:51], v[44:47], a[28:31]
    s_mov_b32 s10, 0x200000
    v_mfma_f32_16x16x32_bf16 a[32:35], v[52:55], v[16:19], a[32:35]
    s_mov_b32 s5, s69
    v_mfma_f32_16x16x32_bf16 a[36:39], v[52:55], v[20:23], a[36:39]
    s_mov_b32 s11, 0x00020000
    v_mfma_f32_16x16x32_bf16 a[40:43], v[52:55], v[24:27], a[40:43]
    s_mov_b32 s6, 0x400000
    v_mfma_f32_16x16x32_bf16 a[44:47], v[52:55], v[28:31], a[44:47]
    s_mov_b32 s7, 0x00020000
    v_mfma_f32_16x16x32_bf16 a[48:51], v[52:55], v[32:35], a[48:51]
    s_add_u32 s20, s78, 0x1000000
    s_addc_u32 s21, s79, 0
    v_mfma_f32_16x16x32_bf16 a[52:55], v[52:55], v[36:39], a[52:55]
    s_mov_b32 s22, 0x1000000
    v_mfma_f32_16x16x32_bf16 a[56:59], v[52:55], v[40:43], a[56:59]
    buffer_store_dwordx4 v[176:179], v152, s[44:47], 0 offen offset:0 sc1
    v_mfma_f32_16x16x32_bf16 a[60:63], v[52:55], v[44:47], a[60:63]
    s_mov_b32 s23, 0x00020000
    v_mfma_f32_16x16x32_bf16 a[64:67], v[56:59], v[16:19], a[64:67]
    ds_read_b128 v[80:83], v249 offset:0
    v_mfma_f32_16x16x32_bf16 a[68:71], v[56:59], v[20:23], a[68:71]
    buffer_store_dwordx4 v[180:183], v152, s[44:47], 0 offen offset:1024 sc1
    v_mfma_f32_16x16x32_bf16 a[72:75], v[56:59], v[24:27], a[72:75]
    ds_read_b128 v[84:87], v249 offset:2048
    v_mfma_f32_16x16x32_bf16 a[76:79], v[56:59], v[28:31], a[76:79]
    ds_read_b128 v[88:91], v249 offset:4096
    v_mfma_f32_16x16x32_bf16 a[80:83], v[56:59], v[32:35], a[80:83]
    buffer_store_dwordx4 v[184:187], v152, s[44:47], 0 offen offset:2048 sc1
    v_mfma_f32_16x16x32_bf16 a[84:87], v[56:59], v[36:39], a[84:87]
    ds_read_b128 v[92:95], v249 offset:6144
    v_mfma_f32_16x16x32_bf16 a[88:91], v[56:59], v[40:43], a[88:91]
    ds_read_b64_tr_b16 v[112:113], v250 offset:8192
    v_mfma_f32_16x16x32_bf16 a[92:95], v[56:59], v[44:47], a[92:95]
    buffer_store_dwordx4 v[188:191], v152, s[44:47], 0 offen offset:3072 sc1
    v_mfma_f32_16x16x32_bf16 a[96:99], v[60:63], v[16:19], a[96:99]
    ds_read_b64_tr_b16 v[114:115], v250 offset:9216
    v_mfma_f32_16x16x32_bf16 a[100:103], v[60:63], v[20:23], a[100:103]
    ds_read_b64_tr_b16 v[116:117], v251 offset:8192
    v_mfma_f32_16x16x32_bf16 a[104:107], v[60:63], v[24:27], a[104:107]
    ds_read_b64_tr_b16 v[118:119], v251 offset:9216
    v_mfma_f32_16x16x32_bf16 a[108:111], v[60:63], v[28:31], a[108:111]
    ds_read_b64_tr_b16 v[120:121], v252 offset:8192
    v_mfma_f32_16x16x32_bf16 a[112:115], v[60:63], v[32:35], a[112:115]
    ds_read_b64_tr_b16 v[122:123], v252 offset:9216
    v_mfma_f32_16x16x32_bf16 a[116:119], v[60:63], v[36:39], a[116:119]
    ds_read_b64_tr_b16 v[124:125], v253 offset:8192
    v_mfma_f32_16x16x32_bf16 a[120:123], v[60:63], v[40:43], a[120:123]
    ds_read_b64_tr_b16 v[126:127], v253 offset:9216
    v_mfma_f32_16x16x32_bf16 a[124:127], v[60:63], v[44:47], a[124:127]
    ds_read_b128 v[96:99], v249 offset:8192
    v_mfma_f32_16x16x32_bf16 a[128:131], v[16:19], v[64:67], a[128:131]
    ds_read_b128 v[100:103], v249 offset:10240
    v_mfma_f32_16x16x32_bf16 a[144:147], v[20:23], v[64:67], a[144:147]
    ds_read_b128 v[104:107], v249 offset:12288
    v_mfma_f32_16x16x32_bf16 a[160:163], v[24:27], v[64:67], a[160:163]
    ds_read_b128 v[108:111], v249 offset:14336
    v_mfma_f32_16x16x32_bf16 a[176:179], v[28:31], v[64:67], a[176:179]
    ds_read_b64_tr_b16 v[128:129], v250 offset:24576
    v_mfma_f32_16x16x32_bf16 a[192:195], v[32:35], v[64:67], a[192:195]
    ds_read_b64_tr_b16 v[130:131], v250 offset:25600
    v_mfma_f32_16x16x32_bf16 a[208:211], v[36:39], v[64:67], a[208:211]
    ds_read_b64_tr_b16 v[132:133], v251 offset:24576
    v_mfma_f32_16x16x32_bf16 a[224:227], v[40:43], v[64:67], a[224:227]
    ds_read_b64_tr_b16 v[134:135], v251 offset:25600
    v_mfma_f32_16x16x32_bf16 a[240:243], v[44:47], v[64:67], a[240:243]
    ds_read_b64_tr_b16 v[136:137], v252 offset:24576
    v_mfma_f32_16x16x32_bf16 a[132:135], v[16:19], v[68:71], a[132:135]
    ds_read_b64_tr_b16 v[138:139], v252 offset:25600
    v_mfma_f32_16x16x32_bf16 a[148:151], v[20:23], v[68:71], a[148:151]
    ds_read_b64_tr_b16 v[140:141], v253 offset:24576
    v_mfma_f32_16x16x32_bf16 a[164:167], v[24:27], v[68:71], a[164:167]
    ds_read_b64_tr_b16 v[142:143], v253 offset:25600
    v_mfma_f32_16x16x32_bf16 a[180:183], v[28:31], v[68:71], a[180:183]
    v_mfma_f32_16x16x32_bf16 a[196:199], v[32:35], v[68:71], a[196:199]
    v_mfma_f32_16x16x32_bf16 a[212:215], v[36:39], v[68:71], a[212:215]
    v_mfma_f32_16x16x32_bf16 a[228:231], v[40:43], v[68:71], a[228:231]
    v_add_u32 v248, 0x10000, v248
    v_add_u32 v249, 0x10000, v249
    v_mfma_f32_16x16x32_bf16 a[244:247], v[44:47], v[68:71], a[244:247]
    v_add_u32 v250, 0x10000, v250
    v_add_u32 v251, 0x10000, v251
    v_mfma_f32_16x16x32_bf16 a[136:139], v[16:19], v[72:75], a[136:139]
    v_add_u32 v252, 0x10000, v252
    v_add_u32 v253, 0x10000, v253
    v_mfma_f32_16x16x32_bf16 a[152:155], v[20:23], v[72:75], a[152:155]
    v_mfma_f32_16x16x32_bf16 a[168:171], v[24:27], v[72:75], a[168:171]
    v_mfma_f32_16x16x32_bf16 a[184:187], v[28:31], v[72:75], a[184:187]
    v_mfma_f32_16x16x32_bf16 a[200:203], v[32:35], v[72:75], a[200:203]
    v_mfma_f32_16x16x32_bf16 a[216:219], v[36:39], v[72:75], a[216:219]
    v_mfma_f32_16x16x32_bf16 a[232:235], v[40:43], v[72:75], a[232:235]
    v_mfma_f32_16x16x32_bf16 a[248:251], v[44:47], v[72:75], a[248:251]
    v_mfma_f32_16x16x32_bf16 a[140:143], v[16:19], v[76:79], a[140:143]
    v_mfma_f32_16x16x32_bf16 a[156:159], v[20:23], v[76:79], a[156:159]
    v_mfma_f32_16x16x32_bf16 a[172:175], v[24:27], v[76:79], a[172:175]
    v_mfma_f32_16x16x32_bf16 a[188:191], v[28:31], v[76:79], a[188:191]
    v_mfma_f32_16x16x32_bf16 a[204:207], v[32:35], v[76:79], a[204:207]
    v_mfma_f32_16x16x32_bf16 a[220:223], v[36:39], v[76:79], a[220:223]
    v_mfma_f32_16x16x32_bf16 a[236:239], v[40:43], v[76:79], a[236:239]
    v_mfma_f32_16x16x32_bf16 a[252:255], v[44:47], v[76:79], a[252:255]
    s_waitcnt vmcnt(4) lgkmcnt(0)
    v_or_b32 v224, v254, v225
    v_cmp_eq_u32 vcc, 0, v224
    s_nop 4
    s_cbranch_vccnz L_spin1
L_back1:
    s_barrier
    v_mfma_f32_16x16x32_bf16 a[0:3], v[112:115], v[80:83], a[0:3]
    s_add_u32 m0, s37, 0
    v_mfma_f32_16x16x32_bf16 a[4:7], v[112:115], v[84:87], a[4:7]
    ds_read_b128 v[16:19], v248 offset:0
    v_cmp_ne_u32 vcc, s98, v254
    v_mfma_f32_16x16x32_bf16 a[8:11], v[112:115], v[88:91], a[8:11]
    s_add_u32 s56, s56, 917504
    v_mfma_f32_16x16x32_bf16 a[12:15], v[112:115], v[92:95], a[12:15]
    s_add_u32 s44, s78, 0x4400000
    s_addc_u32 s45, s79, 0
    v_mov_b32 v255, v173
    v_mfma_f32_16x16x32_bf16 a[16:19], v[112:115], v[96:99], a[16:19]
    s_and_b32 s56, s56, 4194303
    v_mfma_f32_16x16x32_bf16 a[20:23], v[112:115], v[100:103], a[20:23]
    s_mov_b32 s46, 0x1c0000
    v_mfma_f32_16x16x32_bf16 a[24:27], v[112:115], v[104:107], a[24:27]
    buffer_load_dwordx4 v12, s[4:7], s56 offen offset:0  lds
    v_mfma_f32_16x16x32_bf16 a[28:31], v[112:115], v[108:111], a[28:31]
    s_and_b32 s39, vcc_hi, 0xffff
    s_cselect_b32 s98, 0, 1
    v_mfma_f32_16x16x32_bf16 a[32:35], v[116:119], v[80:83], a[32:35]
    buffer_load_dwordx4 v13, s[4:7], s56 offen offset:1024  lds
    v_mfma_f32_16x16x32_bf16 a[36:39], v[116:119], v[84:87], a[36:39]
    s_mov_b32 s47, 0x00020000
    v_mfma_f32_16x16x32_bf16 a[40:43], v[116:119], v[88:91], a[40:43]
    buffer_load_dwordx4 v14, s[4:7], s56 offen offset:2048  lds
    v_mfma_f32_16x16x32_bf16 a[44:47], v[116:119], v[92:95], a[44:47]
    s_mov_b32 s46, s66
    v_mfma_f32_16x16x32_bf16 a[48:51], v[116:119], v[96:99], a[48:51]
    buffer_load_dwordx4 v15, s[4:7], s56 offen offset:3072  lds
    v_mfma_f32_16x16x32_bf16 a[52:55], v[116:119], v[100:103], a[52:55]
    ds_read_b128 v[20:23], v248 offset:2048
    v_mfma_f32_16x16x32_bf16 a[56:59], v[116:119], v[104:107], a[56:59]
    ds_read_b128 v[24:27], v248 offset:4096
    v_mfma_f32_16x16x32_bf16 a[60:63], v[116:119], v[108:111], a[60:63]
    s_add_u32 m0, s37, 4096
    v_mfma_f32_16x16x32_bf16 a[64:67], v[120:123], v[80:83], a[64:67]
    ds_read_b128 v[28:31], v248 offset:6144
    v_mfma_f32_16x16x32_bf16 a[68:71], v[120:123], v[84:87], a[68:71]
    s_add_u32 s56, s56, 131072
    v_mfma_f32_16x16x32_bf16 a[72:75], v[120:123], v[88:91], a[72:75]
    ds_read_b64_tr_b16 v[48:49], v250 offset:0
    v_mfma_f32_16x16x32_bf16 a[76:79], v[120:123], v[92:95], a[76:79]
    buffer_load_dwordx4 v12, s[4:7], s56 offen offset:0  lds
    v_mfma_f32_16x16x32_bf16 a[80:83], v[120:123], v[96:99], a[80:83]
    ds_read_b64_tr_b16 v[50:51], v250 offset:1024
    v_mfma_f32_16x16x32_bf16 a[84:87], v[120:123], v[100:103], a[84:87]
    buffer_load_dwordx4 v13, s[4:7], s56 offen offset:1024  lds
    v_mfma_f32_16x16x32_bf16 a[88:91], v[120:123], v[104:107], a[88:91]
    ds_read_b64_tr_b16 v[52:53], v251 offset:0
    v_mfma_f32_16x16x32_bf16 a[92:95], v[120:123], v[108:111], a[92:95]
    buffer_load_dwordx4 v14, s[4:7], s56 offen offset:2048  lds
    v_mfma_f32_16x16x32_bf16 a[96:99], v[124:127], v[80:83], a[96:99]
    ds_read_b64_tr_b16 v[54:55], v251 offset:1024
    v_mfma_f32_16x16x32_bf16 a[100:103], v[124:127], v[84:87], a[100:103]
    buffer_load_dwordx4 v15, s[4:7], s56 offen offset:3072  lds
    v_mfma_f32_16x16x32_bf16 a[104:107], v[124:127], v[88:91], a[104:107]
    ds_read_b64_tr_b16 v[56:57], v252 offset:0
    v_mfma_f32_16x16x32_bf16 a[108:111], v[124:127], v[92:95], a[108:111]
    ds_read_b64_tr_b16 v[58:59], v252 offset:1024
    v_mfma_f32_16x16x32_bf16 a[112:115], v[124:127], v[96:99], a[112:115]
    s_add_u32 m0, s37, 32768
    v_mfma_f32_16x16x32_bf16 a[116:119], v[124:127], v[100:103], a[116:119]
    ds_read_b64_tr_b16 v[60:61], v253 offset:0
    v_mfma_f32_16x16x32_bf16 a[120:123], v[124:127], v[104:107], a[120:123]
    s_add_u32 s56, s56, 917504
    v_mfma_f32_16x16x32_bf16 a[124:127], v[124:127], v[108:111], a[124:127]
    ds_read_b64_tr_b16 v[62:63], v253 offset:1024
    v_mfma_f32_16x16x32_bf16 a[128:131], v[80:83], v[128:131], a[128:131]
    s_and_b32 s56, s56, 4194303
    v_mfma_f32_16x16x32_bf16 a[144:147], v[84:87], v[128:131], a[144:147]
    ds_read_b128 v[32:35], v248 offset:8192
    v_mfma_f32_16x16x32_bf16 a[160:163], v[88:91], v[128:131], a[160:163]
    buffer_load_dwordx4 v12, s[4:7], s56 offen offset:0  lds
    v_mfma_f32_16x16x32_bf16 a[176:179], v[92:95], v[128:131], a[176:179]
    ds_read_b128 v[36:39], v248 offset:10240
    v_mfma_f32_16x16x32_bf16 a[192:195], v[96:99], v[128:131], a[192:195]
    buffer_load_dwordx4 v13, s[4:7], s56 offen offset:1024  lds
    v_mfma_f32_16x16x32_bf16 a[208:211], v[100:103], v[128:131], a[208:211]
    ds_read_b128 v[40:43], v248 offset:12288
    v_mfma_f32_16x16x32_bf16 a[224:227], v[104:107], v[128:131], a[224:227]
    buffer_load_dwordx4 v14, s[4:7], s56 offen offset:2048  lds
    v_mfma_f32_16x16x32_bf16 a[240:243], v[108:111], v[128:131], a[240:243]
    ds_read_b128 v[44:47], v248 offset:14336
    v_mfma_f32_16x16x32_bf16 a[132:135], v[80:83], v[132:135], a[132:135]
    buffer_load_dwordx4 v15, s[4:7], s56 offen offset:3072  lds
    v_mfma_f32_16x16x32_bf16 a[148:151], v[84:87], v[132:135], a[148:151]
    ds_read_b64_tr_b16 v[64:65], v250 offset:16384
    v_mfma_f32_16x16x32_bf16 a[164:167], v[88:91], v[132:135], a[164:167]
    ds_read_b64_tr_b16 v[66:67], v250 offset:17408
    v_mfma_f32_16x16x32_bf16 a[180:183], v[92:95], v[132:135], a[180:183]
    s_add_u32 m0, s37, 36864
    v_mfma_f32_16x16x32_bf16 a[196:199], v[96:99], v[132:135], a[196:199]
    ds_read_b64_tr_b16 v[68:69], v251 offset:16384
    v_mfma_f32_16x16x32_bf16 a[212:215], v[100:103], v[132:135], a[212:215]
    s_add_u32 s56, s56, 131072
    v_mfma_f32_16x16x32_bf16 a[228:231], v[104:107], v[132:135], a[228:231]
    ds_read_b64_tr_b16 v[70:71], v251 offset:17408
    v_mfma_f32_16x16x32_bf16 a[244:247], v[108:111], v[132:135], a[244:247]
    buffer_load_dwordx4 v12, s[4:7], s56 offen offset:0  lds
    v_mfma_f32_16x16x32_bf16 a[136:139], v[80:83], v[136:139], a[136:139]
    ds_read_b64_tr_b16 v[72:73], v252 offset:16384
    v_mfma_f32_16x16x32_bf16 a[152:155], v[84:87], v[136:139], a[152:155]
    buffer_load_dwordx4 v13, s[4:7], s56 offen offset:1024  lds
    v_mfma_f32_16x16x32_bf16 a[168:171], v[88:91], v[136:139], a[168:171]
    ds_read_b64_tr_b16 v[74:75], v252 offset:17408
    v_mfma_f32_16x16x32_bf16 a[184:187], v[92:95], v[136:139], a[184:187]
    ds_read_b64_tr_b16 v[76:77], v253 offset:16384
    v_mfma_f32_16x16x32_bf16 a[200:203], v[96:99], v[136:139], a[200:203]
    ds_read_b64_tr_b16 v[78:79], v253 offset:17408
    v_mfma_f32_16x16x32_bf16 a[216:219], v[100:103], v[136:139], a[216:219]
    buffer_load_dwordx4 v14, s[4:7], s56 offen offset:2048  lds
    v_mfma_f32_16x16x32_bf16 a[232:235], v[104:107], v[136:139], a[232:235]
    buffer_load_dwordx4 v15, s[4:7], s56 offen offset:3072  lds
    v_mfma_f32_16x16x32_bf16 a[248:251], v[108:111], v[136:139], a[248:251]
    ds_read_b64_tr_b16 v[176:177], v148 offset:4096
    v_mfma_f32_16x16x32_bf16 a[140:143], v[80:83], v[140:143], a[140:143]
    ds_read_b64_tr_b16 v[178:179], v148 offset:6144
    v_mfma_f32_16x16x32_bf16 a[156:159], v[84:87], v[140:143], a[156:159]
    ds_read_b64_tr_b16 v[180:181], v149 offset:4096
    v_mfma_f32_16x16x32_bf16 a[172:175], v[88:91], v[140:143], a[172:175]
    ds_read_b64_tr_b16 v[182:183], v149 offset:6144
    v_mfma_f32_16x16x32_bf16 a[188:191], v[92:95], v[140:143], a[188:191]
    ds_read_b64_tr_b16 v[184:185], v150 offset:4096
    v_mfma_f32_16x16x32_bf16 a[204:207], v[96:99], v[140:143], a[204:207]
    ds_read_b64_tr_b16 v[186:187], v150 offset:6144
    v_mfma_f32_16x16x32_bf16 a[220:223], v[100:103], v[140:143], a[220:223]
    ds_read_b64_tr_b16 v[188:189], v151 offset:4096
    ds_read_b64_tr_b16 v[190:191], v151 offset:6144
    v_mfma_f32_16x16x32_bf16 a[236:239], v[104:107], v[140:143], a[236:239]
    v_mfma_f32_16x16x32_bf16 a[252:255], v[108:111], v[140:143], a[252:255]
    s_waitcnt lgkmcnt(0)
    v_mfma_f32_16x16x32_bf16 a[128:131], v[16:19], v[64:67], a[128:131]
    ds_read_b128 v[80:83], v249 offset:0
    v_mfma_f32_16x16x32_bf16 a[132:135], v[16:19], v[68:71], a[132:135]
    buffer_load_dwordx4 v[208:211], v255, s[8:11], s26 offen offset:0 sc1
    v_mfma_f32_16x16x32_bf16 a[136:139], v[16:19], v[72:75], a[136:139]
    ds_read_b128 v[84:87], v249 offset:2048
    v_mfma_f32_16x16x32_bf16 a[140:143], v[16:19], v[76:79], a[140:143]
    buffer_load_dwordx4 v[212:215], v255, s[8:11], s26 offen offset:1024 sc1
    v_mfma_f32_16x16x32_bf16 a[144:147], v[20:23], v[64:67], a[144:147]
    ds_read_b128 v[88:91], v249 offset:4096
    v_mfma_f32_16x16x32_bf16 a[148:151], v[20:23], v[68:71], a[148:151]
    buffer_load_dwordx4 v[216:219], v255, s[8:11], s26 offen offset:2048 sc1
    v_mfma_f32_16x16x32_bf16 a[152:155], v[20:23], v[72:75], a[152:155]
    ds_read_b128 v[92:95], v249 offset:6144
    v_mfma_f32_16x16x32_bf16 a[156:159], v[20:23], v[76:79], a[156:159]
    buffer_load_dwordx4 v[220:223], v255, s[8:11], s26 offen offset:3072 sc1
    v_mfma_f32_16x16x32_bf16 a[160:163], v[24:27], v[64:67], a[160:163]
    ds_read_b128 v[96:99], v249 offset:8192
    v_mfma_f32_16x16x32_bf16 a[164:167], v[24:27], v[68:71], a[164:167]
    s_add_u32 s26, s26, 4096
    v_mfma_f32_16x16x32_bf16 a[168:171], v[24:27], v[72:75], a[168:171]
    ds_read_b128 v[100:103], v249 offset:10240
    v_mfma_f32_16x16x32_bf16 a[172:175], v[24:27], v[76:79], a[172:175]
    s_and_b32 s26, s26, 0xffff
    v_mfma_f32_16x16x32_bf16 a[176:179], v[28:31], v[64:67], a[176:179]
    ds_read_b128 v[104:107], v249 offset:12288
    v_mfma_f32_16x16x32_bf16 a[180:183], v[28:31], v[68:71], a[180:183]
    buffer_load_dwordx4 v[224:227], v255, s[8:11], s26 offen offset:0 sc1
    v_mfma_f32_16x16x32_bf16 a[184:187], v[28:31], v[72:75], a[184:187]
    ds_read_b128 v[108:111], v249 offset:14336
    v_mfma_f32_16x16x32_bf16 a[188:191], v[28:31], v[76:79], a[188:191]
    buffer_load_dwordx4 v[228:231], v255, s[8:11], s26 offen offset:1024 sc1
    v_mfma_f32_16x16x32_bf16 a[192:195], v[32:35], v[64:67], a[192:195]
    ds_read_b64_tr_b16 v[128:129], v250 offset:24576
    v_mfma_f32_16x16x32_bf16 a[196:199], v[32:35], v[68:71], a[196:199]
    buffer_load_dwordx4 v[232:235], v255, s[8:11], s26 offen offset:2048 sc1
    v_mfma_f32_16x16x32_bf16 a[200:203], v[32:35], v[72:75], a[200:203]
    ds_read_b64_tr_b16 v[130:131], v250 offset:25600
    v_mfma_f32_16x16x32_bf16 a[204:207], v[32:35], v[76:79], a[204:207]
    buffer_load_dwordx4 v[236:239], v255, s[8:11], s26 offen offset:3072 sc1
    v_mfma_f32_16x16x32_bf16 a[208:211], v[36:39], v[64:67], a[208:211]
    ds_read_b64_tr_b16 v[132:133], v251 offset:24576
    v_mfma_f32_16x16x32_bf16 a[212:215], v[36:39], v[68:71], a[212:215]
    s_add_u32 s26, s26, 4096
    v_mfma_f32_16x16x32_bf16 a[216:219], v[36:39], v[72:75], a[216:219]
    ds_read_b64_tr_b16 v[134:135], v251 offset:25600
    v_mfma_f32_16x16x32_bf16 a[220:223], v[36:39], v[76:79], a[220:223]
    ds_read_b64_tr_b16 v[136:137], v252 offset:24576
    v_mfma_f32_16x16x32_bf16 a[224:227], v[40:43], v[64:67], a[224:227]
    ds_read_b64_tr_b16 v[138:139], v252 offset:25600
    v_mfma_f32_16x16x32_bf16 a[228:231], v[40:43], v[68:71], a[228:231]
    ds_read_b64_tr_b16 v[140:141], v253 offset:24576
    v_mfma_f32_16x16x32_bf16 a[232:235], v[40:43], v[72:75], a[232:235]
    ds_read_b64_tr_b16 v[142:143], v253 offset:25600
    v_mfma_f32_16x16x32_bf16 a[236:239], v[40:43], v[76:79], a[236:239]
    s_and_b32 s26, s26, 0xffff
    v_mfma_f32_16x16x32_bf16 a[240:243], v[44:47], v[64:67], a[240:243]
    buffer_store_dwordx4 v[176:179], v153, s[44:47], 0 offen offset:0 sc1
    v_mfma_f32_16x16x32_bf16 a[244:247], v[44:47], v[68:71], a[244:247]
    buffer_store_dwordx4 v[180:183], v153, s[44:47], 0 offen offset:1024 sc1
    v_mfma_f32_16x16x32_bf16 a[248:251], v[44:47], v[72:75], a[248:251]
    buffer_store_dwordx4 v[184:187], v153, s[44:47], 0 offen offset:2048 sc1
    v_mfma_f32_16x16x32_bf16 a[252:255], v[44:47], v[76:79], a[252:255]
    s_waitcnt lgkmcnt(0)
    v_mfma_f32_16x16x32_bf16 a[128:131], v[80:83], v[128:131], a[128:131]
    buffer_store_dwordx4 v[188:191], v153, s[44:47], 0 offen offset:3072 sc1
    v_mfma_f32_16x16x32_bf16 a[132:135], v[80:83], v[132:135], a[132:135]
    buffer_load_dwordx4 v[176:179], v255, s[8:11], s26 offen offset:0 sc1
    v_mfma_f32_16x16x32_bf16 a[136:139], v[80:83], v[136:139], a[136:139]
    ds_read_b64_tr_b16 v[112:113], v250 offset:8192
    v_mfma_f32_16x16x32_bf16 a[140:143], v[80:83], v[140:143], a[140:143]
    buffer_load_dwordx4 v[180:183], v255, s[8:11], s26 offen offset:1024 sc1
    v_mfma_f32_16x16x32_bf16 a[144:147], v[84:87], v[128:131], a[144:147]
    ds_read_b64_tr_b16 v[114:115], v250 offset:9216
    v_mfma_f32_16x16x32_bf16 a[148:151], v[84:87], v[132:135], a[148:151]
    buffer_load_dwordx4 v[184:187], v255, s[8:11], s26 offen offset:2048 sc1
    v_mfma_f32_16x16x32_bf16 a[152:155], v[84:87], v[136:139], a[152:155]
    ds_read_b64_tr_b16 v[116:117], v251 offset:8192
    v_mfma_f32_16x16x32_bf16 a[156:159], v[84:87], v[140:143], a[156:159]
    buffer_load_dwordx4 v[188:191], v255, s[8:11], s26 offen offset:3072 sc1
    v_mfma_f32_16x16x32_bf16 a[160:163], v[88:91], v[128:131], a[160:163]
    ds_read_b64_tr_b16 v[118:119], v251 offset:9216
    v_mfma_f32_16x16x32_bf16 a[164:167], v[88:91], v[132:135], a[164:167]
    s_add_u32 s26, s26, 4096
    v_mfma_f32_16x16x32_bf16 a[168:171], v[88:91], v[136:139], a[168:171]
    ds_read_b64_tr_b16 v[120:121], v252 offset:8192
    v_mfma_f32_16x16x32_bf16 a[172:175], v[88:91], v[140:143], a[172:175]
    s_and_b32 s26, s26, 0xffff
    v_mfma_f32_16x16x32_bf16 a[176:179], v[92:95], v[128:131], a[176:179]
    ds_read_b64_tr_b16 v[122:123], v252 offset:9216
    v_mfma_f32_16x16x32_bf16 a[180:183], v[92:95], v[132:135], a[180:183]
    buffer_load_dwordx4 v[192:195], v255, s[8:11], s26 offen offset:0 sc1
    v_mfma_f32_16x16x32_bf16 a[184:187], v[92:95], v[136:139], a[184:187]
    ds_read_b64_tr_b16 v[124:125], v253 offset:8192
    v_mfma_f32_16x16x32_bf16 a[188:191], v[92:95], v[140:143], a[188:191]
    buffer_load_dwordx4 v[196:199], v255, s[8:11], s26 offen offset:1024 sc1
    v_mfma_f32_16x16x32_bf16 a[192:195], v[96:99], v[128:131], a[192:195]
    ds_read_b64_tr_b16 v[126:127], v253 offset:9216
    v_mfma_f32_16x16x32_bf16 a[196:199], v[96:99], v[132:135], a[196:199]
    buffer_load_dwordx4 v[200:203], v255, s[8:11], s26 offen offset:2048 sc1
    v_mfma_f32_16x16x32_bf16 a[200:203], v[96:99], v[136:139], a[200:203]
    v_mfma_f32_16x16x32_bf16 a[204:207], v[96:99], v[140:143], a[204:207]
    buffer_load_dwordx4 v[204:207], v255, s[8:11], s26 offen offset:3072 sc1
    v_mfma_f32_16x16x32_bf16 a[208:211], v[100:103], v[128:131], a[208:211]
    v_mfma_f32_16x16x32_bf16 a[212:215], v[100:103], v[132:135], a[212:215]
    s_add_u32 s26, s26, 4096
    v_mfma_f32_16x16x32_bf16 a[216:219], v[100:103], v[136:139], a[216:219]
    v_mfma_f32_16x16x32_bf16 a[220:223], v[100:103], v[140:143], a[220:223]
    s_and_b32 s26, s26, 0xffff
    v_mfma_f32_16x16x32_bf16 a[224:227], v[104:107], v[128:131], a[224:227]
    v_mfma_f32_16x16x32_bf16 a[228:231], v[104:107], v[132:135], a[228:231]
    v_mfma_f32_16x16x32_bf16 a[232:235], v[104:107], v[136:139], a[232:235]
    v_mfma_f32_16x16x32_bf16 a[236:239], v[104:107], v[140:143], a[236:239]
    v_mfma_f32_16x16x32_bf16 a[240:243], v[108:111], v[128:131], a[240:243]
    v_mfma_f32_16x16x32_bf16 a[244:247], v[108:111], v[132:135], a[244:247]
    v_mfma_f32_16x16x32_bf16 a[248:251], v[108:111], v[136:139], a[248:251]
    v_mfma_f32_16x16x32_bf16 a[252:255], v[108:111], v[140:143], a[252:255]
    s_waitcnt vmcnt(20) lgkmcnt(0)
    s_barrier
    v_mfma_f32_16x16x32_bf16 a[0:3], v[48:51], v[16:19], a[0:3]
    s_add_u32 m0, s37, 65536
    v_mfma_f32_16x16x32_bf16 a[4:7], v[48:51], v[20:23], a[4:7]
    ds_read_b64_tr_b16 v[144:145], v2 offset:0
    v_mfma_f32_16x16x32_bf16 a[8:11], v[48:51], v[24:27], a[8:11]
    s_add_u32 s56, s56, 917504
    v_mfma_f32_16x16x32_bf16 a[12:15], v[48:51], v[28:31], a[12:15]
    ds_read_b64_tr_b16 v[146:147], v2 offset:1024
    v_mfma_f32_16x16x32_bf16 a[16:19], v[48:51], v[32:35], a[16:19]
    s_and_b32 s56, s56, 4194303
    v_mfma_f32_16x16x32_bf16 a[20:23], v[48:51], v[36:39], a[20:23]
    v_mfma_f32_16x16x32_bf16 a[24:27], v[48:51], v[40:43], a[24:27]
    buffer_load_dwordx4 v12, s[4:7], s56 offen offset:0  lds
    v_mfma_f32_16x16x32_bf16 a[28:31], v[48:51], v[44:47], a[28:31]
    ds_read_b64_tr_b16 v[148:149], v3 offset:0
    v_mfma_f32_16x16x32_bf16 a[32:35], v[52:55], v[16:19], a[32:35]
    s_mov_b32 s59, 0
    v_mfma_f32_16x16x32_bf16 a[36:39], v[52:55], v[20:23], a[36:39]
    ds_read_b64_tr_b16 v[150:151], v3 offset:1024
    v_accvgpr_read_b32 v240, a128
    v_mfma_f32_16x16x32_bf16 a[40:43], v[52:55], v[24:27], a[40:43]
    buffer_load_dwordx4 v13, s[4:7], s56 offen offset:1024  lds
    v_mfma_f32_16x16x32_bf16 a[44:47], v[52:55], v[28:31], a[44:47]
    v_accvgpr_read_b32 v241, a129
    v_accvgpr_read_b32 v242, a130
    v_mfma_f32_16x16x32_bf16 a[48:51], v[52:55], v[32:35], a[48:51]
    buffer_load_dwordx4 v14, s[4:7], s56 offen offset:2048  lds
    v_mfma_f32_16x16x32_bf16 a[52:55], v[52:55], v[36:39], a[52:55]
    v_accvgpr_read_b32 v243, a131
    v_accvgpr_read_b32 v244, a144
    v_mfma_f32_16x16x32_bf16 a[56:59], v[52:55], v[40:43], a[56:59]
    buffer_load_dwordx4 v15, s[4:7], s56 offen offset:3072  lds
    v_mfma_f32_16x16x32_bf16 a[60:63], v[52:55], v[44:47], a[60:63]
    s_add_u32 m0, s37, 69632
    v_accvgpr_read_b32 v245, a145
    v_accvgpr_read_b32 v246, a146
    v_mfma_f32_16x16x32_bf16 a[64:67], v[56:59], v[16:19], a[64:67]
    ds_read_b64_tr_b16 v[152:153], v4 offset:0
    v_accvgpr_read_b32 v247, a147
    v_mfma_f32_16x16x32_bf16 a[68:71], v[56:59], v[20:23], a[68:71]
    s_add_u32 s56, s56, 131072
    v_mfma_f32_16x16x32_bf16 a[72:75], v[56:59], v[24:27], a[72:75]
    ds_read_b64_tr_b16 v[154:155], v4 offset:1024
    v_cvt_pk_bf16_f32 v248, v240, v241
    v_mfma_f32_16x16x32_bf16 a[76:79], v[56:59], v[28:31], a[76:79]
    buffer_load_dwordx4 v12, s[4:7], s56 offen offset:0  lds
    v_mfma_f32_16x16x32_bf16 a[80:83], v[56:59], v[32:35], a[80:83]
    v_cvt_pk_bf16_f32 v249, v242, v243
    v_cvt_pk_bf16_f32 v250, v244, v245
    v_mfma_f32_16x16x32_bf16 a[84:87], v[56:59], v[36:39], a[84:87]
    buffer_load_dwordx4 v13, s[4:7], s56 offen offset:1024  lds
    v_mfma_f32_16x16x32_bf16 a[88:91], v[56:59], v[40:43], a[88:91]
    ds_read_b64_tr_b16 v[156:157], v5 offset:0
    v_cvt_pk_bf16_f32 v251, v246, v247
    v_mfma_f32_16x16x32_bf16 a[92:95], v[56:59], v[44:47], a[92:95]
    buffer_store_dwordx4 v[248:251], v11, s[12:15], s59 offen offset:0
    v_mfma_f32_16x16x32_bf16 a[96:99], v[60:63], v[16:19], a[96:99]
    v_accvgpr_read_b32 v240, a132
    v_accvgpr_read_b32 v241, a133
    v_mfma_f32_16x16x32_bf16 a[100:103], v[60:63], v[20:23], a[100:103]
    buffer_load_dwordx4 v14, s[4:7], s56 offen offset:2048  lds
    v_mfma_f32_16x16x32_bf16 a[104:107], v[60:63], v[24:27], a[104:107]
    ds_read_b64_tr_b16 v[158:159], v5 offset:1024
    v_accvgpr_read_b32 v242, a134
    v_mfma_f32_16x16x32_bf16 a[108:111], v[60:63], v[28:31], a[108:111]
    buffer_load_dwordx4 v15, s[4:7], s56 offen offset:3072  lds
    v_mfma_f32_16x16x32_bf16 a[112:115], v[60:63], v[32:35], a[112:115]
    s_add_u32 m0, s37, 98304
    v_accvgpr_read_b32 v243, a135
    v_accvgpr_read_b32 v244, a148
    v_mfma_f32_16x16x32_bf16 a[116:119], v[60:63], v[36:39], a[116:119]
    ds_read_b64_tr_b16 v[160:161], v6 offset:0
    v_accvgpr_read_b32 v245, a149
    v_mfma_f32_16x16x32_bf16 a[120:123], v[60:63], v[40:43], a[120:123]
    s_add_u32 s56, s56, 917504
    v_accvgpr_read_b32 v246, a150
    v_mfma_f32_16x16x32_bf16 a[124:127], v[60:63], v[44:47], a[124:127]
    ds_read_b64_tr_b16 v[162:163], v6 offset:1024
    v_accvgpr_read_b32 v247, a151
    v_mfma_f32_16x16x32_bf16 a[0:3], v[112:115], v[80:83], a[0:3]
    s_and_b32 s56, s56, 4194303
    v_cvt_pk_bf16_f32 v248, v240, v241
    v_mfma_f32_16x16x32_bf16 a[4:7], v[112:115], v[84:87], a[4:7]
    ds_read_b64_tr_b16 v[164:165], v7 offset:0
    v_cvt_pk_bf16_f32 v249, v242, v243
    v_mfma_f32_16x16x32_bf16 a[8:11], v[112:115], v[88:91], a[8:11]
    buffer_load_dwordx4 v12, s[4:7], s56 offen offset:0  lds
    v_mfma_f32_16x16x32_bf16 a[12:15], v[112:115], v[92:95], a[12:15]
    ds_read_b64_tr_b16 v[166:167], v7 offset:1024
    v_cvt_pk_bf16_f32 v250, v244, v245
    v_mfma_f32_16x16x32_bf16 a[16:19], v[112:115], v[96:99], a[16:19]
    buffer_load_dwordx4 v13, s[4:7], s56 offen offset:1024  lds
    v_mfma_f32_16x16x32_bf16 a[20:23], v[112:115], v[100:103], a[20:23]
    ds_read_b64_tr_b16 v[168:169], v8 offset:0
    v_cvt_pk_bf16_f32 v251, v246, v247
    v_mfma_f32_16x16x32_bf16 a[24:27], v[112:115], v[104:107], a[24:27]
    buffer_store_dwordx4 v[248:251], v11, s[12:15], s59 offen offset:2048
    v_mfma_f32_16x16x32_bf16 a[28:31], v[112:115], v[108:111], a[28:31]
    s_mov_b32 s59, 4096
    v_accvgpr_read_b32 v240, a136
    v_mfma_f32_16x16x32_bf16 a[32:35], v[116:119], v[80:83], a[32:35]
    buffer_load_dwordx4 v14, s[4:7], s56 offen offset:2048  lds
    v_mfma_f32_16x16x32_bf16 a[36:39], v[116:119], v[84:87], a[36:39]
    v_accvgpr_read_b32 v241, a137
    v_accvgpr_read_b32 v242, a138
    v_mfma_f32_16x16x32_bf16 a[40:43], v[116:119], v[88:91], a[40:43]
    buffer_load_dwordx4 v15, s[4:7], s56 offen offset:3072  lds
    v_mfma_f32_16x16x32_bf16 a[44:47], v[116:119], v[92:95], a[44:47]
    s_add_u32 m0, s37, 102400
    v_accvgpr_read_b32 v243, a139
    v_accvgpr_read_b32 v244, a152
    v_mfma_f32_16x16x32_bf16 a[48:51], v[116:119], v[96:99], a[48:51]
    ds_read_b64_tr_b16 v[170:171], v8 offset:1024
    v_accvgpr_read_b32 v245, a153
    v_mfma_f32_16x16x32_bf16 a[52:55], v[116:119], v[100:103], a[52:55]
    s_add_u32 s56, s56, 131072
    v_mfma_f32_16x16x32_bf16 a[56:59], v[116:119], v[104:107], a[56:59]
    ds_read_b64_tr_b16 v[172:173], v9 offset:0
    v_accvgpr_read_b32 v246, a154
    v_mfma_f32_16x16x32_bf16 a[60:63], v[116:119], v[108:111], a[60:63]
    ds_read_b64_tr_b16 v[174:175], v9 offset:1024
    v_accvgpr_read_b32 v247, a155
    v_mfma_f32_16x16x32_bf16 a[64:67], v[120:123], v[80:83], a[64:67]
    buffer_load_dwordx4 v12, s[4:7], s56 offen offset:0  lds
    v_mfma_f32_16x16x32_bf16 a[68:71], v[120:123], v[84:87], a[68:71]
    buffer_load_dwordx4 v13, s[4:7], s56 offen offset:1024  lds
    v_mfma_f32_16x16x32_bf16 a[72:75], v[120:123], v[88:91], a[72:75]
    v_cvt_pk_bf16_f32 v248, v240, v241
    v_cvt_pk_bf16_f32 v249, v242, v243
    v_mfma_f32_16x16x32_bf16 a[76:79], v[120:123], v[92:95], a[76:79]
    buffer_load_dwordx4 v14, s[4:7], s56 offen offset:2048  lds
    v_mfma_f32_16x16x32_bf16 a[80:83], v[120:123], v[96:99], a[80:83]
    v_cvt_pk_bf16_f32 v250, v244, v245
    v_cvt_pk_bf16_f32 v251, v246, v247
    v_mfma_f32_16x16x32_bf16 a[84:87], v[120:123], v[100:103], a[84:87]
    buffer_store_dwordx4 v[248:251], v11, s[12:15], s59 offen offset:0
    v_mfma_f32_16x16x32_bf16 a[88:91], v[120:123], v[104:107], a[88:91]
    v_accvgpr_read_b32 v240, a140
    v_mfma_f32_16x16x32_bf16 a[92:95], v[120:123], v[108:111], a[92:95]
    buffer_load_dwordx4 v15, s[4:7], s56 offen offset:3072  lds
    v_mfma_f32_16x16x32_bf16 a[96:99], v[124:127], v[80:83], a[96:99]
    v_accvgpr_read_b32 v241, a141
    v_accvgpr_read_b32 v242, a142
    v_mfma_f32_16x16x32_bf16 a[100:103], v[124:127], v[84:87], a[100:103]
    v_accvgpr_read_b32 v243, a143
    v_mfma_f32_16x16x32_bf16 a[104:107], v[124:127], v[88:91], a[104:107]
    v_accvgpr_read_b32 v244, a156
    v_mfma_f32_16x16x32_bf16 a[108:111], v[124:127], v[92:95], a[108:111]
    v_accvgpr_read_b32 v245, a157
    v_mfma_f32_16x16x32_bf16 a[112:115], v[124:127], v[96:99], a[112:115]
    v_accvgpr_read_b32 v246, a158
    v_mfma_f32_16x16x32_bf16 a[116:119], v[124:127], v[100:103], a[116:119]
    v_accvgpr_read_b32 v247, a159
    v_mfma_f32_16x16x32_bf16 a[120:123], v[124:127], v[104:107], a[120:123]
    v_cvt_pk_bf16_f32 v248, v240, v241
    v_mfma_f32_16x16x32_bf16 a[124:127], v[124:127], v[108:111], a[124:127]
    s_waitcnt vmcnt(35) lgkmcnt(0)
    v_mfma_f32_16x16x32_bf16 v[16:19], v[144:147], v[208:211], 0
    v_cvt_pk_bf16_f32 v249, v242, v243
    v_mfma_f32_16x16x32_bf16 v[48:51], v[144:147], v[212:215], 0
    buffer_load_dwordx4 a[128:131], v255, s[8:11], s26 offen offset:0 sc1
    v_mfma_f32_16x16x32_bf16 v[80:83], v[144:147], v[216:219], 0
    v_cvt_pk_bf16_f32 v250, v244, v245
    v_cvt_pk_bf16_f32 v251, v246, v247
    v_mfma_f32_16x16x32_bf16 v[112:115], v[144:147], v[220:223], 0
    ds_read_b64_tr_b16 v[144:145], v2 offset:8192
    v_mfma_f32_16x16x32_bf16 v[20:23], v[148:151], v[208:211], 0
    ds_read_b64_tr_b16 v[146:147], v2 offset:9216
    v_mfma_f32_16x16x32_bf16 v[52:55], v[148:151], v[212:215], 0
    buffer_store_dwordx4 v[248:251], v11, s[12:15], s59 offen offset:2048
    v_mfma_f32_16x16x32_bf16 v[84:87], v[148:151], v[216:219], 0
    s_mov_b32 s59, 0
    v_accvgpr_read_b32 v240, a160
    v_accvgpr_read_b32 v241, a161
    v_mfma_f32_16x16x32_bf16 v[116:119], v[148:151], v[220:223], 0
    ds_read_b64_tr_b16 v[148:149], v3 offset:8192
    v_accvgpr_read_b32 v242, a162
    v_mfma_f32_16x16x32_bf16 v[24:27], v[152:155], v[208:211], 0
    ds_read_b64_tr_b16 v[150:151], v3 offset:9216
    v_accvgpr_read_b32 v243, a163
    v_mfma_f32_16x16x32_bf16 v[56:59], v[152:155], v[212:215], 0
    buffer_load_dwordx4 a[144:147], v255, s[8:11], s26 offen offset:1024 sc1
    v_mfma_f32_16x16x32_bf16 v[88:91], v[152:155], v[216:219], 0
    v_accvgpr_read_b32 v244, a176
    v_mfma_f32_16x16x32_bf16 v[120:123], v[152:155], v[220:223], 0
    ds_read_b64_tr_b16 v[152:153], v4 offset:8192
    v_accvgpr_read_b32 v245, a177
    v_mfma_f32_16x16x32_bf16 v[28:31], v[156:159], v[208:211], 0
    buffer_load_dwordx4 a[132:135], v255, s[8:11], s26 offen offset:2048 sc1
    v_mfma_f32_16x16x32_bf16 v[60:63], v[156:159], v[212:215], 0
    ds_read_b64_tr_b16 v[154:155], v4 offset:9216
    v_accvgpr_read_b32 v246, a178
    v_mfma_f32_16x16x32_bf16 v[92:95], v[156:159], v[216:219], 0
    v_accvgpr_read_b32 v247, a179
    v_cvt_pk_bf16_f32 v248, v240, v241
    v_mfma_f32_16x16x32_bf16 v[124:127], v[156:159], v[220:223], 0
    buffer_load_dwordx4 a[148:151], v255, s[8:11], s26 offen offset:3072 sc1
    v_mfma_f32_16x16x32_bf16 v[32:35], v[160:163], v[208:211], 0
    ds_read_b64_tr_b16 v[156:157], v5 offset:8192
    v_cvt_pk_bf16_f32 v249, v242, v243
    v_mfma_f32_16x16x32_bf16 v[64:67], v[160:163], v[212:215], 0
    ds_read_b64_tr_b16 v[158:159], v5 offset:9216
    v_cvt_pk_bf16_f32 v250, v244, v245
    v_mfma_f32_16x16x32_bf16 v[96:99], v[160:163], v[216:219], 0
    s_add_u32 s26, s26, 4096
    v_cvt_pk_bf16_f32 v251, v246, v247
    v_mfma_f32_16x16x32_bf16 v[128:131], v[160:163], v[220:223], 0
    ds_read_b64_tr_b16 v[160:161], v6 offset:8192
    v_mfma_f32_16x16x32_bf16 v[36:39], v[164:167], v[208:211], 0
    ds_read_b64_tr_b16 v[162:163], v6 offset:9216
    v_mfma_f32_16x16x32_bf16 v[68:71], v[164:167], v[212:215], 0
    s_and_b32 s26, s26, 0xffff
    v_mfma_f32_16x16x32_bf16 v[100:103], v[164:167], v[216:219], 0
    buffer_store_dwordx4 v[248:251], v11, s[12:15], s59 offen offset:1024
    v_accvgpr_read_b32 v240, a164
    v_mfma_f32_16x16x32_bf16 v[132:135], v[164:167], v[220:223], 0
    ds_read_b64_tr_b16 v[164:165], v7 offset:8192
    v_accvgpr_read_b32 v241, a165
    v_mfma_f32_16x16x32_bf16 v[40:43], v[168:171], v[208:211], 0
    ds_read_b64_tr_b16 v[166:167], v7 offset:9216
    v_accvgpr_read_b32 v242, a166
    v_mfma_f32_16x16x32_bf16 v[72:75], v[168:171], v[212:215], 0
    v_accvgpr_read_b32 v243, a167
    v_accvgpr_read_b32 v244, a180
    v_mfma_f32_16x16x32_bf16 v[104:107], v[168:171], v[216:219], 0
    v_accvgpr_read_b32 v245, a181
    v_accvgpr_read_b32 v246, a182
    v_mfma_f32_16x16x32_bf16 v[136:139], v[168:171], v[220:223], 0
    ds_read_b64_tr_b16 v[168:169], v8 offset:8192
    v_mfma_f32_16x16x32_bf16 v[44:47], v[172:175], v[208:211], 0
    ds_read_b64_tr_b16 v[170:171], v8 offset:9216
    v_accvgpr_read_b32 v247, a183
    v_mfma_f32_16x16x32_bf16 v[76:79], v[172:175], v[212:215], 0
    buffer_load_dwordx4 a[136:139], v255, s[8:11], s26 offen offset:0 sc1
    v_mfma_f32_16x16x32_bf16 v[108:111], v[172:175], v[216:219], 0
    buffer_load_dwordx4 a[152:155], v255, s[8:11], s26 offen offset:1024 sc1
    v_mfma_f32_16x16x32_bf16 v[140:143], v[172:175], v[220:223], 0
    ds_read_b64_tr_b16 v[172:173], v9 offset:8192
    ds_read_b64_tr_b16 v[174:175], v9 offset:9216
    s_waitcnt vmcnt(39) lgkmcnt(12)
    v_mfma_f32_16x16x32_bf16 v[16:19], v[144:147], v[224:227], v[16:19]
    v_cvt_pk_bf16_f32 v248, v240, v241
    v_cvt_pk_bf16_f32 v249, v242, v243
    v_mfma_f32_16x16x32_bf16 v[48:51], v[144:147], v[228:231], v[48:51]
    buffer_load_dwordx4 a[140:143], v255, s[8:11], s26 offen offset:2048 sc1
    v_mfma_f32_16x16x32_bf16 v[80:83], v[144:147], v[232:235], v[80:83]
    v_cvt_pk_bf16_f32 v250, v244, v245
    v_cvt_pk_bf16_f32 v251, v246, v247
    v_mfma_f32_16x16x32_bf16 v[112:115], v[144:147], v[236:239], v[112:115]
    ds_read_b64_tr_b16 v[144:145], v2 offset:16384
    v_mfma_f32_16x16x32_bf16 v[20:23], v[148:151], v[224:227], v[20:23]
    ds_read_b64_tr_b16 v[146:147], v2 offset:17408
    v_mfma_f32_16x16x32_bf16 v[52:55], v[148:151], v[228:231], v[52:55]
    buffer_store_dwordx4 v[248:251], v11, s[12:15], s59 offen offset:3072
    s_mov_b32 s59, 4096
    v_accvgpr_read_b32 v240, a168
    v_mfma_f32_16x16x32_bf16 v[84:87], v[148:151], v[232:235], v[84:87]
    buffer_load_dwordx4 a[156:159], v255, s[8:11], s26 offen offset:3072 sc1
    v_accvgpr_read_b32 v241, a169
    v_mfma_f32_16x16x32_bf16 v[116:119], v[148:151], v[236:239], v[116:119]
    ds_read_b64_tr_b16 v[148:149], v3 offset:16384
    s_waitcnt lgkmcnt(11)
    v_mfma_f32_16x16x32_bf16 v[24:27], v[152:155], v[224:227], v[24:27]
    ds_read_b64_tr_b16 v[150:151], v3 offset:17408
    v_accvgpr_read_b32 v242, a170
    v_mfma_f32_16x16x32_bf16 v[56:59], v[152:155], v[228:231], v[56:59]
    s_add_u32 s26, s26, 4096
    v_accvgpr_read_b32 v243, a171
    v_accvgpr_read_b32 v244, a184
    v_mfma_f32_16x16x32_bf16 v[88:91], v[152:155], v[232:235], v[88:91]
    s_and_b32 s26, s26, 0xffff
    v_accvgpr_read_b32 v245, a185
    v_accvgpr_read_b32 v246, a186
    v_mfma_f32_16x16x32_bf16 v[120:123], v[152:155], v[236:239], v[120:123]
    ds_read_b64_tr_b16 v[152:153], v4 offset:16384
    v_accvgpr_read_b32 v247, a187
    v_mfma_f32_16x16x32_bf16 v[28:31], v[156:159], v[224:227], v[28:31]
    ds_read_b64_tr_b16 v[154:155], v4 offset:17408
    v_cvt_pk_bf16_f32 v248, v240, v241
    v_mfma_f32_16x16x32_bf16 v[60:63], v[156:159], v[228:231], v[60:63]
    v_cvt_pk_bf16_f32 v249, v242, v243
    v_mfma_f32_16x16x32_bf16 v[92:95], v[156:159], v[232:235], v[92:95]
    v_mfma_f32_16x16x32_bf16 v[124:127], v[156:159], v[236:239], v[124:127]
    ds_read_b64_tr_b16 v[156:157], v5 offset:16384
    s_waitcnt lgkmcnt(11)
    v_mfma_f32_16x16x32_bf16 v[32:35], v[160:163], v[224:227], v[32:35]
    ds_read_b64_tr_b16 v[158:159], v5 offset:17408
    v_cvt_pk_bf16_f32 v250, v244, v245
    v_mfma_f32_16x16x32_bf16 v[64:67], v[160:163], v[228:231], v[64:67]
    v_cvt_pk_bf16_f32 v251, v246, v247
    v_mfma_f32_16x16x32_bf16 v[96:99], v[160:163], v[232:235], v[96:99]
    buffer_store_dwordx4 v[248:251], v11, s[12:15], s59 offen offset:1024
    v_mfma_f32_16x16x32_bf16 v[128:131], v[160:163], v[236:239], v[128:131]
    ds_read_b64_tr_b16 v[160:161], v6 offset:16384
    v_accvgpr_read_b32 v240, a172
    v_mfma_f32_16x16x32_bf16 v[36:39], v[164:167], v[224:227], v[36:39]
    ds_read_b64_tr_b16 v[162:163], v6 offset:17408
    v_accvgpr_read_b32 v241, a173
    v_mfma_f32_16x16x32_bf16 v[68:71], v[164:167], v[228:231], v[68:71]
    buffer_load_dwordx4 v[208:211], v255, s[8:11], s26 offen offset:0 sc1
    v_mfma_f32_16x16x32_bf16 v[100:103], v[164:167], v[232:235], v[100:103]
    v_accvgpr_read_b32 v242, a174
    v_accvgpr_read_b32 v243, a175
    v_mfma_f32_16x16x32_bf16 v[132:135], v[164:167], v[236:239], v[132:135]
    ds_read_b64_tr_b16 v[164:165], v7 offset:16384
    s_waitcnt lgkmcnt(11)
    v_mfma_f32_16x16x32_bf16 v[40:43], v[168:171], v[224:227], v[40:43]
    buffer_load_dwordx4 v[212:215], v255, s[8:11], s26 offen offset:1024 sc1
    v_accvgpr_read_b32 v244, a188
    v_mfma_f32_16x16x32_bf16 v[72:75], v[168:171], v[228:231], v[72:75]
    ds_read_b64_tr_b16 v[166:167], v7 offset:17408
    v_accvgpr_read_b32 v245, a189
    v_mfma_f32_16x16x32_bf16 v[104:107], v[168:171], v[232:235], v[104:107]
    v_accvgpr_read_b32 v246, a190
    v_accvgpr_read_b32 v247, a191
    v_mfma_f32_16x16x32_bf16 v[136:139], v[168:171], v[236:239], v[136:139]
    buffer_load_dwordx4 v[216:219], v255, s[8:11], s26 offen offset:2048 sc1
    v_mfma_f32_16x16x32_bf16 v[44:47], v[172:175], v[224:227], v[44:47]
    ds_read_b64_tr_b16 v[168:169], v8 offset:16384
    v_cvt_pk_bf16_f32 v248, v240, v241
    v_mfma_f32_16x16x32_bf16 v[76:79], v[172:175], v[228:231], v[76:79]
    ds_read_b64_tr_b16 v[170:171], v8 offset:17408
    v_cvt_pk_bf16_f32 v249, v242, v243
    v_mfma_f32_16x16x32_bf16 v[108:111], v[172:175], v[232:235], v[108:111]
    buffer_load_dwordx4 v[220:223], v255, s[8:11], s26 offen offset:3072 sc1
    v_mfma_f32_16x16x32_bf16 v[140:143], v[172:175], v[236:239], v[140:143]
    ds_read_b64_tr_b16 v[172:173], v9 offset:16384
    ds_read_b64_tr_b16 v[174:175], v9 offset:17408
    s_waitcnt vmcnt(39) lgkmcnt(12)
    v_mfma_f32_16x16x32_bf16 v[16:19], v[144:147], v[176:179], v[16:19]
    s_add_u32 s26, s26, 4096
    v_cvt_pk_bf16_f32 v250, v244, v245
    v_cvt_pk_bf16_f32 v251, v246, v247
    v_mfma_f32_16x16x32_bf16 v[48:51], v[144:147], v[180:183], v[48:51]
    buffer_store_dwordx4 v[248:251], v11, s[12:15], s59 offen offset:3072
    v_mfma_f32_16x16x32_bf16 v[80:83], v[144:147], v[184:187], v[80:83]
    s_mov_b32 s59, 32768
    v_accvgpr_read_b32 v240, a192
    v_mfma_f32_16x16x32_bf16 v[112:115], v[144:147], v[188:191], v[112:115]
    ds_read_b64_tr_b16 v[144:145], v2 offset:24576
    v_accvgpr_read_b32 v241, a193
    v_mfma_f32_16x16x32_bf16 v[20:23], v[148:151], v[176:179], v[20:23]
    s_and_b32 s26, s26, 0xffff
    v_accvgpr_read_b32 v242, a194
    v_mfma_f32_16x16x32_bf16 v[52:55], v[148:151], v[180:183], v[52:55]
    ds_read_b64_tr_b16 v[146:147], v2 offset:25600
    v_accvgpr_read_b32 v243, a195
    v_mfma_f32_16x16x32_bf16 v[84:87], v[148:151], v[184:187], v[84:87]
    v_accvgpr_read_b32 v244, a208
    v_mfma_f32_16x16x32_bf16 v[116:119], v[148:151], v[188:191], v[116:119]
    ds_read_b64_tr_b16 v[148:149], v3 offset:24576
    s_waitcnt lgkmcnt(11)
    v_mfma_f32_16x16x32_bf16 v[24:27], v[152:155], v[176:179], v[24:27]
    ds_read_b64_tr_b16 v[150:151], v3 offset:25600
    v_accvgpr_read_b32 v245, a209
    v_mfma_f32_16x16x32_bf16 v[56:59], v[152:155], v[180:183], v[56:59]
    v_accvgpr_read_b32 v246, a210
    v_accvgpr_read_b32 v247, a211
    v_mfma_f32_16x16x32_bf16 v[88:91], v[152:155], v[184:187], v[88:91]
    buffer_load_dwordx4 a[160:163], v255, s[8:11], s26 offen offset:0 sc1
    v_mfma_f32_16x16x32_bf16 v[120:123], v[152:155], v[188:191], v[120:123]
    ds_read_b64_tr_b16 v[152:153], v4 offset:24576
    v_cvt_pk_bf16_f32 v248, v240, v241
    v_mfma_f32_16x16x32_bf16 v[28:31], v[156:159], v[176:179], v[28:31]
    ds_read_b64_tr_b16 v[154:155], v4 offset:25600
    v_cvt_pk_bf16_f32 v249, v242, v243
    v_mfma_f32_16x16x32_bf16 v[60:63], v[156:159], v[180:183], v[60:63]
    buffer_load_dwordx4 a[176:179], v255, s[8:11], s26 offen offset:1024 sc1
    v_mfma_f32_16x16x32_bf16 v[92:95], v[156:159], v[184:187], v[92:95]
    v_cvt_pk_bf16_f32 v250, v244, v245
    v_cvt_pk_bf16_f32 v251, v246, v247
    v_mfma_f32_16x16x32_bf16 v[124:127], v[156:159], v[188:191], v[124:127]
    ds_read_b64_tr_b16 v[156:157], v5 offset:24576
    s_waitcnt lgkmcnt(11)
    v_mfma_f32_16x16x32_bf16 v[32:35], v[160:163], v[176:179], v[32:35]
    ds_read_b64_tr_b16 v[158:159], v5 offset:25600
    v_mfma_f32_16x16x32_bf16 v[64:67], v[160:163], v[180:183], v[64:67]
    buffer_store_dwordx4 v[248:251], v11, s[12:15], s59 offen offset:0
    v_mfma_f32_16x16x32_bf16 v[96:99], v[160:163], v[184:187], v[96:99]
    v_accvgpr_read_b32 v240, a196
    v_accvgpr_read_b32 v241, a197
    v_mfma_f32_16x16x32_bf16 v[128:131], v[160:163], v[188:191], v[128:131]
    buffer_load_dwordx4 a[164:167], v255, s[8:11], s26 offen offset:2048 sc1
    v_mfma_f32_16x16x32_bf16 v[36:39], v[164:167], v[176:179], v[36:39]
    ds_read_b64_tr_b16 v[160:161], v6 offset:24576
    v_accvgpr_read_b32 v242, a198
    v_mfma_f32_16x16x32_bf16 v[68:71], v[164:167], v[180:183], v[68:71]
    ds_read_b64_tr_b16 v[162:163], v6 offset:25600
    v_accvgpr_read_b32 v243, a199
    v_mfma_f32_16x16x32_bf16 v[100:103], v[164:167], v[184:187], v[100:103]
    buffer_load_dwordx4 a[180:183], v255, s[8:11], s26 offen offset:3072 sc1
    v_mfma_f32_16x16x32_bf16 v[132:135], v[164:167], v[188:191], v[132:135]
    ds_read_b64_tr_b16 v[164:165], v7 offset:24576
    s_waitcnt lgkmcnt(11)
    v_accvgpr_read_b32 v244, a212
    v_mfma_f32_16x16x32_bf16 v[40:43], v[168:171], v[176:179], v[40:43]
    ds_read_b64_tr_b16 v[166:167], v7 offset:25600
    v_accvgpr_read_b32 v245, a213
    v_mfma_f32_16x16x32_bf16 v[72:75], v[168:171], v[180:183], v[72:75]
    s_add_u32 s26, s26, 4096
    v_accvgpr_read_b32 v246, a214
    v_accvgpr_read_b32 v247, a215
    v_mfma_f32_16x16x32_bf16 v[104:107], v[168:171], v[184:187], v[104:107]
    s_and_b32 s26, s26, 0xffff
    v_cvt_pk_bf16_f32 v248, v240, v241
    v_cvt_pk_bf16_f32 v249, v242, v243
    v_mfma_f32_16x16x32_bf16 v[136:139], v[168:171], v[188:191], v[136:139]
    ds_read_b64_tr_b16 v[168:169], v8 offset:24576
    v_cvt_pk_bf16_f32 v250, v244, v245
    v_mfma_f32_16x16x32_bf16 v[44:47], v[172:175], v[176:179], v[44:47]
    ds_read_b64_tr_b16 v[170:171], v8 offset:25600
    v_mfma_f32_16x16x32_bf16 v[76:79], v[172:175], v[180:183], v[76:79]
    v_cvt_pk_bf16_f32 v251, v246, v247
    v_mfma_f32_16x16x32_bf16 v[108:111], v[172:175], v[184:187], v[108:111]
    buffer_store_dwordx4 v[248:251], v11, s[12:15], s59 offen offset:2048
    v_mfma_f32_16x16x32_bf16 v[140:143], v[172:175], v[188:191], v[140:143]
    ds_read_b64_tr_b16 v[172:173], v9 offset:24576
    ds_read_b64_tr_b16 v[174:175], v9 offset:25600
    s_waitcnt vmcnt(42) lgkmcnt(12)
    v_mfma_f32_16x16x32_bf16 v[16:19], v[144:147], v[192:195], v[16:19]
    s_mov_b32 s59, 36864
    v_accvgpr_read_b32 v240, a200
    v_mfma_f32_16x16x32_bf16 v[48:51], v[144:147], v[196:199], v[48:51]
    v_accvgpr_read_b32 v241, a201
    v_mfma_f32_16x16x32_bf16 v[80:83], v[144:147], v[200:203], v[80:83]
    v_accvgpr_read_b32 v242, a202
    v_mfma_f32_16x16x32_bf16 v[112:115], v[144:147], v[204:207], v[112:115]
    ds_read_b64_tr_b16 v[144:145], v2 offset:32768
    v_accvgpr_read_b32 v243, a203
    v_mfma_f32_16x16x32_bf16 v[20:23], v[148:151], v[192:195], v[20:23]
    buffer_load_dwordx4 v[224:227], v255, s[8:11], s26 offen offset:0 sc1
    v_mfma_f32_16x16x32_bf16 v[52:55], v[148:151], v[196:199], v[52:55]
    ds_read_b64_tr_b16 v[146:147], v2 offset:33792
    v_accvgpr_read_b32 v244, a216
    v_mfma_f32_16x16x32_bf16 v[84:87], v[148:151], v[200:203], v[84:87]
    v_accvgpr_read_b32 v245, a217
    v_mfma_f32_16x16x32_bf16 v[116:119], v[148:151], v[204:207], v[116:119]
    ds_read_b64_tr_b16 v[148:149], v3 offset:32768
    s_waitcnt lgkmcnt(11)
    buffer_load_dwordx4 v[228:231], v255, s[8:11], s26 offen offset:1024 sc1
    v_mfma_f32_16x16x32_bf16 v[24:27], v[152:155], v[192:195], v[24:27]
    ds_read_b64_tr_b16 v[150:151], v3 offset:33792
    v_accvgpr_read_b32 v246, a218
    v_mfma_f32_16x16x32_bf16 v[56:59], v[152:155], v[196:199], v[56:59]
    v_accvgpr_read_b32 v247, a219
    v_cvt_pk_bf16_f32 v248, v240, v241
    v_mfma_f32_16x16x32_bf16 v[88:91], v[152:155], v[200:203], v[88:91]
    buffer_load_dwordx4 v[232:235], v255, s[8:11], s26 offen offset:2048 sc1
    v_mfma_f32_16x16x32_bf16 v[120:123], v[152:155], v[204:207], v[120:123]
    ds_read_b64_tr_b16 v[152:153], v4 offset:32768
    v_cvt_pk_bf16_f32 v249, v242, v243
    v_mfma_f32_16x16x32_bf16 v[28:31], v[156:159], v[192:195], v[28:31]
    ds_read_b64_tr_b16 v[154:155], v4 offset:33792
    v_cvt_pk_bf16_f32 v250, v244, v245
    v_mfma_f32_16x16x32_bf16 v[60:63], v[156:159], v[196:199], v[60:63]
    buffer_load_dwordx4 v[236:239], v255, s[8:11], s26 offen offset:3072 sc1
    v_mfma_f32_16x16x32_bf16 v[92:95], v[156:159], v[200:203], v[92:95]
    s_add_u32 s26, s26, 4096
    v_cvt_pk_bf16_f32 v251, v246, v247
    v_mfma_f32_16x16x32_bf16 v[124:127], v[156:159], v[204:207], v[124:127]
    ds_read_b64_tr_b16 v[156:157], v5 offset:32768
    s_waitcnt lgkmcnt(11)
    v_mfma_f32_16x16x32_bf16 v[32:35], v[160:163], v[192:195], v[32:35]
    buffer_store_dwordx4 v[248:251], v11, s[12:15], s59 offen offset:0
    v_accvgpr_read_b32 v240, a204
    v_mfma_f32_16x16x32_bf16 v[64:67], v[160:163], v[196:199], v[64:67]
    ds_read_b64_tr_b16 v[158:159], v5 offset:33792
    v_accvgpr_read_b32 v241, a205
    v_mfma_f32_16x16x32_bf16 v[96:99], v[160:163], v[200:203], v[96:99]
    s_and_b32 s26, s26, 0xffff
    v_accvgpr_read_b32 v242, a206
    v_accvgpr_read_b32 v243, a207
    v_mfma_f32_16x16x32_bf16 v[128:131], v[160:163], v[204:207], v[128:131]
    ds_read_b64_tr_b16 v[160:161], v6 offset:32768
    v_accvgpr_read_b32 v244, a220
    v_mfma_f32_16x16x32_bf16 v[36:39], v[164:167], v[192:195], v[36:39]
    ds_read_b64_tr_b16 v[162:163], v6 offset:33792
    v_accvgpr_read_b32 v245, a221
    v_mfma_f32_16x16x32_bf16 v[68:71], v[164:167], v[196:199], v[68:71]
    v_accvgpr_read_b32 v246, a222
    v_mfma_f32_16x16x32_bf16 v[100:103], v[164:167], v[200:203], v[100:103]
    v_accvgpr_read_b32 v247, a223
    v_mfma_f32_16x16x32_bf16 v[132:135], v[164:167], v[204:207], v[132:135]
    ds_read_b64_tr_b16 v[164:165], v7 offset:32768
    s_waitcnt lgkmcnt(11)
    v_mfma_f32_16x16x32_bf16 v[40:43], v[168:171], v[192:195], v[40:43]
    ds_read_b64_tr_b16 v[166:167], v7 offset:33792
    v_cvt_pk_bf16_f32 v248, v240, v241
    v_mfma_f32_16x16x32_bf16 v[72:75], v[168:171], v[196:199], v[72:75]
    buffer_load_dwordx4 a[168:171], v255, s[8:11], s26 offen offset:0 sc1
    v_mfma_f32_16x16x32_bf16 v[104:107], v[168:171], v[200:203], v[104:107]
    v_cvt_pk_bf16_f32 v249, v242, v243
    v_cvt_pk_bf16_f32 v250, v244, v245
    v_mfma_f32_16x16x32_bf16 v[136:139], v[168:171], v[204:207], v[136:139]
    ds_read_b64_tr_b16 v[168:169], v8 offset:32768
    v_cvt_pk_bf16_f32 v251, v246, v247
    v_mfma_f32_16x16x32_bf16 v[44:47], v[172:175], v[192:195], v[44:47]
    ds_read_b64_tr_b16 v[170:171], v8 offset:33792
    v_mfma_f32_16x16x32_bf16 v[76:79], v[172:175], v[196:199], v[76:79]
    buffer_load_dwordx4 a[184:187], v255, s[8:11], s26 offen offset:1024 sc1
    v_mfma_f32_16x16x32_bf16 v[108:111], v[172:175], v[200:203], v[108:111]
    buffer_store_dwordx4 v[248:251], v11, s[12:15], s59 offen offset:2048
    v_mfma_f32_16x16x32_bf16 v[140:143], v[172:175], v[204:207], v[140:143]
    ds_read_b64_tr_b16 v[172:173], v9 offset:32768
    ds_read_b64_tr_b16 v[174:175], v9 offset:33792
    s_waitcnt vmcnt(26) lgkmcnt(12)
    v_mfma_f32_16x16x32_bf16 v[16:19], v[144:147], a[128:131], v[16:19]
    s_mov_b32 s59, 32768
    v_accvgpr_read_b32 v240, a224
    v_accvgpr_read_b32 v241, a225
    v_mfma_f32_16x16x32_bf16 v[48:51], v[144:147], a[144:147], v[48:51]
    s_lshl_b32 s39, s24, 8
    v_accvgpr_read_b32 v242, a226
    v_accvgpr_read_b32 v243, a227
    v_mfma_f32_16x16x32_bf16 v[80:83], v[144:147], a[132:135], v[80:83]
    buffer_load_dwordx4 a[172:175], v255, s[8:11], s26 offen offset:2048 sc1
    v_mfma_f32_16x16x32_bf16 v[112:115], v[144:147], a[148:151], v[112:115]
    ds_read_b64_tr_b16 v[144:145], v2 offset:40960
    v_accvgpr_read_b32 v244, a240
    v_mfma_f32_16x16x32_bf16 v[20:23], v[148:151], a[128:131], v[20:23]
    ds_read_b64_tr_b16 v[146:147], v2 offset:41984
    v_accvgpr_read_b32 v245, a241
    v_mfma_f32_16x16x32_bf16 v[52:55], v[148:151], a[144:147], v[52:55]
    buffer_load_dwordx4 a[188:191], v255, s[8:11], s26 offen offset:3072 sc1
    v_mfma_f32_16x16x32_bf16 v[84:87], v[148:151], a[132:135], v[84:87]
    s_add_u32 s26, s26, 4096
    v_accvgpr_read_b32 v246, a242
    v_accvgpr_read_b32 v247, a243
    v_mfma_f32_16x16x32_bf16 v[116:119], v[148:151], a[148:151], v[116:119]
    ds_read_b64_tr_b16 v[148:149], v3 offset:40960
    s_waitcnt lgkmcnt(11)
    v_mfma_f32_16x16x32_bf16 v[24:27], v[152:155], a[128:131], v[24:27]
    ds_read_b64_tr_b16 v[150:151], v3 offset:41984
    v_cvt_pk_bf16_f32 v248, v240, v241
    v_mfma_f32_16x16x32_bf16 v[56:59], v[152:155], a[144:147], v[56:59]
    s_lshl_b32 s50, s25, 2
    v_cvt_pk_bf16_f32 v249, v242, v243
    v_cvt_pk_bf16_f32 v250, v244, v245
    v_mfma_f32_16x16x32_bf16 v[88:91], v[152:155], a[132:135], v[88:91]
    s_and_b32 s26, s26, 0xffff
    v_cvt_pk_bf16_f32 v251, v246, v247
    v_mfma_f32_16x16x32_bf16 v[120:123], v[152:155], a[148:151], v[120:123]
    ds_read_b64_tr_b16 v[152:153], v4 offset:40960
    v_mfma_f32_16x16x32_bf16 v[28:31], v[156:159], a[128:131], v[28:31]
    ds_read_b64_tr_b16 v[154:155], v4 offset:41984
    v_mfma_f32_16x16x32_bf16 v[60:63], v[156:159], a[144:147], v[60:63]
    s_add_u32 s50, s50, s39
    v_mfma_f32_16x16x32_bf16 v[92:95], v[156:159], a[132:135], v[92:95]
    buffer_store_dwordx4 v[248:251], v11, s[12:15], s59 offen offset:1024
    v_mfma_f32_16x16x32_bf16 v[124:127], v[156:159], a[148:151], v[124:127]
    ds_read_b64_tr_b16 v[156:157], v5 offset:40960
    s_waitcnt lgkmcnt(11)
    s_add_u32 s50, s50, 8192
    v_accvgpr_read_b32 v240, a228
    v_mfma_f32_16x16x32_bf16 v[32:35], v[160:163], a[128:131], v[32:35]
    ds_read_b64_tr_b16 v[158:159], v5 offset:41984
    v_accvgpr_read_b32 v241, a229
    v_mfma_f32_16x16x32_bf16 v[64:67], v[160:163], a[144:147], v[64:67]
    v_accvgpr_read_b32 v242, a230
    v_accvgpr_read_b32 v243, a231
    v_mfma_f32_16x16x32_bf16 v[96:99], v[160:163], a[132:135], v[96:99]
    v_min_u32 v13, 1, v0
    v_accvgpr_read_b32 v244, a244
    v_mfma_f32_16x16x32_bf16 v[128:131], v[160:163], a[148:151], v[128:131]
    ds_read_b64_tr_b16 v[160:161], v6 offset:40960
    v_accvgpr_read_b32 v245, a245
    v_mfma_f32_16x16x32_bf16 v[36:39], v[164:167], a[128:131], v[36:39]
    buffer_load_dwordx4 v[176:179], v255, s[8:11], s26 offen offset:0 sc1
    v_lshlrev_b32 v13, 28, v13
    v_mfma_f32_16x16x32_bf16 v[68:71], v[164:167], a[144:147], v[68:71]
    ds_read_b64_tr_b16 v[162:163], v6 offset:41984
    v_accvgpr_read_b32 v246, a246
    v_mfma_f32_16x16x32_bf16 v[100:103], v[164:167], a[132:135], v[100:103]
    v_accvgpr_read_b32 v247, a247
    v_add_u32 v12, s50, v13
    v_mfma_f32_16x16x32_bf16 v[132:135], v[164:167], a[148:151], v[132:135]
    ds_read_b64_tr_b16 v[164:165], v7 offset:40960
    s_waitcnt lgkmcnt(11)
    buffer_load_dwordx4 v[180:183], v255, s[8:11], s26 offen offset:1024 sc1
    v_mfma_f32_16x16x32_bf16 v[40:43], v[168:171], a[128:131], v[40:43]
    ds_read_b64_tr_b16 v[166:167], v7 offset:41984
    v_mov_b32 v254, 1
    v_mfma_f32_16x16x32_bf16 v[72:75], v[168:171], a[144:147], v[72:75]
    buffer_load_dwordx4 v[184:187], v255, s[8:11], s26 offen offset:2048 sc1
    v_mfma_f32_16x16x32_bf16 v[104:107], v[168:171], a[132:135], v[104:107]
    s_add_u32 s39, s39, 81920
    v_cvt_pk_bf16_f32 v248, v240, v241
    v_cvt_pk_bf16_f32 v249, v242, v243
    v_mfma_f32_16x16x32_bf16 v[136:139], v[168:171], a[148:151], v[136:139]
    ds_read_b64_tr_b16 v[168:169], v8 offset:40960
    v_cvt_pk_bf16_f32 v250, v244, v245
    v_mfma_f32_16x16x32_bf16 v[44:47], v[172:175], a[128:131], v[44:47]
    ds_read_b64_tr_b16 v[170:171], v8 offset:41984
    v_cvt_pk_bf16_f32 v251, v246, v247
    v_mfma_f32_16x16x32_bf16 v[76:79], v[172:175], a[144:147], v[76:79]
    buffer_load_dwordx4 v[188:191], v255, s[8:11], s26 offen offset:3072 sc1
    v_mfma_f32_16x16x32_bf16 v[108:111], v[172:175], a[132:135], v[108:111]
    buffer_store_dwordx4 v[248:251], v11, s[12:15], s59 offen offset:3072
    s_mov_b32 s59, 36864
    v_accvgpr_read_b32 v240, a232
    v_bfe_u32 v252, v1, 4, 3
    v_mfma_f32_16x16x32_bf16 v[140:143], v[172:175], a[148:151], v[140:143]
    ds_read_b64_tr_b16 v[172:173], v9 offset:40960
    ds_read_b64_tr_b16 v[174:175], v9 offset:41984
    s_waitcnt vmcnt(28) lgkmcnt(12)
    v_accvgpr_read_b32 v241, a233
    v_mfma_f32_16x16x32_bf16 v[16:19], v[144:147], a[136:139], v[16:19]
    s_add_u32 s26, s26, 4096
    v_accvgpr_read_b32 v242, a234
    v_cmp_eq_u32 vcc, s25, v252
    v_mfma_f32_16x16x32_bf16 v[48:51], v[144:147], a[152:155], v[48:51]
    s_and_b32 s26, s26, 0xffff
    v_accvgpr_read_b32 v243, a235
    v_accvgpr_read_b32 v244, a248
    v_mfma_f32_16x16x32_bf16 v[80:83], v[144:147], a[140:143], v[80:83]
    v_xor_b32 v253, 1, v252
    v_accvgpr_read_b32 v245, a249
    v_mfma_f32_16x16x32_bf16 v[112:115], v[144:147], a[156:159], v[112:115]
    ds_read_b64_tr_b16 v[144:145], v2 offset:49152
    v_accvgpr_read_b32 v246, a250
    v_mfma_f32_16x16x32_bf16 v[20:23], v[148:151], a[136:139], v[20:23]
    ds_read_b64_tr_b16 v[146:147], v2 offset:50176
    v_accvgpr_read_b32 v247, a251
    v_mfma_f32_16x16x32_bf16 v[52:55], v[148:151], a[152:155], v[52:55]
    v_cndmask_b32 v252, v252, v253, vcc
    v_lshl_add_u32 v253, v252, 2, s39
    v_mfma_f32_16x16x32_bf16 v[84:87], v[148:151], a[140:143], v[84:87]
    s_cmp_eq_u32 s25, 0
    s_cselect_b32 s50, 7, 0
    v_cvt_pk_bf16_f32 v248, v240, v241
    v_mfma_f32_16x16x32_bf16 v[116:119], v[148:151], a[156:159], v[116:119]
    ds_read_b64_tr_b16 v[148:149], v3 offset:49152
    s_waitcnt lgkmcnt(11)
    v_mfma_f32_16x16x32_bf16 v[24:27], v[152:155], a[136:139], v[24:27]
    ds_read_b64_tr_b16 v[150:151], v3 offset:50176
    v_cvt_pk_bf16_f32 v249, v242, v243
    v_mfma_f32_16x16x32_bf16 v[56:59], v[152:155], a[152:155], v[56:59]
    buffer_load_dwordx4 a[192:195], v255, s[8:11], s26 offen offset:0 sc1
    v_mfma_f32_16x16x32_bf16 v[88:91], v[152:155], a[140:143], v[88:91]
    v_cvt_pk_bf16_f32 v250, v244, v245
    v_cvt_pk_bf16_f32 v251, v246, v247
    v_mfma_f32_16x16x32_bf16 v[120:123], v[152:155], a[156:159], v[120:123]
    ds_read_b64_tr_b16 v[152:153], v4 offset:49152
    v_mov_b32 v252, s50
    v_mfma_f32_16x16x32_bf16 v[28:31], v[156:159], a[136:139], v[28:31]
    ds_read_b64_tr_b16 v[154:155], v4 offset:50176
    v_lshl_add_u32 v252, v252, 2, s39
    v_mfma_f32_16x16x32_bf16 v[60:63], v[156:159], a[152:155], v[60:63]
    buffer_store_dwordx4 v[248:251], v11, s[12:15], s59 offen offset:1024
    v_accvgpr_read_b32 v240, a236
    v_mfma_f32_16x16x32_bf16 v[92:95], v[156:159], a[140:143], v[92:95]
    buffer_load_dwordx4 a[208:211], v255, s[8:11], s26 offen offset:1024 sc1
    v_accvgpr_read_b32 v241, a237
    v_mfma_f32_16x16x32_bf16 v[124:127], v[156:159], a[156:159], v[124:127]
    ds_read_b64_tr_b16 v[156:157], v5 offset:49152
    s_waitcnt lgkmcnt(11)
    v_accvgpr_read_b32 v242, a238
    v_mfma_f32_16x16x32_bf16 v[32:35], v[160:163], a[136:139], v[32:35]
    ds_read_b64_tr_b16 v[158:159], v5 offset:50176
    v_accvgpr_read_b32 v243, a239
    v_mfma_f32_16x16x32_bf16 v[64:67], v[160:163], a[152:155], v[64:67]
    buffer_load_dwordx4 a[196:199], v255, s[8:11], s26 offen offset:2048 sc1
    v_accvgpr_read_b32 v244, a252
    v_mfma_f32_16x16x32_bf16 v[96:99], v[160:163], a[140:143], v[96:99]
    s_lshl_b32 s36, s3, 12
    v_accvgpr_read_b32 v245, a253
    v_accvgpr_read_b32 v246, a254
    v_mfma_f32_16x16x32_bf16 v[128:131], v[160:163], a[156:159], v[128:131]
    ds_read_b64_tr_b16 v[160:161], v6 offset:49152
    v_accvgpr_read_b32 v247, a255
    v_mfma_f32_16x16x32_bf16 v[36:39], v[164:167], a[136:139], v[36:39]
    buffer_load_dwordx4 a[212:215], v255, s[8:11], s26 offen offset:3072 sc1
    v_mfma_f32_16x16x32_bf16 v[68:71], v[164:167], a[152:155], v[68:71]
    ds_read_b64_tr_b16 v[162:163], v6 offset:50176
    s_lshl_b32 s50, s24, 20
    v_mfma_f32_16x16x32_bf16 v[100:103], v[164:167], a[140:143], v[100:103]
    s_add_u32 s26, s26, 4096
    v_and_b32 v15, 0x300, v1
    v_cvt_pk_bf16_f32 v248, v240, v241
    v_mfma_f32_16x16x32_bf16 v[132:135], v[164:167], a[156:159], v[132:135]
    ds_read_b64_tr_b16 v[164:165], v7 offset:49152
    s_waitcnt lgkmcnt(11)
    v_mfma_f32_16x16x32_bf16 v[40:43], v[168:171], a[136:139], v[40:43]
    ds_read_b64_tr_b16 v[166:167], v7 offset:50176
    v_add_u32 v15, s50, v15
    v_mfma_f32_16x16x32_bf16 v[72:75], v[168:171], a[152:155], v[72:75]
    s_and_b32 s26, s26, 0xffff
    v_cvt_pk_bf16_f32 v249, v242, v243
    v_cvt_pk_bf16_f32 v250, v244, v245
    v_mfma_f32_16x16x32_bf16 v[104:107], v[168:171], a[140:143], v[104:107]
    s_add_u32 s50, s50, s36
    v_cvt_pk_bf16_f32 v251, v246, v247
    v_add_u32 v14, s50, v1
    v_mfma_f32_16x16x32_bf16 v[136:139], v[168:171], a[156:159], v[136:139]
    ds_read_b64_tr_b16 v[168:169], v8 offset:49152
    v_mfma_f32_16x16x32_bf16 v[44:47], v[172:175], a[136:139], v[44:47]
    buffer_store_dwordx4 v[248:251], v11, s[12:15], s59 offen offset:3072
    s_mov_b32 s59, 0
    v_accvgpr_read_b32 v240, a0
    v_mfma_f32_16x16x32_bf16 v[76:79], v[172:175], a[152:155], v[76:79]
    ds_read_b64_tr_b16 v[170:171], v8 offset:50176
    v_accvgpr_read_b32 v241, a1
    v_mfma_f32_16x16x32_bf16 v[108:111], v[172:175], a[140:143], v[108:111]
    v_accvgpr_read_b32 v242, a2
    v_accvgpr_read_b32 v243, a3
    v_mfma_f32_16x16x32_bf16 v[140:143], v[172:175], a[156:159], v[140:143]
    ds_read_b64_tr_b16 v[172:173], v9 offset:49152
    ds_read_b64_tr_b16 v[174:175], v9 offset:50176
    s_waitcnt vmcnt(29) lgkmcnt(12)
    v_mfma_f32_16x16x32_bf16 v[16:19], v[144:147], v[208:211], v[16:19]
    v_accvgpr_read_b32 v244, a32
    v_accvgpr_read_b32 v245, a33
    v_mfma_f32_16x16x32_bf16 v[48:51], v[144:147], v[212:215], v[48:51]
    v_accvgpr_read_b32 v246, a34
    v_accvgpr_read_b32 v247, a35
    v_mfma_f32_16x16x32_bf16 v[80:83], v[144:147], v[216:219], v[80:83]
    buffer_load_dwordx4 a[200:203], v255, s[8:11], s26 offen offset:0 sc1
    v_mfma_f32_16x16x32_bf16 v[112:115], v[144:147], v[220:223], v[112:115]
    ds_read_b64_tr_b16 v[144:145], v2 offset:57344
    v_cvt_pk_bf16_f32 v248, v240, v241
    v_mfma_f32_16x16x32_bf16 v[20:23], v[148:151], v[208:211], v[20:23]
    ds_read_b64_tr_b16 v[146:147], v2 offset:58368
    v_cvt_pk_bf16_f32 v249, v242, v243
    v_mfma_f32_16x16x32_bf16 v[52:55], v[148:151], v[212:215], v[52:55]
    buffer_load_dwordx4 a[216:219], v255, s[8:11], s26 offen offset:1024 sc1
    v_mfma_f32_16x16x32_bf16 v[84:87], v[148:151], v[216:219], v[84:87]
    v_cvt_pk_bf16_f32 v250, v244, v245
    v_cvt_pk_bf16_f32 v251, v246, v247
    v_mfma_f32_16x16x32_bf16 v[116:119], v[148:151], v[220:223], v[116:119]
    ds_read_b64_tr_b16 v[148:149], v3 offset:57344
    s_waitcnt lgkmcnt(11)
    v_mfma_f32_16x16x32_bf16 v[24:27], v[152:155], v[208:211], v[24:27]
    buffer_store_dwordx4 v[248:251], v10, s[12:15], s59 offen offset:0 sc1
    v_accvgpr_read_b32 v240, a64
    v_mfma_f32_16x16x32_bf16 v[56:59], v[152:155], v[212:215], v[56:59]
    ds_read_b64_tr_b16 v[150:151], v3 offset:58368
    buffer_load_dwordx4 a[204:207], v255, s[8:11], s26 offen offset:2048 sc1
    v_accvgpr_read_b32 v241, a65
    v_mfma_f32_16x16x32_bf16 v[88:91], v[152:155], v[216:219], v[88:91]
    v_accvgpr_read_b32 v242, a66
    v_accvgpr_read_b32 v243, a67
    v_mfma_f32_16x16x32_bf16 v[120:123], v[152:155], v[220:223], v[120:123]
    ds_read_b64_tr_b16 v[152:153], v4 offset:57344
    v_accvgpr_read_b32 v244, a96
    v_mfma_f32_16x16x32_bf16 v[28:31], v[156:159], v[208:211], v[28:31]
    buffer_load_dwordx4 a[220:223], v255, s[8:11], s26 offen offset:3072 sc1
    v_mfma_f32_16x16x32_bf16 v[60:63], v[156:159], v[212:215], v[60:63]
    ds_read_b64_tr_b16 v[154:155], v4 offset:58368
    v_accvgpr_read_b32 v245, a97
    v_mfma_f32_16x16x32_bf16 v[92:95], v[156:159], v[216:219], v[92:95]
    s_add_u32 s26, s26, 4096
    v_accvgpr_read_b32 v246, a98
    v_accvgpr_read_b32 v247, a99
    v_mfma_f32_16x16x32_bf16 v[124:127], v[156:159], v[220:223], v[124:127]
    ds_read_b64_tr_b16 v[156:157], v5 offset:57344
    s_waitcnt lgkmcnt(11)
    v_mfma_f32_16x16x32_bf16 v[32:35], v[160:163], v[208:211], v[32:35]
    ds_read_b64_tr_b16 v[158:159], v5 offset:58368
    v_cvt_pk_bf16_f32 v248, v240, v241
    v_mfma_f32_16x16x32_bf16 v[64:67], v[160:163], v[212:215], v[64:67]
    s_and_b32 s26, s26, 0xffff
    v_cvt_pk_bf16_f32 v249, v242, v243
    v_cvt_pk_bf16_f32 v250, v244, v245
    v_mfma_f32_16x16x32_bf16 v[96:99], v[160:163], v[216:219], v[96:99]
    v_cvt_pk_bf16_f32 v251, v246, v247
    v_mfma_f32_16x16x32_bf16 v[128:131], v[160:163], v[220:223], v[128:131]
    ds_read_b64_tr_b16 v[160:161], v6 offset:57344
    v_mfma_f32_16x16x32_bf16 v[36:39], v[164:167], v[208:211], v[36:39]
    ds_read_b64_tr_b16 v[162:163], v6 offset:58368
    v_mfma_f32_16x16x32_bf16 v[68:71], v[164:167], v[212:215], v[68:71]
    buffer_store_dwordx4 v[248:251], v10, s[12:15], s59 offen offset:1024 sc1
    s_mov_b32 s59, 4096
    v_accvgpr_read_b32 v240, a4
    v_mfma_f32_16x16x32_bf16 v[100:103], v[164:167], v[216:219], v[100:103]
    v_accvgpr_read_b32 v241, a5
    v_accvgpr_read_b32 v242, a6
    v_mfma_f32_16x16x32_bf16 v[132:135], v[164:167], v[220:223], v[132:135]
    ds_read_b64_tr_b16 v[164:165], v7 offset:57344
    s_waitcnt lgkmcnt(11)
    v_mfma_f32_16x16x32_bf16 v[40:43], v[168:171], v[208:211], v[40:43]
    ds_read_b64_tr_b16 v[166:167], v7 offset:58368
    v_accvgpr_read_b32 v243, a7
    v_mfma_f32_16x16x32_bf16 v[72:75], v[168:171], v[212:215], v[72:75]
    v_accvgpr_read_b32 v244, a36
    v_accvgpr_read_b32 v245, a37
    v_mfma_f32_16x16x32_bf16 v[104:107], v[168:171], v[216:219], v[104:107]
    v_accvgpr_read_b32 v246, a38
    v_accvgpr_read_b32 v247, a39
    v_mfma_f32_16x16x32_bf16 v[136:139], v[168:171], v[220:223], v[136:139]
    buffer_load_dwordx4 v[192:195], v255, s[8:11], s26 offen offset:0 sc1
    v_mfma_f32_16x16x32_bf16 v[44:47], v[172:175], v[208:211], v[44:47]
    ds_read_b64_tr_b16 v[168:169], v8 offset:57344
    v_cvt_pk_bf16_f32 v248, v240, v241
    v_mfma_f32_16x16x32_bf16 v[76:79], v[172:175], v[212:215], v[76:79]
    ds_read_b64_tr_b16 v[170:171], v8 offset:58368
    v_cvt_pk_bf16_f32 v249, v242, v243
    v_mfma_f32_16x16x32_bf16 v[108:111], v[172:175], v[216:219], v[108:111]
    buffer_load_dwordx4 v[196:199], v255, s[8:11], s26 offen offset:1024 sc1
    v_mfma_f32_16x16x32_bf16 v[140:143], v[172:175], v[220:223], v[140:143]
    ds_read_b64_tr_b16 v[172:173], v9 offset:57344
    ds_read_b64_tr_b16 v[174:175], v9 offset:58368
    s_waitcnt vmcnt(31) lgkmcnt(12)
    s_barrier
    v_mfma_f32_16x16x32_bf16 v[16:19], v[144:147], a[160:163], v[16:19]
    v_cvt_pk_bf16_f32 v250, v244, v245
    v_cvt_pk_bf16_f32 v251, v246, v247
    v_mfma_f32_16x16x32_bf16 v[48:51], v[144:147], a[176:179], v[48:51]
    buffer_store_dwordx4 v[248:251], v10, s[12:15], s59 offen offset:0 sc1
    buffer_load_dwordx4 v[200:203], v255, s[8:11], s26 offen offset:2048 sc1
    v_accvgpr_read_b32 v240, a68
    v_mfma_f32_16x16x32_bf16 v[80:83], v[144:147], a[164:167], v[80:83]
    s_and_b32 s54, s24, 1
    v_accvgpr_read_b32 v241, a69
    v_add_u32 v2, 0x10000, v2
    v_mfma_f32_16x16x32_bf16 v[112:115], v[144:147], a[180:183], v[112:115]
    ds_read_b64_tr_b16 v[144:145], v2 offset:0
    v_accvgpr_read_b32 v242, a70
    v_mfma_f32_16x16x32_bf16 v[20:23], v[148:151], a[160:163], v[20:23]
    buffer_load_dwordx4 v[204:207], v255, s[8:11], s26 offen offset:3072 sc1
    v_accvgpr_read_b32 v243, a71
    v_mfma_f32_16x16x32_bf16 v[52:55], v[148:151], a[176:179], v[52:55]
    ds_read_b64_tr_b16 v[146:147], v2 offset:1024
    v_accvgpr_read_b32 v244, a100
    v_mfma_f32_16x16x32_bf16 v[84:87], v[148:151], a[164:167], v[84:87]
    s_add_u32 s26, s26, 4096
    v_accvgpr_read_b32 v245, a101
    v_add_u32 v3, 0x10000, v3
    v_mfma_f32_16x16x32_bf16 v[116:119], v[148:151], a[180:183], v[116:119]
    ds_read_b64_tr_b16 v[148:149], v3 offset:0
    s_waitcnt lgkmcnt(11)
    v_accvgpr_read_b32 v246, a102
    v_mfma_f32_16x16x32_bf16 v[24:27], v[152:155], a[160:163], v[24:27]
    ds_read_b64_tr_b16 v[150:151], v3 offset:1024
    v_accvgpr_read_b32 v247, a103
    v_mfma_f32_16x16x32_bf16 v[56:59], v[152:155], a[176:179], v[56:59]
    s_and_b32 s26, s26, 0xffff
    v_add_u32 v4, 0x10000, v4
    v_cvt_pk_bf16_f32 v248, v240, v241
    v_mfma_f32_16x16x32_bf16 v[88:91], v[152:155], a[164:167], v[88:91]
    s_lshl_b32 s55, s54, 2
    v_cvt_pk_bf16_f32 v249, v242, v243
    v_cvt_pk_bf16_f32 v250, v244, v245
    v_mfma_f32_16x16x32_bf16 v[120:123], v[152:155], a[180:183], v[120:123]
    ds_read_b64_tr_b16 v[152:153], v4 offset:0
    v_cvt_pk_bf16_f32 v251, v246, v247
    v_mfma_f32_16x16x32_bf16 v[28:31], v[156:159], a[160:163], v[28:31]
    ds_read_b64_tr_b16 v[154:155], v4 offset:1024
    v_mfma_f32_16x16x32_bf16 v[60:63], v[156:159], a[176:179], v[60:63]
    buffer_store_dwordx4 v[248:251], v10, s[12:15], s59 offen offset:1024 sc1
    v_mfma_f32_16x16x32_bf16 v[92:95], v[156:159], a[164:167], v[92:95]
    s_mov_b32 s59, 8192
    v_accvgpr_read_b32 v240, a8
    v_add_u32 v5, 0x10000, v5
    v_mfma_f32_16x16x32_bf16 v[124:127], v[156:159], a[180:183], v[124:127]
    ds_read_b64_tr_b16 v[156:157], v5 offset:0
    s_waitcnt lgkmcnt(11)
    v_accvgpr_read_b32 v241, a9
    v_mfma_f32_16x16x32_bf16 v[32:35], v[160:163], a[160:163], v[32:35]
    s_add_u32 s55, s55, s3
    v_accvgpr_read_b32 v242, a10
    v_accvgpr_read_b32 v243, a11
    v_mfma_f32_16x16x32_bf16 v[64:67], v[160:163], a[176:179], v[64:67]
    ds_read_b64_tr_b16 v[158:159], v5 offset:1024
    v_accvgpr_read_b32 v244, a40
    v_mfma_f32_16x16x32_bf16 v[96:99], v[160:163], a[164:167], v[96:99]
    s_lshl_b32 s70, s55, 16
    v_add_u32 v6, 0x10000, v6
    v_accvgpr_read_b32 v245, a41
    v_mfma_f32_16x16x32_bf16 v[128:131], v[160:163], a[180:183], v[128:131]
    buffer_load_dwordx4 a[128:131], v255, s[8:11], s26 offen offset:0 sc1
    v_accvgpr_read_b32 v246, a42
    v_mfma_f32_16x16x32_bf16 v[36:39], v[164:167], a[160:163], v[36:39]
    ds_read_b64_tr_b16 v[160:161], v6 offset:0
    v_accvgpr_read_b32 v247, a43
    v_mfma_f32_16x16x32_bf16 v[68:71], v[164:167], a[176:179], v[68:71]
    ds_read_b64_tr_b16 v[162:163], v6 offset:1024
    v_add_u32 v7, 0x10000, v7
    v_mfma_f32_16x16x32_bf16 v[100:103], v[164:167], a[164:167], v[100:103]
    buffer_load_dwordx4 a[144:147], v255, s[8:11], s26 offen offset:1024 sc1
    s_lshr_b32 s68, s55, 1
    v_mfma_f32_16x16x32_bf16 v[132:135], v[164:167], a[180:183], v[132:135]
    ds_read_b64_tr_b16 v[164:165], v7 offset:0
    s_waitcnt lgkmcnt(11)
    v_mfma_f32_16x16x32_bf16 v[40:43], v[168:171], a[160:163], v[40:43]
    ds_read_b64_tr_b16 v[166:167], v7 offset:1024
    v_cvt_pk_bf16_f32 v248, v240, v241
    v_mfma_f32_16x16x32_bf16 v[72:75], v[168:171], a[176:179], v[72:75]
    buffer_load_dwordx4 a[132:135], v255, s[8:11], s26 offen offset:2048 sc1
    s_lshl_b32 s68, s68, 8
    v_mfma_f32_16x16x32_bf16 v[104:107], v[168:171], a[164:167], v[104:107]
    v_cvt_pk_bf16_f32 v249, v242, v243
    v_cvt_pk_bf16_f32 v250, v244, v245
    v_cvt_pk_bf16_f32 v251, v246, v247
    buffer_store_dwordx4 v[248:251], v10, s[12:15], s59 offen offset:0 sc1
    v_accvgpr_read_b32 v240, a72
    v_mfma_f32_16x16x32_bf16 v[136:139], v[168:171], a[180:183], v[136:139]
    s_and_b32 s55, s55, 1
    v_add_u32 v8, 0x10000, v8
    v_accvgpr_read_b32 v241, a73
    v_mfma_f32_16x16x32_bf16 v[44:47], v[172:175], a[160:163], v[44:47]
    ds_read_b64_tr_b16 v[168:169], v8 offset:0
    buffer_load_dwordx4 a[148:151], v255, s[8:11], s26 offen offset:3072 sc1
    v_accvgpr_read_b32 v242, a74
    v_mfma_f32_16x16x32_bf16 v[76:79], v[172:175], a[176:179], v[76:79]
    ds_read_b64_tr_b16 v[170:171], v8 offset:1024
    v_accvgpr_read_b32 v243, a75
    v_mfma_f32_16x16x32_bf16 v[108:111], v[172:175], a[164:167], v[108:111]
    s_add_u32 s26, s26, 4096
    v_accvgpr_read_b32 v244, a104
    v_accvgpr_read_b32 v245, a105
    v_mfma_f32_16x16x32_bf16 v[140:143], v[172:175], a[180:183], v[140:143]
    s_lshl_b32 s55, s55, 4
    v_add_u32 v9, 0x10000, v9
    ds_read_b64_tr_b16 v[172:173], v9 offset:0
    ds_read_b64_tr_b16 v[174:175], v9 offset:1024
    s_waitcnt vmcnt(35) lgkmcnt(12)
    v_accvgpr_read_b32 v246, a106
    v_mfma_f32_16x16x32_bf16 v[16:19], v[144:147], v[224:227], v[16:19]
    s_and_b32 s26, s26, 0xffff
    v_accvgpr_read_b32 v247, a107
    v_cvt_pk_bf16_f32 v248, v240, v241
    v_mfma_f32_16x16x32_bf16 v[48:51], v[144:147], v[228:231], v[48:51]
    s_add_u32 s68, s68, s55
    v_cvt_pk_bf16_f32 v249, v242, v243
    v_cvt_pk_bf16_f32 v250, v244, v245
    v_mfma_f32_16x16x32_bf16 v[80:83], v[144:147], v[232:235], v[80:83]
    s_sub_u32 s55, s24, s54
    v_cvt_pk_bf16_f32 v251, v246, v247
    v_mfma_f32_16x16x32_bf16 v[112:115], v[144:147], v[236:239], v[112:115]
    ds_read_b64_tr_b16 v[144:145], v2 offset:8192
    v_mfma_f32_16x16x32_bf16 v[20:23], v[148:151], v[224:227], v[20:23]
    ds_read_b64_tr_b16 v[146:147], v2 offset:9216
    v_mfma_f32_16x16x32_bf16 v[52:55], v[148:151], v[228:231], v[52:55]
    buffer_store_dwordx4 v[248:251], v10, s[12:15], s59 offen offset:1024 sc1
    v_mfma_f32_16x16x32_bf16 v[84:87], v[148:151], v[232:235], v[84:87]
    s_mov_b32 s59, 12288
    v_accvgpr_read_b32 v240, a12
    v_accvgpr_read_b32 v241, a13
    v_mfma_f32_16x16x32_bf16 v[116:119], v[148:151], v[236:239], v[116:119]
    ds_read_b64_tr_b16 v[148:149], v3 offset:8192
    s_waitcnt lgkmcnt(11)
    v_mfma_f32_16x16x32_bf16 v[24:27], v[152:155], v[224:227], v[24:27]
    s_lshl_b32 s71, s55, 10
    v_accvgpr_read_b32 v242, a14
    v_accvgpr_read_b32 v243, a15
    v_mfma_f32_16x16x32_bf16 v[56:59], v[152:155], v[228:231], v[56:59]
    ds_read_b64_tr_b16 v[150:151], v3 offset:9216
    v_accvgpr_read_b32 v244, a44
    v_mfma_f32_16x16x32_bf16 v[88:91], v[152:155], v[232:235], v[88:91]
    buffer_load_dwordx4 a[136:139], v255, s[8:11], s26 offen offset:0 sc1
    v_mfma_f32_16x16x32_bf16 v[120:123], v[152:155], v[236:239], v[120:123]
    s_add_u32 s68, s68, s71
    v_accvgpr_read_b32 v245, a45
    v_accvgpr_read_b32 v246, a46
    v_mfma_f32_16x16x32_bf16 v[28:31], v[156:159], v[224:227], v[28:31]
    ds_read_b64_tr_b16 v[152:153], v4 offset:8192
    v_accvgpr_read_b32 v247, a47
    v_mfma_f32_16x16x32_bf16 v[60:63], v[156:159], v[228:231], v[60:63]
    ds_read_b64_tr_b16 v[154:155], v4 offset:9216
    buffer_load_dwordx4 a[152:155], v255, s[8:11], s26 offen offset:1024 sc1
    v_mfma_f32_16x16x32_bf16 v[92:95], v[156:159], v[232:235], v[92:95]
    s_add_u32 s68, s68, 40960
    v_cvt_pk_bf16_f32 v248, v240, v241
    v_cvt_pk_bf16_f32 v249, v242, v243
    v_mfma_f32_16x16x32_bf16 v[124:127], v[156:159], v[236:239], v[124:127]
    ds_read_b64_tr_b16 v[156:157], v5 offset:8192
    s_waitcnt lgkmcnt(11)
    v_mfma_f32_16x16x32_bf16 v[32:35], v[160:163], v[224:227], v[32:35]
    buffer_load_dwordx4 a[140:143], v255, s[8:11], s26 offen offset:2048 sc1
    v_mfma_f32_16x16x32_bf16 v[64:67], v[160:163], v[228:231], v[64:67]
    ds_read_b64_tr_b16 v[158:159], v5 offset:9216
    s_lshl_b32 s71, s55, 19
    v_mfma_f32_16x16x32_bf16 v[96:99], v[160:163], v[232:235], v[96:99]
    s_add_u32 s70, s70, s71
    v_cvt_pk_bf16_f32 v250, v244, v245
    v_cvt_pk_bf16_f32 v251, v246, v247
    v_mfma_f32_16x16x32_bf16 v[128:131], v[160:163], v[236:239], v[128:131]
    buffer_store_dwordx4 v[248:251], v10, s[12:15], s59 offen offset:0 sc1
    buffer_load_dwordx4 a[156:159], v255, s[8:11], s26 offen offset:3072 sc1
    v_accvgpr_read_b32 v240, a76
    v_mfma_f32_16x16x32_bf16 v[36:39], v[164:167], v[224:227], v[36:39]
    ds_read_b64_tr_b16 v[160:161], v6 offset:8192
    v_accvgpr_read_b32 v241, a77
    v_accvgpr_read_b32 v242, a78
    v_mfma_f32_16x16x32_bf16 v[68:71], v[164:167], v[228:231], v[68:71]
    ds_read_b64_tr_b16 v[162:163], v6 offset:9216
    v_accvgpr_read_b32 v243, a79
    v_mfma_f32_16x16x32_bf16 v[100:103], v[164:167], v[232:235], v[100:103]
    s_add_u32 s26, s26, 4096
    v_accvgpr_read_b32 v244, a108
    v_accvgpr_read_b32 v245, a109
    v_mfma_f32_16x16x32_bf16 v[132:135], v[164:167], v[236:239], v[132:135]
    ds_read_b64_tr_b16 v[164:165], v7 offset:8192
    s_waitcnt lgkmcnt(11)
    s_lshl_b32 s71, s3, 10
    v_mfma_f32_16x16x32_bf16 v[40:43], v[168:171], v[224:227], v[40:43]
    ds_read_b64_tr_b16 v[166:167], v7 offset:9216
    v_accvgpr_read_b32 v246, a110
    v_mfma_f32_16x16x32_bf16 v[72:75], v[168:171], v[228:231], v[72:75]
    s_and_b32 s26, s26, 0xffff
    v_accvgpr_read_b32 v247, a111
    v_cvt_pk_bf16_f32 v248, v240, v241
    v_mfma_f32_16x16x32_bf16 v[104:107], v[168:171], v[232:235], v[104:107]
    s_add_u32 s70, s70, s71
    v_cvt_pk_bf16_f32 v249, v242, v243
    v_cvt_pk_bf16_f32 v250, v244, v245
    v_mfma_f32_16x16x32_bf16 v[136:139], v[168:171], v[236:239], v[136:139]
    ds_read_b64_tr_b16 v[168:169], v8 offset:8192
    v_cvt_pk_bf16_f32 v251, v246, v247
    v_mfma_f32_16x16x32_bf16 v[44:47], v[172:175], v[224:227], v[44:47]
    ds_read_b64_tr_b16 v[170:171], v8 offset:9216
    v_mfma_f32_16x16x32_bf16 v[76:79], v[172:175], v[228:231], v[76:79]
    s_lshr_b32 s55, s24, 1
    v_mfma_f32_16x16x32_bf16 v[108:111], v[172:175], v[232:235], v[108:111]
    buffer_store_dwordx4 v[248:251], v10, s[12:15], s59 offen offset:1024 sc1
    v_mfma_f32_16x16x32_bf16 v[140:143], v[172:175], v[236:239], v[140:143]
    ds_read_b64_tr_b16 v[172:173], v9 offset:8192
    ds_read_b64_tr_b16 v[174:175], v9 offset:9216
    s_waitcnt vmcnt(36) lgkmcnt(12)
    s_mov_b32 s59, 32768
    v_accvgpr_read_b32 v240, a16
    v_mfma_f32_16x16x32_bf16 v[16:19], v[144:147], a[168:171], v[16:19]
    s_mul_i32 s54, s54, 31
    v_accvgpr_read_b32 v241, a17
    v_accvgpr_read_b32 v242, a18
    v_mfma_f32_16x16x32_bf16 v[48:51], v[144:147], a[184:187], v[48:51]
    s_xor_b32 s55, s55, s54
    v_accvgpr_read_b32 v243, a19
    v_accvgpr_read_b32 v244, a48
    v_mfma_f32_16x16x32_bf16 v[80:83], v[144:147], a[172:175], v[80:83]
    s_lshl_b32 s55, s55, 2
    v_accvgpr_read_b32 v245, a49
    v_mfma_f32_16x16x32_bf16 v[112:115], v[144:147], a[188:191], v[112:115]
    ds_read_b64_tr_b16 v[144:145], v2 offset:16384
    v_accvgpr_read_b32 v246, a50
    v_mfma_f32_16x16x32_bf16 v[20:23], v[148:151], a[168:171], v[20:23]
    ds_read_b64_tr_b16 v[146:147], v2 offset:17408
    v_accvgpr_read_b32 v247, a51
    v_mfma_f32_16x16x32_bf16 v[52:55], v[148:151], a[184:187], v[52:55]
    s_add_u32 s55, s55, s3
    v_cvt_pk_bf16_f32 v248, v240, v241
    v_mfma_f32_16x16x32_bf16 v[84:87], v[148:151], a[172:175], v[84:87]
    s_lshl_b32 s55, s55, 14
    v_cvt_pk_bf16_f32 v249, v242, v243
    v_mfma_f32_16x16x32_bf16 v[116:119], v[148:151], a[188:191], v[116:119]
    ds_read_b64_tr_b16 v[148:149], v3 offset:16384
    s_waitcnt lgkmcnt(11)
    v_mfma_f32_16x16x32_bf16 v[24:27], v[152:155], a[168:171], v[24:27]
    ds_read_b64_tr_b16 v[150:151], v3 offset:17408
    v_cvt_pk_bf16_f32 v250, v244, v245
    v_mfma_f32_16x16x32_bf16 v[56:59], v[152:155], a[184:187], v[56:59]
    s_lshl_b32 s71, s25, 7
    v_cvt_pk_bf16_f32 v251, v246, v247
    v_mfma_f32_16x16x32_bf16 v[88:91], v[152:155], a[172:175], v[88:91]
    buffer_store_dwordx4 v[248:251], v10, s[12:15], s59 offen offset:0 sc1
    v_mfma_f32_16x16x32_bf16 v[120:123], v[152:155], a[188:191], v[120:123]
    ds_read_b64_tr_b16 v[152:153], v4 offset:16384
    v_accvgpr_read_b32 v240, a80
    v_mfma_f32_16x16x32_bf16 v[28:31], v[156:159], a[168:171], v[28:31]
    ds_read_b64_tr_b16 v[154:155], v4 offset:17408
    v_accvgpr_read_b32 v241, a81
    v_mfma_f32_16x16x32_bf16 v[60:63], v[156:159], a[184:187], v[60:63]
    s_add_u32 s71, s71, s55
    v_accvgpr_read_b32 v242, a82
    v_accvgpr_read_b32 v243, a83
    v_mfma_f32_16x16x32_bf16 v[92:95], v[156:159], a[172:175], v[92:95]
    s_lshl_b32 s54, s25, 1
    v_accvgpr_read_b32 v244, a112
    v_accvgpr_read_b32 v245, a113
    v_mfma_f32_16x16x32_bf16 v[124:127], v[156:159], a[188:191], v[124:127]
    ds_read_b64_tr_b16 v[156:157], v5 offset:16384
    s_waitcnt lgkmcnt(11)
    v_mfma_f32_16x16x32_bf16 v[32:35], v[160:163], a[168:171], v[32:35]
    ds_read_b64_tr_b16 v[158:159], v5 offset:17408
    v_accvgpr_read_b32 v246, a114
    v_mfma_f32_16x16x32_bf16 v[64:67], v[160:163], a[184:187], v[64:67]
    s_and_b32 s55, s3, 1
    v_accvgpr_read_b32 v247, a115
    v_cvt_pk_bf16_f32 v248, v240, v241
    v_mfma_f32_16x16x32_bf16 v[96:99], v[160:163], a[172:175], v[96:99]
    v_cvt_pk_bf16_f32 v249, v242, v243
    v_mfma_f32_16x16x32_bf16 v[128:131], v[160:163], a[188:191], v[128:131]
    ds_read_b64_tr_b16 v[160:161], v6 offset:16384
    v_cvt_pk_bf16_f32 v250, v244, v245
    v_mfma_f32_16x16x32_bf16 v[36:39], v[164:167], a[168:171], v[36:39]
    ds_read_b64_tr_b16 v[162:163], v6 offset:17408
    v_cvt_pk_bf16_f32 v251, v246, v247
    v_mfma_f32_16x16x32_bf16 v[68:71], v[164:167], a[184:187], v[68:71]
    buffer_store_dwordx4 v[248:251], v10, s[12:15], s59 offen offset:1024 sc1
    v_mfma_f32_16x16x32_bf16 v[100:103], v[164:167], a[172:175], v[100:103]
    s_mov_b32 s59, 36864
    v_accvgpr_read_b32 v240, a20
    v_mfma_f32_16x16x32_bf16 v[132:135], v[164:167], a[188:191], v[132:135]
    ds_read_b64_tr_b16 v[164:165], v7 offset:16384
    s_waitcnt lgkmcnt(11)
    v_mfma_f32_16x16x32_bf16 v[40:43], v[168:171], a[168:171], v[40:43]
    ds_read_b64_tr_b16 v[166:167], v7 offset:17408
    v_accvgpr_read_b32 v241, a21
    v_mfma_f32_16x16x32_bf16 v[72:75], v[168:171], a[184:187], v[72:75]
    s_add_u32 s54, s54, s55
    v_accvgpr_read_b32 v242, a22
    v_accvgpr_read_b32 v243, a23
    v_mfma_f32_16x16x32_bf16 v[104:107], v[168:171], a[172:175], v[104:107]
    s_lshl_b32 s54, s54, 3
    v_accvgpr_read_b32 v244, a52
    v_mfma_f32_16x16x32_bf16 v[136:139], v[168:171], a[188:191], v[136:139]
    ds_read_b64_tr_b16 v[168:169], v8 offset:16384
    v_accvgpr_read_b32 v245, a53
    v_mfma_f32_16x16x32_bf16 v[44:47], v[172:175], a[168:171], v[44:47]
    ds_read_b64_tr_b16 v[170:171], v8 offset:17408
    v_accvgpr_read_b32 v246, a54
    v_mfma_f32_16x16x32_bf16 v[76:79], v[172:175], a[184:187], v[76:79]
    s_lshr_b32 s55, s24, 3
    v_accvgpr_read_b32 v247, a55
    v_mfma_f32_16x16x32_bf16 v[108:111], v[172:175], a[172:175], v[108:111]
    s_add_u32 s54, s54, s55
    v_cvt_pk_bf16_f32 v248, v240, v241
    v_cvt_pk_bf16_f32 v249, v242, v243
    v_mfma_f32_16x16x32_bf16 v[140:143], v[172:175], a[188:191], v[140:143]
    ds_read_b64_tr_b16 v[172:173], v9 offset:16384
    ds_read_b64_tr_b16 v[174:175], v9 offset:17408
    s_waitcnt vmcnt(33) lgkmcnt(12)
    v_mfma_f32_16x16x32_bf16 v[16:19], v[144:147], v[176:179], v[16:19]
    s_lshl_b32 s54, s54, 6
    v_cvt_pk_bf16_f32 v250, v244, v245
    v_cvt_pk_bf16_f32 v251, v246, v247
    v_mfma_f32_16x16x32_bf16 v[48:51], v[144:147], v[180:183], v[48:51]
    buffer_store_dwordx4 v[248:251], v10, s[12:15], s59 offen offset:0 sc1
    v_mfma_f32_16x16x32_bf16 v[80:83], v[144:147], v[184:187], v[80:83]
    s_and_b32 s55, s24, 7
    v_accvgpr_read_b32 v240, a84
    v_mfma_f32_16x16x32_bf16 v[112:115], v[144:147], v[188:191], v[112:115]
    ds_read_b64_tr_b16 v[144:145], v2 offset:24576
    v_accvgpr_read_b32 v241, a85
    v_mfma_f32_16x16x32_bf16 v[20:23], v[148:151], v[176:179], v[20:23]
    ds_read_b64_tr_b16 v[146:147], v2 offset:25600
    v_accvgpr_read_b32 v242, a86
    v_mfma_f32_16x16x32_bf16 v[52:55], v[148:151], v[180:183], v[52:55]
    s_add_u32 s54, s54, s55
    v_accvgpr_read_b32 v243, a87
    v_mfma_f32_16x16x32_bf16 v[84:87], v[148:151], v[184:187], v[84:87]
    v_accvgpr_read_b32 v244, a116
    v_mfma_f32_16x16x32_bf16 v[116:119], v[148:151], v[188:191], v[116:119]
    ds_read_b64_tr_b16 v[148:149], v3 offset:24576
    s_waitcnt lgkmcnt(11)
    v_mfma_f32_16x16x32_bf16 v[24:27], v[152:155], v[176:179], v[24:27]
    ds_read_b64_tr_b16 v[150:151], v3 offset:25600
    v_accvgpr_read_b32 v245, a117
    v_mfma_f32_16x16x32_bf16 v[56:59], v[152:155], v[180:183], v[56:59]
    s_lshl_b32 s54, s54, 2
    v_accvgpr_read_b32 v246, a118
    v_accvgpr_read_b32 v247, a119
    v_mfma_f32_16x16x32_bf16 v[88:91], v[152:155], v[184:187], v[88:91]
    v_cvt_pk_bf16_f32 v248, v240, v241
    v_cvt_pk_bf16_f32 v249, v242, v243
    v_mfma_f32_16x16x32_bf16 v[120:123], v[152:155], v[188:191], v[120:123]
    ds_read_b64_tr_b16 v[152:153], v4 offset:24576
    v_cvt_pk_bf16_f32 v250, v244, v245
    v_mfma_f32_16x16x32_bf16 v[28:31], v[156:159], v[176:179], v[28:31]
    ds_read_b64_tr_b16 v[154:155], v4 offset:25600
    v_cvt_pk_bf16_f32 v251, v246, v247
    v_mfma_f32_16x16x32_bf16 v[60:63], v[156:159], v[180:183], v[60:63]
    buffer_store_dwordx4 v[248:251], v10, s[12:15], s59 offen offset:1024 sc1
    v_mfma_f32_16x16x32_bf16 v[92:95], v[156:159], v[184:187], v[92:95]
    s_mov_b32 s59, 40960
    v_mfma_f32_16x16x32_bf16 v[124:127], v[156:159], v[188:191], v[124:127]
    ds_read_b64_tr_b16 v[156:157], v5 offset:24576
    s_waitcnt lgkmcnt(11)
    v_mfma_f32_16x16x32_bf16 v[32:35], v[160:163], v[176:179], v[32:35]
    ds_read_b64_tr_b16 v[158:159], v5 offset:25600
    v_accvgpr_read_b32 v240, a24
    v_mfma_f32_16x16x32_bf16 v[64:67], v[160:163], v[180:183], v[64:67]
    s_add_u32 s69, s54, 40960
    v_accvgpr_read_b32 v241, a25
    v_accvgpr_read_b32 v242, a26
    v_mfma_f32_16x16x32_bf16 v[96:99], v[160:163], v[184:187], v[96:99]
    v_accvgpr_read_b32 v243, a27
    v_mfma_f32_16x16x32_bf16 v[128:131], v[160:163], v[188:191], v[128:131]
    ds_read_b64_tr_b16 v[160:161], v6 offset:24576
    v_accvgpr_read_b32 v244, a56
    v_mfma_f32_16x16x32_bf16 v[36:39], v[164:167], v[176:179], v[36:39]
    ds_read_b64_tr_b16 v[162:163], v6 offset:25600
    v_accvgpr_read_b32 v245, a57
    v_mfma_f32_16x16x32_bf16 v[68:71], v[164:167], v[180:183], v[68:71]
    v_accvgpr_read_b32 v246, a58
    v_accvgpr_read_b32 v247, a59
    v_mfma_f32_16x16x32_bf16 v[100:103], v[164:167], v[184:187], v[100:103]
    v_cvt_pk_bf16_f32 v248, v240, v241
    v_mfma_f32_16x16x32_bf16 v[132:135], v[164:167], v[188:191], v[132:135]
    ds_read_b64_tr_b16 v[164:165], v7 offset:24576
    s_waitcnt lgkmcnt(11)
    v_mfma_f32_16x16x32_bf16 v[40:43], v[168:171], v[176:179], v[40:43]
    ds_read_b64_tr_b16 v[166:167], v7 offset:25600
    v_cvt_pk_bf16_f32 v249, v242, v243
    v_mfma_f32_16x16x32_bf16 v[72:75], v[168:171], v[180:183], v[72:75]
    v_cvt_pk_bf16_f32 v250, v244, v245
    v_cvt_pk_bf16_f32 v251, v246, v247
    v_mfma_f32_16x16x32_bf16 v[104:107], v[168:171], v[184:187], v[104:107]
    buffer_store_dwordx4 v[248:251], v10, s[12:15], s59 offen offset:0 sc1
    v_mfma_f32_16x16x32_bf16 v[136:139], v[168:171], v[188:191], v[136:139]
    ds_read_b64_tr_b16 v[168:169], v8 offset:24576
    v_accvgpr_read_b32 v240, a88
    v_mfma_f32_16x16x32_bf16 v[44:47], v[172:175], v[176:179], v[44:47]
    ds_read_b64_tr_b16 v[170:171], v8 offset:25600
    v_accvgpr_read_b32 v241, a89
    v_mfma_f32_16x16x32_bf16 v[76:79], v[172:175], v[180:183], v[76:79]
    v_accvgpr_read_b32 v242, a90
    v_mfma_f32_16x16x32_bf16 v[108:111], v[172:175], v[184:187], v[108:111]
    v_accvgpr_read_b32 v243, a91
    v_mfma_f32_16x16x32_bf16 v[140:143], v[172:175], v[188:191], v[140:143]
    ds_read_b64_tr_b16 v[172:173], v9 offset:24576
    ds_read_b64_tr_b16 v[174:175], v9 offset:25600
    s_waitcnt vmcnt(30) lgkmcnt(12)
    v_mfma_f32_16x16x32_bf16 v[16:19], v[144:147], a[192:195], v[16:19]
    v_accvgpr_read_b32 v244, a120
    v_accvgpr_read_b32 v245, a121
    v_mfma_f32_16x16x32_bf16 v[48:51], v[144:147], a[208:211], v[48:51]
    v_accvgpr_read_b32 v246, a122
    v_accvgpr_read_b32 v247, a123
    v_mfma_f32_16x16x32_bf16 v[80:83], v[144:147], a[196:199], v[80:83]
    v_cvt_pk_bf16_f32 v248, v240, v241
    v_mfma_f32_16x16x32_bf16 v[112:115], v[144:147], a[212:215], v[112:115]
    ds_read_b64_tr_b16 v[144:145], v2 offset:32768
    v_cvt_pk_bf16_f32 v249, v242, v243
    v_mfma_f32_16x16x32_bf16 v[20:23], v[148:151], a[192:195], v[20:23]
    ds_read_b64_tr_b16 v[146:147], v2 offset:33792
    v_cvt_pk_bf16_f32 v250, v244, v245
    v_mfma_f32_16x16x32_bf16 v[52:55], v[148:151], a[208:211], v[52:55]
    v_cvt_pk_bf16_f32 v251, v246, v247
    v_mfma_f32_16x16x32_bf16 v[84:87], v[148:151], a[196:199], v[84:87]
    buffer_store_dwordx4 v[248:251], v10, s[12:15], s59 offen offset:1024 sc1
    v_mfma_f32_16x16x32_bf16 v[116:119], v[148:151], a[212:215], v[116:119]
    ds_read_b64_tr_b16 v[148:149], v3 offset:32768
    s_waitcnt lgkmcnt(11)
    v_mfma_f32_16x16x32_bf16 v[24:27], v[152:155], a[192:195], v[24:27]
    ds_read_b64_tr_b16 v[150:151], v3 offset:33792
    v_mfma_f32_16x16x32_bf16 v[56:59], v[152:155], a[208:211], v[56:59]
    s_mov_b32 s59, 45056
    v_accvgpr_read_b32 v240, a28
    v_accvgpr_read_b32 v241, a29
    v_mfma_f32_16x16x32_bf16 v[88:91], v[152:155], a[196:199], v[88:91]
    v_accvgpr_read_b32 v242, a30
    v_accvgpr_read_b32 v243, a31
    v_mfma_f32_16x16x32_bf16 v[120:123], v[152:155], a[212:215], v[120:123]
    ds_read_b64_tr_b16 v[152:153], v4 offset:32768
    v_accvgpr_read_b32 v244, a60
    v_mfma_f32_16x16x32_bf16 v[28:31], v[156:159], a[192:195], v[28:31]
    ds_read_b64_tr_b16 v[154:155], v4 offset:33792
    v_accvgpr_read_b32 v245, a61
    v_mfma_f32_16x16x32_bf16 v[60:63], v[156:159], a[208:211], v[60:63]
    v_accvgpr_read_b32 v246, a62
    v_mfma_f32_16x16x32_bf16 v[92:95], v[156:159], a[196:199], v[92:95]
    v_accvgpr_read_b32 v247, a63
    v_mfma_f32_16x16x32_bf16 v[124:127], v[156:159], a[212:215], v[124:127]
    ds_read_b64_tr_b16 v[156:157], v5 offset:32768
    s_waitcnt lgkmcnt(11)
    v_mfma_f32_16x16x32_bf16 v[32:35], v[160:163], a[192:195], v[32:35]
    ds_read_b64_tr_b16 v[158:159], v5 offset:33792
    v_cvt_pk_bf16_f32 v248, v240, v241
    v_mfma_f32_16x16x32_bf16 v[64:67], v[160:163], a[208:211], v[64:67]
    v_cvt_pk_bf16_f32 v249, v242, v243
    v_cvt_pk_bf16_f32 v250, v244, v245
    v_mfma_f32_16x16x32_bf16 v[96:99], v[160:163], a[196:199], v[96:99]
    v_cvt_pk_bf16_f32 v251, v246, v247
    v_mfma_f32_16x16x32_bf16 v[128:131], v[160:163], a[212:215], v[128:131]
    ds_read_b64_tr_b16 v[160:161], v6 offset:32768
    v_mfma_f32_16x16x32_bf16 v[36:39], v[164:167], a[192:195], v[36:39]
    ds_read_b64_tr_b16 v[162:163], v6 offset:33792
    v_mfma_f32_16x16x32_bf16 v[68:71], v[164:167], a[208:211], v[68:71]
    buffer_store_dwordx4 v[248:251], v10, s[12:15], s59 offen offset:0 sc1
    v_mfma_f32_16x16x32_bf16 v[100:103], v[164:167], a[196:199], v[100:103]
    v_accvgpr_read_b32 v240, a92
    v_accvgpr_read_b32 v241, a93
    v_mfma_f32_16x16x32_bf16 v[132:135], v[164:167], a[212:215], v[132:135]
    ds_read_b64_tr_b16 v[164:165], v7 offset:32768
    s_waitcnt lgkmcnt(11)
    v_accvgpr_read_b32 v242, a94
    v_mfma_f32_16x16x32_bf16 v[40:43], v[168:171], a[192:195], v[40:43]
    ds_read_b64_tr_b16 v[166:167], v7 offset:33792
    v_accvgpr_read_b32 v243, a95
    v_mfma_f32_16x16x32_bf16 v[72:75], v[168:171], a[208:211], v[72:75]
    v_accvgpr_read_b32 v244, a124
    v_accvgpr_read_b32 v245, a125
    v_mfma_f32_16x16x32_bf16 v[104:107], v[168:171], a[196:199], v[104:107]
    v_accvgpr_read_b32 v246, a126
    v_accvgpr_read_b32 v247, a127
    v_mfma_f32_16x16x32_bf16 v[136:139], v[168:171], a[212:215], v[136:139]
    ds_read_b64_tr_b16 v[168:169], v8 offset:32768
    v_cvt_pk_bf16_f32 v248, v240, v241
    v_mfma_f32_16x16x32_bf16 v[44:47], v[172:175], a[192:195], v[44:47]
    ds_read_b64_tr_b16 v[170:171], v8 offset:33792
    v_cvt_pk_bf16_f32 v249, v242, v243
    v_mfma_f32_16x16x32_bf16 v[76:79], v[172:175], a[208:211], v[76:79]
    v_cvt_pk_bf16_f32 v250, v244, v245
    v_mfma_f32_16x16x32_bf16 v[108:111], v[172:175], a[196:199], v[108:111]
    v_cvt_pk_bf16_f32 v251, v246, v247
    v_mfma_f32_16x16x32_bf16 v[140:143], v[172:175], a[212:215], v[140:143]
    ds_read_b64_tr_b16 v[172:173], v9 offset:32768
    ds_read_b64_tr_b16 v[174:175], v9 offset:33792
    s_waitcnt vmcnt(26) lgkmcnt(12)
    v_mfma_f32_16x16x32_bf16 v[16:19], v[144:147], a[200:203], v[16:19]
    buffer_store_dwordx4 v[248:251], v10, s[12:15], s59 offen offset:1024 sc1
    v_mfma_f32_16x16x32_bf16 v[48:51], v[144:147], a[216:219], v[48:51]
    v_mfma_f32_16x16x32_bf16 v[80:83], v[144:147], a[204:207], v[80:83]
    v_mfma_f32_16x16x32_bf16 v[112:115], v[144:147], a[220:223], v[112:115]
    ds_read_b64_tr_b16 v[144:145], v2 offset:40960
    v_mfma_f32_16x16x32_bf16 v[20:23], v[148:151], a[200:203], v[20:23]
    ds_read_b64_tr_b16 v[146:147], v2 offset:41984
    v_mfma_f32_16x16x32_bf16 v[52:55], v[148:151], a[216:219], v[52:55]
    v_mfma_f32_16x16x32_bf16 v[84:87], v[148:151], a[204:207], v[84:87]
    v_mfma_f32_16x16x32_bf16 v[116:119], v[148:151], a[220:223], v[116:119]
    ds_read_b64_tr_b16 v[148:149], v3 offset:40960
    s_waitcnt lgkmcnt(11)
    v_mfma_f32_16x16x32_bf16 v[24:27], v[152:155], a[200:203], v[24:27]
    ds_read_b64_tr_b16 v[150:151], v3 offset:41984
    v_mfma_f32_16x16x32_bf16 v[56:59], v[152:155], a[216:219], v[56:59]
    v_mfma_f32_16x16x32_bf16 v[88:91], v[152:155], a[204:207], v[88:91]
    v_mfma_f32_16x16x32_bf16 v[120:123], v[152:155], a[220:223], v[120:123]
    ds_read_b64_tr_b16 v[152:153], v4 offset:40960
    v_mfma_f32_16x16x32_bf16 v[28:31], v[156:159], a[200:203], v[28:31]
    ds_read_b64_tr_b16 v[154:155], v4 offset:41984
    v_mfma_f32_16x16x32_bf16 v[60:63], v[156:159], a[216:219], v[60:63]
    v_mfma_f32_16x16x32_bf16 v[92:95], v[156:159], a[204:207], v[92:95]
    v_mfma_f32_16x16x32_bf16 v[124:127], v[156:159], a[220:223], v[124:127]
    ds_read_b64_tr_b16 v[156:157], v5 offset:40960
    s_waitcnt lgkmcnt(11)
    v_mfma_f32_16x16x32_bf16 v[32:35], v[160:163], a[200:203], v[32:35]
    ds_read_b64_tr_b16 v[158:159], v5 offset:41984
    v_mfma_f32_16x16x32_bf16 v[64:67], v[160:163], a[216:219], v[64:67]
    v_mfma_f32_16x16x32_bf16 v[96:99], v[160:163], a[204:207], v[96:99]
    v_mfma_f32_16x16x32_bf16 v[128:131], v[160:163], a[220:223], v[128:131]
    ds_read_b64_tr_b16 v[160:161], v6 offset:40960
    v_mfma_f32_16x16x32_bf16 v[36:39], v[164:167], a[200:203], v[36:39]
    ds_read_b64_tr_b16 v[162:163], v6 offset:41984
    v_mfma_f32_16x16x32_bf16 v[68:71], v[164:167], a[216:219], v[68:71]
    s_mov_b32 s59, 73728
    v_mfma_f32_16x16x32_bf16 v[100:103], v[164:167], a[204:207], v[100:103]
    v_mfma_f32_16x16x32_bf16 v[132:135], v[164:167], a[220:223], v[132:135]
    ds_read_b64_tr_b16 v[164:165], v7 offset:40960
    s_waitcnt lgkmcnt(11)
    v_mfma_f32_16x16x32_bf16 v[40:43], v[168:171], a[200:203], v[40:43]
    ds_read_b64_tr_b16 v[166:167], v7 offset:41984
    v_mfma_f32_16x16x32_bf16 v[72:75], v[168:171], a[216:219], v[72:75]
    v_mfma_f32_16x16x32_bf16 v[104:107], v[168:171], a[204:207], v[104:107]
    v_mfma_f32_16x16x32_bf16 v[136:139], v[168:171], a[220:223], v[136:139]
    ds_read_b64_tr_b16 v[168:169], v8 offset:40960
    v_mfma_f32_16x16x32_bf16 v[44:47], v[172:175], a[200:203], v[44:47]
    ds_read_b64_tr_b16 v[170:171], v8 offset:41984
    v_mfma_f32_16x16x32_bf16 v[76:79], v[172:175], a[216:219], v[76:79]
    v_mfma_f32_16x16x32_bf16 v[108:111], v[172:175], a[204:207], v[108:111]
    v_mfma_f32_16x16x32_bf16 v[140:143], v[172:175], a[220:223], v[140:143]
    ds_read_b64_tr_b16 v[172:173], v9 offset:40960
    ds_read_b64_tr_b16 v[174:175], v9 offset:41984
    s_waitcnt vmcnt(0) lgkmcnt(12)
    s_barrier
    s_or_b32 s99, s98, s3
    s_cmp_eq_u32 s99, 0
    s_cbranch_scc1 L_wb0
    buffer_store_dword v254, v12, s[60:63], s59 offen
L_wbb0:
    v_mfma_f32_16x16x32_bf16 v[16:19], v[144:147], v[192:195], v[16:19]
    v_mov_b32 v13, v15
    v_lshrrev_b32 v251, 8, v1
    v_mfma_f32_16x16x32_bf16 v[48:51], v[144:147], v[196:199], v[48:51]
    v_bfe_u32 v10, v1, 4, 4
    v_mfma_f32_16x16x32_bf16 v[80:83], v[144:147], v[200:203], v[80:83]
    ds_read_b64_tr_b16 a[64:65], v2 offset:57344
    v_mfma_f32_16x16x32_bf16 v[112:115], v[144:147], v[204:207], v[112:115]
    ds_read_b64_tr_b16 a[66:67], v2 offset:58368
    v_mfma_f32_16x16x32_bf16 v[20:23], v[148:151], v[192:195], v[20:23]
    ds_read_b64_tr_b16 v[144:145], v2 offset:49152
    s_lshl_b32 s50, s24, 14
    v_lshlrev_b32 v251, 2, v251
    v_mfma_f32_16x16x32_bf16 v[52:55], v[148:151], v[196:199], v[52:55]
    ds_read_b64_tr_b16 v[146:147], v2 offset:50176
    v_sub_u32 v251, v251, v10
    v_mov_b32 v11, 0x3f803f80
    v_mfma_f32_16x16x32_bf16 v[84:87], v[148:151], v[200:203], v[84:87]
    ds_read_b64_tr_b16 a[68:69], v3 offset:57344
    v_cmp_ge_i32 s[40:41], 0, v251
    v_cmp_ge_i32 s[42:43], -1, v251
    v_mfma_f32_16x16x32_bf16 v[116:119], v[148:151], v[204:207], v[116:119]
    ds_read_b64_tr_b16 a[70:71], v3 offset:58368
    ds_read_b64_tr_b16 v[148:149], v3 offset:49152
    s_waitcnt lgkmcnt(15)
    v_cmp_ge_i32 s[44:45], -2, v251
    v_cmp_ge_i32 s[46:47], -3, v251
    v_mfma_f32_16x16x32_bf16 v[24:27], v[152:155], v[192:195], v[24:27]
    v_and_b32 v10, 1, v10
    v_mul_u32_u24 v10, 0xaaaa, v10
    v_mfma_f32_16x16x32_bf16 v[56:59], v[152:155], v[196:199], v[56:59]
    ds_read_b64_tr_b16 v[150:151], v3 offset:50176
    v_add_u32 v10, 0x4444, v10
    v_lshl_or_b32 v10, v10, 16, v10
    v_mfma_f32_16x16x32_bf16 v[88:91], v[152:155], v[200:203], v[88:91]
    ds_read_b64_tr_b16 a[72:73], v4 offset:57344
    buffer_load_dword v254, v252, s[60:63], 0 offen sc1
    v_accvgpr_write_b32 a208, v11
    v_accvgpr_write_b32 a209, v11
    v_accvgpr_write_b32 a210, v11
    v_mfma_f32_16x16x32_bf16 v[120:123], v[152:155], v[204:207], v[120:123]
    ds_read_b64_tr_b16 a[74:75], v4 offset:58368
    v_accvgpr_write_b32 a211, v11
    s_lshl_b32 s26, s25, 1
    v_mfma_f32_16x16x32_bf16 v[28:31], v[156:159], v[192:195], v[28:31]
    ds_read_b64_tr_b16 v[152:153], v4 offset:49152
    s_add_u32 s26, s26, 2
    s_mov_b32 s49, 0x80000000
    v_mfma_f32_16x16x32_bf16 v[60:63], v[156:159], v[196:199], v[60:63]
    ds_read_b64_tr_b16 v[154:155], v4 offset:50176
    s_mov_b32 s53, 0x8000
    s_mov_b32 s28, 2
    v_mfma_f32_16x16x32_bf16 v[92:95], v[156:159], v[200:203], v[92:95]
    ds_read_b64_tr_b16 a[76:77], v5 offset:57344
    s_mov_b32 s29, 0x10000
    s_mov_b32 s30, 0x10000
    v_mfma_f32_16x16x32_bf16 v[124:127], v[156:159], v[204:207], v[124:127]
    ds_read_b64_tr_b16 a[78:79], v5 offset:58368
    ds_read_b64_tr_b16 v[156:157], v5 offset:49152
    s_waitcnt lgkmcnt(15)
    s_mov_b32 s31, 0x8000
    s_mov_b32 s32, 0
    v_mfma_f32_16x16x32_bf16 v[32:35], v[160:163], v[192:195], v[32:35]
    s_sub_u32 s37, 33, s26
    s_lshl_b32 s37, s37, 15
    v_mfma_f32_16x16x32_bf16 v[64:67], v[160:163], v[196:199], v[64:67]
    ds_read_b64_tr_b16 v[158:159], v5 offset:50176
    s_cmp_eq_u32 s26, 2
    s_cselect_b32 s33, s37, s49
    s_mov_b32 s34, s49
    v_mfma_f32_16x16x32_bf16 v[96:99], v[160:163], v[200:203], v[96:99]
    ds_read_b64_tr_b16 a[80:81], v6 offset:57344
    s_mov_b32 s35, s49
    s_mov_b32 s39, 0
    s_mul_i32 s54, s3, 3
    v_mfma_f32_16x16x32_bf16 v[128:131], v[160:163], v[204:207], v[128:131]
    ds_read_b64_tr_b16 a[82:83], v6 offset:58368
    s_add_u32 s54, s54, 15
    s_add_u32 s55, s26, s3
    v_mfma_f32_16x16x32_bf16 v[36:39], v[164:167], v[192:195], v[36:39]
    ds_read_b64_tr_b16 v[160:161], v6 offset:49152
    s_sub_u32 s55, s55, 2
    s_cmp_ge_u32 s3, 2
    s_cselect_b32 s48, s55, s54
    s_cselect_b32 s58, 0, 1
    v_mfma_f32_16x16x32_bf16 v[68:71], v[164:167], v[196:199], v[68:71]
    ds_read_b64_tr_b16 v[162:163], v6 offset:50176
    s_lshl_b32 s54, s25, 19
    s_and_b32 s55, s70, 0x70000
    v_mfma_f32_16x16x32_bf16 v[100:103], v[164:167], v[200:203], v[100:103]
    ds_read_b64_tr_b16 a[84:85], v7 offset:57344
    s_add_u32 s54, s54, s55
    v_add_u32 v15, s54, v1
    v_mfma_f32_16x16x32_bf16 v[132:135], v[164:167], v[204:207], v[132:135]
    ds_read_b64_tr_b16 a[86:87], v7 offset:58368
    ds_read_b64_tr_b16 v[164:165], v7 offset:49152
    s_waitcnt lgkmcnt(15)
    s_add_u32 s66, s54, 33611776
    s_lshl_b32 s54, s24, 20
    v_mfma_f32_16x16x32_bf16 v[40:43], v[168:171], v[192:195], v[40:43]
    s_add_u32 s54, s54, s36
    s_sub_u32 s66, s66, s54
    v_mfma_f32_16x16x32_bf16 v[72:75], v[168:171], v[196:199], v[72:75]
    ds_read_b64_tr_b16 v[166:167], v7 offset:50176
    s_add_u32 s8, s78, 0x4000000
    s_addc_u32 s9, s79, 0
    s_mov_b32 s10, 0x400000
    v_mfma_f32_16x16x32_bf16 v[104:107], v[168:171], v[200:203], v[104:107]
    ds_read_b64_tr_b16 a[88:89], v8 offset:57344
    s_mov_b32 s11, 0x00020000
    v_accvgpr_write_b32 a192, 0
    v_accvgpr_write_b32 a193, 0
    v_mfma_f32_16x16x32_bf16 v[136:139], v[168:171], v[204:207], v[136:139]
    ds_read_b64_tr_b16 a[90:91], v8 offset:58368
    v_accvgpr_write_b32 a194, 0
    v_accvgpr_write_b32 a195, 0
    v_mfma_f32_16x16x32_bf16 v[44:47], v[172:175], v[192:195], v[44:47]
    ds_read_b64_tr_b16 v[168:169], v8 offset:49152
    v_accvgpr_write_b32 a196, 0
    v_accvgpr_write_b32 a197, 0
    v_mfma_f32_16x16x32_bf16 v[76:79], v[172:175], v[196:199], v[76:79]
    ds_read_b64_tr_b16 v[170:171], v8 offset:50176
    v_accvgpr_write_b32 a198, 0
    v_accvgpr_write_b32 a199, 0
    v_mfma_f32_16x16x32_bf16 v[108:111], v[172:175], v[200:203], v[108:111]
    ds_read_b64_tr_b16 a[92:93], v9 offset:57344
    v_accvgpr_write_b32 a200, 0
    v_accvgpr_write_b32 a201, 0
    v_mfma_f32_16x16x32_bf16 v[140:143], v[172:175], v[204:207], v[140:143]
    ds_read_b64_tr_b16 a[94:95], v9 offset:58368
    ds_read_b64_tr_b16 v[172:173], v9 offset:49152
    ds_read_b64_tr_b16 v[174:175], v9 offset:50176
    s_waitcnt vmcnt(17) lgkmcnt(15)
    v_accvgpr_write_b32 a202, 0
    v_accvgpr_write_b32 a203, 0
    v_accvgpr_write_b32 a204, 0
    v_accvgpr_write_b32 a205, 0
    v_accvgpr_write_b32 a206, 0
    v_accvgpr_write_b32 a207, 0
    v_mfma_f32_16x16x32_bf16 v[16:19], v[144:147], a[128:131], v[16:19]
    v_add_u32 v6, s50, v1
    v_mfma_f32_16x16x32_bf16 v[16:19], a[64:67], a[136:139], v[16:19]
    v_mov_b32 v5, 0xff800000
    v_mfma_f32_16x16x32_bf16 v[20:23], v[148:151], a[128:131], v[20:23]
    v_or_b32 v2, 0x4000, v1
    v_mfma_f32_16x16x32_bf16 v[20:23], a[68:71], a[136:139], v[20:23]
    s_waitcnt lgkmcnt(15)
    v_or_b32 v3, 0x4000, v1
    v_mfma_f32_16x16x32_bf16 v[24:27], v[152:155], a[128:131], v[24:27]
    s_waitcnt vmcnt(0)
    v_cmp_ne_u32 vcc, 1, v254
    v_mov_b32 v7, v10
    v_mfma_f32_16x16x32_bf16 v[24:27], a[72:75], a[136:139], v[24:27]
    v_mov_b32 v4, v14
    v_mfma_f32_16x16x32_bf16 v[28:31], v[156:159], a[128:131], v[28:31]
    s_cbranch_vccnz L_spin2
L_back2:
    v_mov_b32 v11, v253
    v_mfma_f32_16x16x32_bf16 v[28:31], a[76:79], a[136:139], v[28:31]
    s_waitcnt lgkmcnt(8)
    v_mfma_f32_16x16x32_bf16 v[32:35], v[160:163], a[128:131], v[32:35]
    buffer_load_dwordx4 a[212:215], v13, s[12:15], 0 offen offset:0 sc1
    v_mfma_f32_16x16x32_bf16 v[32:35], a[80:83], a[136:139], v[32:35]
    buffer_load_dwordx4 a[216:219], v13, s[12:15], 0 offen offset:1024 sc1
    v_mfma_f32_16x16x32_bf16 v[36:39], v[164:167], a[128:131], v[36:39]
    v_cvt_pk_bf16_f32 v16, v16, v17
    v_cvt_pk_bf16_f32 v17, v18, v19
    v_mfma_f32_16x16x32_bf16 v[36:39], a[84:87], a[136:139], v[36:39]
    s_waitcnt lgkmcnt(0)
    v_cvt_pk_bf16_f32 v18, v20, v21
    v_cvt_pk_bf16_f32 v19, v22, v23
    v_mfma_f32_16x16x32_bf16 v[40:43], v[168:171], a[128:131], v[40:43]
    buffer_load_dwordx4 a[220:223], v13, s[12:15], 0 offen offset:2048 sc1
    v_mfma_f32_16x16x32_bf16 v[40:43], a[88:91], a[136:139], v[40:43]
    buffer_load_dwordx4 a[224:227], v13, s[12:15], 0 offen offset:3072 sc1
    v_mfma_f32_16x16x32_bf16 v[44:47], v[172:175], a[128:131], v[44:47]
    v_accvgpr_write_b32 a0, v16
    v_accvgpr_write_b32 a1, v17
    v_mfma_f32_16x16x32_bf16 v[44:47], a[92:95], a[136:139], v[44:47]
    s_add_u32 m0, s36, 49152
    v_accvgpr_write_b32 a2, v18
    v_accvgpr_write_b32 a3, v19
    v_mfma_f32_16x16x32_bf16 v[48:51], v[144:147], a[144:147], v[48:51]
    v_cvt_pk_bf16_f32 v24, v24, v25
    v_cvt_pk_bf16_f32 v25, v26, v27
    v_mfma_f32_16x16x32_bf16 v[48:51], a[64:67], a[152:155], v[48:51]
    s_mov_b32 s56, 0
    v_cvt_pk_bf16_f32 v26, v28, v29
    v_cvt_pk_bf16_f32 v27, v30, v31
    v_mfma_f32_16x16x32_bf16 v[52:55], v[148:151], a[144:147], v[52:55]
    v_accvgpr_write_b32 a4, v24
    v_accvgpr_write_b32 a5, v25
    v_mfma_f32_16x16x32_bf16 v[52:55], a[68:71], a[152:155], v[52:55]
    buffer_load_dwordx4 v14, s[12:15], s56 offen offset:0 sc1 lds
    v_mfma_f32_16x16x32_bf16 v[56:59], v[152:155], a[144:147], v[56:59]
    v_accvgpr_write_b32 a6, v26
    v_accvgpr_write_b32 a7, v27
    v_mfma_f32_16x16x32_bf16 v[56:59], a[72:75], a[152:155], v[56:59]
    buffer_load_dwordx4 v14, s[12:15], s56 offen offset:1024 sc1 lds
    v_mfma_f32_16x16x32_bf16 v[60:63], v[156:159], a[144:147], v[60:63]
    v_cvt_pk_bf16_f32 v32, v32, v33
    v_cvt_pk_bf16_f32 v33, v34, v35
    v_mfma_f32_16x16x32_bf16 v[60:63], a[76:79], a[152:155], v[60:63]
    buffer_load_dwordx4 v14, s[12:15], s56 offen offset:2048 sc1 lds
    v_mfma_f32_16x16x32_bf16 v[64:67], v[160:163], a[144:147], v[64:67]
    v_cvt_pk_bf16_f32 v34, v36, v37
    v_cvt_pk_bf16_f32 v35, v38, v39
    v_mfma_f32_16x16x32_bf16 v[64:67], a[80:83], a[152:155], v[64:67]
    buffer_load_dwordx4 v14, s[12:15], s56 offen offset:3072 sc1 lds
    v_mfma_f32_16x16x32_bf16 v[68:71], v[164:167], a[144:147], v[68:71]
    v_accvgpr_write_b32 a8, v32
    v_accvgpr_write_b32 a9, v33
    v_mfma_f32_16x16x32_bf16 v[68:71], a[84:87], a[152:155], v[68:71]
    s_add_u32 m0, s36, 16384
    v_accvgpr_write_b32 a10, v34
    v_accvgpr_write_b32 a11, v35
    v_mfma_f32_16x16x32_bf16 v[72:75], v[168:171], a[144:147], v[72:75]
    v_cvt_pk_bf16_f32 v40, v40, v41
    v_cvt_pk_bf16_f32 v41, v42, v43
    v_mfma_f32_16x16x32_bf16 v[72:75], a[88:91], a[152:155], v[72:75]
    s_mov_b32 s56, 32768
    v_cvt_pk_bf16_f32 v42, v44, v45
    v_cvt_pk_bf16_f32 v43, v46, v47
    v_mfma_f32_16x16x32_bf16 v[76:79], v[172:175], a[144:147], v[76:79]
    v_accvgpr_write_b32 a12, v40
    v_accvgpr_write_b32 a13, v41
    v_accvgpr_write_b32 a14, v42
    v_accvgpr_write_b32 a15, v43
    v_mfma_f32_16x16x32_bf16 v[76:79], a[92:95], a[152:155], v[76:79]
    buffer_load_dwordx4 v14, s[12:15], s56 offen offset:0 sc1 lds
    v_mfma_f32_16x16x32_bf16 v[80:83], v[144:147], a[132:135], v[80:83]
    v_cvt_pk_bf16_f32 v48, v48, v49
    v_cvt_pk_bf16_f32 v49, v50, v51
    v_mfma_f32_16x16x32_bf16 v[80:83], a[64:67], a[140:143], v[80:83]
    buffer_load_dwordx4 v14, s[12:15], s56 offen offset:1024 sc1 lds
    v_mfma_f32_16x16x32_bf16 v[84:87], v[148:151], a[132:135], v[84:87]
    v_cvt_pk_bf16_f32 v50, v52, v53
    v_cvt_pk_bf16_f32 v51, v54, v55
    v_mfma_f32_16x16x32_bf16 v[84:87], a[68:71], a[140:143], v[84:87]
    buffer_load_dwordx4 v14, s[12:15], s56 offen offset:2048 sc1 lds
    v_mfma_f32_16x16x32_bf16 v[88:91], v[152:155], a[132:135], v[88:91]
    v_accvgpr_write_b32 a16, v48
    v_accvgpr_write_b32 a17, v49
    v_mfma_f32_16x16x32_bf16 v[88:91], a[72:75], a[140:143], v[88:91]
    buffer_load_dwordx4 v14, s[12:15], s56 offen offset:3072 sc1 lds
    v_mfma_f32_16x16x32_bf16 v[92:95], v[156:159], a[132:135], v[92:95]
    v_accvgpr_write_b32 a18, v50
    v_accvgpr_write_b32 a19, v51
    v_mfma_f32_16x16x32_bf16 v[92:95], a[76:79], a[140:143], v[92:95]
    v_cvt_pk_bf16_f32 v56, v56, v57
    v_cvt_pk_bf16_f32 v57, v58, v59
    v_mfma_f32_16x16x32_bf16 v[96:99], v[160:163], a[132:135], v[96:99]
    v_cvt_pk_bf16_f32 v58, v60, v61
    v_cvt_pk_bf16_f32 v59, v62, v63
    v_mfma_f32_16x16x32_bf16 v[96:99], a[80:83], a[140:143], v[96:99]
    v_accvgpr_write_b32 a20, v56
    v_accvgpr_write_b32 a21, v57
    v_mfma_f32_16x16x32_bf16 v[100:103], v[164:167], a[132:135], v[100:103]
    v_accvgpr_write_b32 a22, v58
    v_accvgpr_write_b32 a23, v59
    v_mfma_f32_16x16x32_bf16 v[100:103], a[84:87], a[140:143], v[100:103]
    v_cvt_pk_bf16_f32 v64, v64, v65
    v_cvt_pk_bf16_f32 v65, v66, v67
    v_mfma_f32_16x16x32_bf16 v[104:107], v[168:171], a[132:135], v[104:107]
    v_cvt_pk_bf16_f32 v66, v68, v69
    v_cvt_pk_bf16_f32 v67, v70, v71
    v_mfma_f32_16x16x32_bf16 v[104:107], a[88:91], a[140:143], v[104:107]
    v_accvgpr_write_b32 a24, v64
    v_accvgpr_write_b32 a25, v65
    v_mfma_f32_16x16x32_bf16 v[108:111], v[172:175], a[132:135], v[108:111]
    v_accvgpr_write_b32 a26, v66
    v_accvgpr_write_b32 a27, v67
    v_cvt_pk_bf16_f32 v72, v72, v73
    v_cvt_pk_bf16_f32 v73, v74, v75
    v_cvt_pk_bf16_f32 v74, v76, v77
    v_cvt_pk_bf16_f32 v75, v78, v79
    v_accvgpr_write_b32 a28, v72
    v_accvgpr_write_b32 a29, v73
    v_accvgpr_write_b32 a30, v74
    v_accvgpr_write_b32 a31, v75
    v_mfma_f32_16x16x32_bf16 v[108:111], a[92:95], a[140:143], v[108:111]
    v_cvt_pk_bf16_f32 v80, v80, v81
    v_cvt_pk_bf16_f32 v81, v82, v83
    v_mfma_f32_16x16x32_bf16 v[112:115], v[144:147], a[148:151], v[112:115]
    v_cvt_pk_bf16_f32 v82, v84, v85
    v_cvt_pk_bf16_f32 v83, v86, v87
    v_mfma_f32_16x16x32_bf16 v[112:115], a[64:67], a[156:159], v[112:115]
    v_accvgpr_write_b32 a32, v80
    v_accvgpr_write_b32 a33, v81
    v_mfma_f32_16x16x32_bf16 v[116:119], v[148:151], a[148:151], v[116:119]
    v_accvgpr_write_b32 a34, v82
    v_accvgpr_write_b32 a35, v83
    v_mfma_f32_16x16x32_bf16 v[116:119], a[68:71], a[156:159], v[116:119]
    v_cvt_pk_bf16_f32 v88, v88, v89
    v_cvt_pk_bf16_f32 v89, v90, v91
    v_mfma_f32_16x16x32_bf16 v[120:123], v[152:155], a[148:151], v[120:123]
    v_cvt_pk_bf16_f32 v90, v92, v93
    v_cvt_pk_bf16_f32 v91, v94, v95
    v_mfma_f32_16x16x32_bf16 v[120:123], a[72:75], a[156:159], v[120:123]
    v_accvgpr_write_b32 a36, v88
    v_accvgpr_write_b32 a37, v89
    v_mfma_f32_16x16x32_bf16 v[124:127], v[156:159], a[148:151], v[124:127]
    v_accvgpr_write_b32 a38, v90
    v_accvgpr_write_b32 a39, v91
    v_mfma_f32_16x16x32_bf16 v[124:127], a[76:79], a[156:159], v[124:127]
    v_cvt_pk_bf16_f32 v96, v96, v97
    v_cvt_pk_bf16_f32 v97, v98, v99
    v_mfma_f32_16x16x32_bf16 v[128:131], v[160:163], a[148:151], v[128:131]
    v_cvt_pk_bf16_f32 v98, v100, v101
    v_cvt_pk_bf16_f32 v99, v102, v103
    v_mfma_f32_16x16x32_bf16 v[128:131], a[80:83], a[156:159], v[128:131]
    v_accvgpr_write_b32 a40, v96
    v_accvgpr_write_b32 a41, v97
    v_mfma_f32_16x16x32_bf16 v[132:135], v[164:167], a[148:151], v[132:135]
    v_accvgpr_write_b32 a42, v98
    v_accvgpr_write_b32 a43, v99
    v_mfma_f32_16x16x32_bf16 v[132:135], a[84:87], a[156:159], v[132:135]
    v_cvt_pk_bf16_f32 v104, v104, v105
    v_cvt_pk_bf16_f32 v105, v106, v107
    v_mfma_f32_16x16x32_bf16 v[136:139], v[168:171], a[148:151], v[136:139]
    v_cvt_pk_bf16_f32 v106, v108, v109
    v_cvt_pk_bf16_f32 v107, v110, v111
    v_mfma_f32_16x16x32_bf16 v[136:139], a[88:91], a[156:159], v[136:139]
    v_accvgpr_write_b32 a44, v104
    v_accvgpr_write_b32 a45, v105
    v_mfma_f32_16x16x32_bf16 v[140:143], v[172:175], a[148:151], v[140:143]
    v_accvgpr_write_b32 a46, v106
    v_accvgpr_write_b32 a47, v107
    v_mfma_f32_16x16x32_bf16 v[140:143], a[92:95], a[156:159], v[140:143]
    s_waitcnt vmcnt(8)
    v_cvt_pk_bf16_f32 v112, v112, v113
    v_cvt_pk_bf16_f32 v113, v114, v115
    v_mfma_f32_16x16x32_bf16 v[240:243], a[212:215], a[0:3], 0
    v_cvt_pk_bf16_f32 v114, v116, v117
    v_cvt_pk_bf16_f32 v115, v118, v119
    v_mfma_f32_16x16x32_bf16 v[240:243], a[216:219], a[4:7], v[240:243]
    v_accvgpr_write_b32 a48, v112
    v_accvgpr_write_b32 a49, v113
    v_mfma_f32_16x16x32_bf16 v[240:243], a[220:223], a[8:11], v[240:243]
    v_accvgpr_write_b32 a50, v114
    v_accvgpr_write_b32 a51, v115
    v_mfma_f32_16x16x32_bf16 v[240:243], a[224:227], a[12:15], v[240:243]
    v_cvt_pk_bf16_f32 v120, v120, v121
    v_cvt_pk_bf16_f32 v121, v122, v123
    v_mfma_f32_16x16x32_bf16 v[244:247], a[212:215], a[16:19], 0
    v_cvt_pk_bf16_f32 v122, v124, v125
    v_cvt_pk_bf16_f32 v123, v126, v127
    v_mfma_f32_16x16x32_bf16 v[244:247], a[216:219], a[20:23], v[244:247]
    v_accvgpr_write_b32 a52, v120
    v_accvgpr_write_b32 a53, v121
    v_mfma_f32_16x16x32_bf16 v[244:247], a[220:223], a[24:27], v[244:247]
    v_accvgpr_write_b32 a54, v122
    v_accvgpr_write_b32 a55, v123
    v_mfma_f32_16x16x32_bf16 v[244:247], a[224:227], a[28:31], v[244:247]
    v_cvt_pk_bf16_f32 v128, v128, v129
    v_cvt_pk_bf16_f32 v129, v130, v131
    v_mfma_f32_16x16x32_bf16 v[248:251], a[212:215], a[32:35], 0
    v_cvt_pk_bf16_f32 v130, v132, v133
    v_cvt_pk_bf16_f32 v131, v134, v135
    v_mfma_f32_16x16x32_bf16 v[248:251], a[216:219], a[36:39], v[248:251]
    v_accvgpr_write_b32 a56, v128
    v_accvgpr_write_b32 a57, v129
    v_mfma_f32_16x16x32_bf16 v[248:251], a[220:223], a[40:43], v[248:251]
    v_accvgpr_write_b32 a58, v130
    v_accvgpr_write_b32 a59, v131
    v_mfma_f32_16x16x32_bf16 v[248:251], a[224:227], a[44:47], v[248:251]
    v_cvt_pk_bf16_f32 v136, v136, v137
    v_cvt_pk_bf16_f32 v137, v138, v139
    v_cvt_pk_bf16_f32 v138, v140, v141
    v_cvt_pk_bf16_f32 v139, v142, v143
    v_accvgpr_write_b32 a60, v136
    v_accvgpr_write_b32 a61, v137
    v_accvgpr_write_b32 a62, v138
    v_accvgpr_write_b32 a63, v139
    s_nop 0
    v_mfma_f32_16x16x32_bf16 v[252:255], a[212:215], a[48:51], 0
    v_mfma_f32_16x16x32_bf16 v[252:255], a[216:219], a[52:55], v[252:255]
    v_mfma_f32_16x16x32_bf16 v[252:255], a[220:223], a[56:59], v[252:255]
    v_mfma_f32_16x16x32_bf16 v[252:255], a[224:227], a[60:63], v[252:255]
    v_sub_f32 v240, 0, v240
    v_sub_f32 v241, 0, v241
    v_sub_f32 v242, 0, v242
    v_sub_f32 v243, 0, v243
    v_sub_f32 v244, 0, v244
    v_sub_f32 v245, 0, v245
    v_sub_f32 v246, 0, v246
    v_sub_f32 v247, 0, v247
    v_sub_f32 v248, 0, v248
    v_sub_f32 v249, 0, v249
    v_sub_f32 v250, 0, v250
    v_sub_f32 v251, 0, v251
    s_cmp_eq_u32 s38, 0
    s_cbranch_scc0 L_nmx1
    v_sub_f32 v252, 0, v252
    v_sub_f32 v253, 0, v253
    v_sub_f32 v254, 0, v254
    v_sub_f32 v255, 0, v255
L_go:
    s_lshl_b32 s54, s3, 14
    s_add_u32 s54, s54, 131072
    v_add_u32 v8, s54, v1
    s_cmp_ge_u32 s3, 2
    s_waitcnt vmcnt(0)
    s_barrier
    buffer_load_dword a232, v11, s[60:63], 0 offen sc1
    v_mov_b32 v9, 1
    buffer_store_dword v9, v12, s[60:63], 0 offen sc1
    ds_read_b128 a[64:67], v1 offset:49152
    ds_read_b128 a[68:71], v1 offset:50176
    ds_read_b128 a[72:75], v1 offset:51200
    ds_read_b128 a[76:79], v1 offset:52224
    ds_read_b128 a[80:83], v1 offset:53248
    ds_read_b128 a[84:87], v1 offset:54272
    ds_read_b128 a[88:91], v1 offset:55296
    ds_read_b128 a[92:95], v1 offset:56320
    ds_read_b128 a[96:99], v1 offset:57344
    ds_read_b128 a[100:103], v1 offset:58368
    ds_read_b128 a[104:107], v1 offset:59392
    ds_read_b128 a[108:111], v1 offset:60416
    ds_read_b128 a[112:115], v1 offset:61440
    ds_read_b128 a[116:119], v1 offset:62464
    ds_read_b128 a[120:123], v1 offset:63488
    ds_read_b128 a[124:127], v1 offset:64512
    v_mov_b64 v[20:21], 0
    v_mov_b64 v[22:23], 0
    v_mov_b64 v[28:29], 0
    v_mov_b64 v[30:31], 0
    v_mov_b64 v[36:37], 0
    v_mov_b64 v[38:39], 0
    v_mov_b64 v[44:45], 0
    v_mov_b64 v[46:47], 0
    v_mov_b64 v[52:53], 0
    v_mov_b64 v[54:55], 0
    v_mov_b64 v[60:61], 0
    v_mov_b64 v[62:63], 0
    v_mov_b64 v[68:69], 0
    v_mov_b64 v[70:71], 0
    v_mov_b64 v[76:77], 0
    v_mov_b64 v[78:79], 0
    v_mov_b64 v[84:85], 0
    v_mov_b64 v[86:87], 0
    v_mov_b64 v[92:93], 0
    v_mov_b64 v[94:95], 0
    v_mov_b64 v[100:101], 0
    v_mov_b64 v[102:103], 0
    v_mov_b64 v[108:109], 0
    v_mov_b64 v[110:111], 0
    v_mov_b64 v[116:117], 0
    v_mov_b64 v[118:119], 0
    v_mov_b64 v[124:125], 0
    v_mov_b64 v[126:127], 0
    v_mov_b64 v[132:133], 0
    v_mov_b64 v[134:135], 0
    v_mov_b64 v[140:141], 0
    v_mov_b64 v[142:143], 0
    v_mov_b64 v[16:17], 0
    v_mov_b64 v[18:19], 0
    v_mov_b64 v[24:25], 0
    v_mov_b64 v[26:27], 0
    v_mov_b64 v[32:33], 0
    v_mov_b64 v[34:35], 0
    v_mov_b64 v[40:41], 0
    v_mov_b64 v[42:43], 0
    v_mov_b64 v[48:49], 0
    v_mov_b64 v[50:51], 0
    v_mov_b64 v[56:57], 0
    v_mov_b64 v[58:59], 0
    v_mov_b64 v[64:65], 0
    v_mov_b64 v[66:67], 0
    v_mov_b64 v[72:73], 0
    v_mov_b64 v[74:75], 0
    v_mov_b64 v[80:81], 0
    v_mov_b64 v[82:83], 0
    v_mov_b64 v[88:89], 0
    v_mov_b64 v[90:91], 0
    v_mov_b64 v[96:97], 0
    v_mov_b64 v[98:99], 0
    v_mov_b64 v[104:105], 0
    v_mov_b64 v[106:107], 0
    v_mov_b64 v[112:113], 0
    v_mov_b64 v[114:115], 0
    v_mov_b64 v[120:121], 0
    v_mov_b64 v[122:123], 0
    v_mov_b64 v[128:129], 0
    v_mov_b64 v[130:131], 0
    v_mov_b64 v[136:137], 0
    v_mov_b64 v[138:139], 0
    s_cbranch_scc1 L_nostash
    s_waitcnt lgkmcnt(8)
    ds_write_b128 v8, a[0:3] offset:0
    ds_write_b128 v8, a[4:7] offset:1024
    ds_write_b128 v8, a[8:11] offset:2048
    ds_write_b128 v8, a[12:15] offset:3072
    ds_write_b128 v8, a[16:19] offset:4096
    ds_write_b128 v8, a[20:23] offset:5120
    ds_write_b128 v8, a[24:27] offset:6144
    s_waitcnt lgkmcnt(7)
    ds_write_b128 v8, a[28:31] offset:7168
    ds_write_b128 v8, a[32:35] offset:8192
    ds_write_b128 v8, a[36:39] offset:9216
    ds_write_b128 v8, a[40:43] offset:10240
    ds_write_b128 v8, a[44:47] offset:11264
    ds_write_b128 v8, a[48:51] offset:12288
    ds_write_b128 v8, a[52:55] offset:13312
    ds_write_b128 v8, a[56:59] offset:14336
    ds_write_b128 v8, a[60:63] offset:15360
    s_branch L_go2
L_nostash:
    s_waitcnt lgkmcnt(0)
L_go2:
    s_cmp_eq_u32 s3, 2
    s_cselect_b32 s50, s25, 1
    s_cmp_eq_u32 s50, 0
    s_cbranch_scc1 L_a_DX
L_a_NX:
    v_mfma_f32_16x16x32_bf16 v[144:147], a[64:67], a[0:3], v[240:243]
    s_add_u32 m0, s36, 32768
    v_xor_b32 v3, 0x4000, v3
    v_mfma_f32_16x16x32_bf16 v[144:147], a[68:71], a[4:7], v[144:147]
    s_add_u32 s28, s28, 1
    v_mfma_f32_16x16x32_bf16 v[144:147], a[72:75], a[8:11], v[144:147]
    v_mfma_f32_16x16x32_bf16 v[144:147], a[76:79], a[12:15], v[144:147]
    buffer_load_dwordx4 v4, s[16:19], s32 offen offset:0 sc1 lds
    v_mfma_f32_16x16x32_bf16 v[160:163], a[64:67], a[16:19], v[244:247]
    v_mfma_f32_16x16x32_bf16 v[160:163], a[68:71], a[20:23], v[160:163]
    buffer_load_dwordx4 v4, s[16:19], s32 offen offset:1024 sc1 lds
    v_mfma_f32_16x16x32_bf16 v[160:163], a[72:75], a[24:27], v[160:163]
    buffer_load_dwordx4 v4, s[16:19], s32 offen offset:2048 sc1 lds
    v_mfma_f32_16x16x32_bf16 v[160:163], a[76:79], a[28:31], v[160:163]
    v_mfma_f32_16x16x32_bf16 v[176:179], a[64:67], a[32:35], v[248:251]
    buffer_load_dwordx4 v4, s[16:19], s32 offen offset:3072 sc1 lds
    v_mfma_f32_16x16x32_bf16 v[176:179], a[68:71], a[36:39], v[176:179]
    v_exp_f32 v144, v144
    v_mfma_f32_16x16x32_bf16 v[176:179], a[72:75], a[40:43], v[176:179]
    s_mov_b32 m0, s36
    v_exp_f32 v145, v145
    v_mfma_f32_16x16x32_bf16 v[176:179], a[76:79], a[44:47], v[176:179]
    s_mov_b32 s32, s31
    v_exp_f32 v146, v146
    v_mfma_f32_16x16x32_bf16 v[192:195], a[64:67], a[48:51], v[252:255]
    v_exp_f32 v147, v147
    v_mfma_f32_16x16x32_bf16 v[192:195], a[68:71], a[52:55], v[192:195]
    v_exp_f32 v160, v160
    v_mfma_f32_16x16x32_bf16 v[192:195], a[72:75], a[56:59], v[192:195]
    v_cvt_pk_bf16_f32 v208, v144, v145
    v_cvt_pk_bf16_f32 v209, v146, v147
    v_mfma_f32_16x16x32_bf16 v[192:195], a[76:79], a[60:63], v[192:195]
    buffer_load_dwordx4 v4, s[12:15], s30 offen offset:0 sc1 lds
    v_mfma_f32_16x16x32_bf16 v[148:151], a[80:83], a[0:3], v[240:243]
    ds_read_b128 a[64:67], v2 offset:0
    v_mfma_f32_16x16x32_bf16 v[148:151], a[84:87], a[4:7], v[148:151]
    v_exp_f32 v161, v161
    v_mfma_f32_16x16x32_bf16 v[148:151], a[88:91], a[8:11], v[148:151]
    v_exp_f32 v162, v162
    v_mfma_f32_16x16x32_bf16 v[148:151], a[92:95], a[12:15], v[148:151]
    ds_read_b128 a[68:71], v2 offset:1024
    v_mfma_f32_16x16x32_bf16 v[164:167], a[80:83], a[16:19], v[244:247]
    buffer_load_dwordx4 v4, s[12:15], s30 offen offset:1024 sc1 lds
    v_mfma_f32_16x16x32_bf16 v[164:167], a[84:87], a[20:23], v[164:167]
    v_exp_f32 v163, v163
    v_mfma_f32_16x16x32_bf16 v[164:167], a[88:91], a[24:27], v[164:167]
    ds_read_b128 a[72:75], v2 offset:2048
    v_mfma_f32_16x16x32_bf16 v[164:167], a[92:95], a[28:31], v[164:167]
    buffer_load_dwordx4 v4, s[12:15], s30 offen offset:2048 sc1 lds
    v_mfma_f32_16x16x32_bf16 v[180:183], a[80:83], a[32:35], v[248:251]
    v_exp_f32 v176, v176
    v_mfma_f32_16x16x32_bf16 v[180:183], a[84:87], a[36:39], v[180:183]
    v_cvt_pk_bf16_f32 v216, v160, v161
    v_cvt_pk_bf16_f32 v217, v162, v163
    v_mfma_f32_16x16x32_bf16 v[180:183], a[88:91], a[40:43], v[180:183]
    buffer_load_dwordx4 v4, s[12:15], s30 offen offset:3072 sc1 lds
    v_exp_f32 v177, v177
    v_mfma_f32_16x16x32_bf16 v[180:183], a[92:95], a[44:47], v[180:183]
    ds_read_b128 a[76:79], v2 offset:3072
    v_exp_f32 v178, v178
    v_mfma_f32_16x16x32_bf16 v[196:199], a[80:83], a[48:51], v[252:255]
    s_mov_b32 s31, s30
    v_exp_f32 v179, v179
    v_mfma_f32_16x16x32_bf16 v[196:199], a[84:87], a[52:55], v[196:199]
    s_add_u32 m0, s36, 98304
    v_exp_f32 v192, v192
    v_mfma_f32_16x16x32_bf16 v[196:199], a[88:91], a[56:59], v[196:199]
    s_cmp_gt_u32 s28, s26
    v_exp_f32 v193, v193
    v_mfma_f32_16x16x32_bf16 v[196:199], a[92:95], a[60:63], v[196:199]
    v_exp_f32 v194, v194
    v_mfma_f32_16x16x32_bf16 v[152:155], a[96:99], a[0:3], v[240:243]
    v_exp_f32 v195, v195
    v_mfma_f32_16x16x32_bf16 v[152:155], a[100:103], a[4:7], v[152:155]
    buffer_load_dwordx4 v4, s[16:19], s35 offen offset:0 sc1 lds
    v_exp_f32 v148, v148
    v_mfma_f32_16x16x32_bf16 v[152:155], a[104:107], a[8:11], v[152:155]
    ds_read_b128 a[80:83], v2 offset:4096
    s_cselect_b32 s50, 0x10000, s53
    v_exp_f32 v149, v149
    v_mfma_f32_16x16x32_bf16 v[152:155], a[108:111], a[12:15], v[152:155]
    v_exp_f32 v150, v150
    v_mfma_f32_16x16x32_bf16 v[168:171], a[96:99], a[16:19], v[244:247]
    buffer_load_dwordx4 v4, s[16:19], s35 offen offset:1024 sc1 lds
    v_exp_f32 v151, v151
    v_mfma_f32_16x16x32_bf16 v[168:171], a[100:103], a[20:23], v[168:171]
    ds_read_b128 a[84:87], v2 offset:5120
    v_exp_f32 v164, v164
    v_cvt_pk_bf16_f32 v210, v148, v149
    v_cvt_pk_bf16_f32 v211, v150, v151
    v_mfma_f32_16x16x32_bf16 v[168:171], a[104:107], a[24:27], v[168:171]
    s_add_u32 s29, s29, s50
    v_exp_f32 v165, v165
    v_mfma_f32_16x16x32_bf16 v[168:171], a[108:111], a[28:31], v[168:171]
    buffer_load_dwordx4 v4, s[16:19], s35 offen offset:2048 sc1 lds
    v_exp_f32 v166, v166
    v_mfma_f32_16x16x32_bf16 v[184:187], a[96:99], a[32:35], v[248:251]
    ds_read_b128 a[88:91], v2 offset:6144
    v_exp_f32 v167, v167
    v_mfma_f32_16x16x32_bf16 v[184:187], a[100:103], a[36:39], v[184:187]
    s_cmp_gt_u32 s28, 16
    v_exp_f32 v180, v180
    v_cvt_pk_bf16_f32 v218, v164, v165
    v_cvt_pk_bf16_f32 v219, v166, v167
    v_mfma_f32_16x16x32_bf16 v[184:187], a[104:107], a[40:43], v[184:187]
    v_exp_f32 v181, v181
    v_mfma_f32_16x16x32_bf16 v[184:187], a[108:111], a[44:47], v[184:187]
    ds_read_b128 a[92:95], v2 offset:7168
    buffer_load_dwordx4 v4, s[16:19], s35 offen offset:3072 sc1 lds
    v_exp_f32 v182, v182
    v_mfma_f32_16x16x32_bf16 v[200:203], a[96:99], a[48:51], v[252:255]
    s_cselect_b32 s30, s66, s29
    v_exp_f32 v183, v183
    v_mfma_f32_16x16x32_bf16 v[200:203], a[100:103], a[52:55], v[200:203]
    s_add_u32 m0, s36, 65536
    v_exp_f32 v196, v196
    v_mfma_f32_16x16x32_bf16 v[200:203], a[104:107], a[56:59], v[200:203]
    s_mov_b32 s35, s34
    v_exp_f32 v197, v197
    v_mfma_f32_16x16x32_bf16 v[200:203], a[108:111], a[60:63], v[200:203]
    v_exp_f32 v198, v198
    v_mfma_f32_16x16x32_bf16 v[156:159], a[112:115], a[0:3], v[240:243]
    v_exp_f32 v199, v199
    v_mfma_f32_16x16x32_bf16 v[156:159], a[116:119], a[4:7], v[156:159]
    buffer_load_dwordx4 v4, s[12:15], s33 offen offset:0 sc1 lds
    v_exp_f32 v152, v152
    v_mfma_f32_16x16x32_bf16 v[156:159], a[120:123], a[8:11], v[156:159]
    ds_read_b128 a[96:99], v2 offset:8192
    v_exp_f32 v153, v153
    v_mfma_f32_16x16x32_bf16 v[156:159], a[124:127], a[12:15], v[156:159]
    buffer_load_dwordx4 v4, s[12:15], s33 offen offset:1024 sc1 lds
    v_exp_f32 v154, v154
    v_mfma_f32_16x16x32_bf16 v[172:175], a[112:115], a[16:19], v[244:247]
    v_exp_f32 v155, v155
    v_mfma_f32_16x16x32_bf16 v[172:175], a[116:119], a[20:23], v[172:175]
    ds_read_b128 a[100:103], v2 offset:9216
    buffer_load_dwordx4 v4, s[12:15], s33 offen offset:2048 sc1 lds
    v_exp_f32 v168, v168
    v_cvt_pk_bf16_f32 v212, v152, v153
    v_cvt_pk_bf16_f32 v213, v154, v155
    v_mfma_f32_16x16x32_bf16 v[172:175], a[120:123], a[24:27], v[172:175]
    buffer_load_dwordx4 v4, s[12:15], s33 offen offset:3072 sc1 lds
    v_exp_f32 v169, v169
    v_mfma_f32_16x16x32_bf16 v[172:175], a[124:127], a[28:31], v[172:175]
    s_mov_b32 s34, s33
    v_exp_f32 v170, v170
    v_mfma_f32_16x16x32_bf16 v[188:191], a[112:115], a[32:35], v[248:251]
    ds_read_b128 a[104:107], v2 offset:10240
    v_exp_f32 v171, v171
    v_mfma_f32_16x16x32_bf16 v[188:191], a[116:119], a[36:39], v[188:191]
    v_exp_f32 v184, v184
    v_cvt_pk_bf16_f32 v220, v168, v169
    v_cvt_pk_bf16_f32 v221, v170, v171
    v_mfma_f32_16x16x32_bf16 v[188:191], a[120:123], a[40:43], v[188:191]
    s_sub_u32 s33, s30, 32768
    v_exp_f32 v185, v185
    v_mfma_f32_16x16x32_bf16 v[188:191], a[124:127], a[44:47], v[188:191]
    ds_read_b128 a[108:111], v2 offset:11264
    s_cmp_eq_u32 s28, s26
    v_exp_f32 v186, v186
    v_mfma_f32_16x16x32_bf16 v[204:207], a[112:115], a[48:51], v[252:255]
    s_cselect_b32 s33, s37, s33
    v_exp_f32 v187, v187
    v_mfma_f32_16x16x32_bf16 v[204:207], a[116:119], a[52:55], v[204:207]
    s_cmp_lt_u32 s28, s26
    v_exp_f32 v156, v156
    v_mfma_f32_16x16x32_bf16 v[204:207], a[120:123], a[56:59], v[204:207]
    s_cselect_b32 s33, s49, s33
    v_exp_f32 v157, v157
    v_mfma_f32_16x16x32_bf16 v[204:207], a[124:127], a[60:63], v[204:207]
    s_xor_b32 s36, s36, 16384
    v_exp_f32 v158, v158
    v_exp_f32 v159, v159
    v_exp_f32 v172, v172
    v_cvt_pk_bf16_f32 v214, v156, v157
    v_cvt_pk_bf16_f32 v215, v158, v159
    v_exp_f32 v173, v173
    v_exp_f32 v174, v174
    v_exp_f32 v175, v175
    ds_read_b128 a[112:115], v2 offset:12288
    v_exp_f32 v188, v188
    v_cvt_pk_bf16_f32 v222, v172, v173
    v_cvt_pk_bf16_f32 v223, v174, v175
    v_exp_f32 v189, v189
    v_exp_f32 v190, v190
    ds_read_b128 a[116:119], v2 offset:13312
    v_exp_f32 v191, v191
    ds_read_b128 a[120:123], v2 offset:14336
    ds_read_b128 a[124:127], v2 offset:15360
    v_xor_b32 v2, 0x4000, v2
    s_waitcnt vmcnt(0) lgkmcnt(0)
    s_barrier
    v_accvgpr_read_b32 v8, a232
    s_nop 0
    v_cmp_ne_u32 vcc, 1, v8
    s_nop 4
    s_cbranch_vccnz L_spin10
L_back10:
    s_lshr_b32 s54, s3, 1
    s_and_b32 s54, s54, s58
    s_cmp_eq_u32 s39, 0
    s_cselect_b32 s54, s54, 0
    s_cmp_eq_u32 s54, 0
    s_cbranch_scc1 L_a_sf0
    v_mov_b32 v9, s69
    v_mov_b32 v8, 1
    buffer_store_dword v8, v9, s[60:63], 0 offen sc1
L_a_sf0:
L_a_loopsel:
    s_min_u32 s50, s26, s48
    s_mov_b32 s57, s48
    s_mov_b32 s48, s50
    s_cmp_lt_u32 s28, s48
    s_cbranch_scc0 L_a_skipA
.p2align 6
L_a_NNA:
    v_mfma_f32_16x16x32_bf16 v[144:147], a[64:67], a[0:3], v[240:243]
    s_add_u32 m0, s36, 32768
    v_exp_f32 v200, v200
    v_mfma_f32_16x16x32_bf16 v[144:147], a[68:71], a[4:7], v[144:147]
    ds_read_b128 a[128:131], v3 offset:32768
    v_cvt_pk_bf16_f32 v224, v176, v177
    v_mfma_f32_16x16x32_bf16 v[144:147], a[72:75], a[8:11], v[144:147]
    v_exp_f32 v201, v201
    v_mfma_f32_16x16x32_bf16 v[144:147], a[76:79], a[12:15], v[144:147]
    ds_read_b128 a[132:135], v3 offset:33792
    v_cvt_pk_bf16_f32 v225, v178, v179
    v_mfma_f32_16x16x32_bf16 v[148:151], a[80:83], a[0:3], v[240:243]
    s_add_u32 s28, s28, 1
    v_exp_f32 v202, v202
    v_mfma_f32_16x16x32_bf16 v[148:151], a[84:87], a[4:7], v[148:151]
    v_cvt_pk_bf16_f32 v226, v180, v181
    v_mfma_f32_16x16x32_bf16 v[148:151], a[88:91], a[8:11], v[148:151]
    ds_read_b128 a[136:139], v3 offset:34816
    v_mfma_f32_16x16x32_bf16 v[148:151], a[92:95], a[12:15], v[148:151]
    v_exp_f32 v203, v203
    v_mfma_f32_16x16x32_bf16 v[152:155], a[96:99], a[0:3], v[240:243]
    v_cvt_pk_bf16_f32 v227, v182, v183
    v_mfma_f32_16x16x32_bf16 v[152:155], a[100:103], a[4:7], v[152:155]
    v_exp_f32 v204, v204
    v_mfma_f32_16x16x32_bf16 v[152:155], a[104:107], a[8:11], v[152:155]
    buffer_load_dwordx4 v4, s[16:19], s32 offen offset:0 sc1 lds
    v_mfma_f32_16x16x32_bf16 v[152:155], a[108:111], a[12:15], v[152:155]
    ds_read_b128 a[140:143], v3 offset:35840
    v_cvt_pk_bf16_f32 v228, v184, v185
    v_mfma_f32_16x16x32_bf16 v[156:159], a[112:115], a[0:3], v[240:243]
    v_exp_f32 v205, v205
    v_mfma_f32_16x16x32_bf16 v[156:159], a[116:119], a[4:7], v[156:159]
    ds_read_b128 a[144:147], v3 offset:36864
    v_cvt_pk_bf16_f32 v229, v186, v187
    v_mfma_f32_16x16x32_bf16 v[156:159], a[120:123], a[8:11], v[156:159]
    buffer_load_dwordx4 v4, s[16:19], s32 offen offset:1024 sc1 lds
    v_mfma_f32_16x16x32_bf16 v[156:159], a[124:127], a[12:15], v[156:159]
    v_exp_f32 v206, v206
    v_mfma_f32_16x16x32_bf16 v[160:163], a[64:67], a[16:19], v[244:247]
    ds_read_b128 a[148:151], v3 offset:37888
    v_cvt_pk_bf16_f32 v230, v188, v189
    v_mfma_f32_16x16x32_bf16 v[160:163], a[68:71], a[20:23], v[160:163]
    v_exp_f32 v207, v207
    v_mfma_f32_16x16x32_bf16 v[160:163], a[72:75], a[24:27], v[160:163]
    v_cvt_pk_bf16_f32 v231, v190, v191
    v_mfma_f32_16x16x32_bf16 v[160:163], a[76:79], a[28:31], v[160:163]
    buffer_load_dwordx4 v4, s[16:19], s32 offen offset:2048 sc1 lds
    v_mfma_f32_16x16x32_bf16 v[164:167], a[80:83], a[16:19], v[244:247]
    ds_read_b128 a[152:155], v3 offset:38912
    v_cvt_pk_bf16_f32 v232, v192, v193
    v_mfma_f32_16x16x32_bf16 v[164:167], a[84:87], a[20:23], v[164:167]
    v_exp_f32 v144, v144
    v_mfma_f32_16x16x32_bf16 v[164:167], a[88:91], a[24:27], v[164:167]
    v_cvt_pk_bf16_f32 v233, v194, v195
    v_mfma_f32_16x16x32_bf16 v[164:167], a[92:95], a[28:31], v[164:167]
    v_exp_f32 v145, v145
    v_mfma_f32_16x16x32_bf16 v[168:171], a[96:99], a[16:19], v[244:247]
    buffer_load_dwordx4 v4, s[16:19], s32 offen offset:3072 sc1 lds
    v_mfma_f32_16x16x32_bf16 v[168:171], a[100:103], a[20:23], v[168:171]
    ds_read_b128 a[156:159], v3 offset:39936
    v_cvt_pk_bf16_f32 v234, v196, v197
    v_mfma_f32_16x16x32_bf16 v[168:171], a[104:107], a[24:27], v[168:171]
    v_exp_f32 v146, v146
    v_mfma_f32_16x16x32_bf16 v[168:171], a[108:111], a[28:31], v[168:171]
    ds_read_b128 a[160:163], v3 offset:40960
    v_cvt_pk_bf16_f32 v235, v198, v199
    v_mfma_f32_16x16x32_bf16 v[172:175], a[112:115], a[16:19], v[244:247]
    s_mov_b32 m0, s36
    v_exp_f32 v147, v147
    v_mfma_f32_16x16x32_bf16 v[172:175], a[116:119], a[20:23], v[172:175]
    v_cvt_pk_bf16_f32 v236, v200, v201
    v_mfma_f32_16x16x32_bf16 v[172:175], a[120:123], a[24:27], v[172:175]
    v_exp_f32 v148, v148
    v_mfma_f32_16x16x32_bf16 v[172:175], a[124:127], a[28:31], v[172:175]
    ds_read_b128 a[164:167], v3 offset:41984
    v_cvt_pk_bf16_f32 v237, v202, v203
    v_mfma_f32_16x16x32_bf16 v[176:179], a[64:67], a[32:35], v[248:251]
    s_mov_b32 s32, s31
    v_exp_f32 v149, v149
    v_mfma_f32_16x16x32_bf16 v[176:179], a[68:71], a[36:39], v[176:179]
    ds_read_b128 a[168:171], v3 offset:43008
    v_cvt_pk_bf16_f32 v238, v204, v205
    v_mfma_f32_16x16x32_bf16 v[176:179], a[72:75], a[40:43], v[176:179]
    v_exp_f32 v150, v150
    v_mfma_f32_16x16x32_bf16 v[176:179], a[76:79], a[44:47], v[176:179]
    v_cvt_pk_bf16_f32 v239, v206, v207
    v_mfma_f32_16x16x32_bf16 v[180:183], a[80:83], a[32:35], v[248:251]
    v_exp_f32 v151, v151
    v_mfma_f32_16x16x32_bf16 v[180:183], a[84:87], a[36:39], v[180:183]
    v_exp_f32 v152, v152
    v_mfma_f32_16x16x32_bf16 v[180:183], a[88:91], a[40:43], v[180:183]
    buffer_load_dwordx4 v4, s[12:15], s30 offen offset:0 sc1 lds
    v_mfma_f32_16x16x32_bf16 v[180:183], a[92:95], a[44:47], v[180:183]
    ds_read_b128 a[172:175], v3 offset:44032
    v_mfma_f32_16x16x32_bf16 v[184:187], a[96:99], a[32:35], v[248:251]
    v_exp_f32 v153, v153
    v_mfma_f32_16x16x32_bf16 v[184:187], a[100:103], a[36:39], v[184:187]
    v_exp_f32 v154, v154
    v_mfma_f32_16x16x32_bf16 v[184:187], a[104:107], a[40:43], v[184:187]
    ds_read_b128 a[176:179], v3 offset:45056
    v_mfma_f32_16x16x32_bf16 v[184:187], a[108:111], a[44:47], v[184:187]
    buffer_load_dwordx4 v4, s[12:15], s30 offen offset:1024 sc1 lds
    v_mfma_f32_16x16x32_bf16 v[188:191], a[112:115], a[32:35], v[248:251]
    v_exp_f32 v155, v155
    v_mfma_f32_16x16x32_bf16 v[188:191], a[116:119], a[36:39], v[188:191]
    ds_read_b128 a[180:183], v3 offset:46080
    v_mfma_f32_16x16x32_bf16 v[188:191], a[120:123], a[40:43], v[188:191]
    v_exp_f32 v156, v156
    v_mfma_f32_16x16x32_bf16 v[188:191], a[124:127], a[44:47], v[188:191]
    buffer_load_dwordx4 v4, s[12:15], s30 offen offset:2048 sc1 lds
    v_mfma_f32_16x16x32_bf16 v[192:195], a[64:67], a[48:51], v[252:255]
    v_exp_f32 v157, v157
    v_mfma_f32_16x16x32_bf16 v[192:195], a[68:71], a[52:55], v[192:195]
    ds_read_b128 a[184:187], v3 offset:47104
    v_mfma_f32_16x16x32_bf16 v[192:195], a[72:75], a[56:59], v[192:195]
    v_exp_f32 v158, v158
    v_mfma_f32_16x16x32_bf16 v[192:195], a[76:79], a[60:63], v[192:195]
    v_exp_f32 v159, v159
    v_mfma_f32_16x16x32_bf16 v[196:199], a[80:83], a[48:51], v[252:255]
    ds_read_b128 a[188:191], v3 offset:48128
    v_mfma_f32_16x16x32_bf16 v[196:199], a[84:87], a[52:55], v[196:199]
    buffer_load_dwordx4 v4, s[12:15], s30 offen offset:3072 sc1 lds
    v_mfma_f32_16x16x32_bf16 v[196:199], a[88:91], a[56:59], v[196:199]
    s_mov_b32 s31, s30
    v_exp_f32 v160, v160
    v_mfma_f32_16x16x32_bf16 v[196:199], a[92:95], a[60:63], v[196:199]
    v_exp_f32 v161, v161
    v_mfma_f32_16x16x32_bf16 v[200:203], a[96:99], a[48:51], v[252:255]
    v_xor_b32 v3, 0x4000, v3
    v_mfma_f32_16x16x32_bf16 v[200:203], a[100:103], a[52:55], v[200:203]
    v_exp_f32 v162, v162
    v_mfma_f32_16x16x32_bf16 v[200:203], a[104:107], a[56:59], v[200:203]
    v_exp_f32 v163, v163
    v_mfma_f32_16x16x32_bf16 v[200:203], a[108:111], a[60:63], v[200:203]
    s_cmp_gt_u32 s28, s26
    v_mfma_f32_16x16x32_bf16 v[204:207], a[112:115], a[48:51], v[252:255]
    v_exp_f32 v164, v164
    v_mfma_f32_16x16x32_bf16 v[204:207], a[116:119], a[52:55], v[204:207]
    v_mfma_f32_16x16x32_bf16 v[204:207], a[120:123], a[56:59], v[204:207]
    v_exp_f32 v165, v165
    v_mfma_f32_16x16x32_bf16 v[204:207], a[124:127], a[60:63], v[204:207]
    s_waitcnt lgkmcnt(0)
    v_smfmac_f32_16x16x64_bf16 a[192:195], a[208:211], v[208:215], v7
    ds_read_b128 a[64:67], v2 offset:0
    v_mfma_f32_16x16x32_bf16 v[16:19], a[128:131], v[208:211], v[16:19]
    s_cselect_b32 s50, 0x10000, s53
    v_exp_f32 v166, v166
    v_mfma_f32_16x16x32_bf16 v[16:19], a[132:135], v[212:215], v[16:19]
    v_exp_f32 v167, v167
    v_mfma_f32_16x16x32_bf16 v[20:23], a[136:139], v[208:211], v[20:23]
    ds_read_b128 a[68:71], v2 offset:1024
    v_mfma_f32_16x16x32_bf16 v[20:23], a[140:143], v[212:215], v[20:23]
    s_add_u32 s29, s29, s50
    v_exp_f32 v168, v168
    v_mfma_f32_16x16x32_bf16 v[24:27], a[144:147], v[208:211], v[24:27]
    v_mfma_f32_16x16x32_bf16 v[24:27], a[148:151], v[212:215], v[24:27]
    ds_read_b128 a[72:75], v2 offset:2048
    v_mfma_f32_16x16x32_bf16 v[28:31], a[152:155], v[208:211], v[28:31]
    v_exp_f32 v169, v169
    v_mfma_f32_16x16x32_bf16 v[28:31], a[156:159], v[212:215], v[28:31]
    v_exp_f32 v170, v170
    v_mfma_f32_16x16x32_bf16 v[32:35], a[160:163], v[208:211], v[32:35]
    ds_read_b128 a[76:79], v2 offset:3072
    v_mfma_f32_16x16x32_bf16 v[32:35], a[164:167], v[212:215], v[32:35]
    s_cmp_gt_u32 s28, 16
    v_exp_f32 v171, v171
    v_mfma_f32_16x16x32_bf16 v[36:39], a[168:171], v[208:211], v[36:39]
    v_mfma_f32_16x16x32_bf16 v[36:39], a[172:175], v[212:215], v[36:39]
    v_exp_f32 v172, v172
    v_mfma_f32_16x16x32_bf16 v[40:43], a[176:179], v[208:211], v[40:43]
    ds_read_b128 a[80:83], v2 offset:4096
    v_mfma_f32_16x16x32_bf16 v[40:43], a[180:183], v[212:215], v[40:43]
    s_cselect_b32 s30, s66, s29
    v_exp_f32 v173, v173
    v_mfma_f32_16x16x32_bf16 v[44:47], a[184:187], v[208:211], v[44:47]
    v_mfma_f32_16x16x32_bf16 v[44:47], a[188:191], v[212:215], v[44:47]
    ds_read_b128 a[84:87], v2 offset:5120
    v_smfmac_f32_16x16x64_bf16 a[196:199], a[208:211], v[216:223], v7
    v_exp_f32 v174, v174
    v_mfma_f32_16x16x32_bf16 v[48:51], a[128:131], v[216:219], v[48:51]
    s_cmp_eq_u32 s28, s26
    v_cvt_pk_bf16_f32 v208, v144, v145
    v_mfma_f32_16x16x32_bf16 v[48:51], a[132:135], v[220:223], v[48:51]
    ds_read_b128 a[88:91], v2 offset:6144
    v_mfma_f32_16x16x32_bf16 v[52:55], a[136:139], v[216:219], v[52:55]
    v_exp_f32 v175, v175
    v_mfma_f32_16x16x32_bf16 v[52:55], a[140:143], v[220:223], v[52:55]
    v_cvt_pk_bf16_f32 v209, v146, v147
    v_mfma_f32_16x16x32_bf16 v[56:59], a[144:147], v[216:219], v[56:59]
    ds_read_b128 a[92:95], v2 offset:7168
    v_mfma_f32_16x16x32_bf16 v[56:59], a[148:151], v[220:223], v[56:59]
    s_cselect_b32 s33, s37, s33
    v_exp_f32 v176, v176
    v_mfma_f32_16x16x32_bf16 v[60:63], a[152:155], v[216:219], v[60:63]
    v_cvt_pk_bf16_f32 v210, v148, v149
    v_mfma_f32_16x16x32_bf16 v[60:63], a[156:159], v[220:223], v[60:63]
    v_exp_f32 v177, v177
    v_mfma_f32_16x16x32_bf16 v[64:67], a[160:163], v[216:219], v[64:67]
    ds_read_b128 a[96:99], v2 offset:8192
    v_cvt_pk_bf16_f32 v211, v150, v151
    v_mfma_f32_16x16x32_bf16 v[64:67], a[164:167], v[220:223], v[64:67]
    s_xor_b32 s36, s36, 16384
    v_exp_f32 v178, v178
    v_mfma_f32_16x16x32_bf16 v[68:71], a[168:171], v[216:219], v[68:71]
    v_cvt_pk_bf16_f32 v212, v152, v153
    v_mfma_f32_16x16x32_bf16 v[68:71], a[172:175], v[220:223], v[68:71]
    ds_read_b128 a[100:103], v2 offset:9216
    v_mfma_f32_16x16x32_bf16 v[72:75], a[176:179], v[216:219], v[72:75]
    v_exp_f32 v179, v179
    v_mfma_f32_16x16x32_bf16 v[72:75], a[180:183], v[220:223], v[72:75]
    v_cvt_pk_bf16_f32 v213, v154, v155
    v_mfma_f32_16x16x32_bf16 v[76:79], a[184:187], v[216:219], v[76:79]
    v_exp_f32 v180, v180
    v_mfma_f32_16x16x32_bf16 v[76:79], a[188:191], v[220:223], v[76:79]
    ds_read_b128 a[104:107], v2 offset:10240
    v_cvt_pk_bf16_f32 v214, v156, v157
    v_smfmac_f32_16x16x64_bf16 a[200:203], a[208:211], v[224:231], v7
    v_exp_f32 v181, v181
    v_mfma_f32_16x16x32_bf16 v[80:83], a[128:131], v[224:227], v[80:83]
    ds_read_b128 a[108:111], v2 offset:11264
    v_cvt_pk_bf16_f32 v215, v158, v159
    v_mfma_f32_16x16x32_bf16 v[80:83], a[132:135], v[228:231], v[80:83]
    v_exp_f32 v182, v182
    v_mfma_f32_16x16x32_bf16 v[84:87], a[136:139], v[224:227], v[84:87]
    v_exp_f32 v183, v183
    v_mfma_f32_16x16x32_bf16 v[84:87], a[140:143], v[228:231], v[84:87]
    v_cvt_pk_bf16_f32 v216, v160, v161
    v_mfma_f32_16x16x32_bf16 v[88:91], a[144:147], v[224:227], v[88:91]
    ds_read_b128 a[112:115], v2 offset:12288
    v_mfma_f32_16x16x32_bf16 v[88:91], a[148:151], v[228:231], v[88:91]
    v_exp_f32 v184, v184
    v_mfma_f32_16x16x32_bf16 v[92:95], a[152:155], v[224:227], v[92:95]
    v_cvt_pk_bf16_f32 v217, v162, v163
    v_mfma_f32_16x16x32_bf16 v[92:95], a[156:159], v[228:231], v[92:95]
    v_exp_f32 v185, v185
    v_mfma_f32_16x16x32_bf16 v[96:99], a[160:163], v[224:227], v[96:99]
    ds_read_b128 a[116:119], v2 offset:13312
    v_cvt_pk_bf16_f32 v218, v164, v165
    v_mfma_f32_16x16x32_bf16 v[96:99], a[164:167], v[228:231], v[96:99]
    v_exp_f32 v186, v186
    v_mfma_f32_16x16x32_bf16 v[100:103], a[168:171], v[224:227], v[100:103]
    ds_read_b128 a[120:123], v2 offset:14336
    v_cvt_pk_bf16_f32 v219, v166, v167
    v_mfma_f32_16x16x32_bf16 v[100:103], a[172:175], v[228:231], v[100:103]
    v_exp_f32 v187, v187
    v_mfma_f32_16x16x32_bf16 v[104:107], a[176:179], v[224:227], v[104:107]
    v_cvt_pk_bf16_f32 v220, v168, v169
    v_mfma_f32_16x16x32_bf16 v[104:107], a[180:183], v[228:231], v[104:107]
    v_exp_f32 v188, v188
    v_mfma_f32_16x16x32_bf16 v[108:111], a[184:187], v[224:227], v[108:111]
    ds_read_b128 a[124:127], v2 offset:15360
    v_cvt_pk_bf16_f32 v221, v170, v171
    v_mfma_f32_16x16x32_bf16 v[108:111], a[188:191], v[228:231], v[108:111]
    v_exp_f32 v189, v189
    v_smfmac_f32_16x16x64_bf16 a[204:207], a[208:211], v[232:239], v7
    v_cvt_pk_bf16_f32 v222, v172, v173
    v_mfma_f32_16x16x32_bf16 v[112:115], a[128:131], v[232:235], v[112:115]
    v_exp_f32 v190, v190
    v_mfma_f32_16x16x32_bf16 v[112:115], a[132:135], v[236:239], v[112:115]
    v_cvt_pk_bf16_f32 v223, v174, v175
    v_mfma_f32_16x16x32_bf16 v[116:119], a[136:139], v[232:235], v[116:119]
    v_exp_f32 v191, v191
    v_mfma_f32_16x16x32_bf16 v[116:119], a[140:143], v[236:239], v[116:119]
    v_exp_f32 v192, v192
    v_mfma_f32_16x16x32_bf16 v[120:123], a[144:147], v[232:235], v[120:123]
    v_exp_f32 v193, v193
    v_mfma_f32_16x16x32_bf16 v[120:123], a[148:151], v[236:239], v[120:123]
    v_exp_f32 v194, v194
    v_mfma_f32_16x16x32_bf16 v[124:127], a[152:155], v[232:235], v[124:127]
    v_exp_f32 v195, v195
    v_mfma_f32_16x16x32_bf16 v[124:127], a[156:159], v[236:239], v[124:127]
    v_mfma_f32_16x16x32_bf16 v[128:131], a[160:163], v[232:235], v[128:131]
    v_exp_f32 v196, v196
    v_mfma_f32_16x16x32_bf16 v[128:131], a[164:167], v[236:239], v[128:131]
    v_mfma_f32_16x16x32_bf16 v[132:135], a[168:171], v[232:235], v[132:135]
    v_exp_f32 v197, v197
    v_mfma_f32_16x16x32_bf16 v[132:135], a[172:175], v[236:239], v[132:135]
    s_waitcnt vmcnt(0) lgkmcnt(0)
    s_barrier
    v_mfma_f32_16x16x32_bf16 v[136:139], a[176:179], v[232:235], v[136:139]
    s_cmp_lt_u32 s28, s48
    v_xor_b32 v2, 0x4000, v2
    v_mfma_f32_16x16x32_bf16 v[136:139], a[180:183], v[236:239], v[136:139]
    v_exp_f32 v198, v198
    v_mfma_f32_16x16x32_bf16 v[140:143], a[184:187], v[232:235], v[140:143]
    v_exp_f32 v199, v199
    v_mfma_f32_16x16x32_bf16 v[140:143], a[188:191], v[236:239], v[140:143]
    s_cbranch_scc1 L_a_NNA
L_a_skipA:
    s_mov_b32 s48, s57
    s_cmp_lt_u32 s28, s48
    s_cbranch_scc0 L_a_skipB
.p2align 6
L_a_NNB:
    v_mfma_f32_16x16x32_bf16 v[144:147], a[64:67], a[0:3], v[240:243]
    s_add_u32 m0, s36, 32768
    v_exp_f32 v200, v200
    v_mfma_f32_16x16x32_bf16 v[144:147], a[68:71], a[4:7], v[144:147]
    ds_read_b128 a[128:131], v3 offset:32768
    v_cvt_pk_bf16_f32 v224, v176, v177
    v_mfma_f32_16x16x32_bf16 v[144:147], a[72:75], a[8:11], v[144:147]
    s_add_u32 s28, s28, 1
    v_exp_f32 v201, v201
    v_mfma_f32_16x16x32_bf16 v[144:147], a[76:79], a[12:15], v[144:147]
    ds_read_b128 a[132:135], v3 offset:33792
    v_cvt_pk_bf16_f32 v225, v178, v179
    v_mfma_f32_16x16x32_bf16 v[148:151], a[80:83], a[0:3], v[240:243]
    v_exp_f32 v202, v202
    v_mfma_f32_16x16x32_bf16 v[148:151], a[84:87], a[4:7], v[148:151]
    v_cvt_pk_bf16_f32 v226, v180, v181
    v_mfma_f32_16x16x32_bf16 v[148:151], a[88:91], a[8:11], v[148:151]
    buffer_load_dwordx4 v4, s[16:19], s32 offen offset:0 sc1 lds
    v_mfma_f32_16x16x32_bf16 v[148:151], a[92:95], a[12:15], v[148:151]
    ds_read_b128 a[136:139], v3 offset:34816
    v_mfma_f32_16x16x32_bf16 v[152:155], a[96:99], a[0:3], v[240:243]
    v_exp_f32 v203, v203
    v_mfma_f32_16x16x32_bf16 v[152:155], a[100:103], a[4:7], v[152:155]
    v_cvt_pk_bf16_f32 v227, v182, v183
    v_mfma_f32_16x16x32_bf16 v[152:155], a[104:107], a[8:11], v[152:155]
    buffer_load_dwordx4 v4, s[16:19], s32 offen offset:1024 sc1 lds
    v_mfma_f32_16x16x32_bf16 v[152:155], a[108:111], a[12:15], v[152:155]
    v_exp_f32 v204, v204
    v_mfma_f32_16x16x32_bf16 v[156:159], a[112:115], a[0:3], v[240:243]
    ds_read_b128 a[140:143], v3 offset:35840
    v_cvt_pk_bf16_f32 v228, v184, v185
    v_mfma_f32_16x16x32_bf16 v[156:159], a[116:119], a[4:7], v[156:159]
    buffer_load_dwordx4 v4, s[16:19], s32 offen offset:2048 sc1 lds
    v_mfma_f32_16x16x32_bf16 v[156:159], a[120:123], a[8:11], v[156:159]
    v_exp_f32 v205, v205
    v_mfma_f32_16x16x32_bf16 v[156:159], a[124:127], a[12:15], v[156:159]
    ds_read_b128 a[144:147], v3 offset:36864
    v_cvt_pk_bf16_f32 v229, v186, v187
    v_mfma_f32_16x16x32_bf16 v[160:163], a[64:67], a[16:19], v[244:247]
    buffer_load_dwordx4 v4, s[16:19], s32 offen offset:3072 sc1 lds
    v_mfma_f32_16x16x32_bf16 v[160:163], a[68:71], a[20:23], v[160:163]
    s_mov_b32 m0, s36
    v_exp_f32 v206, v206
    v_mfma_f32_16x16x32_bf16 v[160:163], a[72:75], a[24:27], v[160:163]
    ds_read_b128 a[148:151], v3 offset:37888
    v_cvt_pk_bf16_f32 v230, v188, v189
    v_mfma_f32_16x16x32_bf16 v[160:163], a[76:79], a[28:31], v[160:163]
    s_mov_b32 s32, s31
    v_exp_f32 v207, v207
    v_mfma_f32_16x16x32_bf16 v[164:167], a[80:83], a[16:19], v[244:247]
    v_cvt_pk_bf16_f32 v231, v190, v191
    v_cvt_pk_bf16_f32 v232, v192, v193
    v_mfma_f32_16x16x32_bf16 v[164:167], a[84:87], a[20:23], v[164:167]
    v_exp_f32 v144, v144
    v_mfma_f32_16x16x32_bf16 v[164:167], a[88:91], a[24:27], v[164:167]
    ds_read_b128 a[152:155], v3 offset:38912
    v_cvt_pk_bf16_f32 v233, v194, v195
    v_mfma_f32_16x16x32_bf16 v[164:167], a[92:95], a[28:31], v[164:167]
    buffer_load_dwordx4 v4, s[12:15], s30 offen offset:0 sc1 lds
    v_mfma_f32_16x16x32_bf16 v[168:171], a[96:99], a[16:19], v[244:247]
    v_exp_f32 v145, v145
    v_mfma_f32_16x16x32_bf16 v[168:171], a[100:103], a[20:23], v[168:171]
    ds_read_b128 a[156:159], v3 offset:39936
    v_cvt_pk_bf16_f32 v234, v196, v197
    v_mfma_f32_16x16x32_bf16 v[168:171], a[104:107], a[24:27], v[168:171]
    v_exp_f32 v146, v146
    v_mfma_f32_16x16x32_bf16 v[168:171], a[108:111], a[28:31], v[168:171]
    buffer_load_dwordx4 v4, s[12:15], s30 offen offset:1024 sc1 lds
    v_mfma_f32_16x16x32_bf16 v[172:175], a[112:115], a[16:19], v[244:247]
    ds_read_b128 a[160:163], v3 offset:40960
    v_cvt_pk_bf16_f32 v235, v198, v199
    v_mfma_f32_16x16x32_bf16 v[172:175], a[116:119], a[20:23], v[172:175]
    v_exp_f32 v147, v147
    v_mfma_f32_16x16x32_bf16 v[172:175], a[120:123], a[24:27], v[172:175]
    buffer_load_dwordx4 v4, s[12:15], s30 offen offset:2048 sc1 lds
    v_mfma_f32_16x16x32_bf16 v[172:175], a[124:127], a[28:31], v[172:175]
    ds_read_b128 a[164:167], v3 offset:41984
    v_cvt_pk_bf16_f32 v236, v200, v201
    v_mfma_f32_16x16x32_bf16 v[176:179], a[64:67], a[32:35], v[248:251]
    v_exp_f32 v148, v148
    v_mfma_f32_16x16x32_bf16 v[176:179], a[68:71], a[36:39], v[176:179]
    buffer_load_dwordx4 v4, s[12:15], s30 offen offset:3072 sc1 lds
    v_mfma_f32_16x16x32_bf16 v[176:179], a[72:75], a[40:43], v[176:179]
    s_mov_b32 s31, s30
    v_cvt_pk_bf16_f32 v237, v202, v203
    v_mfma_f32_16x16x32_bf16 v[176:179], a[76:79], a[44:47], v[176:179]
    s_add_u32 m0, s36, 98304
    v_exp_f32 v149, v149
    v_mfma_f32_16x16x32_bf16 v[180:183], a[80:83], a[32:35], v[248:251]
    ds_read_b128 a[168:171], v3 offset:43008
    v_cvt_pk_bf16_f32 v238, v204, v205
    v_mfma_f32_16x16x32_bf16 v[180:183], a[84:87], a[36:39], v[180:183]
    s_cmp_gt_u32 s28, s26
    v_exp_f32 v150, v150
    v_mfma_f32_16x16x32_bf16 v[180:183], a[88:91], a[40:43], v[180:183]
    ds_read_b128 a[172:175], v3 offset:44032
    v_cvt_pk_bf16_f32 v239, v206, v207
    v_mfma_f32_16x16x32_bf16 v[180:183], a[92:95], a[44:47], v[180:183]
    v_exp_f32 v151, v151
    v_mfma_f32_16x16x32_bf16 v[184:187], a[96:99], a[32:35], v[248:251]
    v_exp_f32 v152, v152
    v_mfma_f32_16x16x32_bf16 v[184:187], a[100:103], a[36:39], v[184:187]
    v_exp_f32 v153, v153
    v_mfma_f32_16x16x32_bf16 v[184:187], a[104:107], a[40:43], v[184:187]
    v_exp_f32 v154, v154
    v_mfma_f32_16x16x32_bf16 v[184:187], a[108:111], a[44:47], v[184:187]
    ds_read_b128 a[176:179], v3 offset:45056
    v_mfma_f32_16x16x32_bf16 v[188:191], a[112:115], a[32:35], v[248:251]
    buffer_load_dwordx4 v4, s[16:19], s35 offen offset:0 sc1 lds
    v_mfma_f32_16x16x32_bf16 v[188:191], a[116:119], a[36:39], v[188:191]
    s_cselect_b32 s50, 0x10000, s53
    v_exp_f32 v155, v155
    v_mfma_f32_16x16x32_bf16 v[188:191], a[120:123], a[40:43], v[188:191]
    ds_read_b128 a[180:183], v3 offset:46080
    v_mfma_f32_16x16x32_bf16 v[188:191], a[124:127], a[44:47], v[188:191]
    v_exp_f32 v156, v156
    v_mfma_f32_16x16x32_bf16 v[192:195], a[64:67], a[48:51], v[252:255]
    buffer_load_dwordx4 v4, s[16:19], s35 offen offset:1024 sc1 lds
    v_mfma_f32_16x16x32_bf16 v[192:195], a[68:71], a[52:55], v[192:195]
    s_add_u32 s29, s29, s50
    v_exp_f32 v157, v157
    v_mfma_f32_16x16x32_bf16 v[192:195], a[72:75], a[56:59], v[192:195]
    ds_read_b128 a[184:187], v3 offset:47104
    v_mfma_f32_16x16x32_bf16 v[192:195], a[76:79], a[60:63], v[192:195]
    v_exp_f32 v158, v158
    v_mfma_f32_16x16x32_bf16 v[196:199], a[80:83], a[48:51], v[252:255]
    v_exp_f32 v159, v159
    v_mfma_f32_16x16x32_bf16 v[196:199], a[84:87], a[52:55], v[196:199]
    ds_read_b128 a[188:191], v3 offset:48128
    v_mfma_f32_16x16x32_bf16 v[196:199], a[88:91], a[56:59], v[196:199]
    buffer_load_dwordx4 v4, s[16:19], s35 offen offset:2048 sc1 lds
    v_mfma_f32_16x16x32_bf16 v[196:199], a[92:95], a[60:63], v[196:199]
    s_cmp_gt_u32 s28, 16
    v_exp_f32 v160, v160
    v_mfma_f32_16x16x32_bf16 v[200:203], a[96:99], a[48:51], v[252:255]
    v_exp_f32 v161, v161
    v_mfma_f32_16x16x32_bf16 v[200:203], a[100:103], a[52:55], v[200:203]
    v_xor_b32 v3, 0x4000, v3
    v_mfma_f32_16x16x32_bf16 v[200:203], a[104:107], a[56:59], v[200:203]
    v_exp_f32 v162, v162
    v_mfma_f32_16x16x32_bf16 v[200:203], a[108:111], a[60:63], v[200:203]
    buffer_load_dwordx4 v4, s[16:19], s35 offen offset:3072 sc1 lds
    v_mfma_f32_16x16x32_bf16 v[204:207], a[112:115], a[48:51], v[252:255]
    s_cselect_b32 s30, s66, s29
    v_exp_f32 v163, v163
    v_mfma_f32_16x16x32_bf16 v[204:207], a[116:119], a[52:55], v[204:207]
    s_add_u32 m0, s36, 65536
    v_exp_f32 v164, v164
    v_mfma_f32_16x16x32_bf16 v[204:207], a[120:123], a[56:59], v[204:207]
    v_exp_f32 v165, v165
    v_mfma_f32_16x16x32_bf16 v[204:207], a[124:127], a[60:63], v[204:207]
    s_waitcnt lgkmcnt(0)
    v_smfmac_f32_16x16x64_bf16 a[192:195], a[208:211], v[208:215], v7
    ds_read_b128 a[64:67], v2 offset:0
    v_mfma_f32_16x16x32_bf16 v[16:19], a[128:131], v[208:211], v[16:19]
    s_mov_b32 s35, s34
    v_exp_f32 v166, v166
    v_mfma_f32_16x16x32_bf16 v[16:19], a[132:135], v[212:215], v[16:19]
    v_exp_f32 v167, v167
    v_mfma_f32_16x16x32_bf16 v[20:23], a[136:139], v[208:211], v[20:23]
    ds_read_b128 a[68:71], v2 offset:1024
    v_mfma_f32_16x16x32_bf16 v[20:23], a[140:143], v[212:215], v[20:23]
    buffer_load_dwordx4 v4, s[12:15], s33 offen offset:0 sc1 lds
    v_mfma_f32_16x16x32_bf16 v[24:27], a[144:147], v[208:211], v[24:27]
    v_exp_f32 v168, v168
    v_mfma_f32_16x16x32_bf16 v[24:27], a[148:151], v[212:215], v[24:27]
    ds_read_b128 a[72:75], v2 offset:2048
    v_mfma_f32_16x16x32_bf16 v[28:31], a[152:155], v[208:211], v[28:31]
    buffer_load_dwordx4 v4, s[12:15], s33 offen offset:1024 sc1 lds
    v_mfma_f32_16x16x32_bf16 v[28:31], a[156:159], v[212:215], v[28:31]
    v_exp_f32 v169, v169
    v_mfma_f32_16x16x32_bf16 v[32:35], a[160:163], v[208:211], v[32:35]
    ds_read_b128 a[76:79], v2 offset:3072
    v_mfma_f32_16x16x32_bf16 v[32:35], a[164:167], v[212:215], v[32:35]
    v_exp_f32 v170, v170
    v_mfma_f32_16x16x32_bf16 v[36:39], a[168:171], v[208:211], v[36:39]
    buffer_load_dwordx4 v4, s[12:15], s33 offen offset:2048 sc1 lds
    v_mfma_f32_16x16x32_bf16 v[36:39], a[172:175], v[212:215], v[36:39]
    v_exp_f32 v171, v171
    v_mfma_f32_16x16x32_bf16 v[40:43], a[176:179], v[208:211], v[40:43]
    ds_read_b128 a[80:83], v2 offset:4096
    v_mfma_f32_16x16x32_bf16 v[40:43], a[180:183], v[212:215], v[40:43]
    buffer_load_dwordx4 v4, s[12:15], s33 offen offset:3072 sc1 lds
    v_mfma_f32_16x16x32_bf16 v[44:47], a[184:187], v[208:211], v[44:47]
    s_mov_b32 s34, s33
    v_exp_f32 v172, v172
    v_mfma_f32_16x16x32_bf16 v[44:47], a[188:191], v[212:215], v[44:47]
    ds_read_b128 a[84:87], v2 offset:5120
    v_smfmac_f32_16x16x64_bf16 a[196:199], a[208:211], v[216:223], v7
    s_sub_u32 s33, s30, 32768
    v_exp_f32 v173, v173
    v_mfma_f32_16x16x32_bf16 v[48:51], a[128:131], v[216:219], v[48:51]
    s_cmp_eq_u32 s28, s26
    v_exp_f32 v174, v174
    v_mfma_f32_16x16x32_bf16 v[48:51], a[132:135], v[220:223], v[48:51]
    ds_read_b128 a[88:91], v2 offset:6144
    v_cvt_pk_bf16_f32 v208, v144, v145
    v_mfma_f32_16x16x32_bf16 v[52:55], a[136:139], v[216:219], v[52:55]
    v_exp_f32 v175, v175
    v_mfma_f32_16x16x32_bf16 v[52:55], a[140:143], v[220:223], v[52:55]
    s_cselect_b32 s33, s37, s33
    v_cvt_pk_bf16_f32 v209, v146, v147
    v_mfma_f32_16x16x32_bf16 v[56:59], a[144:147], v[216:219], v[56:59]
    ds_read_b128 a[92:95], v2 offset:7168
    v_mfma_f32_16x16x32_bf16 v[56:59], a[148:151], v[220:223], v[56:59]
    v_exp_f32 v176, v176
    v_mfma_f32_16x16x32_bf16 v[60:63], a[152:155], v[216:219], v[60:63]
    s_cmp_lt_u32 s28, s26
    v_cvt_pk_bf16_f32 v210, v148, v149
    v_mfma_f32_16x16x32_bf16 v[60:63], a[156:159], v[220:223], v[60:63]
    v_exp_f32 v177, v177
    v_mfma_f32_16x16x32_bf16 v[64:67], a[160:163], v[216:219], v[64:67]
    ds_read_b128 a[96:99], v2 offset:8192
    v_cvt_pk_bf16_f32 v211, v150, v151
    v_mfma_f32_16x16x32_bf16 v[64:67], a[164:167], v[220:223], v[64:67]
    s_cselect_b32 s33, s49, s33
    v_exp_f32 v178, v178
    v_mfma_f32_16x16x32_bf16 v[68:71], a[168:171], v[216:219], v[68:71]
    v_cvt_pk_bf16_f32 v212, v152, v153
    v_mfma_f32_16x16x32_bf16 v[68:71], a[172:175], v[220:223], v[68:71]
    ds_read_b128 a[100:103], v2 offset:9216
    v_mfma_f32_16x16x32_bf16 v[72:75], a[176:179], v[216:219], v[72:75]
    s_xor_b32 s36, s36, 16384
    v_exp_f32 v179, v179
    v_mfma_f32_16x16x32_bf16 v[72:75], a[180:183], v[220:223], v[72:75]
    v_cvt_pk_bf16_f32 v213, v154, v155
    v_mfma_f32_16x16x32_bf16 v[76:79], a[184:187], v[216:219], v[76:79]
    v_exp_f32 v180, v180
    v_mfma_f32_16x16x32_bf16 v[76:79], a[188:191], v[220:223], v[76:79]
    ds_read_b128 a[104:107], v2 offset:10240
    v_cvt_pk_bf16_f32 v214, v156, v157
    v_smfmac_f32_16x16x64_bf16 a[200:203], a[208:211], v[224:231], v7
    v_exp_f32 v181, v181
    v_mfma_f32_16x16x32_bf16 v[80:83], a[128:131], v[224:227], v[80:83]
    ds_read_b128 a[108:111], v2 offset:11264
    v_cvt_pk_bf16_f32 v215, v158, v159
    v_mfma_f32_16x16x32_bf16 v[80:83], a[132:135], v[228:231], v[80:83]
    v_exp_f32 v182, v182
    v_mfma_f32_16x16x32_bf16 v[84:87], a[136:139], v[224:227], v[84:87]
    v_exp_f32 v183, v183
    v_mfma_f32_16x16x32_bf16 v[84:87], a[140:143], v[228:231], v[84:87]
    v_cvt_pk_bf16_f32 v216, v160, v161
    v_mfma_f32_16x16x32_bf16 v[88:91], a[144:147], v[224:227], v[88:91]
    ds_read_b128 a[112:115], v2 offset:12288
    v_mfma_f32_16x16x32_bf16 v[88:91], a[148:151], v[228:231], v[88:91]
    v_exp_f32 v184, v184
    v_mfma_f32_16x16x32_bf16 v[92:95], a[152:155], v[224:227], v[92:95]
    v_cvt_pk_bf16_f32 v217, v162, v163
    v_mfma_f32_16x16x32_bf16 v[92:95], a[156:159], v[228:231], v[92:95]
    v_exp_f32 v185, v185
    v_mfma_f32_16x16x32_bf16 v[96:99], a[160:163], v[224:227], v[96:99]
    ds_read_b128 a[116:119], v2 offset:13312
    v_cvt_pk_bf16_f32 v218, v164, v165
    v_mfma_f32_16x16x32_bf16 v[96:99], a[164:167], v[228:231], v[96:99]
    v_exp_f32 v186, v186
    v_mfma_f32_16x16x32_bf16 v[100:103], a[168:171], v[224:227], v[100:103]
    ds_read_b128 a[120:123], v2 offset:14336
    v_cvt_pk_bf16_f32 v219, v166, v167
    v_mfma_f32_16x16x32_bf16 v[100:103], a[172:175], v[228:231], v[100:103]
    v_exp_f32 v187, v187
    v_mfma_f32_16x16x32_bf16 v[104:107], a[176:179], v[224:227], v[104:107]
    v_cvt_pk_bf16_f32 v220, v168, v169
    v_mfma_f32_16x16x32_bf16 v[104:107], a[180:183], v[228:231], v[104:107]
    v_exp_f32 v188, v188
    v_mfma_f32_16x16x32_bf16 v[108:111], a[184:187], v[224:227], v[108:111]
    ds_read_b128 a[124:127], v2 offset:15360
    v_cvt_pk_bf16_f32 v221, v170, v171
    v_mfma_f32_16x16x32_bf16 v[108:111], a[188:191], v[228:231], v[108:111]
    v_exp_f32 v189, v189
    v_smfmac_f32_16x16x64_bf16 a[204:207], a[208:211], v[232:239], v7
    v_cvt_pk_bf16_f32 v222, v172, v173
    v_mfma_f32_16x16x32_bf16 v[112:115], a[128:131], v[232:235], v[112:115]
    v_exp_f32 v190, v190
    v_mfma_f32_16x16x32_bf16 v[112:115], a[132:135], v[236:239], v[112:115]
    v_cvt_pk_bf16_f32 v223, v174, v175
    v_mfma_f32_16x16x32_bf16 v[116:119], a[136:139], v[232:235], v[116:119]
    v_exp_f32 v191, v191
    v_mfma_f32_16x16x32_bf16 v[116:119], a[140:143], v[236:239], v[116:119]
    v_exp_f32 v192, v192
    v_mfma_f32_16x16x32_bf16 v[120:123], a[144:147], v[232:235], v[120:123]
    v_exp_f32 v193, v193
    v_mfma_f32_16x16x32_bf16 v[120:123], a[148:151], v[236:239], v[120:123]
    v_exp_f32 v194, v194
    v_mfma_f32_16x16x32_bf16 v[124:127], a[152:155], v[232:235], v[124:127]
    v_exp_f32 v195, v195
    v_mfma_f32_16x16x32_bf16 v[124:127], a[156:159], v[236:239], v[124:127]
    v_mfma_f32_16x16x32_bf16 v[128:131], a[160:163], v[232:235], v[128:131]
    v_exp_f32 v196, v196
    v_mfma_f32_16x16x32_bf16 v[128:131], a[164:167], v[236:239], v[128:131]
    v_mfma_f32_16x16x32_bf16 v[132:135], a[168:171], v[232:235], v[132:135]
    v_exp_f32 v197, v197
    v_mfma_f32_16x16x32_bf16 v[132:135], a[172:175], v[236:239], v[132:135]
    s_waitcnt vmcnt(0) lgkmcnt(0)
    s_barrier
    v_mfma_f32_16x16x32_bf16 v[136:139], a[176:179], v[232:235], v[136:139]
    s_cmp_lt_u32 s28, s48
    v_xor_b32 v2, 0x4000, v2
    v_mfma_f32_16x16x32_bf16 v[136:139], a[180:183], v[236:239], v[136:139]
    v_exp_f32 v198, v198
    v_mfma_f32_16x16x32_bf16 v[140:143], a[184:187], v[232:235], v[140:143]
    v_exp_f32 v199, v199
    v_mfma_f32_16x16x32_bf16 v[140:143], a[188:191], v[236:239], v[140:143]
    s_cbranch_scc1 L_a_NNB
L_a_skipB:
    s_cmp_eq_u32 s58, 0
    s_cbranch_scc1 L_a_preDN
    s_cmp_eq_u32 s3, 0
    s_cbranch_scc1 L_a_seg
    v_mfma_f32_16x16x32_bf16 v[144:147], a[64:67], a[0:3], v[240:243]
    s_add_u32 m0, s36, 32768
    v_exp_f32 v200, v200
    v_mfma_f32_16x16x32_bf16 v[144:147], a[68:71], a[4:7], v[144:147]
    s_nop 0
    v_cvt_pk_bf16_f32 v224, v176, v177
    v_mfma_f32_16x16x32_bf16 v[144:147], a[72:75], a[8:11], v[144:147]
    ds_read_b128 a[128:131], v3 offset:32768
    v_mfma_f32_16x16x32_bf16 v[144:147], a[76:79], a[12:15], v[144:147]
    buffer_load_dwordx4 v4, s[16:19], s32 offen offset:0 sc1 lds
    v_mfma_f32_16x16x32_bf16 v[148:151], a[80:83], a[0:3], v[240:243]
    v_exp_f32 v201, v201
    v_mfma_f32_16x16x32_bf16 v[148:151], a[84:87], a[4:7], v[148:151]
    buffer_load_dwordx4 v4, s[16:19], s32 offen offset:1024 sc1 lds
    v_mfma_f32_16x16x32_bf16 v[148:151], a[88:91], a[8:11], v[148:151]
    buffer_load_dwordx4 v4, s[16:19], s32 offen offset:2048 sc1 lds
    v_mfma_f32_16x16x32_bf16 v[148:151], a[92:95], a[12:15], v[148:151]
    ds_read_b128 a[132:135], v3 offset:33792
    v_cvt_pk_bf16_f32 v225, v178, v179
    v_mfma_f32_16x16x32_bf16 v[152:155], a[96:99], a[0:3], v[240:243]
    v_exp_f32 v202, v202
    v_mfma_f32_16x16x32_bf16 v[152:155], a[100:103], a[4:7], v[152:155]
    buffer_load_dwordx4 v4, s[16:19], s32 offen offset:3072 sc1 lds
    v_mfma_f32_16x16x32_bf16 v[152:155], a[104:107], a[8:11], v[152:155]
    ds_read_b128 a[136:139], v3 offset:34816
    v_cvt_pk_bf16_f32 v226, v180, v181
    v_mfma_f32_16x16x32_bf16 v[152:155], a[108:111], a[12:15], v[152:155]
    s_add_u32 m0, s36, 98304
    v_exp_f32 v203, v203
    v_mfma_f32_16x16x32_bf16 v[156:159], a[112:115], a[0:3], v[240:243]
    s_add_u32 s30, s30, 4096
    v_cvt_pk_bf16_f32 v227, v182, v183
    v_mfma_f32_16x16x32_bf16 v[156:159], a[116:119], a[4:7], v[156:159]
    v_exp_f32 v204, v204
    v_mfma_f32_16x16x32_bf16 v[156:159], a[120:123], a[8:11], v[156:159]
    buffer_load_dwordx4 v4, s[16:19], s35 offen offset:0 sc1 lds
    v_mfma_f32_16x16x32_bf16 v[156:159], a[124:127], a[12:15], v[156:159]
    ds_read_b128 a[140:143], v3 offset:35840
    v_cvt_pk_bf16_f32 v228, v184, v185
    v_mfma_f32_16x16x32_bf16 v[160:163], a[64:67], a[16:19], v[244:247]
    buffer_load_dwordx4 v4, s[16:19], s35 offen offset:1024 sc1 lds
    v_mfma_f32_16x16x32_bf16 v[160:163], a[68:71], a[20:23], v[160:163]
    v_exp_f32 v205, v205
    v_mfma_f32_16x16x32_bf16 v[160:163], a[72:75], a[24:27], v[160:163]
    buffer_load_dwordx4 v4, s[16:19], s35 offen offset:2048 sc1 lds
    v_mfma_f32_16x16x32_bf16 v[160:163], a[76:79], a[28:31], v[160:163]
    ds_read_b128 a[144:147], v3 offset:36864
    v_cvt_pk_bf16_f32 v229, v186, v187
    v_mfma_f32_16x16x32_bf16 v[164:167], a[80:83], a[16:19], v[244:247]
    v_exp_f32 v206, v206
    v_mfma_f32_16x16x32_bf16 v[164:167], a[84:87], a[20:23], v[164:167]
    buffer_load_dwordx4 v4, s[16:19], s35 offen offset:3072 sc1 lds
    v_mfma_f32_16x16x32_bf16 v[164:167], a[88:91], a[24:27], v[164:167]
    ds_read_b128 a[148:151], v3 offset:37888
    v_cvt_pk_bf16_f32 v230, v188, v189
    v_mfma_f32_16x16x32_bf16 v[164:167], a[92:95], a[28:31], v[164:167]
    s_mov_b32 m0, s36
    v_exp_f32 v207, v207
    v_mfma_f32_16x16x32_bf16 v[168:171], a[96:99], a[16:19], v[244:247]
    s_nop 0
    v_cvt_pk_bf16_f32 v231, v190, v191
    v_cvt_pk_bf16_f32 v232, v192, v193
    v_mfma_f32_16x16x32_bf16 v[168:171], a[100:103], a[20:23], v[168:171]
    v_exp_f32 v144, v144
    v_mfma_f32_16x16x32_bf16 v[168:171], a[104:107], a[24:27], v[168:171]
    ds_read_b128 a[152:155], v3 offset:38912
    v_cvt_pk_bf16_f32 v233, v194, v195
    v_mfma_f32_16x16x32_bf16 v[168:171], a[108:111], a[28:31], v[168:171]
    v_exp_f32 v145, v145
    v_mfma_f32_16x16x32_bf16 v[172:175], a[112:115], a[16:19], v[244:247]
    ds_read_b128 a[156:159], v3 offset:39936
    v_cvt_pk_bf16_f32 v234, v196, v197
    v_mfma_f32_16x16x32_bf16 v[172:175], a[116:119], a[20:23], v[172:175]
    v_exp_f32 v146, v146
    v_mfma_f32_16x16x32_bf16 v[172:175], a[120:123], a[24:27], v[172:175]
    buffer_load_dwordx4 v4, s[12:15], s30 offen offset:0 sc1 lds
    v_mfma_f32_16x16x32_bf16 v[172:175], a[124:127], a[28:31], v[172:175]
    ds_read_b128 a[160:163], v3 offset:40960
    v_cvt_pk_bf16_f32 v235, v198, v199
    v_mfma_f32_16x16x32_bf16 v[176:179], a[64:67], a[32:35], v[248:251]
    v_exp_f32 v147, v147
    v_mfma_f32_16x16x32_bf16 v[176:179], a[68:71], a[36:39], v[176:179]
    ds_read_b128 a[164:167], v3 offset:41984
    v_cvt_pk_bf16_f32 v236, v200, v201
    v_mfma_f32_16x16x32_bf16 v[176:179], a[72:75], a[40:43], v[176:179]
    v_exp_f32 v148, v148
    v_mfma_f32_16x16x32_bf16 v[176:179], a[76:79], a[44:47], v[176:179]
    buffer_load_dwordx4 v4, s[12:15], s30 offen offset:1024 sc1 lds
    v_mfma_f32_16x16x32_bf16 v[180:183], a[80:83], a[32:35], v[248:251]
    ds_read_b128 a[168:171], v3 offset:43008
    v_cvt_pk_bf16_f32 v237, v202, v203
    v_mfma_f32_16x16x32_bf16 v[180:183], a[84:87], a[36:39], v[180:183]
    v_exp_f32 v149, v149
    v_mfma_f32_16x16x32_bf16 v[180:183], a[88:91], a[40:43], v[180:183]
    buffer_load_dwordx4 v4, s[12:15], s30 offen offset:2048 sc1 lds
    v_mfma_f32_16x16x32_bf16 v[180:183], a[92:95], a[44:47], v[180:183]
    ds_read_b128 a[172:175], v3 offset:44032
    v_cvt_pk_bf16_f32 v238, v204, v205
    v_mfma_f32_16x16x32_bf16 v[184:187], a[96:99], a[32:35], v[248:251]
    v_exp_f32 v150, v150
    v_mfma_f32_16x16x32_bf16 v[184:187], a[100:103], a[36:39], v[184:187]
    ds_read_b128 a[176:179], v3 offset:45056
    v_cvt_pk_bf16_f32 v239, v206, v207
    v_mfma_f32_16x16x32_bf16 v[184:187], a[104:107], a[40:43], v[184:187]
    buffer_load_dwordx4 v4, s[12:15], s30 offen offset:3072 sc1 lds
    v_exp_f32 v151, v151
    v_mfma_f32_16x16x32_bf16 v[184:187], a[108:111], a[44:47], v[184:187]
    s_mov_b32 s56, 8192
    v_exp_f32 v152, v152
    v_mfma_f32_16x16x32_bf16 v[188:191], a[112:115], a[32:35], v[248:251]
    v_exp_f32 v153, v153
    v_mfma_f32_16x16x32_bf16 v[188:191], a[116:119], a[36:39], v[188:191]
    v_exp_f32 v154, v154
    v_mfma_f32_16x16x32_bf16 v[188:191], a[120:123], a[40:43], v[188:191]
    buffer_load_dwordx4 a[224:227], v15, s[8:11], s56 offen offset:0 sc1
    v_mfma_f32_16x16x32_bf16 v[188:191], a[124:127], a[44:47], v[188:191]
    v_exp_f32 v155, v155
    v_mfma_f32_16x16x32_bf16 v[192:195], a[64:67], a[48:51], v[252:255]
    ds_read_b128 a[180:183], v3 offset:46080
    v_mfma_f32_16x16x32_bf16 v[192:195], a[68:71], a[52:55], v[192:195]
    buffer_load_dwordx4 a[228:231], v15, s[8:11], s56 offen offset:1024 sc1
    v_mfma_f32_16x16x32_bf16 v[192:195], a[72:75], a[56:59], v[192:195]
    v_exp_f32 v156, v156
    v_mfma_f32_16x16x32_bf16 v[192:195], a[76:79], a[60:63], v[192:195]
    v_exp_f32 v157, v157
    v_mfma_f32_16x16x32_bf16 v[196:199], a[80:83], a[48:51], v[252:255]
    buffer_load_dwordx4 a[232:235], v15, s[8:11], s56 offen offset:2048 sc1
    v_mfma_f32_16x16x32_bf16 v[196:199], a[84:87], a[52:55], v[196:199]
    ds_read_b128 a[184:187], v3 offset:47104
    v_mfma_f32_16x16x32_bf16 v[196:199], a[88:91], a[56:59], v[196:199]
    v_exp_f32 v158, v158
    v_mfma_f32_16x16x32_bf16 v[196:199], a[92:95], a[60:63], v[196:199]
    buffer_load_dwordx4 a[236:239], v15, s[8:11], s56 offen offset:3072 sc1
    v_mfma_f32_16x16x32_bf16 v[200:203], a[96:99], a[48:51], v[252:255]
    s_mov_b32 s56, 12288
    v_exp_f32 v159, v159
    v_mfma_f32_16x16x32_bf16 v[200:203], a[100:103], a[52:55], v[200:203]
    ds_read_b128 a[188:191], v3 offset:48128
    v_xor_b32 v3, 0x4000, v3
    v_mfma_f32_16x16x32_bf16 v[200:203], a[104:107], a[56:59], v[200:203]
    v_exp_f32 v160, v160
    v_mfma_f32_16x16x32_bf16 v[200:203], a[108:111], a[60:63], v[200:203]
    v_exp_f32 v161, v161
    v_mfma_f32_16x16x32_bf16 v[204:207], a[112:115], a[48:51], v[252:255]
    buffer_load_dwordx4 a[240:243], v15, s[8:11], s56 offen offset:0 sc1
    v_mfma_f32_16x16x32_bf16 v[204:207], a[116:119], a[52:55], v[204:207]
    v_exp_f32 v162, v162
    v_mfma_f32_16x16x32_bf16 v[204:207], a[120:123], a[56:59], v[204:207]
    v_exp_f32 v163, v163
    v_mfma_f32_16x16x32_bf16 v[204:207], a[124:127], a[60:63], v[204:207]
    s_waitcnt lgkmcnt(0)
    v_exp_f32 v164, v164
    v_smfmac_f32_16x16x64_bf16 a[192:195], a[208:211], v[208:215], v7
    buffer_load_dwordx4 a[244:247], v15, s[8:11], s56 offen offset:1024 sc1
    v_mfma_f32_16x16x32_bf16 v[16:19], a[128:131], v[208:211], v[16:19]
    buffer_load_dwordx4 a[248:251], v15, s[8:11], s56 offen offset:2048 sc1
    v_mfma_f32_16x16x32_bf16 v[16:19], a[132:135], v[212:215], v[16:19]
    v_exp_f32 v165, v165
    v_mfma_f32_16x16x32_bf16 v[20:23], a[136:139], v[208:211], v[20:23]
    v_exp_f32 v166, v166
    v_mfma_f32_16x16x32_bf16 v[20:23], a[140:143], v[212:215], v[20:23]
    buffer_load_dwordx4 a[252:255], v15, s[8:11], s56 offen offset:3072 sc1
    v_mfma_f32_16x16x32_bf16 v[24:27], a[144:147], v[208:211], v[24:27]
    s_mov_b32 s56, 16384
    v_exp_f32 v167, v167
    v_mfma_f32_16x16x32_bf16 v[24:27], a[148:151], v[212:215], v[24:27]
    v_exp_f32 v168, v168
    v_mfma_f32_16x16x32_bf16 v[28:31], a[152:155], v[208:211], v[28:31]
    v_exp_f32 v169, v169
    v_mfma_f32_16x16x32_bf16 v[28:31], a[156:159], v[212:215], v[28:31]
    buffer_load_dwordx4 a[0:3], v15, s[8:11], s56 offen offset:0 sc1
    v_mfma_f32_16x16x32_bf16 v[32:35], a[160:163], v[208:211], v[32:35]
    v_exp_f32 v170, v170
    v_mfma_f32_16x16x32_bf16 v[32:35], a[164:167], v[212:215], v[32:35]
    buffer_load_dwordx4 a[4:7], v15, s[8:11], s56 offen offset:1024 sc1
    v_mfma_f32_16x16x32_bf16 v[36:39], a[168:171], v[208:211], v[36:39]
    v_exp_f32 v171, v171
    v_mfma_f32_16x16x32_bf16 v[36:39], a[172:175], v[212:215], v[36:39]
    v_exp_f32 v172, v172
    v_mfma_f32_16x16x32_bf16 v[40:43], a[176:179], v[208:211], v[40:43]
    buffer_load_dwordx4 a[8:11], v15, s[8:11], s56 offen offset:2048 sc1
    v_mfma_f32_16x16x32_bf16 v[40:43], a[180:183], v[212:215], v[40:43]
    v_exp_f32 v173, v173
    v_mfma_f32_16x16x32_bf16 v[44:47], a[184:187], v[208:211], v[44:47]
    v_mfma_f32_16x16x32_bf16 v[44:47], a[188:191], v[212:215], v[44:47]
    buffer_load_dwordx4 a[12:15], v15, s[8:11], s56 offen offset:3072 sc1
    v_smfmac_f32_16x16x64_bf16 a[196:199], a[208:211], v[216:223], v7
    v_exp_f32 v174, v174
    v_mfma_f32_16x16x32_bf16 v[48:51], a[128:131], v[216:219], v[48:51]
    v_cvt_pk_bf16_f32 v208, v144, v145
    v_mfma_f32_16x16x32_bf16 v[48:51], a[132:135], v[220:223], v[48:51]
    s_mov_b32 s56, 20480
    v_exp_f32 v175, v175
    v_mfma_f32_16x16x32_bf16 v[52:55], a[136:139], v[216:219], v[52:55]
    v_cvt_pk_bf16_f32 v209, v146, v147
    v_mfma_f32_16x16x32_bf16 v[52:55], a[140:143], v[220:223], v[52:55]
    v_exp_f32 v176, v176
    v_mfma_f32_16x16x32_bf16 v[56:59], a[144:147], v[216:219], v[56:59]
    buffer_load_dwordx4 a[16:19], v15, s[8:11], s56 offen offset:0 sc1
    v_mfma_f32_16x16x32_bf16 v[56:59], a[148:151], v[220:223], v[56:59]
    v_cvt_pk_bf16_f32 v210, v148, v149
    v_mfma_f32_16x16x32_bf16 v[60:63], a[152:155], v[216:219], v[60:63]
    v_exp_f32 v177, v177
    v_mfma_f32_16x16x32_bf16 v[60:63], a[156:159], v[220:223], v[60:63]
    v_cvt_pk_bf16_f32 v211, v150, v151
    v_mfma_f32_16x16x32_bf16 v[64:67], a[160:163], v[216:219], v[64:67]
    buffer_load_dwordx4 a[20:23], v15, s[8:11], s56 offen offset:1024 sc1
    v_mfma_f32_16x16x32_bf16 v[64:67], a[164:167], v[220:223], v[64:67]
    v_exp_f32 v178, v178
    v_mfma_f32_16x16x32_bf16 v[68:71], a[168:171], v[216:219], v[68:71]
    v_cvt_pk_bf16_f32 v212, v152, v153
    v_mfma_f32_16x16x32_bf16 v[68:71], a[172:175], v[220:223], v[68:71]
    v_exp_f32 v179, v179
    v_mfma_f32_16x16x32_bf16 v[72:75], a[176:179], v[216:219], v[72:75]
    buffer_load_dwordx4 a[24:27], v15, s[8:11], s56 offen offset:2048 sc1
    v_mfma_f32_16x16x32_bf16 v[72:75], a[180:183], v[220:223], v[72:75]
    v_cvt_pk_bf16_f32 v213, v154, v155
    v_mfma_f32_16x16x32_bf16 v[76:79], a[184:187], v[216:219], v[76:79]
    v_exp_f32 v180, v180
    v_mfma_f32_16x16x32_bf16 v[76:79], a[188:191], v[220:223], v[76:79]
    v_cvt_pk_bf16_f32 v214, v156, v157
    v_smfmac_f32_16x16x64_bf16 a[200:203], a[208:211], v[224:231], v7
    buffer_load_dwordx4 a[28:31], v15, s[8:11], s56 offen offset:3072 sc1
    v_mfma_f32_16x16x32_bf16 v[80:83], a[128:131], v[224:227], v[80:83]
    s_mov_b32 s56, 28672
    v_exp_f32 v181, v181
    v_mfma_f32_16x16x32_bf16 v[80:83], a[132:135], v[228:231], v[80:83]
    v_cvt_pk_bf16_f32 v215, v158, v159
    v_mfma_f32_16x16x32_bf16 v[84:87], a[136:139], v[224:227], v[84:87]
    v_exp_f32 v182, v182
    v_mfma_f32_16x16x32_bf16 v[84:87], a[140:143], v[228:231], v[84:87]
    v_exp_f32 v183, v183
    v_mfma_f32_16x16x32_bf16 v[88:91], a[144:147], v[224:227], v[88:91]
    v_cvt_pk_bf16_f32 v216, v160, v161
    v_mfma_f32_16x16x32_bf16 v[88:91], a[148:151], v[228:231], v[88:91]
    buffer_load_dwordx4 a[32:35], v15, s[8:11], s56 offen offset:0 sc1
    v_mfma_f32_16x16x32_bf16 v[92:95], a[152:155], v[224:227], v[92:95]
    v_exp_f32 v184, v184
    v_mfma_f32_16x16x32_bf16 v[92:95], a[156:159], v[228:231], v[92:95]
    v_cvt_pk_bf16_f32 v217, v162, v163
    v_mfma_f32_16x16x32_bf16 v[96:99], a[160:163], v[224:227], v[96:99]
    v_exp_f32 v185, v185
    v_mfma_f32_16x16x32_bf16 v[96:99], a[164:167], v[228:231], v[96:99]
    v_cvt_pk_bf16_f32 v218, v164, v165
    v_mfma_f32_16x16x32_bf16 v[100:103], a[168:171], v[224:227], v[100:103]
    buffer_load_dwordx4 a[36:39], v15, s[8:11], s56 offen offset:1024 sc1
    v_mfma_f32_16x16x32_bf16 v[100:103], a[172:175], v[228:231], v[100:103]
    v_exp_f32 v186, v186
    v_mfma_f32_16x16x32_bf16 v[104:107], a[176:179], v[224:227], v[104:107]
    v_cvt_pk_bf16_f32 v219, v166, v167
    v_mfma_f32_16x16x32_bf16 v[104:107], a[180:183], v[228:231], v[104:107]
    buffer_load_dwordx4 a[40:43], v15, s[8:11], s56 offen offset:2048 sc1
    v_mfma_f32_16x16x32_bf16 v[108:111], a[184:187], v[224:227], v[108:111]
    v_exp_f32 v187, v187
    v_mfma_f32_16x16x32_bf16 v[108:111], a[188:191], v[228:231], v[108:111]
    v_cvt_pk_bf16_f32 v220, v168, v169
    v_smfmac_f32_16x16x64_bf16 a[204:207], a[208:211], v[232:239], v7
    v_exp_f32 v188, v188
    v_mfma_f32_16x16x32_bf16 v[112:115], a[128:131], v[232:235], v[112:115]
    buffer_load_dwordx4 a[44:47], v15, s[8:11], s56 offen offset:3072 sc1
    v_cvt_pk_bf16_f32 v221, v170, v171
    v_mfma_f32_16x16x32_bf16 v[112:115], a[132:135], v[236:239], v[112:115]
    s_mov_b32 s56, 32768
    v_exp_f32 v189, v189
    v_mfma_f32_16x16x32_bf16 v[116:119], a[136:139], v[232:235], v[116:119]
    v_cvt_pk_bf16_f32 v222, v172, v173
    v_mfma_f32_16x16x32_bf16 v[116:119], a[140:143], v[236:239], v[116:119]
    v_exp_f32 v190, v190
    v_mfma_f32_16x16x32_bf16 v[120:123], a[144:147], v[232:235], v[120:123]
    v_cvt_pk_bf16_f32 v223, v174, v175
    v_mfma_f32_16x16x32_bf16 v[120:123], a[148:151], v[236:239], v[120:123]
    v_exp_f32 v191, v191
    v_mfma_f32_16x16x32_bf16 v[124:127], a[152:155], v[232:235], v[124:127]
    buffer_load_dwordx4 a[48:51], v15, s[8:11], s56 offen offset:0 sc1
    v_mfma_f32_16x16x32_bf16 v[124:127], a[156:159], v[236:239], v[124:127]
    v_exp_f32 v192, v192
    v_mfma_f32_16x16x32_bf16 v[128:131], a[160:163], v[232:235], v[128:131]
    buffer_load_dwordx4 a[52:55], v15, s[8:11], s56 offen offset:1024 sc1
    v_mfma_f32_16x16x32_bf16 v[128:131], a[164:167], v[236:239], v[128:131]
    v_exp_f32 v193, v193
    v_mfma_f32_16x16x32_bf16 v[132:135], a[168:171], v[232:235], v[132:135]
    v_exp_f32 v194, v194
    v_mfma_f32_16x16x32_bf16 v[132:135], a[172:175], v[236:239], v[132:135]
    s_waitcnt vmcnt(26) lgkmcnt(0)
    s_barrier
    v_mfma_f32_16x16x32_bf16 v[136:139], a[176:179], v[232:235], v[136:139]
    buffer_load_dwordx4 a[56:59], v15, s[8:11], s56 offen offset:2048 sc1
    v_mfma_f32_16x16x32_bf16 v[136:139], a[180:183], v[236:239], v[136:139]
    v_exp_f32 v195, v195
    v_mfma_f32_16x16x32_bf16 v[140:143], a[184:187], v[232:235], v[140:143]
    v_xor_b32 v2, 0x4000, v2
    v_mfma_f32_16x16x32_bf16 v[140:143], a[188:191], v[236:239], v[140:143]
    buffer_load_dwordx4 a[60:63], v15, s[8:11], s56 offen offset:3072 sc1
    v_exp_f32 v196, v196
    v_exp_f32 v197, v197
    v_exp_f32 v198, v198
    v_exp_f32 v199, v199
    s_cmp_eq_u32 s3, 1
    s_cbranch_scc1 L_a_FNL
    ds_read_b128 a[128:131], v3 offset:32768
    ds_read_b128 a[132:135], v3 offset:33792
    ds_read_b128 a[136:139], v3 offset:34816
    ds_read_b128 a[140:143], v3 offset:35840
    v_smfmac_f32_16x16x64_bf16 a[192:195], a[208:211], v[208:215], v7
    ds_read_b128 a[144:147], v3 offset:36864
    v_cvt_pk_bf16_f32 v224, v176, v177
    v_smfmac_f32_16x16x64_bf16 a[196:199], a[208:211], v[216:223], v7
    ds_read_b128 a[148:151], v3 offset:37888
    s_waitcnt lgkmcnt(4)
    v_mfma_f32_16x16x32_bf16 v[16:19], a[128:131], v[208:211], v[16:19]
    ds_read_b128 a[152:155], v3 offset:38912
    v_cvt_pk_bf16_f32 v225, v178, v179
    v_mfma_f32_16x16x32_bf16 v[16:19], a[132:135], v[212:215], v[16:19]
    ds_read_b128 a[156:159], v3 offset:39936
    v_cvt_pk_bf16_f32 v226, v180, v181
    v_mfma_f32_16x16x32_bf16 v[48:51], a[128:131], v[216:219], v[48:51]
    s_and_b32 s50, s3, 1
    v_cvt_pk_bf16_f32 v227, v182, v183
    v_mfma_f32_16x16x32_bf16 v[48:51], a[132:135], v[220:223], v[48:51]
    s_waitcnt lgkmcnt(4)
    v_cvt_pk_bf16_f32 v228, v184, v185
    v_mfma_f32_16x16x32_bf16 v[20:23], a[136:139], v[208:211], v[20:23]
    ds_read_b128 a[160:163], v3 offset:40960
    v_cvt_pk_bf16_f32 v229, v186, v187
    v_mfma_f32_16x16x32_bf16 v[20:23], a[140:143], v[212:215], v[20:23]
    ds_read_b128 a[164:167], v3 offset:41984
    v_cvt_pk_bf16_f32 v230, v188, v189
    v_mfma_f32_16x16x32_bf16 v[52:55], a[136:139], v[216:219], v[52:55]
    s_lshl_b32 s51, s50, 14
    v_cvt_pk_bf16_f32 v231, v190, v191
    v_mfma_f32_16x16x32_bf16 v[52:55], a[140:143], v[220:223], v[52:55]
    s_waitcnt lgkmcnt(4)
    v_mfma_f32_16x16x32_bf16 v[24:27], a[144:147], v[208:211], v[24:27]
    ds_read_b128 a[168:171], v3 offset:43008
    v_mfma_f32_16x16x32_bf16 v[24:27], a[148:151], v[212:215], v[24:27]
    ds_read_b128 a[172:175], v3 offset:44032
    v_mfma_f32_16x16x32_bf16 v[56:59], a[144:147], v[216:219], v[56:59]
    s_add_u32 s51, s51, 131072
    v_exp_f32 v200, v200
    v_mfma_f32_16x16x32_bf16 v[56:59], a[148:151], v[220:223], v[56:59]
    s_waitcnt lgkmcnt(4)
    v_exp_f32 v201, v201
    v_mfma_f32_16x16x32_bf16 v[28:31], a[152:155], v[208:211], v[28:31]
    ds_read_b128 a[176:179], v3 offset:45056
    v_add_u32 v12, s51, v1
    v_mfma_f32_16x16x32_bf16 v[28:31], a[156:159], v[212:215], v[28:31]
    ds_read_b128 a[180:183], v3 offset:46080
    v_mfma_f32_16x16x32_bf16 v[60:63], a[152:155], v[216:219], v[60:63]
    s_lshl_b32 s51, s50, 16
    v_exp_f32 v202, v202
    v_mfma_f32_16x16x32_bf16 v[60:63], a[156:159], v[220:223], v[60:63]
    s_waitcnt lgkmcnt(4)
    v_exp_f32 v203, v203
    v_mfma_f32_16x16x32_bf16 v[32:35], a[160:163], v[208:211], v[32:35]
    ds_read_b128 a[184:187], v3 offset:47104
    v_mfma_f32_16x16x32_bf16 v[32:35], a[164:167], v[212:215], v[32:35]
    ds_read_b128 a[188:191], v3 offset:48128
    v_mfma_f32_16x16x32_bf16 v[64:67], a[160:163], v[216:219], v[64:67]
    s_sub_u32 s51, 114688, s51
    v_exp_f32 v204, v204
    v_mfma_f32_16x16x32_bf16 v[64:67], a[164:167], v[220:223], v[64:67]
    s_waitcnt lgkmcnt(4)
    v_exp_f32 v205, v205
    v_mfma_f32_16x16x32_bf16 v[36:39], a[168:171], v[208:211], v[36:39]
    s_mov_b32 s56, 0
    v_exp_f32 v206, v206
    v_mfma_f32_16x16x32_bf16 v[36:39], a[172:175], v[212:215], v[36:39]
    v_exp_f32 v207, v207
    v_mfma_f32_16x16x32_bf16 v[68:71], a[168:171], v[216:219], v[68:71]
    v_cvt_pk_bf16_f32 v232, v192, v193
    v_cvt_pk_bf16_f32 v233, v194, v195
    v_mfma_f32_16x16x32_bf16 v[68:71], a[172:175], v[220:223], v[68:71]
    s_waitcnt lgkmcnt(2)
    v_cvt_pk_bf16_f32 v234, v196, v197
    v_cvt_pk_bf16_f32 v235, v198, v199
    v_mfma_f32_16x16x32_bf16 v[40:43], a[176:179], v[208:211], v[40:43]
    v_cvt_pk_bf16_f32 v236, v200, v201
    v_cvt_pk_bf16_f32 v237, v202, v203
    v_mfma_f32_16x16x32_bf16 v[40:43], a[180:183], v[212:215], v[40:43]
    v_cvt_pk_bf16_f32 v238, v204, v205
    v_add_u32 v13, s51, v1
    v_mfma_f32_16x16x32_bf16 v[72:75], a[176:179], v[216:219], v[72:75]
    s_lshl_b32 s50, s3, 10
    v_cvt_pk_bf16_f32 v239, v206, v207
    v_mfma_f32_16x16x32_bf16 v[72:75], a[180:183], v[220:223], v[72:75]
    s_waitcnt lgkmcnt(0)
    v_mfma_f32_16x16x32_bf16 v[44:47], a[184:187], v[208:211], v[44:47]
    s_add_u32 s50, s50, 65536
    v_add_u32 v2, s50, v1
    v_mfma_f32_16x16x32_bf16 v[44:47], a[188:191], v[212:215], v[44:47]
    s_xor_b32 s50, s50, 3072
    v_add_u32 v4, s50, v1
    v_mfma_f32_16x16x32_bf16 v[76:79], a[184:187], v[216:219], v[76:79]
    s_lshl_b32 s50, s3, 2
    v_mfma_f32_16x16x32_bf16 v[76:79], a[188:191], v[220:223], v[76:79]
    s_add_u32 s50, s50, 69632
    v_mov_b32 v5, s50
    v_smfmac_f32_16x16x64_bf16 a[200:203], a[208:211], v[224:231], v7
    buffer_load_dwordx4 v[144:147], v15, s[8:11], s56 offen offset:0 sc1
    v_smfmac_f32_16x16x64_bf16 a[204:207], a[208:211], v[232:239], v7
    buffer_load_dwordx4 v[148:151], v15, s[8:11], s56 offen offset:1024 sc1
    v_mfma_f32_16x16x32_bf16 v[80:83], a[128:131], v[224:227], v[80:83]
    buffer_load_dwordx4 v[152:155], v15, s[8:11], s56 offen offset:2048 sc1
    v_mfma_f32_16x16x32_bf16 v[80:83], a[132:135], v[228:231], v[80:83]
    buffer_load_dwordx4 v[156:159], v15, s[8:11], s56 offen offset:3072 sc1
    v_mfma_f32_16x16x32_bf16 v[112:115], a[128:131], v[232:235], v[112:115]
    ds_write_b128 v12, v[16:19] offset:0
    v_mfma_f32_16x16x32_bf16 v[112:115], a[132:135], v[236:239], v[112:115]
    ds_write_b128 v12, v[48:51] offset:1024
    v_mfma_f32_16x16x32_bf16 v[84:87], a[136:139], v[224:227], v[84:87]
    s_mov_b32 s56, 4096
    v_mfma_f32_16x16x32_bf16 v[84:87], a[140:143], v[228:231], v[84:87]
    ds_write_b128 v12, v[20:23] offset:2048
    v_mfma_f32_16x16x32_bf16 v[116:119], a[136:139], v[232:235], v[116:119]
    v_accvgpr_read_b32 v8, a192
    v_mfma_f32_16x16x32_bf16 v[116:119], a[140:143], v[236:239], v[116:119]
    ds_write_b128 v12, v[52:55] offset:3072
    v_accvgpr_read_b32 v9, a196
    v_mfma_f32_16x16x32_bf16 v[88:91], a[144:147], v[224:227], v[88:91]
    v_accvgpr_read_b32 v10, a200
    v_mfma_f32_16x16x32_bf16 v[88:91], a[148:151], v[228:231], v[88:91]
    ds_write_b128 v12, v[24:27] offset:4096
    v_accvgpr_read_b32 v11, a204
    v_mfma_f32_16x16x32_bf16 v[120:123], a[144:147], v[232:235], v[120:123]
    ds_write_b128 v12, v[56:59] offset:5120
    v_accvgpr_read_b32 v184, a193
    v_mfma_f32_16x16x32_bf16 v[120:123], a[148:151], v[236:239], v[120:123]
    v_accvgpr_read_b32 v185, a197
    v_mfma_f32_16x16x32_bf16 v[92:95], a[152:155], v[224:227], v[92:95]
    ds_write_b128 v12, v[28:31] offset:6144
    v_accvgpr_read_b32 v186, a201
    v_mfma_f32_16x16x32_bf16 v[92:95], a[156:159], v[228:231], v[92:95]
    v_accvgpr_read_b32 v187, a205
    v_mfma_f32_16x16x32_bf16 v[124:127], a[152:155], v[232:235], v[124:127]
    ds_write_b128 v12, v[60:63] offset:7168
    v_add_f32 v8, v8, v184
    v_mfma_f32_16x16x32_bf16 v[124:127], a[156:159], v[236:239], v[124:127]
    v_add_f32 v9, v9, v185
    v_mfma_f32_16x16x32_bf16 v[96:99], a[160:163], v[224:227], v[96:99]
    ds_write_b128 v12, v[32:35] offset:8192
    v_add_f32 v10, v10, v186
    v_mfma_f32_16x16x32_bf16 v[96:99], a[164:167], v[228:231], v[96:99]
    ds_write_b128 v12, v[64:67] offset:9216
    v_add_f32 v11, v11, v187
    v_mfma_f32_16x16x32_bf16 v[128:131], a[160:163], v[232:235], v[128:131]
    s_mov_b32 s51, 0x53800000
    v_mfma_f32_16x16x32_bf16 v[128:131], a[164:167], v[236:239], v[128:131]
    ds_write_b128 v12, v[36:39] offset:10240
    v_add_f32 v14, v8, v9
    v_mfma_f32_16x16x32_bf16 v[100:103], a[168:171], v[224:227], v[100:103]
    v_add_f32 v14, v14, v10
    v_mfma_f32_16x16x32_bf16 v[100:103], a[172:175], v[228:231], v[100:103]
    ds_write_b128 v12, v[68:71] offset:11264
    v_add_f32 v14, v14, v11
    v_mfma_f32_16x16x32_bf16 v[132:135], a[168:171], v[232:235], v[132:135]
    v_cmp_nge_f32 vcc, s51, v14
    v_mfma_f32_16x16x32_bf16 v[132:135], a[172:175], v[236:239], v[132:135]
    ds_write_b128 v12, v[40:43] offset:12288
    v_mfma_f32_16x16x32_bf16 v[104:107], a[176:179], v[224:227], v[104:107]
    ds_write_b128 v12, v[72:75] offset:13312
    v_mfma_f32_16x16x32_bf16 v[104:107], a[180:183], v[228:231], v[104:107]
    s_nop 0
    v_mfma_f32_16x16x32_bf16 v[136:139], a[176:179], v[232:235], v[136:139]
    ds_write_b128 v12, v[44:47] offset:14336
    v_mfma_f32_16x16x32_bf16 v[136:139], a[180:183], v[236:239], v[136:139]
    s_or_b32 s39, s39, vcc_lo
    v_mfma_f32_16x16x32_bf16 v[108:111], a[184:187], v[224:227], v[108:111]
    ds_write_b128 v12, v[76:79] offset:15360
    v_mfma_f32_16x16x32_bf16 v[108:111], a[188:191], v[228:231], v[108:111]
    s_or_b32 s39, s39, vcc_hi
    v_mfma_f32_16x16x32_bf16 v[140:143], a[184:187], v[232:235], v[140:143]
    v_mov_b32 v14, s39
    v_mfma_f32_16x16x32_bf16 v[140:143], a[188:191], v[236:239], v[140:143]
    ds_write_b128 v2, v[8:11]
    buffer_load_dwordx4 v[160:163], v15, s[8:11], s56 offen offset:0 sc1
    buffer_load_dwordx4 v[164:167], v15, s[8:11], s56 offen offset:1024 sc1
    buffer_load_dwordx4 v[168:171], v15, s[8:11], s56 offen offset:2048 sc1
    buffer_load_dwordx4 v[172:175], v15, s[8:11], s56 offen offset:3072 sc1
    v_bfe_u32 v188, v1, 4, 2
    v_lshl_add_u32 v188, v188, 2, s68
    buffer_load_dword v189, v188, s[60:63], 0 offen offset:0 sc1
    ds_write_b32 v5, v14
    s_waitcnt lgkmcnt(0)
    s_barrier
L_a_recvS:
    v_mov_b32 v14, 69632
    ds_read_b128 v[176:179], v14
    ds_read_b128 v[180:183], v4
    ds_read_b128 v[16:19], v13 offset:0
    ds_read_b128 v[20:23], v13 offset:2048
    ds_read_b128 v[48:51], v13 offset:1024
    ds_read_b128 v[52:55], v13 offset:3072
    ds_read_b128 v[24:27], v13 offset:4096
    ds_read_b128 v[28:31], v13 offset:6144
    ds_read_b128 v[56:59], v13 offset:5120
    ds_read_b128 v[60:63], v13 offset:7168
    ds_read_b128 v[32:35], v13 offset:8192
    ds_read_b128 v[36:39], v13 offset:10240
    ds_read_b128 v[64:67], v13 offset:9216
    ds_read_b128 v[68:71], v13 offset:11264
    ds_read_b128 v[40:43], v13 offset:12288
    s_waitcnt vmcnt(54)
    s_waitcnt lgkmcnt(13)
    v_or3_b32 v176, v176, v177, v178
    v_or_b32 v176, v176, v179
    v_add_f32 v10, v10, v182
    v_add_f32 v11, v11, v183
    s_waitcnt lgkmcnt(12)
    ds_read_b128 v[44:47], v13 offset:14336
    ds_read_b128 v[72:75], v13 offset:13312
    ds_read_b128 v[76:79], v13 offset:15360
    v_readfirstlane_b32 s50, v176
    v_rcp_f32 v10, v10
    v_rcp_f32 v11, v11
    s_cmp_eq_u32 s38, 0
    s_cselect_b32 s50, s50, 0
    s_cmp_lg_u32 s50, 0
    s_cbranch_scc1 L_a_redo
    s_lshl_b32 s50, s27, 20
    s_sub_u32 s50, 33030144, s50
    s_waitcnt lgkmcnt(14)
    v_pk_add_f32 v[80:81], v[80:81], v[16:17]
    v_pk_add_f32 v[82:83], v[82:83], v[18:19]
    v_pk_add_f32 v[84:85], v[84:85], v[20:21]
    v_pk_add_f32 v[86:87], v[86:87], v[22:23]
    v_pk_mul_f32 v[80:81], v[80:81], v[10:11] op_sel:[0,0] op_sel_hi:[1,0]
    v_pk_mul_f32 v[82:83], v[82:83], v[10:11] op_sel:[0,0] op_sel_hi:[1,0]
    v_pk_mul_f32 v[84:85], v[84:85], v[10:11] op_sel:[0,0] op_sel_hi:[1,0]
    v_pk_mul_f32 v[86:87], v[86:87], v[10:11] op_sel:[0,0] op_sel_hi:[1,0]
    v_cvt_pk_bf16_f32 v80, v80, v81
    v_cvt_pk_bf16_f32 v81, v82, v83
    v_cvt_pk_bf16_f32 v82, v84, v85
    v_cvt_pk_bf16_f32 v83, v86, v87
    buffer_store_dwordx4 v[80:83], v6, s[20:23], s50 offen offset:2048 sc1
    s_waitcnt lgkmcnt(12)
    v_pk_add_f32 v[112:113], v[112:113], v[48:49]
    v_pk_add_f32 v[114:115], v[114:115], v[50:51]
    v_pk_add_f32 v[116:117], v[116:117], v[52:53]
    v_pk_add_f32 v[118:119], v[118:119], v[54:55]
    v_pk_mul_f32 v[112:113], v[112:113], v[10:11] op_sel:[0,1] op_sel_hi:[1,1]
    v_pk_mul_f32 v[114:115], v[114:115], v[10:11] op_sel:[0,1] op_sel_hi:[1,1]
    v_pk_mul_f32 v[116:117], v[116:117], v[10:11] op_sel:[0,1] op_sel_hi:[1,1]
    v_pk_mul_f32 v[118:119], v[118:119], v[10:11] op_sel:[0,1] op_sel_hi:[1,1]
    v_cvt_pk_bf16_f32 v112, v112, v113
    v_cvt_pk_bf16_f32 v113, v114, v115
    v_cvt_pk_bf16_f32 v114, v116, v117
    v_cvt_pk_bf16_f32 v115, v118, v119
    buffer_store_dwordx4 v[112:115], v6, s[20:23], s50 offen offset:3072 sc1
    s_add_u32 s50, s50, 4096
    s_waitcnt lgkmcnt(10)
    v_pk_add_f32 v[88:89], v[88:89], v[24:25]
    v_pk_add_f32 v[90:91], v[90:91], v[26:27]
    v_pk_add_f32 v[92:93], v[92:93], v[28:29]
    v_pk_add_f32 v[94:95], v[94:95], v[30:31]
    v_pk_mul_f32 v[88:89], v[88:89], v[10:11] op_sel:[0,0] op_sel_hi:[1,0]
    v_pk_mul_f32 v[90:91], v[90:91], v[10:11] op_sel:[0,0] op_sel_hi:[1,0]
    v_pk_mul_f32 v[92:93], v[92:93], v[10:11] op_sel:[0,0] op_sel_hi:[1,0]
    v_pk_mul_f32 v[94:95], v[94:95], v[10:11] op_sel:[0,0] op_sel_hi:[1,0]
    v_cvt_pk_bf16_f32 v88, v88, v89
    v_cvt_pk_bf16_f32 v89, v90, v91
    v_cvt_pk_bf16_f32 v90, v92, v93
    v_cvt_pk_bf16_f32 v91, v94, v95
    buffer_store_dwordx4 v[88:91], v6, s[20:23], s50 offen offset:2048 sc1
    s_waitcnt lgkmcnt(8)
    v_pk_add_f32 v[120:121], v[120:121], v[56:57]
    v_pk_add_f32 v[122:123], v[122:123], v[58:59]
    v_pk_add_f32 v[124:125], v[124:125], v[60:61]
    v_pk_add_f32 v[126:127], v[126:127], v[62:63]
    v_pk_mul_f32 v[120:121], v[120:121], v[10:11] op_sel:[0,1] op_sel_hi:[1,1]
    v_pk_mul_f32 v[122:123], v[122:123], v[10:11] op_sel:[0,1] op_sel_hi:[1,1]
    v_pk_mul_f32 v[124:125], v[124:125], v[10:11] op_sel:[0,1] op_sel_hi:[1,1]
    v_pk_mul_f32 v[126:127], v[126:127], v[10:11] op_sel:[0,1] op_sel_hi:[1,1]
    v_cvt_pk_bf16_f32 v120, v120, v121
    v_cvt_pk_bf16_f32 v121, v122, v123
    v_cvt_pk_bf16_f32 v122, v124, v125
    v_cvt_pk_bf16_f32 v123, v126, v127
    buffer_store_dwordx4 v[120:123], v6, s[20:23], s50 offen offset:3072 sc1
    s_add_u32 s50, s50, 4096
    s_waitcnt lgkmcnt(6)
    v_pk_add_f32 v[96:97], v[96:97], v[32:33]
    v_pk_add_f32 v[98:99], v[98:99], v[34:35]
    v_pk_add_f32 v[100:101], v[100:101], v[36:37]
    v_pk_add_f32 v[102:103], v[102:103], v[38:39]
    v_pk_mul_f32 v[96:97], v[96:97], v[10:11] op_sel:[0,0] op_sel_hi:[1,0]
    v_pk_mul_f32 v[98:99], v[98:99], v[10:11] op_sel:[0,0] op_sel_hi:[1,0]
    v_pk_mul_f32 v[100:101], v[100:101], v[10:11] op_sel:[0,0] op_sel_hi:[1,0]
    v_pk_mul_f32 v[102:103], v[102:103], v[10:11] op_sel:[0,0] op_sel_hi:[1,0]
    v_cvt_pk_bf16_f32 v96, v96, v97
    v_cvt_pk_bf16_f32 v97, v98, v99
    v_cvt_pk_bf16_f32 v98, v100, v101
    v_cvt_pk_bf16_f32 v99, v102, v103
    buffer_store_dwordx4 v[96:99], v6, s[20:23], s50 offen offset:2048 sc1
    s_waitcnt lgkmcnt(4)
    v_pk_add_f32 v[128:129], v[128:129], v[64:65]
    v_pk_add_f32 v[130:131], v[130:131], v[66:67]
    v_pk_add_f32 v[132:133], v[132:133], v[68:69]
    v_pk_add_f32 v[134:135], v[134:135], v[70:71]
    v_pk_mul_f32 v[128:129], v[128:129], v[10:11] op_sel:[0,1] op_sel_hi:[1,1]
    v_pk_mul_f32 v[130:131], v[130:131], v[10:11] op_sel:[0,1] op_sel_hi:[1,1]
    v_pk_mul_f32 v[132:133], v[132:133], v[10:11] op_sel:[0,1] op_sel_hi:[1,1]
    v_pk_mul_f32 v[134:135], v[134:135], v[10:11] op_sel:[0,1] op_sel_hi:[1,1]
    v_cvt_pk_bf16_f32 v128, v128, v129
    v_cvt_pk_bf16_f32 v129, v130, v131
    v_cvt_pk_bf16_f32 v130, v132, v133
    v_cvt_pk_bf16_f32 v131, v134, v135
    buffer_store_dwordx4 v[128:131], v6, s[20:23], s50 offen offset:3072 sc1
    s_add_u32 s50, s50, 4096
    s_waitcnt lgkmcnt(2)
    v_pk_add_f32 v[104:105], v[104:105], v[40:41]
    v_pk_add_f32 v[106:107], v[106:107], v[42:43]
    v_pk_add_f32 v[108:109], v[108:109], v[44:45]
    v_pk_add_f32 v[110:111], v[110:111], v[46:47]
    v_pk_mul_f32 v[104:105], v[104:105], v[10:11] op_sel:[0,0] op_sel_hi:[1,0]
    v_pk_mul_f32 v[106:107], v[106:107], v[10:11] op_sel:[0,0] op_sel_hi:[1,0]
    v_pk_mul_f32 v[108:109], v[108:109], v[10:11] op_sel:[0,0] op_sel_hi:[1,0]
    v_pk_mul_f32 v[110:111], v[110:111], v[10:11] op_sel:[0,0] op_sel_hi:[1,0]
    v_cvt_pk_bf16_f32 v104, v104, v105
    v_cvt_pk_bf16_f32 v105, v106, v107
    v_cvt_pk_bf16_f32 v106, v108, v109
    v_cvt_pk_bf16_f32 v107, v110, v111
    buffer_store_dwordx4 v[104:107], v6, s[20:23], s50 offen offset:2048 sc1
    s_waitcnt lgkmcnt(0)
    v_pk_add_f32 v[136:137], v[136:137], v[72:73]
    v_pk_add_f32 v[138:139], v[138:139], v[74:75]
    v_pk_add_f32 v[140:141], v[140:141], v[76:77]
    v_pk_add_f32 v[142:143], v[142:143], v[78:79]
    v_pk_mul_f32 v[136:137], v[136:137], v[10:11] op_sel:[0,1] op_sel_hi:[1,1]
    v_pk_mul_f32 v[138:139], v[138:139], v[10:11] op_sel:[0,1] op_sel_hi:[1,1]
    v_pk_mul_f32 v[140:141], v[140:141], v[10:11] op_sel:[0,1] op_sel_hi:[1,1]
    v_pk_mul_f32 v[142:143], v[142:143], v[10:11] op_sel:[0,1] op_sel_hi:[1,1]
    v_cvt_pk_bf16_f32 v136, v136, v137
    v_cvt_pk_bf16_f32 v137, v138, v139
    v_cvt_pk_bf16_f32 v138, v140, v141
    v_cvt_pk_bf16_f32 v139, v142, v143
    buffer_store_dwordx4 v[136:139], v6, s[20:23], s50 offen offset:3072 sc1
    s_branch L_a_done
L_a_seg:
    s_cmp_eq_u32 s28, 18
    s_cbranch_scc1 L_a_DF
    s_cmp_eq_u32 s28, 15
    s_cselect_b32 s48, 16, 18
    s_cbranch_scc0 L_a_seg2
    v_and_b32 v14, 16, v1
    v_lshrrev_b32 v8, 5, v1
    v_lshl_add_u32 v14, v8, 8, v14
    v_add_u32 v14, 8192, v14
    buffer_load_dwordx4 a[228:231], v14, s[60:63], 0 offen sc1
    s_branch L_a_loopsel
L_a_seg2:
    v_accvgpr_read_b32 v8, a228
    v_accvgpr_read_b32 v9, a229
    v_accvgpr_read_b32 v10, a230
    v_accvgpr_read_b32 v11, a231
    v_and_b32 v8, v8, v9
    v_and_b32 v10, v10, v11
    v_and_b32 v8, v8, v10
    v_cmp_ne_u32 vcc, 1, v8
    s_nop 4
    s_cbranch_vccnz L_spin3
L_back3:
    s_branch L_a_loopsel
L_a_preDN:
    s_cmp_eq_u32 s3, 3
    s_cbranch_scc0 L_a_DN
    v_or_b32 v2, 0x10000, v2
L_a_DN:
    v_cndmask_b32 v144, v5, v240, s[40:41]
    v_cndmask_b32 v145, v5, v241, s[42:43]
    v_cndmask_b32 v146, v5, v242, s[44:45]
    v_cndmask_b32 v147, v5, v243, s[46:47]
    s_nop 1
    v_mfma_f32_16x16x32_bf16 v[144:147], a[64:67], a[0:3], v[144:147]
    s_add_u32 m0, s36, 32768
    v_exp_f32 v200, v200
    v_mfma_f32_16x16x32_bf16 v[144:147], a[68:71], a[4:7], v[144:147]
    ds_read_b128 a[128:131], v3 offset:32768
    v_cvt_pk_bf16_f32 v224, v176, v177
    v_mfma_f32_16x16x32_bf16 v[144:147], a[72:75], a[8:11], v[144:147]
    s_add_u32 s28, s28, 1
    v_exp_f32 v201, v201
    v_mfma_f32_16x16x32_bf16 v[144:147], a[76:79], a[12:15], v[144:147]
    v_cndmask_b32 v164, v5, v244, s[40:41]
    v_cvt_pk_bf16_f32 v225, v178, v179
    v_mfma_f32_16x16x32_bf16 v[160:163], a[64:67], a[16:19], v[244:247]
    ds_read_b128 a[132:135], v3 offset:33792
    v_cndmask_b32 v165, v5, v245, s[42:43]
    v_mfma_f32_16x16x32_bf16 v[160:163], a[68:71], a[20:23], v[160:163]
    v_exp_f32 v202, v202
    v_cndmask_b32 v166, v5, v246, s[44:45]
    v_cndmask_b32 v167, v5, v247, s[46:47]
    v_mfma_f32_16x16x32_bf16 v[160:163], a[72:75], a[24:27], v[160:163]
    ds_read_b128 a[136:139], v3 offset:34816
    v_cvt_pk_bf16_f32 v226, v180, v181
    v_mfma_f32_16x16x32_bf16 v[160:163], a[76:79], a[28:31], v[160:163]
    v_exp_f32 v203, v203
    v_mfma_f32_16x16x32_bf16 v[164:167], a[80:83], a[16:19], v[164:167]
    ds_read_b128 a[140:143], v3 offset:35840
    v_cvt_pk_bf16_f32 v227, v182, v183
    v_mfma_f32_16x16x32_bf16 v[164:167], a[84:87], a[20:23], v[164:167]
    buffer_load_dwordx4 v4, s[16:19], s32 offen offset:0 sc1 lds
    v_mfma_f32_16x16x32_bf16 v[164:167], a[88:91], a[24:27], v[164:167]
    v_exp_f32 v204, v204
    v_mfma_f32_16x16x32_bf16 v[164:167], a[92:95], a[28:31], v[164:167]
    ds_read_b128 a[144:147], v3 offset:36864
    v_cvt_pk_bf16_f32 v228, v184, v185
    v_mfma_f32_16x16x32_bf16 v[176:179], a[64:67], a[32:35], v[248:251]
    v_exp_f32 v205, v205
    v_mfma_f32_16x16x32_bf16 v[176:179], a[68:71], a[36:39], v[176:179]
    buffer_load_dwordx4 v4, s[16:19], s32 offen offset:1024 sc1 lds
    v_mfma_f32_16x16x32_bf16 v[176:179], a[72:75], a[40:43], v[176:179]
    ds_read_b128 a[148:151], v3 offset:37888
    v_cvt_pk_bf16_f32 v229, v186, v187
    v_mfma_f32_16x16x32_bf16 v[176:179], a[76:79], a[44:47], v[176:179]
    v_exp_f32 v206, v206
    v_mfma_f32_16x16x32_bf16 v[180:183], a[80:83], a[32:35], v[248:251]
    ds_read_b128 a[152:155], v3 offset:38912
    v_cvt_pk_bf16_f32 v230, v188, v189
    v_mfma_f32_16x16x32_bf16 v[180:183], a[84:87], a[36:39], v[180:183]
    v_exp_f32 v207, v207
    v_cvt_pk_bf16_f32 v231, v190, v191
    v_cvt_pk_bf16_f32 v232, v192, v193
    v_exp_f32 v144, v144
    v_cvt_pk_bf16_f32 v233, v194, v195
    v_cndmask_b32 v184, v5, v248, s[40:41]
    v_cndmask_b32 v185, v5, v249, s[42:43]
    v_cvt_pk_bf16_f32 v234, v196, v197
    v_cndmask_b32 v186, v5, v250, s[44:45]
    v_exp_f32 v145, v145
    v_cndmask_b32 v187, v5, v251, s[46:47]
    v_mfma_f32_16x16x32_bf16 v[180:183], a[88:91], a[40:43], v[180:183]
    buffer_load_dwordx4 v4, s[16:19], s32 offen offset:2048 sc1 lds
    v_mfma_f32_16x16x32_bf16 v[180:183], a[92:95], a[44:47], v[180:183]
    buffer_load_dwordx4 v4, s[16:19], s32 offen offset:3072 sc1 lds
    v_mfma_f32_16x16x32_bf16 v[184:187], a[96:99], a[32:35], v[184:187]
    ds_read_b128 a[156:159], v3 offset:39936
    v_cvt_pk_bf16_f32 v235, v198, v199
    v_mfma_f32_16x16x32_bf16 v[184:187], a[100:103], a[36:39], v[184:187]
    ds_read_b128 a[160:163], v3 offset:40960
    v_cvt_pk_bf16_f32 v236, v200, v201
    v_mfma_f32_16x16x32_bf16 v[184:187], a[104:107], a[40:43], v[184:187]
    s_mov_b32 m0, s36
    v_exp_f32 v146, v146
    v_mfma_f32_16x16x32_bf16 v[184:187], a[108:111], a[44:47], v[184:187]
    ds_read_b128 a[164:167], v3 offset:41984
    v_cvt_pk_bf16_f32 v237, v202, v203
    v_mfma_f32_16x16x32_bf16 v[192:195], a[64:67], a[48:51], v[252:255]
    s_mov_b32 s32, s31
    v_cvt_pk_bf16_f32 v238, v204, v205
    v_cvt_pk_bf16_f32 v239, v206, v207
    v_mfma_f32_16x16x32_bf16 v[192:195], a[68:71], a[52:55], v[192:195]
    ds_read_b128 a[168:171], v3 offset:43008
    v_mfma_f32_16x16x32_bf16 v[192:195], a[72:75], a[56:59], v[192:195]
    ds_read_b128 a[172:175], v3 offset:44032
    v_mfma_f32_16x16x32_bf16 v[192:195], a[76:79], a[60:63], v[192:195]
    buffer_load_dwordx4 v4, s[12:15], s30 offen offset:0 sc1 lds
    v_mfma_f32_16x16x32_bf16 v[196:199], a[80:83], a[48:51], v[252:255]
    v_exp_f32 v147, v147
    v_mfma_f32_16x16x32_bf16 v[196:199], a[84:87], a[52:55], v[196:199]
    ds_read_b128 a[176:179], v3 offset:45056
    v_mfma_f32_16x16x32_bf16 v[196:199], a[88:91], a[56:59], v[196:199]
    buffer_load_dwordx4 v4, s[12:15], s30 offen offset:1024 sc1 lds
    v_mfma_f32_16x16x32_bf16 v[196:199], a[92:95], a[60:63], v[196:199]
    v_exp_f32 v160, v160
    v_mfma_f32_16x16x32_bf16 v[200:203], a[96:99], a[48:51], v[252:255]
    ds_read_b128 a[180:183], v3 offset:46080
    v_mfma_f32_16x16x32_bf16 v[200:203], a[100:103], a[52:55], v[200:203]
    buffer_load_dwordx4 v4, s[12:15], s30 offen offset:2048 sc1 lds
    v_exp_f32 v161, v161
    v_cndmask_b32 v204, v5, v252, s[40:41]
    v_exp_f32 v162, v162
    v_cndmask_b32 v205, v5, v253, s[42:43]
    v_cndmask_b32 v206, v5, v254, s[44:45]
    v_cndmask_b32 v207, v5, v255, s[46:47]
    v_mfma_f32_16x16x32_bf16 v[200:203], a[104:107], a[56:59], v[200:203]
    ds_read_b128 a[184:187], v3 offset:47104
    v_mfma_f32_16x16x32_bf16 v[200:203], a[108:111], a[60:63], v[200:203]
    ds_read_b128 a[188:191], v3 offset:48128
    v_xor_b32 v3, 0x4000, v3
    v_mfma_f32_16x16x32_bf16 v[204:207], a[112:115], a[48:51], v[204:207]
    buffer_load_dwordx4 v4, s[12:15], s30 offen offset:3072 sc1 lds
    v_mfma_f32_16x16x32_bf16 v[204:207], a[116:119], a[52:55], v[204:207]
    s_mov_b32 s31, s30
    v_exp_f32 v163, v163
    v_mfma_f32_16x16x32_bf16 v[204:207], a[120:123], a[56:59], v[204:207]
    s_add_u32 m0, s36, 98304
    v_exp_f32 v164, v164
    v_mfma_f32_16x16x32_bf16 v[204:207], a[124:127], a[60:63], v[204:207]
    s_waitcnt lgkmcnt(0)
    v_exp_f32 v165, v165
    v_smfmac_f32_16x16x64_bf16 a[192:195], a[208:211], v[208:215], v7
    s_cmp_gt_u32 s28, s26
    v_mfma_f32_16x16x32_bf16 v[16:19], a[128:131], v[208:211], v[16:19]
    ds_read_b128 a[64:67], v2 offset:0
    v_mfma_f32_16x16x32_bf16 v[16:19], a[132:135], v[212:215], v[16:19]
    buffer_load_dwordx4 v4, s[16:19], s35 offen offset:0 sc1 lds
    v_mfma_f32_16x16x32_bf16 v[20:23], a[136:139], v[208:211], v[20:23]
    ds_read_b128 a[68:71], v2 offset:1024
    v_mfma_f32_16x16x32_bf16 v[20:23], a[140:143], v[212:215], v[20:23]
    s_cselect_b32 s50, 0x10000, s53
    v_exp_f32 v166, v166
    v_mfma_f32_16x16x32_bf16 v[24:27], a[144:147], v[208:211], v[24:27]
    buffer_load_dwordx4 v4, s[16:19], s35 offen offset:1024 sc1 lds
    v_mfma_f32_16x16x32_bf16 v[24:27], a[148:151], v[212:215], v[24:27]
    ds_read_b128 a[72:75], v2 offset:2048
    v_mfma_f32_16x16x32_bf16 v[28:31], a[152:155], v[208:211], v[28:31]
    s_add_u32 s29, s29, s50
    v_exp_f32 v167, v167
    v_mfma_f32_16x16x32_bf16 v[28:31], a[156:159], v[212:215], v[28:31]
    v_exp_f32 v176, v176
    v_mfma_f32_16x16x32_bf16 v[32:35], a[160:163], v[208:211], v[32:35]
    ds_read_b128 a[76:79], v2 offset:3072
    v_mfma_f32_16x16x32_bf16 v[32:35], a[164:167], v[212:215], v[32:35]
    buffer_load_dwordx4 v4, s[16:19], s35 offen offset:2048 sc1 lds
    v_mfma_f32_16x16x32_bf16 v[36:39], a[168:171], v[208:211], v[36:39]
    s_cmp_gt_u32 s28, 16
    v_exp_f32 v177, v177
    v_mfma_f32_16x16x32_bf16 v[36:39], a[172:175], v[212:215], v[36:39]
    v_mfma_f32_16x16x32_bf16 v[40:43], a[176:179], v[208:211], v[40:43]
    ds_read_b128 a[80:83], v2 offset:4096
    v_mfma_f32_16x16x32_bf16 v[40:43], a[180:183], v[212:215], v[40:43]
    buffer_load_dwordx4 v4, s[16:19], s35 offen offset:3072 sc1 lds
    v_mfma_f32_16x16x32_bf16 v[44:47], a[184:187], v[208:211], v[44:47]
    v_exp_f32 v178, v178
    v_mfma_f32_16x16x32_bf16 v[44:47], a[188:191], v[212:215], v[44:47]
    ds_read_b128 a[84:87], v2 offset:5120
    v_smfmac_f32_16x16x64_bf16 a[196:199], a[208:211], v[216:223], v7
    s_cselect_b32 s30, s66, s29
    v_cvt_pk_bf16_f32 v208, v144, v145
    v_mfma_f32_16x16x32_bf16 v[48:51], a[128:131], v[216:219], v[48:51]
    s_add_u32 m0, s36, 65536
    v_exp_f32 v179, v179
    v_mfma_f32_16x16x32_bf16 v[48:51], a[132:135], v[220:223], v[48:51]
    ds_read_b128 a[88:91], v2 offset:6144
    v_cvt_pk_bf16_f32 v209, v146, v147
    v_mfma_f32_16x16x32_bf16 v[52:55], a[136:139], v[216:219], v[52:55]
    v_exp_f32 v180, v180
    v_mfma_f32_16x16x32_bf16 v[52:55], a[140:143], v[220:223], v[52:55]
    s_mov_b32 s35, s34
    v_mov_b32 v210, 0
    v_mfma_f32_16x16x32_bf16 v[56:59], a[144:147], v[216:219], v[56:59]
    ds_read_b128 a[92:95], v2 offset:7168
    v_mfma_f32_16x16x32_bf16 v[56:59], a[148:151], v[220:223], v[56:59]
    v_mov_b32 v211, 0
    v_mfma_f32_16x16x32_bf16 v[60:63], a[152:155], v[216:219], v[60:63]
    v_exp_f32 v181, v181
    v_mfma_f32_16x16x32_bf16 v[60:63], a[156:159], v[220:223], v[60:63]
    buffer_load_dwordx4 v4, s[12:15], s33 offen offset:0 sc1 lds
    v_mfma_f32_16x16x32_bf16 v[64:67], a[160:163], v[216:219], v[64:67]
    ds_read_b128 a[96:99], v2 offset:8192
    v_mfma_f32_16x16x32_bf16 v[64:67], a[164:167], v[220:223], v[64:67]
    v_exp_f32 v182, v182
    v_mfma_f32_16x16x32_bf16 v[68:71], a[168:171], v[216:219], v[68:71]
    buffer_load_dwordx4 v4, s[12:15], s33 offen offset:1024 sc1 lds
    v_mfma_f32_16x16x32_bf16 v[68:71], a[172:175], v[220:223], v[68:71]
    ds_read_b128 a[100:103], v2 offset:9216
    v_mfma_f32_16x16x32_bf16 v[72:75], a[176:179], v[216:219], v[72:75]
    v_exp_f32 v183, v183
    v_mfma_f32_16x16x32_bf16 v[72:75], a[180:183], v[220:223], v[72:75]
    buffer_load_dwordx4 v4, s[12:15], s33 offen offset:2048 sc1 lds
    v_mfma_f32_16x16x32_bf16 v[76:79], a[184:187], v[216:219], v[76:79]
    ds_read_b128 a[104:107], v2 offset:10240
    v_mfma_f32_16x16x32_bf16 v[76:79], a[188:191], v[220:223], v[76:79]
    buffer_load_dwordx4 v4, s[12:15], s33 offen offset:3072 sc1 lds
    v_smfmac_f32_16x16x64_bf16 a[200:203], a[208:211], v[224:231], v7
    s_mov_b32 s34, s33
    v_exp_f32 v184, v184
    v_mfma_f32_16x16x32_bf16 v[80:83], a[128:131], v[224:227], v[80:83]
    ds_read_b128 a[108:111], v2 offset:11264
    v_cvt_pk_bf16_f32 v216, v160, v161
    v_mfma_f32_16x16x32_bf16 v[80:83], a[132:135], v[228:231], v[80:83]
    s_sub_u32 s33, s30, 32768
    v_exp_f32 v185, v185
    v_mfma_f32_16x16x32_bf16 v[84:87], a[136:139], v[224:227], v[84:87]
    v_cvt_pk_bf16_f32 v217, v162, v163
    v_mfma_f32_16x16x32_bf16 v[84:87], a[140:143], v[228:231], v[84:87]
    v_cvt_pk_bf16_f32 v218, v164, v165
    v_mfma_f32_16x16x32_bf16 v[88:91], a[144:147], v[224:227], v[88:91]
    ds_read_b128 a[112:115], v2 offset:12288
    v_mfma_f32_16x16x32_bf16 v[88:91], a[148:151], v[228:231], v[88:91]
    s_cmp_eq_u32 s28, s26
    v_exp_f32 v186, v186
    v_mfma_f32_16x16x32_bf16 v[92:95], a[152:155], v[224:227], v[92:95]
    s_cselect_b32 s33, s37, s33
    v_cvt_pk_bf16_f32 v219, v166, v167
    v_mfma_f32_16x16x32_bf16 v[92:95], a[156:159], v[228:231], v[92:95]
    ds_read_b128 a[116:119], v2 offset:13312
    v_mfma_f32_16x16x32_bf16 v[96:99], a[160:163], v[224:227], v[96:99]
    v_exp_f32 v187, v187
    v_mfma_f32_16x16x32_bf16 v[96:99], a[164:167], v[228:231], v[96:99]
    s_cmp_lt_u32 s28, s26
    v_exp_f32 v192, v192
    v_mfma_f32_16x16x32_bf16 v[100:103], a[168:171], v[224:227], v[100:103]
    ds_read_b128 a[120:123], v2 offset:14336
    v_mfma_f32_16x16x32_bf16 v[100:103], a[172:175], v[228:231], v[100:103]
    s_cselect_b32 s33, s49, s33
    v_mfma_f32_16x16x32_bf16 v[104:107], a[176:179], v[224:227], v[104:107]
    v_exp_f32 v193, v193
    v_mfma_f32_16x16x32_bf16 v[104:107], a[180:183], v[228:231], v[104:107]
    ds_read_b128 a[124:127], v2 offset:15360
    v_mfma_f32_16x16x32_bf16 v[108:111], a[184:187], v[224:227], v[108:111]
    s_xor_b32 s36, s36, 16384
    v_mfma_f32_16x16x32_bf16 v[108:111], a[188:191], v[228:231], v[108:111]
    v_exp_f32 v194, v194
    v_smfmac_f32_16x16x64_bf16 a[204:207], a[208:211], v[232:239], v7
    v_mfma_f32_16x16x32_bf16 v[112:115], a[128:131], v[232:235], v[112:115]
    v_mfma_f32_16x16x32_bf16 v[112:115], a[132:135], v[236:239], v[112:115]
    v_exp_f32 v195, v195
    v_mfma_f32_16x16x32_bf16 v[116:119], a[136:139], v[232:235], v[116:119]
    v_mfma_f32_16x16x32_bf16 v[116:119], a[140:143], v[236:239], v[116:119]
    v_mfma_f32_16x16x32_bf16 v[120:123], a[144:147], v[232:235], v[120:123]
    v_exp_f32 v196, v196
    v_mfma_f32_16x16x32_bf16 v[120:123], a[148:151], v[236:239], v[120:123]
    v_mfma_f32_16x16x32_bf16 v[124:127], a[152:155], v[232:235], v[124:127]
    v_mfma_f32_16x16x32_bf16 v[124:127], a[156:159], v[236:239], v[124:127]
    v_exp_f32 v197, v197
    v_mfma_f32_16x16x32_bf16 v[128:131], a[160:163], v[232:235], v[128:131]
    v_mfma_f32_16x16x32_bf16 v[128:131], a[164:167], v[236:239], v[128:131]
    v_mfma_f32_16x16x32_bf16 v[132:135], a[168:171], v[232:235], v[132:135]
    v_exp_f32 v198, v198
    v_mfma_f32_16x16x32_bf16 v[132:135], a[172:175], v[236:239], v[132:135]
    s_waitcnt vmcnt(0) lgkmcnt(0)
    s_barrier
    v_mfma_f32_16x16x32_bf16 v[136:139], a[176:179], v[232:235], v[136:139]
    v_xor_b32 v2, 0x4000, v2
    v_mfma_f32_16x16x32_bf16 v[136:139], a[180:183], v[236:239], v[136:139]
    v_exp_f32 v199, v199
    v_mfma_f32_16x16x32_bf16 v[140:143], a[184:187], v[232:235], v[140:143]
    v_mfma_f32_16x16x32_bf16 v[140:143], a[188:191], v[236:239], v[140:143]
L_a_preXD:
    s_cmp_eq_u32 s28, 18
    s_cselect_b32 s50, 4096, 0
    s_add_u32 s30, s30, s50
    s_cmp_eq_u32 s3, 2
    s_cbranch_scc0 L_a_XD
    v_or_b32 v2, 0x10000, v2
L_a_XD:
    ds_read_b128 a[128:131], v3 offset:32768
    ds_read_b128 a[132:135], v3 offset:33792
    ds_read_b128 a[136:139], v3 offset:34816
    ds_read_b128 a[140:143], v3 offset:35840
    v_smfmac_f32_16x16x32_bf16 a[192:195], a[208:209], v[208:211], v7
    ds_read_b128 a[144:147], v3 offset:36864
    v_cvt_pk_bf16_f32 v224, v176, v177
    v_smfmac_f32_16x16x32_bf16 a[196:199], a[208:209], v[216:219], v7
    ds_read_b128 a[148:151], v3 offset:37888
    s_waitcnt lgkmcnt(4)
    v_mfma_f32_16x16x32_bf16 v[16:19], a[128:131], v[208:211], v[16:19]
    ds_read_b128 a[152:155], v3 offset:38912
    v_cvt_pk_bf16_f32 v225, v178, v179
    v_mfma_f32_16x16x32_bf16 v[48:51], a[128:131], v[216:219], v[48:51]
    ds_read_b128 a[156:159], v3 offset:39936
    s_waitcnt lgkmcnt(4)
    v_mfma_f32_16x16x32_bf16 v[20:23], a[136:139], v[208:211], v[20:23]
    s_add_u32 m0, s36, 32768
    v_cvt_pk_bf16_f32 v226, v180, v181
    v_cvt_pk_bf16_f32 v227, v182, v183
    v_mfma_f32_16x16x32_bf16 v[52:55], a[136:139], v[216:219], v[52:55]
    ds_read_b128 a[160:163], v3 offset:40960
    ds_read_b128 a[164:167], v3 offset:41984
    s_waitcnt lgkmcnt(4)
    s_add_u32 s28, s28, 1
    v_mfma_f32_16x16x32_bf16 v[24:27], a[144:147], v[208:211], v[24:27]
    buffer_load_dwordx4 v4, s[16:19], s32 offen offset:0 sc1 lds
    v_mfma_f32_16x16x32_bf16 v[56:59], a[144:147], v[216:219], v[56:59]
    ds_read_b128 a[168:171], v3 offset:43008
    ds_read_b128 a[172:175], v3 offset:44032
    s_waitcnt lgkmcnt(4)
    v_mfma_f32_16x16x32_bf16 v[28:31], a[152:155], v[208:211], v[28:31]
    buffer_load_dwordx4 v4, s[16:19], s32 offen offset:1024 sc1 lds
    v_mfma_f32_16x16x32_bf16 v[60:63], a[152:155], v[216:219], v[60:63]
    ds_read_b128 a[176:179], v3 offset:45056
    ds_read_b128 a[180:183], v3 offset:46080
    s_waitcnt lgkmcnt(4)
    buffer_load_dwordx4 v4, s[16:19], s32 offen offset:2048 sc1 lds
    v_mfma_f32_16x16x32_bf16 v[32:35], a[160:163], v[208:211], v[32:35]
    buffer_load_dwordx4 v4, s[16:19], s32 offen offset:3072 sc1 lds
    v_mfma_f32_16x16x32_bf16 v[64:67], a[160:163], v[216:219], v[64:67]
    ds_read_b128 a[184:187], v3 offset:47104
    ds_read_b128 a[188:191], v3 offset:48128
    s_waitcnt lgkmcnt(4)
    v_mfma_f32_16x16x32_bf16 v[36:39], a[168:171], v[208:211], v[36:39]
    s_mov_b32 m0, s36
    v_cvt_pk_bf16_f32 v228, v184, v185
    v_cvt_pk_bf16_f32 v229, v186, v187
    v_mfma_f32_16x16x32_bf16 v[68:71], a[168:171], v[216:219], v[68:71]
    s_waitcnt lgkmcnt(2)
    s_mov_b32 s32, s31
    v_mov_b32 v230, 0
    v_mfma_f32_16x16x32_bf16 v[40:43], a[176:179], v[208:211], v[40:43]
    v_mov_b32 v231, 0
    v_mfma_f32_16x16x32_bf16 v[72:75], a[176:179], v[216:219], v[72:75]
    s_waitcnt lgkmcnt(0)
    buffer_load_dwordx4 v4, s[12:15], s30 offen offset:0 sc1 lds
    v_exp_f32 v200, v200
    v_exp_f32 v201, v201
    v_exp_f32 v202, v202
    v_exp_f32 v203, v203
    v_exp_f32 v204, v204
    v_exp_f32 v205, v205
    v_exp_f32 v206, v206
    v_exp_f32 v207, v207
    v_cvt_pk_bf16_f32 v232, v192, v193
    v_cvt_pk_bf16_f32 v233, v194, v195
    v_cvt_pk_bf16_f32 v234, v196, v197
    v_cvt_pk_bf16_f32 v235, v198, v199
    v_cvt_pk_bf16_f32 v236, v200, v201
    v_cvt_pk_bf16_f32 v237, v202, v203
    v_cvt_pk_bf16_f32 v238, v204, v205
    v_cvt_pk_bf16_f32 v239, v206, v207
    v_mfma_f32_16x16x32_bf16 v[44:47], a[184:187], v[208:211], v[44:47]
    buffer_load_dwordx4 v4, s[12:15], s30 offen offset:1024 sc1 lds
    v_mfma_f32_16x16x32_bf16 v[76:79], a[184:187], v[216:219], v[76:79]
    buffer_load_dwordx4 v4, s[12:15], s30 offen offset:2048 sc1 lds
    v_smfmac_f32_16x16x64_bf16 a[200:203], a[208:211], v[224:231], v7
    buffer_load_dwordx4 v4, s[12:15], s30 offen offset:3072 sc1 lds
    v_smfmac_f32_16x16x64_bf16 a[204:207], a[208:211], v[232:239], v7
    s_mov_b32 s31, s30
    v_xor_b32 v3, 0x4000, v3
    v_mfma_f32_16x16x32_bf16 v[80:83], a[128:131], v[224:227], v[80:83]
    ds_read_b128 a[64:67], v2 offset:0
    v_mfma_f32_16x16x32_bf16 v[80:83], a[132:135], v[228:231], v[80:83]
    ds_read_b128 a[68:71], v2 offset:1024
    v_mfma_f32_16x16x32_bf16 v[112:115], a[128:131], v[232:235], v[112:115]
    s_add_u32 m0, s36, 98304
    v_mfma_f32_16x16x32_bf16 v[112:115], a[132:135], v[236:239], v[112:115]
    s_cmp_gt_u32 s28, s26
    v_mfma_f32_16x16x32_bf16 v[84:87], a[136:139], v[224:227], v[84:87]
    ds_read_b128 a[72:75], v2 offset:2048
    buffer_load_dwordx4 v4, s[16:19], s35 offen offset:0 sc1 lds
    v_mfma_f32_16x16x32_bf16 v[84:87], a[140:143], v[228:231], v[84:87]
    ds_read_b128 a[76:79], v2 offset:3072
    v_mfma_f32_16x16x32_bf16 v[116:119], a[136:139], v[232:235], v[116:119]
    s_cselect_b32 s50, 0x10000, s53
    v_mfma_f32_16x16x32_bf16 v[116:119], a[140:143], v[236:239], v[116:119]
    buffer_load_dwordx4 v4, s[16:19], s35 offen offset:1024 sc1 lds
    v_mfma_f32_16x16x32_bf16 v[88:91], a[144:147], v[224:227], v[88:91]
    ds_read_b128 a[80:83], v2 offset:4096
    v_mfma_f32_16x16x32_bf16 v[88:91], a[148:151], v[228:231], v[88:91]
    s_add_u32 s29, s29, s50
    v_mfma_f32_16x16x32_bf16 v[120:123], a[144:147], v[232:235], v[120:123]
    ds_read_b128 a[84:87], v2 offset:5120
    buffer_load_dwordx4 v4, s[16:19], s35 offen offset:2048 sc1 lds
    v_mfma_f32_16x16x32_bf16 v[120:123], a[148:151], v[236:239], v[120:123]
    s_cmp_gt_u32 s28, 16
    v_mfma_f32_16x16x32_bf16 v[92:95], a[152:155], v[224:227], v[92:95]
    ds_read_b128 a[88:91], v2 offset:6144
    v_mfma_f32_16x16x32_bf16 v[92:95], a[156:159], v[228:231], v[92:95]
    buffer_load_dwordx4 v4, s[16:19], s35 offen offset:3072 sc1 lds
    v_mfma_f32_16x16x32_bf16 v[124:127], a[152:155], v[232:235], v[124:127]
    ds_read_b128 a[92:95], v2 offset:7168
    s_cselect_b32 s30, s66, s29
    v_mfma_f32_16x16x32_bf16 v[124:127], a[156:159], v[236:239], v[124:127]
    s_add_u32 m0, s36, 65536
    v_mfma_f32_16x16x32_bf16 v[96:99], a[160:163], v[224:227], v[96:99]
    ds_read_b128 a[96:99], v2 offset:8192
    v_mfma_f32_16x16x32_bf16 v[96:99], a[164:167], v[228:231], v[96:99]
    ds_read_b128 a[100:103], v2 offset:9216
    s_mov_b32 s35, s34
    v_mfma_f32_16x16x32_bf16 v[128:131], a[160:163], v[232:235], v[128:131]
    buffer_load_dwordx4 v4, s[12:15], s33 offen offset:0 sc1 lds
    v_mfma_f32_16x16x32_bf16 v[128:131], a[164:167], v[236:239], v[128:131]
    ds_read_b128 a[104:107], v2 offset:10240
    v_mfma_f32_16x16x32_bf16 v[100:103], a[168:171], v[224:227], v[100:103]
    buffer_load_dwordx4 v4, s[12:15], s33 offen offset:1024 sc1 lds
    v_mfma_f32_16x16x32_bf16 v[100:103], a[172:175], v[228:231], v[100:103]
    ds_read_b128 a[108:111], v2 offset:11264
    buffer_load_dwordx4 v4, s[12:15], s33 offen offset:2048 sc1 lds
    v_mfma_f32_16x16x32_bf16 v[132:135], a[168:171], v[232:235], v[132:135]
    buffer_load_dwordx4 v4, s[12:15], s33 offen offset:3072 sc1 lds
    v_mfma_f32_16x16x32_bf16 v[132:135], a[172:175], v[236:239], v[132:135]
    ds_read_b128 a[112:115], v2 offset:12288
    v_mfma_f32_16x16x32_bf16 v[104:107], a[176:179], v[224:227], v[104:107]
    s_mov_b32 s34, s33
    v_mfma_f32_16x16x32_bf16 v[104:107], a[180:183], v[228:231], v[104:107]
    ds_read_b128 a[116:119], v2 offset:13312
    s_sub_u32 s33, s30, 32768
    v_mfma_f32_16x16x32_bf16 v[136:139], a[176:179], v[232:235], v[136:139]
    ds_read_b128 a[120:123], v2 offset:14336
    v_mfma_f32_16x16x32_bf16 v[136:139], a[180:183], v[236:239], v[136:139]
    s_cmp_eq_u32 s28, s26
    v_mfma_f32_16x16x32_bf16 v[108:111], a[184:187], v[224:227], v[108:111]
    s_cselect_b32 s33, s37, s33
    v_mfma_f32_16x16x32_bf16 v[108:111], a[188:191], v[228:231], v[108:111]
    ds_read_b128 a[124:127], v2 offset:15360
    s_cmp_lt_u32 s28, s26
    v_mfma_f32_16x16x32_bf16 v[140:143], a[184:187], v[232:235], v[140:143]
    s_cselect_b32 s33, s49, s33
    v_mfma_f32_16x16x32_bf16 v[140:143], a[188:191], v[236:239], v[140:143]
    s_xor_b32 s36, s36, 16384
    v_xor_b32 v2, 0x4000, v2
    s_nop 7
    s_lshl_b32 s50, s27, 20
    v_accvgpr_read_b32 v8, a192
    v_accvgpr_read_b32 v9, a196
    v_accvgpr_read_b32 v10, a200
    v_accvgpr_read_b32 v11, a204
    v_accvgpr_read_b32 v184, a193
    v_accvgpr_read_b32 v185, a197
    v_accvgpr_read_b32 v186, a201
    v_accvgpr_read_b32 v187, a205
    v_add_f32 v8, v8, v184
    v_add_f32 v9, v9, v185
    v_add_f32 v10, v10, v186
    v_add_f32 v11, v11, v187
    s_mov_b32 s51, 0x53800000
    v_add_f32 v14, v8, v9
    v_add_f32 v14, v14, v10
    v_add_f32 v14, v14, v11
    v_cmp_nge_f32 vcc, s51, v14
    s_nop 0
    s_or_b32 s39, s39, vcc_lo
    s_or_b32 s39, s39, vcc_hi
    v_rcp_f32 v8, v8
    v_rcp_f32 v9, v9
    v_rcp_f32 v10, v10
    v_rcp_f32 v11, v11
    s_nop 0
    v_pk_mul_f32 v[16:17], v[16:17], v[8:9] op_sel:[0,0] op_sel_hi:[1,0]
    v_pk_mul_f32 v[18:19], v[18:19], v[8:9] op_sel:[0,0] op_sel_hi:[1,0]
    v_pk_mul_f32 v[20:21], v[20:21], v[8:9] op_sel:[0,0] op_sel_hi:[1,0]
    v_pk_mul_f32 v[22:23], v[22:23], v[8:9] op_sel:[0,0] op_sel_hi:[1,0]
    v_cvt_pk_bf16_f32 v16, v16, v17
    v_cvt_pk_bf16_f32 v17, v18, v19
    v_cvt_pk_bf16_f32 v18, v20, v21
    v_cvt_pk_bf16_f32 v19, v22, v23
    buffer_store_dwordx4 v[16:19], v6, s[20:23], s50 offen offset:0 sc1
    v_pk_mul_f32 v[48:49], v[48:49], v[8:9] op_sel:[0,1] op_sel_hi:[1,1]
    v_pk_mul_f32 v[50:51], v[50:51], v[8:9] op_sel:[0,1] op_sel_hi:[1,1]
    v_pk_mul_f32 v[52:53], v[52:53], v[8:9] op_sel:[0,1] op_sel_hi:[1,1]
    v_pk_mul_f32 v[54:55], v[54:55], v[8:9] op_sel:[0,1] op_sel_hi:[1,1]
    v_cvt_pk_bf16_f32 v48, v48, v49
    v_cvt_pk_bf16_f32 v49, v50, v51
    v_cvt_pk_bf16_f32 v50, v52, v53
    v_cvt_pk_bf16_f32 v51, v54, v55
    buffer_store_dwordx4 v[48:51], v6, s[20:23], s50 offen offset:1024 sc1
    v_pk_mul_f32 v[80:81], v[80:81], v[10:11] op_sel:[0,0] op_sel_hi:[1,0]
    v_pk_mul_f32 v[82:83], v[82:83], v[10:11] op_sel:[0,0] op_sel_hi:[1,0]
    v_pk_mul_f32 v[84:85], v[84:85], v[10:11] op_sel:[0,0] op_sel_hi:[1,0]
    v_pk_mul_f32 v[86:87], v[86:87], v[10:11] op_sel:[0,0] op_sel_hi:[1,0]
    v_cvt_pk_bf16_f32 v80, v80, v81
    v_cvt_pk_bf16_f32 v81, v82, v83
    v_cvt_pk_bf16_f32 v82, v84, v85
    v_cvt_pk_bf16_f32 v83, v86, v87
    buffer_store_dwordx4 v[80:83], v6, s[20:23], s50 offen offset:2048 sc1
    v_pk_mul_f32 v[112:113], v[112:113], v[10:11] op_sel:[0,1] op_sel_hi:[1,1]
    v_pk_mul_f32 v[114:115], v[114:115], v[10:11] op_sel:[0,1] op_sel_hi:[1,1]
    v_pk_mul_f32 v[116:117], v[116:117], v[10:11] op_sel:[0,1] op_sel_hi:[1,1]
    v_pk_mul_f32 v[118:119], v[118:119], v[10:11] op_sel:[0,1] op_sel_hi:[1,1]
    v_cvt_pk_bf16_f32 v112, v112, v113
    v_cvt_pk_bf16_f32 v113, v114, v115
    v_cvt_pk_bf16_f32 v114, v116, v117
    v_cvt_pk_bf16_f32 v115, v118, v119
    buffer_store_dwordx4 v[112:115], v6, s[20:23], s50 offen offset:3072 sc1
    s_add_u32 s50, s50, 4096
    v_pk_mul_f32 v[24:25], v[24:25], v[8:9] op_sel:[0,0] op_sel_hi:[1,0]
    v_pk_mul_f32 v[26:27], v[26:27], v[8:9] op_sel:[0,0] op_sel_hi:[1,0]
    v_pk_mul_f32 v[28:29], v[28:29], v[8:9] op_sel:[0,0] op_sel_hi:[1,0]
    v_pk_mul_f32 v[30:31], v[30:31], v[8:9] op_sel:[0,0] op_sel_hi:[1,0]
    v_cvt_pk_bf16_f32 v24, v24, v25
    v_cvt_pk_bf16_f32 v25, v26, v27
    v_cvt_pk_bf16_f32 v26, v28, v29
    v_cvt_pk_bf16_f32 v27, v30, v31
    buffer_store_dwordx4 v[24:27], v6, s[20:23], s50 offen offset:0 sc1
    v_pk_mul_f32 v[56:57], v[56:57], v[8:9] op_sel:[0,1] op_sel_hi:[1,1]
    v_pk_mul_f32 v[58:59], v[58:59], v[8:9] op_sel:[0,1] op_sel_hi:[1,1]
    v_pk_mul_f32 v[60:61], v[60:61], v[8:9] op_sel:[0,1] op_sel_hi:[1,1]
    v_pk_mul_f32 v[62:63], v[62:63], v[8:9] op_sel:[0,1] op_sel_hi:[1,1]
    v_cvt_pk_bf16_f32 v56, v56, v57
    v_cvt_pk_bf16_f32 v57, v58, v59
    v_cvt_pk_bf16_f32 v58, v60, v61
    v_cvt_pk_bf16_f32 v59, v62, v63
    buffer_store_dwordx4 v[56:59], v6, s[20:23], s50 offen offset:1024 sc1
    v_pk_mul_f32 v[88:89], v[88:89], v[10:11] op_sel:[0,0] op_sel_hi:[1,0]
    v_pk_mul_f32 v[90:91], v[90:91], v[10:11] op_sel:[0,0] op_sel_hi:[1,0]
    v_pk_mul_f32 v[92:93], v[92:93], v[10:11] op_sel:[0,0] op_sel_hi:[1,0]
    v_pk_mul_f32 v[94:95], v[94:95], v[10:11] op_sel:[0,0] op_sel_hi:[1,0]
    v_cvt_pk_bf16_f32 v88, v88, v89
    v_cvt_pk_bf16_f32 v89, v90, v91
    v_cvt_pk_bf16_f32 v90, v92, v93
    v_cvt_pk_bf16_f32 v91, v94, v95
    buffer_store_dwordx4 v[88:91], v6, s[20:23], s50 offen offset:2048 sc1
    v_pk_mul_f32 v[120:121], v[120:121], v[10:11] op_sel:[0,1] op_sel_hi:[1,1]
    v_pk_mul_f32 v[122:123], v[122:123], v[10:11] op_sel:[0,1] op_sel_hi:[1,1]
    v_pk_mul_f32 v[124:125], v[124:125], v[10:11] op_sel:[0,1] op_sel_hi:[1,1]
    v_pk_mul_f32 v[126:127], v[126:127], v[10:11] op_sel:[0,1] op_sel_hi:[1,1]
    v_cvt_pk_bf16_f32 v120, v120, v121
    v_cvt_pk_bf16_f32 v121, v122, v123
    v_cvt_pk_bf16_f32 v122, v124, v125
    v_cvt_pk_bf16_f32 v123, v126, v127
    buffer_store_dwordx4 v[120:123], v6, s[20:23], s50 offen offset:3072 sc1
    s_add_u32 s50, s50, 4096
    v_pk_mul_f32 v[32:33], v[32:33], v[8:9] op_sel:[0,0] op_sel_hi:[1,0]
    v_pk_mul_f32 v[34:35], v[34:35], v[8:9] op_sel:[0,0] op_sel_hi:[1,0]
    v_pk_mul_f32 v[36:37], v[36:37], v[8:9] op_sel:[0,0] op_sel_hi:[1,0]
    v_pk_mul_f32 v[38:39], v[38:39], v[8:9] op_sel:[0,0] op_sel_hi:[1,0]
    v_cvt_pk_bf16_f32 v32, v32, v33
    v_cvt_pk_bf16_f32 v33, v34, v35
    v_cvt_pk_bf16_f32 v34, v36, v37
    v_cvt_pk_bf16_f32 v35, v38, v39
    buffer_store_dwordx4 v[32:35], v6, s[20:23], s50 offen offset:0 sc1
    v_pk_mul_f32 v[64:65], v[64:65], v[8:9] op_sel:[0,1] op_sel_hi:[1,1]
    v_pk_mul_f32 v[66:67], v[66:67], v[8:9] op_sel:[0,1] op_sel_hi:[1,1]
    v_pk_mul_f32 v[68:69], v[68:69], v[8:9] op_sel:[0,1] op_sel_hi:[1,1]
    v_pk_mul_f32 v[70:71], v[70:71], v[8:9] op_sel:[0,1] op_sel_hi:[1,1]
    v_cvt_pk_bf16_f32 v64, v64, v65
    v_cvt_pk_bf16_f32 v65, v66, v67
    v_cvt_pk_bf16_f32 v66, v68, v69
    v_cvt_pk_bf16_f32 v67, v70, v71
    buffer_store_dwordx4 v[64:67], v6, s[20:23], s50 offen offset:1024 sc1
    v_pk_mul_f32 v[96:97], v[96:97], v[10:11] op_sel:[0,0] op_sel_hi:[1,0]
    v_pk_mul_f32 v[98:99], v[98:99], v[10:11] op_sel:[0,0] op_sel_hi:[1,0]
    v_pk_mul_f32 v[100:101], v[100:101], v[10:11] op_sel:[0,0] op_sel_hi:[1,0]
    v_pk_mul_f32 v[102:103], v[102:103], v[10:11] op_sel:[0,0] op_sel_hi:[1,0]
    v_cvt_pk_bf16_f32 v96, v96, v97
    v_cvt_pk_bf16_f32 v97, v98, v99
    v_cvt_pk_bf16_f32 v98, v100, v101
    v_cvt_pk_bf16_f32 v99, v102, v103
    buffer_store_dwordx4 v[96:99], v6, s[20:23], s50 offen offset:2048 sc1
    v_pk_mul_f32 v[128:129], v[128:129], v[10:11] op_sel:[0,1] op_sel_hi:[1,1]
    v_pk_mul_f32 v[130:131], v[130:131], v[10:11] op_sel:[0,1] op_sel_hi:[1,1]
    v_pk_mul_f32 v[132:133], v[132:133], v[10:11] op_sel:[0,1] op_sel_hi:[1,1]
    v_pk_mul_f32 v[134:135], v[134:135], v[10:11] op_sel:[0,1] op_sel_hi:[1,1]
    v_cvt_pk_bf16_f32 v128, v128, v129
    v_cvt_pk_bf16_f32 v129, v130, v131
    v_cvt_pk_bf16_f32 v130, v132, v133
    v_cvt_pk_bf16_f32 v131, v134, v135
    buffer_store_dwordx4 v[128:131], v6, s[20:23], s50 offen offset:3072 sc1
    s_add_u32 s50, s50, 4096
    v_pk_mul_f32 v[40:41], v[40:41], v[8:9] op_sel:[0,0] op_sel_hi:[1,0]
    v_pk_mul_f32 v[42:43], v[42:43], v[8:9] op_sel:[0,0] op_sel_hi:[1,0]
    v_pk_mul_f32 v[44:45], v[44:45], v[8:9] op_sel:[0,0] op_sel_hi:[1,0]
    v_pk_mul_f32 v[46:47], v[46:47], v[8:9] op_sel:[0,0] op_sel_hi:[1,0]
    v_cvt_pk_bf16_f32 v40, v40, v41
    v_cvt_pk_bf16_f32 v41, v42, v43
    v_cvt_pk_bf16_f32 v42, v44, v45
    v_cvt_pk_bf16_f32 v43, v46, v47
    buffer_store_dwordx4 v[40:43], v6, s[20:23], s50 offen offset:0 sc1
    v_pk_mul_f32 v[72:73], v[72:73], v[8:9] op_sel:[0,1] op_sel_hi:[1,1]
    v_pk_mul_f32 v[74:75], v[74:75], v[8:9] op_sel:[0,1] op_sel_hi:[1,1]
    v_pk_mul_f32 v[76:77], v[76:77], v[8:9] op_sel:[0,1] op_sel_hi:[1,1]
    v_pk_mul_f32 v[78:79], v[78:79], v[8:9] op_sel:[0,1] op_sel_hi:[1,1]
    v_cvt_pk_bf16_f32 v72, v72, v73
    v_cvt_pk_bf16_f32 v73, v74, v75
    v_cvt_pk_bf16_f32 v74, v76, v77
    v_cvt_pk_bf16_f32 v75, v78, v79
    buffer_store_dwordx4 v[72:75], v6, s[20:23], s50 offen offset:1024 sc1
    v_pk_mul_f32 v[104:105], v[104:105], v[10:11] op_sel:[0,0] op_sel_hi:[1,0]
    v_pk_mul_f32 v[106:107], v[106:107], v[10:11] op_sel:[0,0] op_sel_hi:[1,0]
    v_pk_mul_f32 v[108:109], v[108:109], v[10:11] op_sel:[0,0] op_sel_hi:[1,0]
    v_pk_mul_f32 v[110:111], v[110:111], v[10:11] op_sel:[0,0] op_sel_hi:[1,0]
    v_cvt_pk_bf16_f32 v104, v104, v105
    v_cvt_pk_bf16_f32 v105, v106, v107
    v_cvt_pk_bf16_f32 v106, v108, v109
    v_cvt_pk_bf16_f32 v107, v110, v111
    buffer_store_dwordx4 v[104:107], v6, s[20:23], s50 offen offset:2048 sc1
    v_pk_mul_f32 v[136:137], v[136:137], v[10:11] op_sel:[0,1] op_sel_hi:[1,1]
    v_pk_mul_f32 v[138:139], v[138:139], v[10:11] op_sel:[0,1] op_sel_hi:[1,1]
    v_pk_mul_f32 v[140:141], v[140:141], v[10:11] op_sel:[0,1] op_sel_hi:[1,1]
    v_pk_mul_f32 v[142:143], v[142:143], v[10:11] op_sel:[0,1] op_sel_hi:[1,1]
    v_cvt_pk_bf16_f32 v136, v136, v137
    v_cvt_pk_bf16_f32 v137, v138, v139
    v_cvt_pk_bf16_f32 v138, v140, v141
    v_cvt_pk_bf16_f32 v139, v142, v143
    buffer_store_dwordx4 v[136:139], v6, s[20:23], s50 offen offset:3072 sc1
    s_waitcnt vmcnt(16) lgkmcnt(0)
    s_barrier
    s_sub_u32 s27, 33, s3
    s_lshl_b32 s50, s25, 1
    s_sub_u32 s27, s27, s50
    s_cmp_eq_u32 s28, 19
    s_cbranch_scc1 L_a_FX
    s_cmp_eq_u32 s28, 18
    s_cselect_b32 s50, 4096, 0
    s_add_u32 s30, s30, s50
    s_mov_b32 s58, 1
    s_mov_b32 s48, 18
    v_or_b32 v3, 0x10000, v3
    s_and_b32 s50, s27, 1
    s_lshl_b32 s50, s50, 14
    s_add_u32 s50, s50, 131072
    v_add_u32 v8, s50, v1
    ds_read_b128 a[0:3], v8 offset:0
    ds_read_b128 a[4:7], v8 offset:1024
    ds_read_b128 a[8:11], v8 offset:2048
    ds_read_b128 a[12:15], v8 offset:3072
    ds_read_b128 a[16:19], v8 offset:4096
    ds_read_b128 a[20:23], v8 offset:5120
    ds_read_b128 a[24:27], v8 offset:6144
    ds_read_b128 a[28:31], v8 offset:7168
    ds_read_b128 a[32:35], v8 offset:8192
    ds_read_b128 a[36:39], v8 offset:9216
    ds_read_b128 a[40:43], v8 offset:10240
    ds_read_b128 a[44:47], v8 offset:11264
    ds_read_b128 a[48:51], v8 offset:12288
    ds_read_b128 a[52:55], v8 offset:13312
    ds_read_b128 a[56:59], v8 offset:14336
    ds_read_b128 a[60:63], v8 offset:15360
    v_accvgpr_write_b32 a192, 0
    v_accvgpr_write_b32 a193, 0
    v_accvgpr_write_b32 a194, 0
    v_accvgpr_write_b32 a195, 0
    v_accvgpr_write_b32 a196, 0
    v_accvgpr_write_b32 a197, 0
    v_accvgpr_write_b32 a198, 0
    v_accvgpr_write_b32 a199, 0
    v_accvgpr_write_b32 a200, 0
    v_accvgpr_write_b32 a201, 0
    v_accvgpr_write_b32 a202, 0
    v_accvgpr_write_b32 a203, 0
    v_accvgpr_write_b32 a204, 0
    v_accvgpr_write_b32 a205, 0
    v_accvgpr_write_b32 a206, 0
    v_accvgpr_write_b32 a207, 0
    v_mov_b64 v[16:17], 0
    v_mov_b64 v[18:19], 0
    v_mov_b64 v[20:21], 0
    v_mov_b64 v[22:23], 0
    v_mov_b64 v[24:25], 0
    v_mov_b64 v[26:27], 0
    v_mov_b64 v[28:29], 0
    v_mov_b64 v[30:31], 0
    v_mov_b64 v[32:33], 0
    v_mov_b64 v[34:35], 0
    v_mov_b64 v[36:37], 0
    v_mov_b64 v[38:39], 0
    v_mov_b64 v[40:41], 0
    v_mov_b64 v[42:43], 0
    v_mov_b64 v[44:45], 0
    v_mov_b64 v[46:47], 0
    v_mov_b64 v[48:49], 0
    v_mov_b64 v[50:51], 0
    v_mov_b64 v[52:53], 0
    v_mov_b64 v[54:55], 0
    v_mov_b64 v[56:57], 0
    v_mov_b64 v[58:59], 0
    v_mov_b64 v[60:61], 0
    v_mov_b64 v[62:63], 0
    v_mov_b64 v[64:65], 0
    v_mov_b64 v[66:67], 0
    v_mov_b64 v[68:69], 0
    v_mov_b64 v[70:71], 0
    v_mov_b64 v[72:73], 0
    v_mov_b64 v[74:75], 0
    v_mov_b64 v[76:77], 0
    v_mov_b64 v[78:79], 0
    v_mov_b64 v[80:81], 0
    v_mov_b64 v[82:83], 0
    v_mov_b64 v[84:85], 0
    v_mov_b64 v[86:87], 0
    v_mov_b64 v[88:89], 0
    v_mov_b64 v[90:91], 0
    v_mov_b64 v[92:93], 0
    v_mov_b64 v[94:95], 0
    s_waitcnt lgkmcnt(0)
    s_cmp_eq_u32 s38, 0
    s_cbranch_scc0 L_a_nmx2
    v_mfma_f32_16x16x32_bf16 v[240:243], a[212:215], a[0:3], 0
    v_mov_b64 v[96:97], 0
    v_mov_b64 v[98:99], 0
    v_mfma_f32_16x16x32_bf16 v[240:243], a[216:219], a[4:7], v[240:243]
    v_mov_b64 v[100:101], 0
    v_mov_b64 v[102:103], 0
    v_mfma_f32_16x16x32_bf16 v[240:243], a[220:223], a[8:11], v[240:243]
    v_mov_b64 v[104:105], 0
    v_mov_b64 v[106:107], 0
    v_mfma_f32_16x16x32_bf16 v[240:243], a[224:227], a[12:15], v[240:243]
    v_mov_b64 v[108:109], 0
    v_mov_b64 v[110:111], 0
    v_mfma_f32_16x16x32_bf16 v[244:247], a[212:215], a[16:19], 0
    v_mov_b64 v[112:113], 0
    v_mov_b64 v[114:115], 0
    v_mfma_f32_16x16x32_bf16 v[244:247], a[216:219], a[20:23], v[244:247]
    v_mov_b64 v[116:117], 0
    v_mov_b64 v[118:119], 0
    v_mfma_f32_16x16x32_bf16 v[244:247], a[220:223], a[24:27], v[244:247]
    v_mov_b64 v[120:121], 0
    v_mov_b64 v[122:123], 0
    v_mfma_f32_16x16x32_bf16 v[244:247], a[224:227], a[28:31], v[244:247]
    v_mov_b64 v[124:125], 0
    v_mov_b64 v[126:127], 0
    v_mfma_f32_16x16x32_bf16 v[248:251], a[212:215], a[32:35], 0
    v_mov_b64 v[128:129], 0
    v_mov_b64 v[130:131], 0
    v_mfma_f32_16x16x32_bf16 v[248:251], a[216:219], a[36:39], v[248:251]
    v_mov_b64 v[132:133], 0
    v_mov_b64 v[134:135], 0
    v_mfma_f32_16x16x32_bf16 v[248:251], a[220:223], a[40:43], v[248:251]
    v_mov_b64 v[136:137], 0
    v_mov_b64 v[138:139], 0
    v_mfma_f32_16x16x32_bf16 v[248:251], a[224:227], a[44:47], v[248:251]
    v_mov_b64 v[140:141], 0
    v_mov_b64 v[142:143], 0
    v_mfma_f32_16x16x32_bf16 v[252:255], a[212:215], a[48:51], 0
    v_mfma_f32_16x16x32_bf16 v[252:255], a[216:219], a[52:55], v[252:255]
    v_mfma_f32_16x16x32_bf16 v[252:255], a[220:223], a[56:59], v[252:255]
    v_mfma_f32_16x16x32_bf16 v[252:255], a[224:227], a[60:63], v[252:255]
    s_nop 7
    v_sub_f32 v240, 0, v240
    v_sub_f32 v241, 0, v241
    v_sub_f32 v242, 0, v242
    v_sub_f32 v243, 0, v243
    v_sub_f32 v244, 0, v244
    v_sub_f32 v245, 0, v245
    v_sub_f32 v246, 0, v246
    v_sub_f32 v247, 0, v247
    v_sub_f32 v248, 0, v248
    v_sub_f32 v249, 0, v249
    v_sub_f32 v250, 0, v250
    v_sub_f32 v251, 0, v251
    v_sub_f32 v252, 0, v252
    v_sub_f32 v253, 0, v253
    v_sub_f32 v254, 0, v254
    v_sub_f32 v255, 0, v255
L_a_sw2:
    s_cmp_eq_u32 s3, 2
    s_cbranch_scc1 L_a_DX
    s_branch L_a_NX
L_a_FX:
    v_mov_b64 v[16:17], 0
    v_mov_b64 v[18:19], 0
    v_mov_b64 v[8:9], 0
    v_mov_b64 v[10:11], 0
    s_and_b32 s50, s3, 1
    s_lshl_b32 s51, s50, 14
    s_add_u32 s51, s51, 131072
    v_add_u32 v12, s51, v1
    s_lshl_b32 s51, s50, 16
    s_sub_u32 s51, 114688, s51
    v_add_u32 v13, s51, v1
    s_lshl_b32 s50, s3, 10
    s_add_u32 s50, s50, 65536
    v_add_u32 v2, s50, v1
    s_xor_b32 s50, s50, 3072
    v_add_u32 v4, s50, v1
    s_lshl_b32 s50, s3, 2
    s_add_u32 s50, s50, 69632
    v_mov_b32 v5, s50
    ds_write_b128 v12, v[16:19] offset:0
    ds_write_b128 v12, v[16:19] offset:1024
    ds_write_b128 v12, v[16:19] offset:2048
    ds_write_b128 v12, v[16:19] offset:3072
    ds_write_b128 v12, v[16:19] offset:4096
    ds_write_b128 v12, v[16:19] offset:5120
    ds_write_b128 v12, v[16:19] offset:6144
    ds_write_b128 v12, v[16:19] offset:7168
    ds_write_b128 v12, v[16:19] offset:8192
    ds_write_b128 v12, v[16:19] offset:9216
    ds_write_b128 v12, v[16:19] offset:10240
    ds_write_b128 v12, v[16:19] offset:11264
    ds_write_b128 v12, v[16:19] offset:12288
    ds_write_b128 v12, v[16:19] offset:13312
    ds_write_b128 v12, v[16:19] offset:14336
    ds_write_b128 v12, v[16:19] offset:15360
    v_mov_b32 v14, s39
    ds_write_b128 v2, v[8:11]
    ds_write_b32 v5, v14
    s_mov_b32 s56, 8192
    buffer_load_dwordx4 a[224:227], v15, s[8:11], s56 offen offset:0 sc1
    v_mov_b64 v[142:143], 0
    buffer_load_dwordx4 a[228:231], v15, s[8:11], s56 offen offset:1024 sc1
    v_mov_b64 v[140:141], 0
    buffer_load_dwordx4 a[232:235], v15, s[8:11], s56 offen offset:2048 sc1
    v_mov_b64 v[138:139], 0
    buffer_load_dwordx4 a[236:239], v15, s[8:11], s56 offen offset:3072 sc1
    v_mov_b64 v[136:137], 0
    s_mov_b32 s56, 12288
    buffer_load_dwordx4 a[240:243], v15, s[8:11], s56 offen offset:0 sc1
    v_mov_b64 v[134:135], 0
    buffer_load_dwordx4 a[244:247], v15, s[8:11], s56 offen offset:1024 sc1
    v_mov_b64 v[132:133], 0
    buffer_load_dwordx4 a[248:251], v15, s[8:11], s56 offen offset:2048 sc1
    v_mov_b64 v[130:131], 0
    buffer_load_dwordx4 a[252:255], v15, s[8:11], s56 offen offset:3072 sc1
    v_mov_b64 v[128:129], 0
    s_mov_b32 s56, 16384
    buffer_load_dwordx4 a[0:3], v15, s[8:11], s56 offen offset:0 sc1
    v_mov_b64 v[126:127], 0
    buffer_load_dwordx4 a[4:7], v15, s[8:11], s56 offen offset:1024 sc1
    v_mov_b64 v[124:125], 0
    buffer_load_dwordx4 a[8:11], v15, s[8:11], s56 offen offset:2048 sc1
    v_mov_b64 v[122:123], 0
    buffer_load_dwordx4 a[12:15], v15, s[8:11], s56 offen offset:3072 sc1
    v_mov_b64 v[120:121], 0
    s_mov_b32 s56, 20480
    buffer_load_dwordx4 a[16:19], v15, s[8:11], s56 offen offset:0 sc1
    v_mov_b64 v[118:119], 0
    buffer_load_dwordx4 a[20:23], v15, s[8:11], s56 offen offset:1024 sc1
    v_mov_b64 v[116:117], 0
    buffer_load_dwordx4 a[24:27], v15, s[8:11], s56 offen offset:2048 sc1
    v_mov_b64 v[114:115], 0
    buffer_load_dwordx4 a[28:31], v15, s[8:11], s56 offen offset:3072 sc1
    v_mov_b64 v[112:113], 0
    s_mov_b32 s56, 28672
    buffer_load_dwordx4 a[32:35], v15, s[8:11], s56 offen offset:0 sc1
    v_mov_b64 v[110:111], 0
    buffer_load_dwordx4 a[36:39], v15, s[8:11], s56 offen offset:1024 sc1
    v_mov_b64 v[108:109], 0
    buffer_load_dwordx4 a[40:43], v15, s[8:11], s56 offen offset:2048 sc1
    v_mov_b64 v[106:107], 0
    buffer_load_dwordx4 a[44:47], v15, s[8:11], s56 offen offset:3072 sc1
    v_mov_b64 v[104:105], 0
    s_mov_b32 s56, 32768
    buffer_load_dwordx4 a[48:51], v15, s[8:11], s56 offen offset:0 sc1
    v_mov_b64 v[102:103], 0
    buffer_load_dwordx4 a[52:55], v15, s[8:11], s56 offen offset:1024 sc1
    v_mov_b64 v[100:101], 0
    buffer_load_dwordx4 a[56:59], v15, s[8:11], s56 offen offset:2048 sc1
    v_mov_b64 v[98:99], 0
    buffer_load_dwordx4 a[60:63], v15, s[8:11], s56 offen offset:3072 sc1
    v_mov_b64 v[96:97], 0
    s_waitcnt vmcnt(24)
    s_cmp_eq_u32 s39, 0
    s_cselect_b32 s54, s69, s49
    v_mov_b32 v193, s54
    v_mov_b32 v192, 1
    buffer_store_dword v192, v193, s[60:63], 0 offen sc1
    s_mov_b32 s56, 0
    buffer_load_dwordx4 v[144:147], v15, s[8:11], s56 offen offset:0 sc1
    v_mov_b64 v[94:95], 0
    buffer_load_dwordx4 v[148:151], v15, s[8:11], s56 offen offset:1024 sc1
    v_mov_b64 v[92:93], 0
    buffer_load_dwordx4 v[152:155], v15, s[8:11], s56 offen offset:2048 sc1
    v_mov_b64 v[90:91], 0
    buffer_load_dwordx4 v[156:159], v15, s[8:11], s56 offen offset:3072 sc1
    v_mov_b64 v[88:89], 0
    s_mov_b32 s56, 4096
    buffer_load_dwordx4 v[160:163], v15, s[8:11], s56 offen offset:0 sc1
    v_mov_b64 v[86:87], 0
    buffer_load_dwordx4 v[164:167], v15, s[8:11], s56 offen offset:1024 sc1
    v_mov_b64 v[84:85], 0
    buffer_load_dwordx4 v[168:171], v15, s[8:11], s56 offen offset:2048 sc1
    v_mov_b64 v[82:83], 0
    buffer_load_dwordx4 v[172:175], v15, s[8:11], s56 offen offset:3072 sc1
    v_mov_b64 v[80:81], 0
    v_bfe_u32 v188, v1, 4, 2
    v_lshl_add_u32 v188, v188, 2, s68
    buffer_load_dword v189, v188, s[60:63], 0 offen offset:0 sc1
    s_waitcnt lgkmcnt(0)
    s_barrier
    s_branch L_a_recvS
L_a_nmx2:
    v_mov_b64 v[96:97], 0
    v_mov_b64 v[98:99], 0
    v_mov_b64 v[100:101], 0
    v_mov_b64 v[102:103], 0
    v_mov_b64 v[104:105], 0
    v_mov_b64 v[106:107], 0
    v_mov_b64 v[108:109], 0
    v_mov_b64 v[110:111], 0
    v_mov_b64 v[112:113], 0
    v_mov_b64 v[114:115], 0
    v_mov_b64 v[116:117], 0
    v_mov_b64 v[118:119], 0
    v_mov_b64 v[120:121], 0
    v_mov_b64 v[122:123], 0
    v_mov_b64 v[124:125], 0
    v_mov_b64 v[126:127], 0
    v_mov_b64 v[128:129], 0
    v_mov_b64 v[130:131], 0
    v_mov_b64 v[132:133], 0
    v_mov_b64 v[134:135], 0
    v_mov_b64 v[136:137], 0
    v_mov_b64 v[138:139], 0
    v_mov_b64 v[140:141], 0
    v_mov_b64 v[142:143], 0
    v_mov_b32 v160, v5
    v_mov_b32 v161, v5
    v_mov_b32 v162, v5
    v_mov_b32 v163, v5
    v_lshrrev_b32 v10, 8, v1
    v_lshlrev_b32 v10, 2, v10
    v_bfe_u32 v9, v1, 4, 4
    v_sub_u32 v10, v10, v9
    s_lshl_b32 s52, s27, 6
    s_mov_b32 s50, 0
    s_lshl_b32 s51, s24, 20
    v_add_u32 v8, s51, v1
L_a_nmx2loop:
    s_lshr_b32 s54, s50, 2
    s_lshl_b32 s54, s54, 15
    s_and_b32 s55, s50, 3
    s_lshl_b32 s55, s55, 12
    s_add_u32 s54, s54, s55
    buffer_load_dwordx4 a[128:131], v8, s[12:15], s54 offen offset:0 sc1
    buffer_load_dwordx4 a[132:135], v8, s[12:15], s54 offen offset:1024 sc1
    buffer_load_dwordx4 a[136:139], v8, s[12:15], s54 offen offset:2048 sc1
    buffer_load_dwordx4 a[140:143], v8, s[12:15], s54 offen offset:3072 sc1
    s_waitcnt vmcnt(0)
    v_mfma_f32_16x16x32_bf16 v[144:147], a[128:131], a[0:3], 0
    v_mfma_f32_16x16x32_bf16 v[144:147], a[132:135], a[4:7], v[144:147]
    v_mfma_f32_16x16x32_bf16 v[144:147], a[136:139], a[8:11], v[144:147]
    v_mfma_f32_16x16x32_bf16 v[144:147], a[140:143], a[12:15], v[144:147]
    v_mfma_f32_16x16x32_bf16 v[148:151], a[128:131], a[16:19], 0
    v_mfma_f32_16x16x32_bf16 v[148:151], a[132:135], a[20:23], v[148:151]
    v_mfma_f32_16x16x32_bf16 v[148:151], a[136:139], a[24:27], v[148:151]
    v_mfma_f32_16x16x32_bf16 v[148:151], a[140:143], a[28:31], v[148:151]
    v_mfma_f32_16x16x32_bf16 v[152:155], a[128:131], a[32:35], 0
    v_mfma_f32_16x16x32_bf16 v[152:155], a[132:135], a[36:39], v[152:155]
    v_mfma_f32_16x16x32_bf16 v[152:155], a[136:139], a[40:43], v[152:155]
    v_mfma_f32_16x16x32_bf16 v[152:155], a[140:143], a[44:47], v[152:155]
    v_mfma_f32_16x16x32_bf16 v[156:159], a[128:131], a[48:51], 0
    v_mfma_f32_16x16x32_bf16 v[156:159], a[132:135], a[52:55], v[156:159]
    v_mfma_f32_16x16x32_bf16 v[156:159], a[136:139], a[56:59], v[156:159]
    v_mfma_f32_16x16x32_bf16 v[156:159], a[140:143], a[60:63], v[156:159]
    s_nop 7
    s_add_i32 s54, s52, 0
    v_cmp_ge_i32 vcc, s54, v10
    s_nop 1
    v_cndmask_b32 v9, v5, v144, vcc
    v_max_f32 v160, v160, v9
    s_add_i32 s54, s52, -1
    v_cmp_ge_i32 vcc, s54, v10
    s_nop 1
    v_cndmask_b32 v9, v5, v145, vcc
    v_max_f32 v160, v160, v9
    s_add_i32 s54, s52, -2
    v_cmp_ge_i32 vcc, s54, v10
    s_nop 1
    v_cndmask_b32 v9, v5, v146, vcc
    v_max_f32 v160, v160, v9
    s_add_i32 s54, s52, -3
    v_cmp_ge_i32 vcc, s54, v10
    s_nop 1
    v_cndmask_b32 v9, v5, v147, vcc
    v_max_f32 v160, v160, v9
    s_add_i32 s54, s52, 16
    v_cmp_ge_i32 vcc, s54, v10
    s_nop 1
    v_cndmask_b32 v9, v5, v148, vcc
    v_max_f32 v161, v161, v9
    s_add_i32 s54, s52, 15
    v_cmp_ge_i32 vcc, s54, v10
    s_nop 1
    v_cndmask_b32 v9, v5, v149, vcc
    v_max_f32 v161, v161, v9
    s_add_i32 s54, s52, 14
    v_cmp_ge_i32 vcc, s54, v10
    s_nop 1
    v_cndmask_b32 v9, v5, v150, vcc
    v_max_f32 v161, v161, v9
    s_add_i32 s54, s52, 13
    v_cmp_ge_i32 vcc, s54, v10
    s_nop 1
    v_cndmask_b32 v9, v5, v151, vcc
    v_max_f32 v161, v161, v9
    s_add_i32 s54, s52, 32
    v_cmp_ge_i32 vcc, s54, v10
    s_nop 1
    v_cndmask_b32 v9, v5, v152, vcc
    v_max_f32 v162, v162, v9
    s_add_i32 s54, s52, 31
    v_cmp_ge_i32 vcc, s54, v10
    s_nop 1
    v_cndmask_b32 v9, v5, v153, vcc
    v_max_f32 v162, v162, v9
    s_add_i32 s54, s52, 30
    v_cmp_ge_i32 vcc, s54, v10
    s_nop 1
    v_cndmask_b32 v9, v5, v154, vcc
    v_max_f32 v162, v162, v9
    s_add_i32 s54, s52, 29
    v_cmp_ge_i32 vcc, s54, v10
    s_nop 1
    v_cndmask_b32 v9, v5, v155, vcc
    v_max_f32 v162, v162, v9
    s_add_i32 s54, s52, 48
    v_cmp_ge_i32 vcc, s54, v10
    s_nop 1
    v_cndmask_b32 v9, v5, v156, vcc
    v_max_f32 v163, v163, v9
    s_add_i32 s54, s52, 47
    v_cmp_ge_i32 vcc, s54, v10
    s_nop 1
    v_cndmask_b32 v9, v5, v157, vcc
    v_max_f32 v163, v163, v9
    s_add_i32 s54, s52, 46
    v_cmp_ge_i32 vcc, s54, v10
    s_nop 1
    v_cndmask_b32 v9, v5, v158, vcc
    v_max_f32 v163, v163, v9
    s_add_i32 s54, s52, 45
    v_cmp_ge_i32 vcc, s54, v10
    s_nop 1
    v_cndmask_b32 v9, v5, v159, vcc
    v_max_f32 v163, v163, v9
    s_sub_i32 s52, s52, 16
    s_add_u32 s50, s50, 1
    s_cmp_ge_i32 s52, -48
    s_cbranch_scc1 L_a_nmx2loop
    v_mov_b32 v9, v160
    s_nop 1
    v_permlane32_swap_b32 v160, v9
    v_max_f32 v160, v160, v9
    v_mov_b32 v9, v160
    s_nop 1
    v_permlane16_swap_b32 v160, v9
    v_max_f32 v160, v160, v9
    v_sub_f32 v240, 0, v160
    v_sub_f32 v241, 0, v160
    v_sub_f32 v242, 0, v160
    v_sub_f32 v243, 0, v160
    v_mov_b32 v9, v161
    s_nop 1
    v_permlane32_swap_b32 v161, v9
    v_max_f32 v161, v161, v9
    v_mov_b32 v9, v161
    s_nop 1
    v_permlane16_swap_b32 v161, v9
    v_max_f32 v161, v161, v9
    v_sub_f32 v244, 0, v161
    v_sub_f32 v245, 0, v161
    v_sub_f32 v246, 0, v161
    v_sub_f32 v247, 0, v161
    v_mov_b32 v9, v162
    s_nop 1
    v_permlane32_swap_b32 v162, v9
    v_max_f32 v162, v162, v9
    v_mov_b32 v9, v162
    s_nop 1
    v_permlane16_swap_b32 v162, v9
    v_max_f32 v162, v162, v9
    v_sub_f32 v248, 0, v162
    v_sub_f32 v249, 0, v162
    v_sub_f32 v250, 0, v162
    v_sub_f32 v251, 0, v162
    v_mov_b32 v9, v163
    s_nop 1
    v_permlane32_swap_b32 v163, v9
    v_max_f32 v163, v163, v9
    v_mov_b32 v9, v163
    s_nop 1
    v_permlane16_swap_b32 v163, v9
    v_max_f32 v163, v163, v9
    v_sub_f32 v252, 0, v163
    v_sub_f32 v253, 0, v163
    v_sub_f32 v254, 0, v163
    v_sub_f32 v255, 0, v163
    s_branch L_a_sw2
L_a_DX:
    v_cndmask_b32 v144, v5, v240, s[40:41]
    v_cndmask_b32 v145, v5, v241, s[42:43]
    v_cndmask_b32 v146, v5, v242, s[44:45]
    v_cndmask_b32 v147, v5, v243, s[46:47]
    s_nop 1
    v_mfma_f32_16x16x32_bf16 v[144:147], a[64:67], a[0:3], v[144:147]
    s_add_u32 m0, s36, 32768
    v_xor_b32 v3, 0x4000, v3
    v_mfma_f32_16x16x32_bf16 v[144:147], a[68:71], a[4:7], v[144:147]
    s_add_u32 s28, s28, 1
    v_mov_b32 v210, 0
    v_mov_b32 v211, 0
    v_mfma_f32_16x16x32_bf16 v[144:147], a[72:75], a[8:11], v[144:147]
    buffer_load_dwordx4 v4, s[16:19], s32 offen offset:0 sc1 lds
    v_mfma_f32_16x16x32_bf16 v[144:147], a[76:79], a[12:15], v[144:147]
    buffer_load_dwordx4 v4, s[16:19], s32 offen offset:1024 sc1 lds
    v_mfma_f32_16x16x32_bf16 v[160:163], a[64:67], a[16:19], v[244:247]
    buffer_load_dwordx4 v4, s[16:19], s32 offen offset:2048 sc1 lds
    v_mfma_f32_16x16x32_bf16 v[160:163], a[68:71], a[20:23], v[160:163]
    buffer_load_dwordx4 v4, s[16:19], s32 offen offset:3072 sc1 lds
    v_mfma_f32_16x16x32_bf16 v[160:163], a[72:75], a[24:27], v[160:163]
    s_mov_b32 m0, s36
    v_mfma_f32_16x16x32_bf16 v[160:163], a[76:79], a[28:31], v[160:163]
    s_mov_b32 s32, s31
    v_mfma_f32_16x16x32_bf16 v[176:179], a[64:67], a[32:35], v[248:251]
    buffer_load_dwordx4 v4, s[12:15], s30 offen offset:0 sc1 lds
    v_mfma_f32_16x16x32_bf16 v[176:179], a[68:71], a[36:39], v[176:179]
    v_exp_f32 v144, v144
    v_mfma_f32_16x16x32_bf16 v[176:179], a[72:75], a[40:43], v[176:179]
    v_exp_f32 v145, v145
    v_mfma_f32_16x16x32_bf16 v[176:179], a[76:79], a[44:47], v[176:179]
    v_cndmask_b32 v164, v5, v244, s[40:41]
    v_cndmask_b32 v165, v5, v245, s[42:43]
    v_mfma_f32_16x16x32_bf16 v[192:195], a[64:67], a[48:51], v[252:255]
    v_exp_f32 v146, v146
    v_mfma_f32_16x16x32_bf16 v[192:195], a[68:71], a[52:55], v[192:195]
    v_cndmask_b32 v166, v5, v246, s[44:45]
    v_cndmask_b32 v167, v5, v247, s[46:47]
    v_mfma_f32_16x16x32_bf16 v[192:195], a[72:75], a[56:59], v[192:195]
    buffer_load_dwordx4 v4, s[12:15], s30 offen offset:1024 sc1 lds
    v_mfma_f32_16x16x32_bf16 v[192:195], a[76:79], a[60:63], v[192:195]
    buffer_load_dwordx4 v4, s[12:15], s30 offen offset:2048 sc1 lds
    v_mfma_f32_16x16x32_bf16 v[164:167], a[80:83], a[16:19], v[164:167]
    ds_read_b128 a[64:67], v2 offset:0
    v_mfma_f32_16x16x32_bf16 v[164:167], a[84:87], a[20:23], v[164:167]
    buffer_load_dwordx4 v4, s[12:15], s30 offen offset:3072 sc1 lds
    v_mfma_f32_16x16x32_bf16 v[164:167], a[88:91], a[24:27], v[164:167]
    s_mov_b32 s31, s30
    v_exp_f32 v147, v147
    v_mfma_f32_16x16x32_bf16 v[164:167], a[92:95], a[28:31], v[164:167]
    s_add_u32 m0, s36, 98304
    v_exp_f32 v160, v160
    v_mfma_f32_16x16x32_bf16 v[180:183], a[80:83], a[32:35], v[248:251]
    s_cmp_gt_u32 s28, s26
    v_cvt_pk_bf16_f32 v208, v144, v145
    v_cvt_pk_bf16_f32 v209, v146, v147
    v_mfma_f32_16x16x32_bf16 v[180:183], a[84:87], a[36:39], v[180:183]
    ds_read_b128 a[68:71], v2 offset:1024
    v_mfma_f32_16x16x32_bf16 v[180:183], a[88:91], a[40:43], v[180:183]
    v_exp_f32 v161, v161
    v_mfma_f32_16x16x32_bf16 v[180:183], a[92:95], a[44:47], v[180:183]
    buffer_load_dwordx4 v4, s[16:19], s35 offen offset:0 sc1 lds
    v_exp_f32 v162, v162
    v_mfma_f32_16x16x32_bf16 v[196:199], a[80:83], a[48:51], v[252:255]
    ds_read_b128 a[72:75], v2 offset:2048
    s_cselect_b32 s50, 0x10000, s53
    v_exp_f32 v163, v163
    v_mfma_f32_16x16x32_bf16 v[196:199], a[84:87], a[52:55], v[196:199]
    buffer_load_dwordx4 v4, s[16:19], s35 offen offset:1024 sc1 lds
    v_exp_f32 v176, v176
    v_cvt_pk_bf16_f32 v216, v160, v161
    v_cvt_pk_bf16_f32 v217, v162, v163
    v_exp_f32 v177, v177
    v_exp_f32 v178, v178
    v_exp_f32 v179, v179
    v_exp_f32 v192, v192
    v_exp_f32 v193, v193
    v_cndmask_b32 v184, v5, v248, s[40:41]
    v_cndmask_b32 v185, v5, v249, s[42:43]
    v_exp_f32 v194, v194
    v_cndmask_b32 v186, v5, v250, s[44:45]
    v_cndmask_b32 v187, v5, v251, s[46:47]
    v_mfma_f32_16x16x32_bf16 v[196:199], a[88:91], a[56:59], v[196:199]
    s_add_u32 s29, s29, s50
    v_exp_f32 v195, v195
    v_mfma_f32_16x16x32_bf16 v[196:199], a[92:95], a[60:63], v[196:199]
    ds_read_b128 a[76:79], v2 offset:3072
    buffer_load_dwordx4 v4, s[16:19], s35 offen offset:2048 sc1 lds
    v_mfma_f32_16x16x32_bf16 v[184:187], a[96:99], a[32:35], v[184:187]
    s_cmp_gt_u32 s28, 16
    v_exp_f32 v164, v164
    v_mfma_f32_16x16x32_bf16 v[184:187], a[100:103], a[36:39], v[184:187]
    buffer_load_dwordx4 v4, s[16:19], s35 offen offset:3072 sc1 lds
    v_mfma_f32_16x16x32_bf16 v[184:187], a[104:107], a[40:43], v[184:187]
    ds_read_b128 a[80:83], v2 offset:4096
    s_cselect_b32 s30, s66, s29
    v_mfma_f32_16x16x32_bf16 v[184:187], a[108:111], a[44:47], v[184:187]
    s_add_u32 m0, s36, 65536
    v_exp_f32 v165, v165
    v_mfma_f32_16x16x32_bf16 v[200:203], a[96:99], a[48:51], v[252:255]
    s_mov_b32 s35, s34
    v_exp_f32 v166, v166
    v_mfma_f32_16x16x32_bf16 v[200:203], a[100:103], a[52:55], v[200:203]
    ds_read_b128 a[84:87], v2 offset:5120
    buffer_load_dwordx4 v4, s[12:15], s33 offen offset:0 sc1 lds
    v_exp_f32 v167, v167
    v_exp_f32 v180, v180
    v_cvt_pk_bf16_f32 v218, v164, v165
    v_cvt_pk_bf16_f32 v219, v166, v167
    v_exp_f32 v181, v181
    v_cndmask_b32 v204, v5, v252, s[40:41]
    v_cndmask_b32 v205, v5, v253, s[42:43]
    v_exp_f32 v182, v182
    v_cndmask_b32 v206, v5, v254, s[44:45]
    v_cndmask_b32 v207, v5, v255, s[46:47]
    v_mfma_f32_16x16x32_bf16 v[200:203], a[104:107], a[56:59], v[200:203]
    buffer_load_dwordx4 v4, s[12:15], s33 offen offset:1024 sc1 lds
    v_mfma_f32_16x16x32_bf16 v[200:203], a[108:111], a[60:63], v[200:203]
    buffer_load_dwordx4 v4, s[12:15], s33 offen offset:2048 sc1 lds
    v_mfma_f32_16x16x32_bf16 v[204:207], a[112:115], a[48:51], v[204:207]
    ds_read_b128 a[88:91], v2 offset:6144
    buffer_load_dwordx4 v4, s[12:15], s33 offen offset:3072 sc1 lds
    v_mfma_f32_16x16x32_bf16 v[204:207], a[116:119], a[52:55], v[204:207]
    s_mov_b32 s34, s33
    v_exp_f32 v183, v183
    v_mfma_f32_16x16x32_bf16 v[204:207], a[120:123], a[56:59], v[204:207]
    ds_read_b128 a[92:95], v2 offset:7168
    ds_read_b128 a[96:99], v2 offset:8192
    s_sub_u32 s33, s30, 32768
    v_mfma_f32_16x16x32_bf16 v[204:207], a[124:127], a[60:63], v[204:207]
    s_cmp_eq_u32 s28, s26
    v_exp_f32 v196, v196
    s_cselect_b32 s33, s37, s33
    s_cmp_lt_u32 s28, s26
    v_exp_f32 v197, v197
    s_cselect_b32 s33, s49, s33
    v_exp_f32 v198, v198
    s_xor_b32 s36, s36, 16384
    v_exp_f32 v199, v199
    v_exp_f32 v184, v184
    v_exp_f32 v185, v185
    v_exp_f32 v186, v186
    ds_read_b128 a[100:103], v2 offset:9216
    v_exp_f32 v187, v187
    ds_read_b128 a[104:107], v2 offset:10240
    ds_read_b128 a[108:111], v2 offset:11264
    ds_read_b128 a[112:115], v2 offset:12288
    ds_read_b128 a[116:119], v2 offset:13312
    ds_read_b128 a[120:123], v2 offset:14336
    ds_read_b128 a[124:127], v2 offset:15360
    v_xor_b32 v2, 0x4000, v2
    s_cmp_eq_u32 s28, 19
    s_cbranch_scc1 L_a_DXf
    s_waitcnt vmcnt(0) lgkmcnt(0)
    s_barrier
    v_accvgpr_read_b32 v8, a232
    s_nop 0
    v_cmp_ne_u32 vcc, 1, v8
    s_nop 4
    s_cbranch_vccnz L_spin11
L_back11:
    s_lshr_b32 s54, s3, 1
    s_and_b32 s54, s54, s58
    s_cmp_eq_u32 s39, 0
    s_cselect_b32 s54, s54, 0
    s_cmp_eq_u32 s54, 0
    s_cbranch_scc1 L_a_sf1
    v_mov_b32 v9, s69
    v_mov_b32 v8, 1
    buffer_store_dword v8, v9, s[60:63], 0 offen sc1
L_a_sf1:
    s_cmp_eq_u32 s58, 0
    s_cbranch_scc1 L_a_preXD
    v_mfma_f32_16x16x32_bf16 v[144:147], a[64:67], a[0:3], v[240:243]
    s_add_u32 m0, s36, 32768
    v_exp_f32 v200, v200
    v_mfma_f32_16x16x32_bf16 v[144:147], a[68:71], a[4:7], v[144:147]
    ds_read_b128 a[128:131], v3 offset:32768
    v_cvt_pk_bf16_f32 v224, v176, v177
    v_mfma_f32_16x16x32_bf16 v[144:147], a[72:75], a[8:11], v[144:147]
    s_add_u32 s28, s28, 1
    v_exp_f32 v201, v201
    v_mfma_f32_16x16x32_bf16 v[144:147], a[76:79], a[12:15], v[144:147]
    ds_read_b128 a[132:135], v3 offset:33792
    v_cvt_pk_bf16_f32 v225, v178, v179
    v_mfma_f32_16x16x32_bf16 v[148:151], a[80:83], a[0:3], v[240:243]
    v_exp_f32 v202, v202
    v_mfma_f32_16x16x32_bf16 v[148:151], a[84:87], a[4:7], v[148:151]
    v_cvt_pk_bf16_f32 v226, v180, v181
    v_mfma_f32_16x16x32_bf16 v[148:151], a[88:91], a[8:11], v[148:151]
    buffer_load_dwordx4 v4, s[16:19], s32 offen offset:0 sc1 lds
    v_mfma_f32_16x16x32_bf16 v[148:151], a[92:95], a[12:15], v[148:151]
    ds_read_b128 a[136:139], v3 offset:34816
    v_mfma_f32_16x16x32_bf16 v[152:155], a[96:99], a[0:3], v[240:243]
    v_exp_f32 v203, v203
    v_mfma_f32_16x16x32_bf16 v[152:155], a[100:103], a[4:7], v[152:155]
    v_cvt_pk_bf16_f32 v227, v182, v183
    v_mfma_f32_16x16x32_bf16 v[152:155], a[104:107], a[8:11], v[152:155]
    buffer_load_dwordx4 v4, s[16:19], s32 offen offset:1024 sc1 lds
    v_mfma_f32_16x16x32_bf16 v[152:155], a[108:111], a[12:15], v[152:155]
    v_exp_f32 v204, v204
    v_mfma_f32_16x16x32_bf16 v[156:159], a[112:115], a[0:3], v[240:243]
    ds_read_b128 a[140:143], v3 offset:35840
    v_cvt_pk_bf16_f32 v228, v184, v185
    v_mfma_f32_16x16x32_bf16 v[156:159], a[116:119], a[4:7], v[156:159]
    buffer_load_dwordx4 v4, s[16:19], s32 offen offset:2048 sc1 lds
    v_mfma_f32_16x16x32_bf16 v[156:159], a[120:123], a[8:11], v[156:159]
    v_exp_f32 v205, v205
    v_mfma_f32_16x16x32_bf16 v[156:159], a[124:127], a[12:15], v[156:159]
    ds_read_b128 a[144:147], v3 offset:36864
    v_cvt_pk_bf16_f32 v229, v186, v187
    v_mfma_f32_16x16x32_bf16 v[160:163], a[64:67], a[16:19], v[244:247]
    buffer_load_dwordx4 v4, s[16:19], s32 offen offset:3072 sc1 lds
    v_mfma_f32_16x16x32_bf16 v[160:163], a[68:71], a[20:23], v[160:163]
    s_mov_b32 m0, s36
    v_exp_f32 v206, v206
    v_mfma_f32_16x16x32_bf16 v[160:163], a[72:75], a[24:27], v[160:163]
    ds_read_b128 a[148:151], v3 offset:37888
    v_mov_b32 v230, 0
    v_mfma_f32_16x16x32_bf16 v[160:163], a[76:79], a[28:31], v[160:163]
    s_mov_b32 s32, s31
    v_exp_f32 v207, v207
    v_mfma_f32_16x16x32_bf16 v[164:167], a[80:83], a[16:19], v[244:247]
    v_mov_b32 v231, 0
    v_cvt_pk_bf16_f32 v232, v192, v193
    v_mfma_f32_16x16x32_bf16 v[164:167], a[84:87], a[20:23], v[164:167]
    v_exp_f32 v144, v144
    v_mfma_f32_16x16x32_bf16 v[164:167], a[88:91], a[24:27], v[164:167]
    ds_read_b128 a[152:155], v3 offset:38912
    v_mfma_f32_16x16x32_bf16 v[164:167], a[92:95], a[28:31], v[164:167]
    v_exp_f32 v145, v145
    v_mfma_f32_16x16x32_bf16 v[168:171], a[96:99], a[16:19], v[244:247]
    buffer_load_dwordx4 v4, s[12:15], s30 offen offset:0 sc1 lds
    v_mfma_f32_16x16x32_bf16 v[168:171], a[100:103], a[20:23], v[168:171]
    ds_read_b128 a[156:159], v3 offset:39936
    v_cvt_pk_bf16_f32 v233, v194, v195
    v_mfma_f32_16x16x32_bf16 v[168:171], a[104:107], a[24:27], v[168:171]
    v_exp_f32 v146, v146
    v_mfma_f32_16x16x32_bf16 v[168:171], a[108:111], a[28:31], v[168:171]
    ds_read_b128 a[160:163], v3 offset:40960
    v_cvt_pk_bf16_f32 v234, v196, v197
    v_mfma_f32_16x16x32_bf16 v[172:175], a[112:115], a[16:19], v[244:247]
    buffer_load_dwordx4 v4, s[12:15], s30 offen offset:1024 sc1 lds
    v_mfma_f32_16x16x32_bf16 v[172:175], a[116:119], a[20:23], v[172:175]
    v_exp_f32 v147, v147
    v_mfma_f32_16x16x32_bf16 v[172:175], a[120:123], a[24:27], v[172:175]
    ds_read_b128 a[164:167], v3 offset:41984
    v_cvt_pk_bf16_f32 v235, v198, v199
    v_mfma_f32_16x16x32_bf16 v[172:175], a[124:127], a[28:31], v[172:175]
    v_exp_f32 v148, v148
    v_mfma_f32_16x16x32_bf16 v[176:179], a[64:67], a[32:35], v[248:251]
    buffer_load_dwordx4 v4, s[12:15], s30 offen offset:2048 sc1 lds
    v_mfma_f32_16x16x32_bf16 v[176:179], a[68:71], a[36:39], v[176:179]
    ds_read_b128 a[168:171], v3 offset:43008
    v_cvt_pk_bf16_f32 v236, v200, v201
    v_mfma_f32_16x16x32_bf16 v[176:179], a[72:75], a[40:43], v[176:179]
    v_exp_f32 v149, v149
    v_mfma_f32_16x16x32_bf16 v[176:179], a[76:79], a[44:47], v[176:179]
    buffer_load_dwordx4 v4, s[12:15], s30 offen offset:3072 sc1 lds
    v_mfma_f32_16x16x32_bf16 v[180:183], a[80:83], a[32:35], v[248:251]
    s_mov_b32 s31, s30
    v_cvt_pk_bf16_f32 v237, v202, v203
    v_mfma_f32_16x16x32_bf16 v[180:183], a[84:87], a[36:39], v[180:183]
    s_add_u32 m0, s36, 98304
    v_exp_f32 v150, v150
    v_mfma_f32_16x16x32_bf16 v[180:183], a[88:91], a[40:43], v[180:183]
    ds_read_b128 a[172:175], v3 offset:44032
    v_cvt_pk_bf16_f32 v238, v204, v205
    v_mfma_f32_16x16x32_bf16 v[180:183], a[92:95], a[44:47], v[180:183]
    s_cmp_gt_u32 s28, s26
    v_exp_f32 v151, v151
    v_mfma_f32_16x16x32_bf16 v[184:187], a[96:99], a[32:35], v[248:251]
    v_exp_f32 v152, v152
    v_mfma_f32_16x16x32_bf16 v[184:187], a[100:103], a[36:39], v[184:187]
    ds_read_b128 a[176:179], v3 offset:45056
    v_cvt_pk_bf16_f32 v239, v206, v207
    v_mfma_f32_16x16x32_bf16 v[184:187], a[104:107], a[40:43], v[184:187]
    v_exp_f32 v153, v153
    v_mfma_f32_16x16x32_bf16 v[184:187], a[108:111], a[44:47], v[184:187]
    v_exp_f32 v154, v154
    v_mfma_f32_16x16x32_bf16 v[188:191], a[112:115], a[32:35], v[248:251]
    v_exp_f32 v155, v155
    v_mfma_f32_16x16x32_bf16 v[188:191], a[116:119], a[36:39], v[188:191]
    v_exp_f32 v156, v156
    v_mfma_f32_16x16x32_bf16 v[188:191], a[120:123], a[40:43], v[188:191]
    buffer_load_dwordx4 v4, s[16:19], s35 offen offset:0 sc1 lds
    v_mfma_f32_16x16x32_bf16 v[188:191], a[124:127], a[44:47], v[188:191]
    s_cselect_b32 s50, 0x10000, s53
    v_exp_f32 v157, v157
    v_mfma_f32_16x16x32_bf16 v[192:195], a[64:67], a[48:51], v[252:255]
    ds_read_b128 a[180:183], v3 offset:46080
    v_mfma_f32_16x16x32_bf16 v[192:195], a[68:71], a[52:55], v[192:195]
    v_exp_f32 v158, v158
    v_mfma_f32_16x16x32_bf16 v[192:195], a[72:75], a[56:59], v[192:195]
    v_exp_f32 v159, v159
    v_mfma_f32_16x16x32_bf16 v[192:195], a[76:79], a[60:63], v[192:195]
    buffer_load_dwordx4 v4, s[16:19], s35 offen offset:1024 sc1 lds
    v_mfma_f32_16x16x32_bf16 v[196:199], a[80:83], a[48:51], v[252:255]
    s_add_u32 s29, s29, s50
    v_exp_f32 v160, v160
    v_mfma_f32_16x16x32_bf16 v[196:199], a[84:87], a[52:55], v[196:199]
    ds_read_b128 a[184:187], v3 offset:47104
    v_mfma_f32_16x16x32_bf16 v[196:199], a[88:91], a[56:59], v[196:199]
    v_exp_f32 v161, v161
    v_mfma_f32_16x16x32_bf16 v[196:199], a[92:95], a[60:63], v[196:199]
    v_exp_f32 v162, v162
    v_mfma_f32_16x16x32_bf16 v[200:203], a[96:99], a[48:51], v[252:255]
    ds_read_b128 a[188:191], v3 offset:48128
    v_xor_b32 v3, 0x4000, v3
    v_mfma_f32_16x16x32_bf16 v[200:203], a[100:103], a[52:55], v[200:203]
    buffer_load_dwordx4 v4, s[16:19], s35 offen offset:2048 sc1 lds
    v_mfma_f32_16x16x32_bf16 v[200:203], a[104:107], a[56:59], v[200:203]
    s_cmp_gt_u32 s28, 16
    v_exp_f32 v163, v163
    v_mfma_f32_16x16x32_bf16 v[200:203], a[108:111], a[60:63], v[200:203]
    v_exp_f32 v164, v164
    v_mfma_f32_16x16x32_bf16 v[204:207], a[112:115], a[48:51], v[252:255]
    v_exp_f32 v165, v165
    v_mfma_f32_16x16x32_bf16 v[204:207], a[116:119], a[52:55], v[204:207]
    buffer_load_dwordx4 v4, s[16:19], s35 offen offset:3072 sc1 lds
    v_mfma_f32_16x16x32_bf16 v[204:207], a[120:123], a[56:59], v[204:207]
    s_cselect_b32 s30, s66, s29
    v_exp_f32 v166, v166
    v_mfma_f32_16x16x32_bf16 v[204:207], a[124:127], a[60:63], v[204:207]
    s_waitcnt lgkmcnt(0)
    v_exp_f32 v167, v167
    v_smfmac_f32_16x16x32_bf16 a[192:195], a[208:209], v[208:211], v7
    ds_read_b128 a[64:67], v2 offset:0
    v_mfma_f32_16x16x32_bf16 v[16:19], a[128:131], v[208:211], v[16:19]
    s_add_u32 m0, s36, 65536
    v_exp_f32 v168, v168
    v_mfma_f32_16x16x32_bf16 v[20:23], a[136:139], v[208:211], v[20:23]
    s_mov_b32 s35, s34
    v_exp_f32 v169, v169
    v_mfma_f32_16x16x32_bf16 v[24:27], a[144:147], v[208:211], v[24:27]
    ds_read_b128 a[68:71], v2 offset:1024
    v_mfma_f32_16x16x32_bf16 v[28:31], a[152:155], v[208:211], v[28:31]
    v_exp_f32 v170, v170
    v_mfma_f32_16x16x32_bf16 v[32:35], a[160:163], v[208:211], v[32:35]
    ds_read_b128 a[72:75], v2 offset:2048
    v_mfma_f32_16x16x32_bf16 v[36:39], a[168:171], v[208:211], v[36:39]
    v_exp_f32 v171, v171
    v_mfma_f32_16x16x32_bf16 v[40:43], a[176:179], v[208:211], v[40:43]
    ds_read_b128 a[76:79], v2 offset:3072
    v_mfma_f32_16x16x32_bf16 v[44:47], a[184:187], v[208:211], v[44:47]
    buffer_load_dwordx4 v4, s[12:15], s33 offen offset:0 sc1 lds
    v_smfmac_f32_16x16x32_bf16 a[196:199], a[208:209], v[216:219], v7
    v_exp_f32 v172, v172
    v_mfma_f32_16x16x32_bf16 v[48:51], a[128:131], v[216:219], v[48:51]
    v_exp_f32 v173, v173
    v_mfma_f32_16x16x32_bf16 v[52:55], a[136:139], v[216:219], v[52:55]
    ds_read_b128 a[80:83], v2 offset:4096
    v_mfma_f32_16x16x32_bf16 v[56:59], a[144:147], v[216:219], v[56:59]
    buffer_load_dwordx4 v4, s[12:15], s33 offen offset:1024 sc1 lds
    v_mfma_f32_16x16x32_bf16 v[60:63], a[152:155], v[216:219], v[60:63]
    v_exp_f32 v174, v174
    v_mfma_f32_16x16x32_bf16 v[64:67], a[160:163], v[216:219], v[64:67]
    ds_read_b128 a[84:87], v2 offset:5120
    v_cvt_pk_bf16_f32 v208, v144, v145
    v_mfma_f32_16x16x32_bf16 v[68:71], a[168:171], v[216:219], v[68:71]
    buffer_load_dwordx4 v4, s[12:15], s33 offen offset:2048 sc1 lds
    v_mfma_f32_16x16x32_bf16 v[72:75], a[176:179], v[216:219], v[72:75]
    v_exp_f32 v175, v175
    v_mfma_f32_16x16x32_bf16 v[76:79], a[184:187], v[216:219], v[76:79]
    ds_read_b128 a[88:91], v2 offset:6144
    v_smfmac_f32_16x16x64_bf16 a[200:203], a[208:211], v[224:231], v7
    buffer_load_dwordx4 v4, s[12:15], s33 offen offset:3072 sc1 lds
    v_exp_f32 v176, v176
    v_mfma_f32_16x16x32_bf16 v[80:83], a[128:131], v[224:227], v[80:83]
    ds_read_b128 a[92:95], v2 offset:7168
    v_cvt_pk_bf16_f32 v209, v146, v147
    v_mfma_f32_16x16x32_bf16 v[80:83], a[132:135], v[228:231], v[80:83]
    s_mov_b32 s34, s33
    v_exp_f32 v177, v177
    v_mfma_f32_16x16x32_bf16 v[84:87], a[136:139], v[224:227], v[84:87]
    ds_read_b128 a[96:99], v2 offset:8192
    v_cvt_pk_bf16_f32 v210, v148, v149
    v_mfma_f32_16x16x32_bf16 v[84:87], a[140:143], v[228:231], v[84:87]
    s_sub_u32 s33, s30, 32768
    v_exp_f32 v178, v178
    v_mfma_f32_16x16x32_bf16 v[88:91], a[144:147], v[224:227], v[88:91]
    v_cvt_pk_bf16_f32 v211, v150, v151
    v_exp_f32 v179, v179
    v_mfma_f32_16x16x32_bf16 v[88:91], a[148:151], v[228:231], v[88:91]
    ds_read_b128 a[100:103], v2 offset:9216
    v_cvt_pk_bf16_f32 v212, v152, v153
    v_mfma_f32_16x16x32_bf16 v[92:95], a[152:155], v[224:227], v[92:95]
    s_cmp_eq_u32 s28, s26
    v_exp_f32 v180, v180
    v_mfma_f32_16x16x32_bf16 v[92:95], a[156:159], v[228:231], v[92:95]
    ds_read_b128 a[104:107], v2 offset:10240
    v_cvt_pk_bf16_f32 v216, v160, v161
    v_mfma_f32_16x16x32_bf16 v[96:99], a[160:163], v[224:227], v[96:99]
    v_cvt_pk_bf16_f32 v213, v154, v155
    v_exp_f32 v181, v181
    v_mfma_f32_16x16x32_bf16 v[96:99], a[164:167], v[228:231], v[96:99]
    ds_read_b128 a[108:111], v2 offset:11264
    v_cvt_pk_bf16_f32 v217, v162, v163
    v_mfma_f32_16x16x32_bf16 v[100:103], a[168:171], v[224:227], v[100:103]
    s_cselect_b32 s33, s37, s33
    v_cvt_pk_bf16_f32 v214, v156, v157
    v_exp_f32 v182, v182
    v_mfma_f32_16x16x32_bf16 v[100:103], a[172:175], v[228:231], v[100:103]
    v_cvt_pk_bf16_f32 v218, v164, v165
    v_exp_f32 v183, v183
    v_mfma_f32_16x16x32_bf16 v[104:107], a[176:179], v[224:227], v[104:107]
    ds_read_b128 a[112:115], v2 offset:12288
    v_cvt_pk_bf16_f32 v215, v158, v159
    v_mfma_f32_16x16x32_bf16 v[104:107], a[180:183], v[228:231], v[104:107]
    s_cmp_lt_u32 s28, s26
    v_cvt_pk_bf16_f32 v219, v166, v167
    v_exp_f32 v184, v184
    v_mfma_f32_16x16x32_bf16 v[108:111], a[184:187], v[224:227], v[108:111]
    ds_read_b128 a[116:119], v2 offset:13312
    v_cvt_pk_bf16_f32 v220, v168, v169
    v_mfma_f32_16x16x32_bf16 v[108:111], a[188:191], v[228:231], v[108:111]
    s_cselect_b32 s33, s49, s33
    v_exp_f32 v185, v185
    v_smfmac_f32_16x16x64_bf16 a[204:207], a[208:211], v[232:239], v7
    ds_read_b128 a[120:123], v2 offset:14336
    v_exp_f32 v186, v186
    v_mfma_f32_16x16x32_bf16 v[112:115], a[128:131], v[232:235], v[112:115]
    ds_read_b128 a[124:127], v2 offset:15360
    v_cvt_pk_bf16_f32 v221, v170, v171
    v_mfma_f32_16x16x32_bf16 v[112:115], a[132:135], v[236:239], v[112:115]
    s_xor_b32 s36, s36, 16384
    v_exp_f32 v187, v187
    v_mfma_f32_16x16x32_bf16 v[116:119], a[136:139], v[232:235], v[116:119]
    v_cvt_pk_bf16_f32 v222, v172, v173
    v_mfma_f32_16x16x32_bf16 v[116:119], a[140:143], v[236:239], v[116:119]
    v_exp_f32 v188, v188
    v_mfma_f32_16x16x32_bf16 v[120:123], a[144:147], v[232:235], v[120:123]
    v_cvt_pk_bf16_f32 v223, v174, v175
    v_mfma_f32_16x16x32_bf16 v[120:123], a[148:151], v[236:239], v[120:123]
    v_exp_f32 v189, v189
    v_mfma_f32_16x16x32_bf16 v[124:127], a[152:155], v[232:235], v[124:127]
    v_exp_f32 v190, v190
    v_mfma_f32_16x16x32_bf16 v[124:127], a[156:159], v[236:239], v[124:127]
    v_exp_f32 v191, v191
    v_mfma_f32_16x16x32_bf16 v[128:131], a[160:163], v[232:235], v[128:131]
    v_exp_f32 v192, v192
    v_mfma_f32_16x16x32_bf16 v[128:131], a[164:167], v[236:239], v[128:131]
    v_exp_f32 v193, v193
    v_mfma_f32_16x16x32_bf16 v[132:135], a[168:171], v[232:235], v[132:135]
    v_exp_f32 v194, v194
    v_mfma_f32_16x16x32_bf16 v[132:135], a[172:175], v[236:239], v[132:135]
    s_waitcnt vmcnt(0) lgkmcnt(0)
    s_barrier
    v_mfma_f32_16x16x32_bf16 v[136:139], a[176:179], v[232:235], v[136:139]
    v_exp_f32 v195, v195
    v_mfma_f32_16x16x32_bf16 v[136:139], a[180:183], v[236:239], v[136:139]
    v_xor_b32 v2, 0x4000, v2
    v_mfma_f32_16x16x32_bf16 v[140:143], a[184:187], v[232:235], v[140:143]
    v_exp_f32 v196, v196
    v_mfma_f32_16x16x32_bf16 v[140:143], a[188:191], v[236:239], v[140:143]
    v_exp_f32 v197, v197
    v_exp_f32 v198, v198
    v_exp_f32 v199, v199
    s_branch L_a_loopsel
L_a_DXf:
    s_waitcnt vmcnt(12) lgkmcnt(0)
    s_mov_b32 s56, 8192
    buffer_load_dwordx4 a[224:227], v15, s[8:11], s56 offen offset:0 sc1
    buffer_load_dwordx4 a[228:231], v15, s[8:11], s56 offen offset:1024 sc1
    buffer_load_dwordx4 a[232:235], v15, s[8:11], s56 offen offset:2048 sc1
    buffer_load_dwordx4 a[236:239], v15, s[8:11], s56 offen offset:3072 sc1
    s_mov_b32 s56, 12288
    buffer_load_dwordx4 a[240:243], v15, s[8:11], s56 offen offset:0 sc1
    buffer_load_dwordx4 a[244:247], v15, s[8:11], s56 offen offset:1024 sc1
    buffer_load_dwordx4 a[248:251], v15, s[8:11], s56 offen offset:2048 sc1
    buffer_load_dwordx4 a[252:255], v15, s[8:11], s56 offen offset:3072 sc1
    s_mov_b32 s56, 16384
    buffer_load_dwordx4 a[0:3], v15, s[8:11], s56 offen offset:0 sc1
    buffer_load_dwordx4 a[4:7], v15, s[8:11], s56 offen offset:1024 sc1
    buffer_load_dwordx4 a[8:11], v15, s[8:11], s56 offen offset:2048 sc1
    buffer_load_dwordx4 a[12:15], v15, s[8:11], s56 offen offset:3072 sc1
    s_mov_b32 s56, 20480
    buffer_load_dwordx4 a[16:19], v15, s[8:11], s56 offen offset:0 sc1
    buffer_load_dwordx4 a[20:23], v15, s[8:11], s56 offen offset:1024 sc1
    buffer_load_dwordx4 a[24:27], v15, s[8:11], s56 offen offset:2048 sc1
    buffer_load_dwordx4 a[28:31], v15, s[8:11], s56 offen offset:3072 sc1
    s_mov_b32 s56, 28672
    buffer_load_dwordx4 a[32:35], v15, s[8:11], s56 offen offset:0 sc1
    buffer_load_dwordx4 a[36:39], v15, s[8:11], s56 offen offset:1024 sc1
    buffer_load_dwordx4 a[40:43], v15, s[8:11], s56 offen offset:2048 sc1
    buffer_load_dwordx4 a[44:47], v15, s[8:11], s56 offen offset:3072 sc1
    s_mov_b32 s56, 32768
    buffer_load_dwordx4 a[48:51], v15, s[8:11], s56 offen offset:0 sc1
    buffer_load_dwordx4 a[52:55], v15, s[8:11], s56 offen offset:1024 sc1
    buffer_load_dwordx4 a[56:59], v15, s[8:11], s56 offen offset:2048 sc1
    buffer_load_dwordx4 a[60:63], v15, s[8:11], s56 offen offset:3072 sc1
    s_waitcnt vmcnt(24) lgkmcnt(0)
    s_barrier
    s_cmp_eq_u32 s39, 0
    s_cselect_b32 s54, s69, s49
    v_mov_b32 v9, s54
    v_mov_b32 v8, 1
    buffer_store_dword v8, v9, s[60:63], 0 offen sc1
    ds_read_b128 a[128:131], v3 offset:32768
    ds_read_b128 a[132:135], v3 offset:33792
    ds_read_b128 a[136:139], v3 offset:34816
    ds_read_b128 a[140:143], v3 offset:35840
    v_smfmac_f32_16x16x32_bf16 a[192:195], a[208:209], v[208:211], v7
    ds_read_b128 a[144:147], v3 offset:36864
    v_cvt_pk_bf16_f32 v224, v176, v177
    v_smfmac_f32_16x16x32_bf16 a[196:199], a[208:209], v[216:219], v7
    ds_read_b128 a[148:151], v3 offset:37888
    s_waitcnt lgkmcnt(4)
    v_mfma_f32_16x16x32_bf16 v[16:19], a[128:131], v[208:211], v[16:19]
    ds_read_b128 a[152:155], v3 offset:38912
    v_cvt_pk_bf16_f32 v225, v178, v179
    v_mfma_f32_16x16x32_bf16 v[48:51], a[128:131], v[216:219], v[48:51]
    ds_read_b128 a[156:159], v3 offset:39936
    s_waitcnt lgkmcnt(4)
    v_mfma_f32_16x16x32_bf16 v[20:23], a[136:139], v[208:211], v[20:23]
    ds_read_b128 a[160:163], v3 offset:40960
    v_cvt_pk_bf16_f32 v226, v180, v181
    v_mfma_f32_16x16x32_bf16 v[52:55], a[136:139], v[216:219], v[52:55]
    ds_read_b128 a[164:167], v3 offset:41984
    s_waitcnt lgkmcnt(4)
    v_mfma_f32_16x16x32_bf16 v[24:27], a[144:147], v[208:211], v[24:27]
    ds_read_b128 a[168:171], v3 offset:43008
    v_cvt_pk_bf16_f32 v227, v182, v183
    v_mfma_f32_16x16x32_bf16 v[56:59], a[144:147], v[216:219], v[56:59]
    ds_read_b128 a[172:175], v3 offset:44032
    s_waitcnt lgkmcnt(4)
    v_mfma_f32_16x16x32_bf16 v[28:31], a[152:155], v[208:211], v[28:31]
    ds_read_b128 a[176:179], v3 offset:45056
    v_cvt_pk_bf16_f32 v228, v184, v185
    v_mfma_f32_16x16x32_bf16 v[60:63], a[152:155], v[216:219], v[60:63]
    ds_read_b128 a[180:183], v3 offset:46080
    s_waitcnt lgkmcnt(4)
    v_mfma_f32_16x16x32_bf16 v[32:35], a[160:163], v[208:211], v[32:35]
    ds_read_b128 a[184:187], v3 offset:47104
    v_cvt_pk_bf16_f32 v229, v186, v187
    v_mfma_f32_16x16x32_bf16 v[64:67], a[160:163], v[216:219], v[64:67]
    ds_read_b128 a[188:191], v3 offset:48128
    s_waitcnt lgkmcnt(4)
    v_mfma_f32_16x16x32_bf16 v[36:39], a[168:171], v[208:211], v[36:39]
    s_and_b32 s50, s3, 1
    v_mov_b32 v230, 0
    v_mov_b32 v231, 0
    v_mfma_f32_16x16x32_bf16 v[68:71], a[168:171], v[216:219], v[68:71]
    s_waitcnt lgkmcnt(2)
    v_exp_f32 v200, v200
    v_mfma_f32_16x16x32_bf16 v[40:43], a[176:179], v[208:211], v[40:43]
    s_lshl_b32 s51, s50, 14
    v_exp_f32 v201, v201
    v_mfma_f32_16x16x32_bf16 v[72:75], a[176:179], v[216:219], v[72:75]
    s_waitcnt lgkmcnt(0)
    v_exp_f32 v202, v202
    v_exp_f32 v203, v203
    v_exp_f32 v204, v204
    v_exp_f32 v205, v205
    v_exp_f32 v206, v206
    v_exp_f32 v207, v207
    v_cvt_pk_bf16_f32 v232, v192, v193
    v_cvt_pk_bf16_f32 v233, v194, v195
    v_cvt_pk_bf16_f32 v234, v196, v197
    v_cvt_pk_bf16_f32 v235, v198, v199
    v_cvt_pk_bf16_f32 v236, v200, v201
    v_cvt_pk_bf16_f32 v237, v202, v203
    v_cvt_pk_bf16_f32 v238, v204, v205
    v_cvt_pk_bf16_f32 v239, v206, v207
    v_mfma_f32_16x16x32_bf16 v[44:47], a[184:187], v[208:211], v[44:47]
    s_add_u32 s51, s51, 131072
    v_add_u32 v12, s51, v1
    v_mfma_f32_16x16x32_bf16 v[76:79], a[184:187], v[216:219], v[76:79]
    s_lshl_b32 s51, s50, 16
    v_smfmac_f32_16x16x64_bf16 a[200:203], a[208:211], v[224:231], v7
    s_sub_u32 s51, 114688, s51
    v_add_u32 v13, s51, v1
    s_lshl_b32 s50, s3, 10
    s_add_u32 s50, s50, 65536
    v_add_u32 v2, s50, v1
    s_xor_b32 s50, s50, 3072
    v_add_u32 v4, s50, v1
    s_lshl_b32 s50, s3, 2
    s_add_u32 s50, s50, 69632
    v_mov_b32 v5, s50
    v_smfmac_f32_16x16x64_bf16 a[204:207], a[208:211], v[232:239], v7
    s_mov_b32 s56, 0
    v_mfma_f32_16x16x32_bf16 v[80:83], a[128:131], v[224:227], v[80:83]
    buffer_load_dwordx4 v[144:147], v15, s[8:11], s56 offen offset:0 sc1
    v_mfma_f32_16x16x32_bf16 v[80:83], a[132:135], v[228:231], v[80:83]
    buffer_load_dwordx4 v[148:151], v15, s[8:11], s56 offen offset:1024 sc1
    v_mfma_f32_16x16x32_bf16 v[112:115], a[128:131], v[232:235], v[112:115]
    ds_write_b128 v12, v[16:19] offset:0
    v_mfma_f32_16x16x32_bf16 v[112:115], a[132:135], v[236:239], v[112:115]
    ds_write_b128 v12, v[48:51] offset:1024
    v_mfma_f32_16x16x32_bf16 v[84:87], a[136:139], v[224:227], v[84:87]
    buffer_load_dwordx4 v[152:155], v15, s[8:11], s56 offen offset:2048 sc1
    v_mfma_f32_16x16x32_bf16 v[84:87], a[140:143], v[228:231], v[84:87]
    ds_write_b128 v12, v[20:23] offset:2048
    v_mfma_f32_16x16x32_bf16 v[116:119], a[136:139], v[232:235], v[116:119]
    v_accvgpr_read_b32 v8, a192
    v_mfma_f32_16x16x32_bf16 v[116:119], a[140:143], v[236:239], v[116:119]
    ds_write_b128 v12, v[52:55] offset:3072
    v_accvgpr_read_b32 v9, a196
    v_mfma_f32_16x16x32_bf16 v[88:91], a[144:147], v[224:227], v[88:91]
    v_accvgpr_read_b32 v10, a200
    v_mfma_f32_16x16x32_bf16 v[88:91], a[148:151], v[228:231], v[88:91]
    ds_write_b128 v12, v[24:27] offset:4096
    v_accvgpr_read_b32 v11, a204
    v_mfma_f32_16x16x32_bf16 v[120:123], a[144:147], v[232:235], v[120:123]
    ds_write_b128 v12, v[56:59] offset:5120
    v_accvgpr_read_b32 v184, a193
    v_mfma_f32_16x16x32_bf16 v[120:123], a[148:151], v[236:239], v[120:123]
    v_accvgpr_read_b32 v185, a197
    v_mfma_f32_16x16x32_bf16 v[92:95], a[152:155], v[224:227], v[92:95]
    ds_write_b128 v12, v[28:31] offset:6144
    v_accvgpr_read_b32 v186, a201
    v_mfma_f32_16x16x32_bf16 v[92:95], a[156:159], v[228:231], v[92:95]
    v_accvgpr_read_b32 v187, a205
    v_mfma_f32_16x16x32_bf16 v[124:127], a[152:155], v[232:235], v[124:127]
    ds_write_b128 v12, v[60:63] offset:7168
    v_add_f32 v8, v8, v184
    v_mfma_f32_16x16x32_bf16 v[124:127], a[156:159], v[236:239], v[124:127]
    v_add_f32 v9, v9, v185
    v_mfma_f32_16x16x32_bf16 v[96:99], a[160:163], v[224:227], v[96:99]
    ds_write_b128 v12, v[32:35] offset:8192
    v_add_f32 v10, v10, v186
    v_mfma_f32_16x16x32_bf16 v[96:99], a[164:167], v[228:231], v[96:99]
    ds_write_b128 v12, v[64:67] offset:9216
    v_add_f32 v11, v11, v187
    v_mfma_f32_16x16x32_bf16 v[128:131], a[160:163], v[232:235], v[128:131]
    s_mov_b32 s51, 0x53800000
    v_mfma_f32_16x16x32_bf16 v[128:131], a[164:167], v[236:239], v[128:131]
    ds_write_b128 v12, v[36:39] offset:10240
    v_add_f32 v14, v8, v9
    v_mfma_f32_16x16x32_bf16 v[100:103], a[168:171], v[224:227], v[100:103]
    v_add_f32 v14, v14, v10
    v_mfma_f32_16x16x32_bf16 v[100:103], a[172:175], v[228:231], v[100:103]
    ds_write_b128 v12, v[68:71] offset:11264
    v_add_f32 v14, v14, v11
    v_mfma_f32_16x16x32_bf16 v[132:135], a[168:171], v[232:235], v[132:135]
    v_cmp_nge_f32 vcc, s51, v14
    v_mfma_f32_16x16x32_bf16 v[132:135], a[172:175], v[236:239], v[132:135]
    ds_write_b128 v12, v[40:43] offset:12288
    v_mfma_f32_16x16x32_bf16 v[104:107], a[176:179], v[224:227], v[104:107]
    ds_write_b128 v12, v[72:75] offset:13312
    v_mfma_f32_16x16x32_bf16 v[104:107], a[180:183], v[228:231], v[104:107]
    s_nop 0
    v_mfma_f32_16x16x32_bf16 v[136:139], a[176:179], v[232:235], v[136:139]
    ds_write_b128 v12, v[44:47] offset:14336
    v_mfma_f32_16x16x32_bf16 v[136:139], a[180:183], v[236:239], v[136:139]
    s_or_b32 s39, s39, vcc_lo
    v_mfma_f32_16x16x32_bf16 v[108:111], a[184:187], v[224:227], v[108:111]
    ds_write_b128 v12, v[76:79] offset:15360
    v_mfma_f32_16x16x32_bf16 v[108:111], a[188:191], v[228:231], v[108:111]
    s_or_b32 s39, s39, vcc_hi
    v_mfma_f32_16x16x32_bf16 v[140:143], a[184:187], v[232:235], v[140:143]
    v_mov_b32 v14, s39
    v_mfma_f32_16x16x32_bf16 v[140:143], a[188:191], v[236:239], v[140:143]
    ds_write_b128 v2, v[8:11]
    buffer_load_dwordx4 v[156:159], v15, s[8:11], s56 offen offset:3072 sc1
    s_mov_b32 s56, 4096
    buffer_load_dwordx4 v[160:163], v15, s[8:11], s56 offen offset:0 sc1
    buffer_load_dwordx4 v[164:167], v15, s[8:11], s56 offen offset:1024 sc1
    buffer_load_dwordx4 v[168:171], v15, s[8:11], s56 offen offset:2048 sc1
    buffer_load_dwordx4 v[172:175], v15, s[8:11], s56 offen offset:3072 sc1
    v_bfe_u32 v188, v1, 4, 2
    v_lshl_add_u32 v188, v188, 2, s68
    buffer_load_dword v189, v188, s[60:63], 0 offen offset:0 sc1
    ds_write_b32 v5, v14
    s_waitcnt lgkmcnt(0)
    s_barrier
    s_branch L_a_recvS
L_a_redo:
    s_waitcnt vmcnt(0) lgkmcnt(0)
    s_mov_b32 s38, 1
    s_barrier
    s_branch L_restart
L_a_DF:
    v_cndmask_b32 v144, v5, v240, s[40:41]
    v_cndmask_b32 v145, v5, v241, s[42:43]
    v_cndmask_b32 v146, v5, v242, s[44:45]
    v_cndmask_b32 v147, v5, v243, s[46:47]
    s_nop 1
    v_mfma_f32_16x16x32_bf16 v[144:147], a[64:67], a[0:3], v[144:147]
    s_add_u32 m0, s36, 32768
    v_exp_f32 v200, v200
    v_mfma_f32_16x16x32_bf16 v[144:147], a[68:71], a[4:7], v[144:147]
    s_nop 0
    v_cvt_pk_bf16_f32 v224, v176, v177
    v_mfma_f32_16x16x32_bf16 v[144:147], a[72:75], a[8:11], v[144:147]
    v_exp_f32 v201, v201
    v_mfma_f32_16x16x32_bf16 v[144:147], a[76:79], a[12:15], v[144:147]
    v_cndmask_b32 v164, v5, v244, s[40:41]
    v_cvt_pk_bf16_f32 v225, v178, v179
    v_mfma_f32_16x16x32_bf16 v[160:163], a[64:67], a[16:19], v[244:247]
    ds_read_b128 a[128:131], v3 offset:32768
    v_cndmask_b32 v165, v5, v245, s[42:43]
    v_mfma_f32_16x16x32_bf16 v[160:163], a[68:71], a[20:23], v[160:163]
    v_exp_f32 v202, v202
    v_cndmask_b32 v166, v5, v246, s[44:45]
    v_cndmask_b32 v167, v5, v247, s[46:47]
    v_mfma_f32_16x16x32_bf16 v[160:163], a[72:75], a[24:27], v[160:163]
    buffer_load_dwordx4 v4, s[16:19], s32 offen offset:0 sc1 lds
    v_mfma_f32_16x16x32_bf16 v[160:163], a[76:79], a[28:31], v[160:163]
    ds_read_b128 a[132:135], v3 offset:33792
    v_cvt_pk_bf16_f32 v226, v180, v181
    v_mfma_f32_16x16x32_bf16 v[164:167], a[80:83], a[16:19], v[164:167]
    buffer_load_dwordx4 v4, s[16:19], s32 offen offset:1024 sc1 lds
    v_mfma_f32_16x16x32_bf16 v[164:167], a[84:87], a[20:23], v[164:167]
    buffer_load_dwordx4 v4, s[16:19], s32 offen offset:2048 sc1 lds
    v_mfma_f32_16x16x32_bf16 v[164:167], a[88:91], a[24:27], v[164:167]
    ds_read_b128 a[136:139], v3 offset:34816
    v_mfma_f32_16x16x32_bf16 v[164:167], a[92:95], a[28:31], v[164:167]
    v_exp_f32 v203, v203
    v_mfma_f32_16x16x32_bf16 v[176:179], a[64:67], a[32:35], v[248:251]
    buffer_load_dwordx4 v4, s[16:19], s32 offen offset:3072 sc1 lds
    v_mfma_f32_16x16x32_bf16 v[176:179], a[68:71], a[36:39], v[176:179]
    ds_read_b128 a[140:143], v3 offset:35840
    v_cvt_pk_bf16_f32 v227, v182, v183
    v_mfma_f32_16x16x32_bf16 v[176:179], a[72:75], a[40:43], v[176:179]
    s_add_u32 m0, s36, 98304
    v_exp_f32 v204, v204
    v_mfma_f32_16x16x32_bf16 v[176:179], a[76:79], a[44:47], v[176:179]
    ds_read_b128 a[144:147], v3 offset:36864
    s_add_u32 s30, s30, 4096
    v_cvt_pk_bf16_f32 v228, v184, v185
    v_exp_f32 v205, v205
    v_mfma_f32_16x16x32_bf16 v[180:183], a[80:83], a[32:35], v[248:251]
    ds_read_b128 a[148:151], v3 offset:37888
    v_cvt_pk_bf16_f32 v229, v186, v187
    v_mfma_f32_16x16x32_bf16 v[180:183], a[84:87], a[36:39], v[180:183]
    buffer_load_dwordx4 v4, s[16:19], s35 offen offset:0 sc1 lds
    v_exp_f32 v206, v206
    v_cvt_pk_bf16_f32 v230, v188, v189
    v_exp_f32 v207, v207
    v_cvt_pk_bf16_f32 v231, v190, v191
    v_cvt_pk_bf16_f32 v232, v192, v193
    v_exp_f32 v144, v144
    v_cvt_pk_bf16_f32 v233, v194, v195
    v_cndmask_b32 v184, v5, v248, s[40:41]
    v_cndmask_b32 v185, v5, v249, s[42:43]
    v_cvt_pk_bf16_f32 v234, v196, v197
    v_cndmask_b32 v186, v5, v250, s[44:45]
    v_exp_f32 v145, v145
    v_cndmask_b32 v187, v5, v251, s[46:47]
    v_mfma_f32_16x16x32_bf16 v[180:183], a[88:91], a[40:43], v[180:183]
    ds_read_b128 a[152:155], v3 offset:38912
    v_cvt_pk_bf16_f32 v235, v198, v199
    v_mfma_f32_16x16x32_bf16 v[180:183], a[92:95], a[44:47], v[180:183]
    buffer_load_dwordx4 v4, s[16:19], s35 offen offset:1024 sc1 lds
    v_mfma_f32_16x16x32_bf16 v[184:187], a[96:99], a[32:35], v[184:187]
    buffer_load_dwordx4 v4, s[16:19], s35 offen offset:2048 sc1 lds
    v_mfma_f32_16x16x32_bf16 v[184:187], a[100:103], a[36:39], v[184:187]
    ds_read_b128 a[156:159], v3 offset:39936
    v_cvt_pk_bf16_f32 v236, v200, v201
    v_mfma_f32_16x16x32_bf16 v[184:187], a[104:107], a[40:43], v[184:187]
    buffer_load_dwordx4 v4, s[16:19], s35 offen offset:3072 sc1 lds
    v_mfma_f32_16x16x32_bf16 v[184:187], a[108:111], a[44:47], v[184:187]
    ds_read_b128 a[160:163], v3 offset:40960
    v_mfma_f32_16x16x32_bf16 v[192:195], a[64:67], a[48:51], v[252:255]
    ds_read_b128 a[164:167], v3 offset:41984
    v_mfma_f32_16x16x32_bf16 v[192:195], a[68:71], a[52:55], v[192:195]
    s_mov_b32 m0, s36
    v_exp_f32 v146, v146
    v_mfma_f32_16x16x32_bf16 v[192:195], a[72:75], a[56:59], v[192:195]
    ds_read_b128 a[168:171], v3 offset:43008
    v_cvt_pk_bf16_f32 v237, v202, v203
    v_mfma_f32_16x16x32_bf16 v[192:195], a[76:79], a[60:63], v[192:195]
    ds_read_b128 a[172:175], v3 offset:44032
    v_cvt_pk_bf16_f32 v238, v204, v205
    v_mfma_f32_16x16x32_bf16 v[196:199], a[80:83], a[48:51], v[252:255]
    ds_read_b128 a[176:179], v3 offset:45056
    v_cvt_pk_bf16_f32 v239, v206, v207
    v_mfma_f32_16x16x32_bf16 v[196:199], a[84:87], a[52:55], v[196:199]
    s_nop 0
    v_exp_f32 v147, v147
    v_mfma_f32_16x16x32_bf16 v[196:199], a[88:91], a[56:59], v[196:199]
    v_exp_f32 v160, v160
    v_mfma_f32_16x16x32_bf16 v[196:199], a[92:95], a[60:63], v[196:199]
    ds_read_b128 a[180:183], v3 offset:46080
    v_mfma_f32_16x16x32_bf16 v[200:203], a[96:99], a[48:51], v[252:255]
    buffer_load_dwordx4 v4, s[12:15], s30 offen offset:0 sc1 lds
    v_mfma_f32_16x16x32_bf16 v[200:203], a[100:103], a[52:55], v[200:203]
    v_exp_f32 v161, v161
    v_cndmask_b32 v204, v5, v252, s[40:41]
    v_exp_f32 v162, v162
    v_cndmask_b32 v205, v5, v253, s[42:43]
    v_cndmask_b32 v206, v5, v254, s[44:45]
    v_cndmask_b32 v207, v5, v255, s[46:47]
    v_mfma_f32_16x16x32_bf16 v[200:203], a[104:107], a[56:59], v[200:203]
    ds_read_b128 a[184:187], v3 offset:47104
    buffer_load_dwordx4 v4, s[12:15], s30 offen offset:1024 sc1 lds
    v_mfma_f32_16x16x32_bf16 v[200:203], a[108:111], a[60:63], v[200:203]
    ds_read_b128 a[188:191], v3 offset:48128
    v_xor_b32 v3, 0x4000, v3
    v_mfma_f32_16x16x32_bf16 v[204:207], a[112:115], a[48:51], v[204:207]
    buffer_load_dwordx4 v4, s[12:15], s30 offen offset:2048 sc1 lds
    v_mfma_f32_16x16x32_bf16 v[204:207], a[116:119], a[52:55], v[204:207]
    buffer_load_dwordx4 v4, s[12:15], s30 offen offset:3072 sc1 lds
    v_mfma_f32_16x16x32_bf16 v[204:207], a[120:123], a[56:59], v[204:207]
    s_mov_b32 s56, 8192
    v_exp_f32 v163, v163
    v_mfma_f32_16x16x32_bf16 v[204:207], a[124:127], a[60:63], v[204:207]
    s_waitcnt lgkmcnt(0)
    v_exp_f32 v164, v164
    v_smfmac_f32_16x16x64_bf16 a[192:195], a[208:211], v[208:215], v7
    buffer_load_dwordx4 a[224:227], v15, s[8:11], s56 offen offset:0 sc1
    v_mfma_f32_16x16x32_bf16 v[16:19], a[128:131], v[208:211], v[16:19]
    buffer_load_dwordx4 a[228:231], v15, s[8:11], s56 offen offset:1024 sc1
    v_mfma_f32_16x16x32_bf16 v[16:19], a[132:135], v[212:215], v[16:19]
    v_exp_f32 v165, v165
    v_mfma_f32_16x16x32_bf16 v[20:23], a[136:139], v[208:211], v[20:23]
    buffer_load_dwordx4 a[232:235], v15, s[8:11], s56 offen offset:2048 sc1
    v_mfma_f32_16x16x32_bf16 v[20:23], a[140:143], v[212:215], v[20:23]
    v_exp_f32 v166, v166
    v_mfma_f32_16x16x32_bf16 v[24:27], a[144:147], v[208:211], v[24:27]
    buffer_load_dwordx4 a[236:239], v15, s[8:11], s56 offen offset:3072 sc1
    v_mfma_f32_16x16x32_bf16 v[24:27], a[148:151], v[212:215], v[24:27]
    v_exp_f32 v167, v167
    v_mfma_f32_16x16x32_bf16 v[28:31], a[152:155], v[208:211], v[28:31]
    s_mov_b32 s56, 12288
    v_mfma_f32_16x16x32_bf16 v[28:31], a[156:159], v[212:215], v[28:31]
    v_exp_f32 v176, v176
    v_mfma_f32_16x16x32_bf16 v[32:35], a[160:163], v[208:211], v[32:35]
    buffer_load_dwordx4 a[240:243], v15, s[8:11], s56 offen offset:0 sc1
    v_mfma_f32_16x16x32_bf16 v[32:35], a[164:167], v[212:215], v[32:35]
    v_mfma_f32_16x16x32_bf16 v[36:39], a[168:171], v[208:211], v[36:39]
    buffer_load_dwordx4 a[244:247], v15, s[8:11], s56 offen offset:1024 sc1
    v_mfma_f32_16x16x32_bf16 v[36:39], a[172:175], v[212:215], v[36:39]
    v_exp_f32 v177, v177
    v_mfma_f32_16x16x32_bf16 v[40:43], a[176:179], v[208:211], v[40:43]
    buffer_load_dwordx4 a[248:251], v15, s[8:11], s56 offen offset:2048 sc1
    v_mfma_f32_16x16x32_bf16 v[40:43], a[180:183], v[212:215], v[40:43]
    v_exp_f32 v178, v178
    v_mfma_f32_16x16x32_bf16 v[44:47], a[184:187], v[208:211], v[44:47]
    v_mfma_f32_16x16x32_bf16 v[44:47], a[188:191], v[212:215], v[44:47]
    buffer_load_dwordx4 a[252:255], v15, s[8:11], s56 offen offset:3072 sc1
    v_smfmac_f32_16x16x64_bf16 a[196:199], a[208:211], v[216:223], v7
    v_cvt_pk_bf16_f32 v208, v144, v145
    v_mfma_f32_16x16x32_bf16 v[48:51], a[128:131], v[216:219], v[48:51]
    s_mov_b32 s56, 16384
    v_exp_f32 v179, v179
    v_mfma_f32_16x16x32_bf16 v[48:51], a[132:135], v[220:223], v[48:51]
    v_cvt_pk_bf16_f32 v209, v146, v147
    v_mfma_f32_16x16x32_bf16 v[52:55], a[136:139], v[216:219], v[52:55]
    buffer_load_dwordx4 a[0:3], v15, s[8:11], s56 offen offset:0 sc1
    v_mfma_f32_16x16x32_bf16 v[52:55], a[140:143], v[220:223], v[52:55]
    v_exp_f32 v180, v180
    v_mfma_f32_16x16x32_bf16 v[56:59], a[144:147], v[216:219], v[56:59]
    v_mov_b32 v210, 0
    v_mfma_f32_16x16x32_bf16 v[56:59], a[148:151], v[220:223], v[56:59]
    buffer_load_dwordx4 a[4:7], v15, s[8:11], s56 offen offset:1024 sc1
    v_mfma_f32_16x16x32_bf16 v[60:63], a[152:155], v[216:219], v[60:63]
    v_mov_b32 v211, 0
    v_mfma_f32_16x16x32_bf16 v[60:63], a[156:159], v[220:223], v[60:63]
    v_exp_f32 v181, v181
    v_mfma_f32_16x16x32_bf16 v[64:67], a[160:163], v[216:219], v[64:67]
    buffer_load_dwordx4 a[8:11], v15, s[8:11], s56 offen offset:2048 sc1
    v_mfma_f32_16x16x32_bf16 v[64:67], a[164:167], v[220:223], v[64:67]
    buffer_load_dwordx4 a[12:15], v15, s[8:11], s56 offen offset:3072 sc1
    v_mfma_f32_16x16x32_bf16 v[68:71], a[168:171], v[216:219], v[68:71]
    v_exp_f32 v182, v182
    v_mfma_f32_16x16x32_bf16 v[68:71], a[172:175], v[220:223], v[68:71]
    s_mov_b32 s56, 20480
    v_exp_f32 v183, v183
    v_mfma_f32_16x16x32_bf16 v[72:75], a[176:179], v[216:219], v[72:75]
    v_mfma_f32_16x16x32_bf16 v[72:75], a[180:183], v[220:223], v[72:75]
    v_mfma_f32_16x16x32_bf16 v[76:79], a[184:187], v[216:219], v[76:79]
    buffer_load_dwordx4 a[16:19], v15, s[8:11], s56 offen offset:0 sc1
    v_mfma_f32_16x16x32_bf16 v[76:79], a[188:191], v[220:223], v[76:79]
    v_exp_f32 v184, v184
    v_smfmac_f32_16x16x64_bf16 a[200:203], a[208:211], v[224:231], v7
    buffer_load_dwordx4 a[20:23], v15, s[8:11], s56 offen offset:1024 sc1
    v_mfma_f32_16x16x32_bf16 v[80:83], a[128:131], v[224:227], v[80:83]
    v_cvt_pk_bf16_f32 v216, v160, v161
    v_mfma_f32_16x16x32_bf16 v[80:83], a[132:135], v[228:231], v[80:83]
    buffer_load_dwordx4 a[24:27], v15, s[8:11], s56 offen offset:2048 sc1
    v_mfma_f32_16x16x32_bf16 v[84:87], a[136:139], v[224:227], v[84:87]
    v_exp_f32 v185, v185
    v_mfma_f32_16x16x32_bf16 v[84:87], a[140:143], v[228:231], v[84:87]
    v_cvt_pk_bf16_f32 v217, v162, v163
    v_cvt_pk_bf16_f32 v218, v164, v165
    v_mfma_f32_16x16x32_bf16 v[88:91], a[144:147], v[224:227], v[88:91]
    buffer_load_dwordx4 a[28:31], v15, s[8:11], s56 offen offset:3072 sc1
    v_mfma_f32_16x16x32_bf16 v[88:91], a[148:151], v[228:231], v[88:91]
    v_exp_f32 v186, v186
    v_mfma_f32_16x16x32_bf16 v[92:95], a[152:155], v[224:227], v[92:95]
    s_mov_b32 s56, 28672
    v_cvt_pk_bf16_f32 v219, v166, v167
    v_mfma_f32_16x16x32_bf16 v[92:95], a[156:159], v[228:231], v[92:95]
    v_exp_f32 v187, v187
    v_mfma_f32_16x16x32_bf16 v[96:99], a[160:163], v[224:227], v[96:99]
    buffer_load_dwordx4 a[32:35], v15, s[8:11], s56 offen offset:0 sc1
    v_mfma_f32_16x16x32_bf16 v[96:99], a[164:167], v[228:231], v[96:99]
    v_exp_f32 v192, v192
    v_mfma_f32_16x16x32_bf16 v[100:103], a[168:171], v[224:227], v[100:103]
    buffer_load_dwordx4 a[36:39], v15, s[8:11], s56 offen offset:1024 sc1
    v_mfma_f32_16x16x32_bf16 v[100:103], a[172:175], v[228:231], v[100:103]
    v_mfma_f32_16x16x32_bf16 v[104:107], a[176:179], v[224:227], v[104:107]
    v_exp_f32 v193, v193
    v_mfma_f32_16x16x32_bf16 v[104:107], a[180:183], v[228:231], v[104:107]
    buffer_load_dwordx4 a[40:43], v15, s[8:11], s56 offen offset:2048 sc1
    v_mfma_f32_16x16x32_bf16 v[108:111], a[184:187], v[224:227], v[108:111]
    v_mfma_f32_16x16x32_bf16 v[108:111], a[188:191], v[228:231], v[108:111]
    buffer_load_dwordx4 a[44:47], v15, s[8:11], s56 offen offset:3072 sc1
    v_smfmac_f32_16x16x64_bf16 a[204:207], a[208:211], v[232:239], v7
    v_exp_f32 v194, v194
    v_mfma_f32_16x16x32_bf16 v[112:115], a[128:131], v[232:235], v[112:115]
    s_mov_b32 s56, 32768
    v_mfma_f32_16x16x32_bf16 v[112:115], a[132:135], v[236:239], v[112:115]
    v_exp_f32 v195, v195
    v_mfma_f32_16x16x32_bf16 v[116:119], a[136:139], v[232:235], v[116:119]
    buffer_load_dwordx4 a[48:51], v15, s[8:11], s56 offen offset:0 sc1
    v_mfma_f32_16x16x32_bf16 v[116:119], a[140:143], v[236:239], v[116:119]
    v_mfma_f32_16x16x32_bf16 v[120:123], a[144:147], v[232:235], v[120:123]
    v_exp_f32 v196, v196
    v_mfma_f32_16x16x32_bf16 v[120:123], a[148:151], v[236:239], v[120:123]
    buffer_load_dwordx4 a[52:55], v15, s[8:11], s56 offen offset:1024 sc1
    v_mfma_f32_16x16x32_bf16 v[124:127], a[152:155], v[232:235], v[124:127]
    v_mfma_f32_16x16x32_bf16 v[124:127], a[156:159], v[236:239], v[124:127]
    buffer_load_dwordx4 a[56:59], v15, s[8:11], s56 offen offset:2048 sc1
    v_mfma_f32_16x16x32_bf16 v[128:131], a[160:163], v[232:235], v[128:131]
    v_exp_f32 v197, v197
    v_mfma_f32_16x16x32_bf16 v[128:131], a[164:167], v[236:239], v[128:131]
    buffer_load_dwordx4 a[60:63], v15, s[8:11], s56 offen offset:3072 sc1
    v_mfma_f32_16x16x32_bf16 v[132:135], a[168:171], v[232:235], v[132:135]
    v_exp_f32 v198, v198
    v_mfma_f32_16x16x32_bf16 v[132:135], a[172:175], v[236:239], v[132:135]
    s_waitcnt vmcnt(28) lgkmcnt(0)
    s_barrier
    v_mfma_f32_16x16x32_bf16 v[136:139], a[176:179], v[232:235], v[136:139]
    v_xor_b32 v2, 0x4000, v2
    v_mfma_f32_16x16x32_bf16 v[136:139], a[180:183], v[236:239], v[136:139]
    v_exp_f32 v199, v199
    v_mfma_f32_16x16x32_bf16 v[140:143], a[184:187], v[232:235], v[140:143]
    v_mfma_f32_16x16x32_bf16 v[140:143], a[188:191], v[236:239], v[140:143]
    ds_read_b128 a[128:131], v3 offset:32768
    ds_read_b128 a[132:135], v3 offset:33792
    ds_read_b128 a[136:139], v3 offset:34816
    ds_read_b128 a[140:143], v3 offset:35840
    ds_read_b128 a[144:147], v3 offset:36864
    ds_read_b128 a[148:151], v3 offset:37888
    v_cvt_pk_bf16_f32 v224, v176, v177
    v_cvt_pk_bf16_f32 v225, v178, v179
    v_cvt_pk_bf16_f32 v226, v180, v181
    v_cvt_pk_bf16_f32 v227, v182, v183
    v_cvt_pk_bf16_f32 v228, v184, v185
    v_cvt_pk_bf16_f32 v229, v186, v187
    v_mov_b32 v230, 0
    v_mov_b32 v231, 0
    v_exp_f32 v200, v200
    v_exp_f32 v201, v201
    v_exp_f32 v202, v202
    v_exp_f32 v203, v203
    v_exp_f32 v204, v204
    v_exp_f32 v205, v205
    v_exp_f32 v206, v206
    v_exp_f32 v207, v207
    v_cvt_pk_bf16_f32 v232, v192, v193
    v_cvt_pk_bf16_f32 v233, v194, v195
    v_cvt_pk_bf16_f32 v234, v196, v197
    v_cvt_pk_bf16_f32 v235, v198, v199
    v_cvt_pk_bf16_f32 v236, v200, v201
    v_cvt_pk_bf16_f32 v237, v202, v203
    v_cvt_pk_bf16_f32 v238, v204, v205
    v_cvt_pk_bf16_f32 v239, v206, v207
    s_nop 0
    v_smfmac_f32_16x16x64_bf16 a[200:203], a[208:211], v[224:231], v7
    s_and_b32 s50, s3, 1
    v_smfmac_f32_16x16x64_bf16 a[204:207], a[208:211], v[232:239], v7
    s_waitcnt lgkmcnt(4)
    v_mfma_f32_16x16x32_bf16 v[80:83], a[128:131], v[224:227], v[80:83]
    ds_read_b128 a[152:155], v3 offset:38912
    v_mfma_f32_16x16x32_bf16 v[80:83], a[132:135], v[228:231], v[80:83]
    ds_read_b128 a[156:159], v3 offset:39936
    v_mfma_f32_16x16x32_bf16 v[112:115], a[128:131], v[232:235], v[112:115]
    s_lshl_b32 s51, s50, 16
    v_mfma_f32_16x16x32_bf16 v[112:115], a[132:135], v[236:239], v[112:115]
    s_waitcnt lgkmcnt(4)
    v_mfma_f32_16x16x32_bf16 v[84:87], a[136:139], v[224:227], v[84:87]
    ds_read_b128 a[160:163], v3 offset:40960
    v_mfma_f32_16x16x32_bf16 v[84:87], a[140:143], v[228:231], v[84:87]
    ds_read_b128 a[164:167], v3 offset:41984
    v_mfma_f32_16x16x32_bf16 v[116:119], a[136:139], v[232:235], v[116:119]
    s_add_u32 s51, s51, 49152
    v_add_u32 v12, s51, v1
    v_mfma_f32_16x16x32_bf16 v[116:119], a[140:143], v[236:239], v[116:119]
    s_waitcnt lgkmcnt(4)
    v_mfma_f32_16x16x32_bf16 v[88:91], a[144:147], v[224:227], v[88:91]
    ds_read_b128 a[168:171], v3 offset:43008
    v_mfma_f32_16x16x32_bf16 v[88:91], a[148:151], v[228:231], v[88:91]
    ds_read_b128 a[172:175], v3 offset:44032
    v_mfma_f32_16x16x32_bf16 v[120:123], a[144:147], v[232:235], v[120:123]
    s_lshl_b32 s51, s50, 14
    v_mfma_f32_16x16x32_bf16 v[120:123], a[148:151], v[236:239], v[120:123]
    s_waitcnt lgkmcnt(4)
    v_mfma_f32_16x16x32_bf16 v[92:95], a[152:155], v[224:227], v[92:95]
    ds_read_b128 a[176:179], v3 offset:45056
    v_mfma_f32_16x16x32_bf16 v[92:95], a[156:159], v[228:231], v[92:95]
    ds_read_b128 a[180:183], v3 offset:46080
    v_mfma_f32_16x16x32_bf16 v[124:127], a[152:155], v[232:235], v[124:127]
    s_sub_u32 s51, 147456, s51
    v_add_u32 v13, s51, v1
    v_mfma_f32_16x16x32_bf16 v[124:127], a[156:159], v[236:239], v[124:127]
    s_waitcnt lgkmcnt(4)
    v_mfma_f32_16x16x32_bf16 v[96:99], a[160:163], v[224:227], v[96:99]
    ds_read_b128 a[184:187], v3 offset:47104
    v_mfma_f32_16x16x32_bf16 v[96:99], a[164:167], v[228:231], v[96:99]
    ds_read_b128 a[188:191], v3 offset:48128
    v_mfma_f32_16x16x32_bf16 v[128:131], a[160:163], v[232:235], v[128:131]
    s_lshl_b32 s50, s3, 10
    v_mfma_f32_16x16x32_bf16 v[128:131], a[164:167], v[236:239], v[128:131]
    s_waitcnt lgkmcnt(4)
    v_mfma_f32_16x16x32_bf16 v[100:103], a[168:171], v[224:227], v[100:103]
    s_add_u32 s50, s50, 65536
    v_add_u32 v2, s50, v1
    v_mfma_f32_16x16x32_bf16 v[100:103], a[172:175], v[228:231], v[100:103]
    s_xor_b32 s50, s50, 3072
    v_add_u32 v4, s50, v1
    v_mfma_f32_16x16x32_bf16 v[132:135], a[168:171], v[232:235], v[132:135]
    s_lshl_b32 s50, s3, 2
    v_mfma_f32_16x16x32_bf16 v[132:135], a[172:175], v[236:239], v[132:135]
    s_waitcnt lgkmcnt(2)
    v_mfma_f32_16x16x32_bf16 v[104:107], a[176:179], v[224:227], v[104:107]
    s_add_u32 s50, s50, 69632
    v_mov_b32 v5, s50
    v_mfma_f32_16x16x32_bf16 v[104:107], a[180:183], v[228:231], v[104:107]
    s_mov_b32 s56, 0
    v_mfma_f32_16x16x32_bf16 v[136:139], a[176:179], v[232:235], v[136:139]
    buffer_load_dwordx4 v[144:147], v15, s[8:11], s56 offen offset:0 sc1
    v_mfma_f32_16x16x32_bf16 v[136:139], a[180:183], v[236:239], v[136:139]
    s_waitcnt lgkmcnt(0)
    v_mfma_f32_16x16x32_bf16 v[108:111], a[184:187], v[224:227], v[108:111]
    buffer_load_dwordx4 v[148:151], v15, s[8:11], s56 offen offset:1024 sc1
    v_mfma_f32_16x16x32_bf16 v[108:111], a[188:191], v[228:231], v[108:111]
    buffer_load_dwordx4 v[152:155], v15, s[8:11], s56 offen offset:2048 sc1
    v_mfma_f32_16x16x32_bf16 v[140:143], a[184:187], v[232:235], v[140:143]
    buffer_load_dwordx4 v[156:159], v15, s[8:11], s56 offen offset:3072 sc1
    v_mfma_f32_16x16x32_bf16 v[140:143], a[188:191], v[236:239], v[140:143]
    s_mov_b32 s56, 4096
    v_smfmac_f32_16x16x32_bf16 a[192:195], a[208:209], v[208:211], v7
    buffer_load_dwordx4 v[160:163], v15, s[8:11], s56 offen offset:0 sc1
    v_smfmac_f32_16x16x32_bf16 a[196:199], a[208:209], v[216:219], v7
    buffer_load_dwordx4 v[164:167], v15, s[8:11], s56 offen offset:1024 sc1
    v_mfma_f32_16x16x32_bf16 v[16:19], a[128:131], v[208:211], v[16:19]
    buffer_load_dwordx4 v[168:171], v15, s[8:11], s56 offen offset:2048 sc1
    v_mfma_f32_16x16x32_bf16 v[48:51], a[128:131], v[216:219], v[48:51]
    buffer_load_dwordx4 v[172:175], v15, s[8:11], s56 offen offset:3072 sc1
    v_mfma_f32_16x16x32_bf16 v[20:23], a[136:139], v[208:211], v[20:23]
    ds_write_b128 v12, v[80:83] offset:0
    v_bfe_u32 v188, v1, 4, 2
    v_mfma_f32_16x16x32_bf16 v[52:55], a[136:139], v[216:219], v[52:55]
    ds_write_b128 v12, v[112:115] offset:1024
    v_mfma_f32_16x16x32_bf16 v[24:27], a[144:147], v[208:211], v[24:27]
    ds_write_b128 v12, v[84:87] offset:2048
    v_mfma_f32_16x16x32_bf16 v[56:59], a[144:147], v[216:219], v[56:59]
    ds_write_b128 v12, v[116:119] offset:3072
    v_mfma_f32_16x16x32_bf16 v[28:31], a[152:155], v[208:211], v[28:31]
    ds_write_b128 v12, v[88:91] offset:4096
    v_accvgpr_read_b32 v8, a192
    v_mfma_f32_16x16x32_bf16 v[60:63], a[152:155], v[216:219], v[60:63]
    ds_write_b128 v12, v[120:123] offset:5120
    v_accvgpr_read_b32 v9, a196
    v_mfma_f32_16x16x32_bf16 v[32:35], a[160:163], v[208:211], v[32:35]
    ds_write_b128 v12, v[92:95] offset:6144
    v_accvgpr_read_b32 v10, a200
    v_mfma_f32_16x16x32_bf16 v[64:67], a[160:163], v[216:219], v[64:67]
    ds_write_b128 v12, v[124:127] offset:7168
    v_accvgpr_read_b32 v11, a204
    v_mfma_f32_16x16x32_bf16 v[36:39], a[168:171], v[208:211], v[36:39]
    ds_write_b128 v12, v[96:99] offset:8192
    v_accvgpr_read_b32 v184, a193
    v_mfma_f32_16x16x32_bf16 v[68:71], a[168:171], v[216:219], v[68:71]
    ds_write_b128 v12, v[128:131] offset:9216
    v_accvgpr_read_b32 v185, a197
    v_mfma_f32_16x16x32_bf16 v[40:43], a[176:179], v[208:211], v[40:43]
    ds_write_b128 v12, v[100:103] offset:10240
    v_accvgpr_read_b32 v186, a201
    v_mfma_f32_16x16x32_bf16 v[72:75], a[176:179], v[216:219], v[72:75]
    ds_write_b128 v12, v[132:135] offset:11264
    v_accvgpr_read_b32 v187, a205
    v_mfma_f32_16x16x32_bf16 v[44:47], a[184:187], v[208:211], v[44:47]
    ds_write_b128 v12, v[104:107] offset:12288
    v_add_f32 v8, v8, v184
    v_mfma_f32_16x16x32_bf16 v[76:79], a[184:187], v[216:219], v[76:79]
    ds_write_b128 v12, v[136:139] offset:13312
    ds_write_b128 v12, v[108:111] offset:14336
    ds_write_b128 v12, v[140:143] offset:15360
    v_add_f32 v9, v9, v185
    v_lshl_add_u32 v188, v188, 2, s68
    buffer_load_dword v189, v188, s[60:63], 0 offen offset:0 sc1
    v_add_f32 v10, v10, v186
    v_add_f32 v11, v11, v187
    s_mov_b32 s51, 0x53800000
    v_add_f32 v14, v8, v9
    v_add_f32 v14, v14, v10
    v_add_f32 v14, v14, v11
    v_cmp_nge_f32 vcc, s51, v14
    s_nop 0
    s_or_b32 s39, s39, vcc_lo
    s_or_b32 s39, s39, vcc_hi
    v_mov_b32 v14, s39
    ds_write_b128 v2, v[8:11]
    ds_write_b32 v5, v14
    s_waitcnt lgkmcnt(0)
    s_barrier
    s_branch L_a_recvL
L_a_FNL:
    ds_read_b128 a[128:131], v3 offset:32768
    ds_read_b128 a[132:135], v3 offset:33792
    ds_read_b128 a[136:139], v3 offset:34816
    ds_read_b128 a[140:143], v3 offset:35840
    ds_read_b128 a[144:147], v3 offset:36864
    ds_read_b128 a[148:151], v3 offset:37888
    v_cvt_pk_bf16_f32 v224, v176, v177
    v_cvt_pk_bf16_f32 v225, v178, v179
    v_cvt_pk_bf16_f32 v226, v180, v181
    v_cvt_pk_bf16_f32 v227, v182, v183
    v_cvt_pk_bf16_f32 v228, v184, v185
    v_cvt_pk_bf16_f32 v229, v186, v187
    v_cvt_pk_bf16_f32 v230, v188, v189
    v_cvt_pk_bf16_f32 v231, v190, v191
    v_exp_f32 v200, v200
    v_exp_f32 v201, v201
    v_exp_f32 v202, v202
    v_exp_f32 v203, v203
    v_exp_f32 v204, v204
    v_exp_f32 v205, v205
    v_exp_f32 v206, v206
    v_exp_f32 v207, v207
    v_cvt_pk_bf16_f32 v232, v192, v193
    v_cvt_pk_bf16_f32 v233, v194, v195
    v_cvt_pk_bf16_f32 v234, v196, v197
    v_cvt_pk_bf16_f32 v235, v198, v199
    v_cvt_pk_bf16_f32 v236, v200, v201
    v_cvt_pk_bf16_f32 v237, v202, v203
    v_cvt_pk_bf16_f32 v238, v204, v205
    v_cvt_pk_bf16_f32 v239, v206, v207
    s_nop 0
    v_smfmac_f32_16x16x64_bf16 a[200:203], a[208:211], v[224:231], v7
    s_and_b32 s50, s3, 1
    v_smfmac_f32_16x16x64_bf16 a[204:207], a[208:211], v[232:239], v7
    s_waitcnt lgkmcnt(4)
    v_mfma_f32_16x16x32_bf16 v[80:83], a[128:131], v[224:227], v[80:83]
    ds_read_b128 a[152:155], v3 offset:38912
    v_mfma_f32_16x16x32_bf16 v[80:83], a[132:135], v[228:231], v[80:83]
    ds_read_b128 a[156:159], v3 offset:39936
    v_mfma_f32_16x16x32_bf16 v[112:115], a[128:131], v[232:235], v[112:115]
    s_lshl_b32 s51, s50, 16
    v_mfma_f32_16x16x32_bf16 v[112:115], a[132:135], v[236:239], v[112:115]
    s_waitcnt lgkmcnt(4)
    v_mfma_f32_16x16x32_bf16 v[84:87], a[136:139], v[224:227], v[84:87]
    ds_read_b128 a[160:163], v3 offset:40960
    v_mfma_f32_16x16x32_bf16 v[84:87], a[140:143], v[228:231], v[84:87]
    ds_read_b128 a[164:167], v3 offset:41984
    v_mfma_f32_16x16x32_bf16 v[116:119], a[136:139], v[232:235], v[116:119]
    s_add_u32 s51, s51, 49152
    v_add_u32 v12, s51, v1
    v_mfma_f32_16x16x32_bf16 v[116:119], a[140:143], v[236:239], v[116:119]
    s_waitcnt lgkmcnt(4)
    v_mfma_f32_16x16x32_bf16 v[88:91], a[144:147], v[224:227], v[88:91]
    ds_read_b128 a[168:171], v3 offset:43008
    v_mfma_f32_16x16x32_bf16 v[88:91], a[148:151], v[228:231], v[88:91]
    ds_read_b128 a[172:175], v3 offset:44032
    v_mfma_f32_16x16x32_bf16 v[120:123], a[144:147], v[232:235], v[120:123]
    s_lshl_b32 s51, s50, 14
    v_mfma_f32_16x16x32_bf16 v[120:123], a[148:151], v[236:239], v[120:123]
    s_waitcnt lgkmcnt(4)
    v_mfma_f32_16x16x32_bf16 v[92:95], a[152:155], v[224:227], v[92:95]
    ds_read_b128 a[176:179], v3 offset:45056
    v_mfma_f32_16x16x32_bf16 v[92:95], a[156:159], v[228:231], v[92:95]
    ds_read_b128 a[180:183], v3 offset:46080
    v_mfma_f32_16x16x32_bf16 v[124:127], a[152:155], v[232:235], v[124:127]
    s_sub_u32 s51, 147456, s51
    v_add_u32 v13, s51, v1
    v_mfma_f32_16x16x32_bf16 v[124:127], a[156:159], v[236:239], v[124:127]
    s_waitcnt lgkmcnt(4)
    v_mfma_f32_16x16x32_bf16 v[96:99], a[160:163], v[224:227], v[96:99]
    ds_read_b128 a[184:187], v3 offset:47104
    v_mfma_f32_16x16x32_bf16 v[96:99], a[164:167], v[228:231], v[96:99]
    ds_read_b128 a[188:191], v3 offset:48128
    v_mfma_f32_16x16x32_bf16 v[128:131], a[160:163], v[232:235], v[128:131]
    s_lshl_b32 s50, s3, 10
    v_mfma_f32_16x16x32_bf16 v[128:131], a[164:167], v[236:239], v[128:131]
    s_waitcnt lgkmcnt(4)
    v_mfma_f32_16x16x32_bf16 v[100:103], a[168:171], v[224:227], v[100:103]
    s_add_u32 s50, s50, 65536
    v_add_u32 v2, s50, v1
    v_mfma_f32_16x16x32_bf16 v[100:103], a[172:175], v[228:231], v[100:103]
    s_xor_b32 s50, s50, 3072
    v_add_u32 v4, s50, v1
    v_mfma_f32_16x16x32_bf16 v[132:135], a[168:171], v[232:235], v[132:135]
    s_lshl_b32 s50, s3, 2
    v_mfma_f32_16x16x32_bf16 v[132:135], a[172:175], v[236:239], v[132:135]
    s_waitcnt lgkmcnt(2)
    v_mfma_f32_16x16x32_bf16 v[104:107], a[176:179], v[224:227], v[104:107]
    s_add_u32 s50, s50, 69632
    v_mov_b32 v5, s50
    v_mfma_f32_16x16x32_bf16 v[104:107], a[180:183], v[228:231], v[104:107]
    s_mov_b32 s56, 0
    v_mfma_f32_16x16x32_bf16 v[136:139], a[176:179], v[232:235], v[136:139]
    buffer_load_dwordx4 v[144:147], v15, s[8:11], s56 offen offset:0 sc1
    v_mfma_f32_16x16x32_bf16 v[136:139], a[180:183], v[236:239], v[136:139]
    s_waitcnt lgkmcnt(0)
    v_mfma_f32_16x16x32_bf16 v[108:111], a[184:187], v[224:227], v[108:111]
    buffer_load_dwordx4 v[148:151], v15, s[8:11], s56 offen offset:1024 sc1
    v_mfma_f32_16x16x32_bf16 v[108:111], a[188:191], v[228:231], v[108:111]
    buffer_load_dwordx4 v[152:155], v15, s[8:11], s56 offen offset:2048 sc1
    v_mfma_f32_16x16x32_bf16 v[140:143], a[184:187], v[232:235], v[140:143]
    buffer_load_dwordx4 v[156:159], v15, s[8:11], s56 offen offset:3072 sc1
    v_mfma_f32_16x16x32_bf16 v[140:143], a[188:191], v[236:239], v[140:143]
    s_mov_b32 s56, 4096
    v_smfmac_f32_16x16x64_bf16 a[192:195], a[208:211], v[208:215], v7
    buffer_load_dwordx4 v[160:163], v15, s[8:11], s56 offen offset:0 sc1
    v_smfmac_f32_16x16x64_bf16 a[196:199], a[208:211], v[216:223], v7
    buffer_load_dwordx4 v[164:167], v15, s[8:11], s56 offen offset:1024 sc1
    v_mfma_f32_16x16x32_bf16 v[16:19], a[128:131], v[208:211], v[16:19]
    v_mfma_f32_16x16x32_bf16 v[16:19], a[132:135], v[212:215], v[16:19]
    v_mfma_f32_16x16x32_bf16 v[48:51], a[128:131], v[216:219], v[48:51]
    ds_write_b128 v12, v[80:83] offset:0
    v_mfma_f32_16x16x32_bf16 v[48:51], a[132:135], v[220:223], v[48:51]
    ds_write_b128 v12, v[112:115] offset:1024
    v_mfma_f32_16x16x32_bf16 v[20:23], a[136:139], v[208:211], v[20:23]
    buffer_load_dwordx4 v[168:171], v15, s[8:11], s56 offen offset:2048 sc1
    v_mfma_f32_16x16x32_bf16 v[20:23], a[140:143], v[212:215], v[20:23]
    ds_write_b128 v12, v[84:87] offset:2048
    v_mfma_f32_16x16x32_bf16 v[52:55], a[136:139], v[216:219], v[52:55]
    v_accvgpr_read_b32 v8, a192
    v_mfma_f32_16x16x32_bf16 v[52:55], a[140:143], v[220:223], v[52:55]
    ds_write_b128 v12, v[116:119] offset:3072
    v_accvgpr_read_b32 v9, a196
    v_mfma_f32_16x16x32_bf16 v[24:27], a[144:147], v[208:211], v[24:27]
    v_accvgpr_read_b32 v10, a200
    v_mfma_f32_16x16x32_bf16 v[24:27], a[148:151], v[212:215], v[24:27]
    ds_write_b128 v12, v[88:91] offset:4096
    v_accvgpr_read_b32 v11, a204
    v_mfma_f32_16x16x32_bf16 v[56:59], a[144:147], v[216:219], v[56:59]
    ds_write_b128 v12, v[120:123] offset:5120
    v_accvgpr_read_b32 v184, a193
    v_mfma_f32_16x16x32_bf16 v[56:59], a[148:151], v[220:223], v[56:59]
    v_accvgpr_read_b32 v185, a197
    v_mfma_f32_16x16x32_bf16 v[28:31], a[152:155], v[208:211], v[28:31]
    ds_write_b128 v12, v[92:95] offset:6144
    v_accvgpr_read_b32 v186, a201
    v_mfma_f32_16x16x32_bf16 v[28:31], a[156:159], v[212:215], v[28:31]
    v_accvgpr_read_b32 v187, a205
    v_mfma_f32_16x16x32_bf16 v[60:63], a[152:155], v[216:219], v[60:63]
    ds_write_b128 v12, v[124:127] offset:7168
    v_add_f32 v8, v8, v184
    v_mfma_f32_16x16x32_bf16 v[60:63], a[156:159], v[220:223], v[60:63]
    v_add_f32 v9, v9, v185
    v_mfma_f32_16x16x32_bf16 v[32:35], a[160:163], v[208:211], v[32:35]
    ds_write_b128 v12, v[96:99] offset:8192
    v_add_f32 v10, v10, v186
    v_mfma_f32_16x16x32_bf16 v[32:35], a[164:167], v[212:215], v[32:35]
    ds_write_b128 v12, v[128:131] offset:9216
    v_add_f32 v11, v11, v187
    v_mfma_f32_16x16x32_bf16 v[64:67], a[160:163], v[216:219], v[64:67]
    s_mov_b32 s51, 0x53800000
    v_mfma_f32_16x16x32_bf16 v[64:67], a[164:167], v[220:223], v[64:67]
    ds_write_b128 v12, v[100:103] offset:10240
    v_add_f32 v14, v8, v9
    v_mfma_f32_16x16x32_bf16 v[36:39], a[168:171], v[208:211], v[36:39]
    v_add_f32 v14, v14, v10
    v_mfma_f32_16x16x32_bf16 v[36:39], a[172:175], v[212:215], v[36:39]
    ds_write_b128 v12, v[132:135] offset:11264
    v_add_f32 v14, v14, v11
    v_mfma_f32_16x16x32_bf16 v[68:71], a[168:171], v[216:219], v[68:71]
    v_cmp_nge_f32 vcc, s51, v14
    v_mfma_f32_16x16x32_bf16 v[68:71], a[172:175], v[220:223], v[68:71]
    ds_write_b128 v12, v[104:107] offset:12288
    v_mfma_f32_16x16x32_bf16 v[40:43], a[176:179], v[208:211], v[40:43]
    ds_write_b128 v12, v[136:139] offset:13312
    v_mfma_f32_16x16x32_bf16 v[40:43], a[180:183], v[212:215], v[40:43]
    s_nop 0
    v_mfma_f32_16x16x32_bf16 v[72:75], a[176:179], v[216:219], v[72:75]
    ds_write_b128 v12, v[108:111] offset:14336
    v_mfma_f32_16x16x32_bf16 v[72:75], a[180:183], v[220:223], v[72:75]
    s_or_b32 s39, s39, vcc_lo
    v_mfma_f32_16x16x32_bf16 v[44:47], a[184:187], v[208:211], v[44:47]
    ds_write_b128 v12, v[140:143] offset:15360
    v_mfma_f32_16x16x32_bf16 v[44:47], a[188:191], v[212:215], v[44:47]
    s_or_b32 s39, s39, vcc_hi
    v_mfma_f32_16x16x32_bf16 v[76:79], a[184:187], v[216:219], v[76:79]
    v_mov_b32 v14, s39
    v_mfma_f32_16x16x32_bf16 v[76:79], a[188:191], v[220:223], v[76:79]
    ds_write_b128 v2, v[8:11]
    buffer_load_dwordx4 v[172:175], v15, s[8:11], s56 offen offset:3072 sc1
    v_bfe_u32 v188, v1, 4, 2
    v_lshl_add_u32 v188, v188, 2, s68
    buffer_load_dword v189, v188, s[60:63], 0 offen offset:0 sc1
    ds_write_b32 v5, v14
    s_waitcnt lgkmcnt(0)
    s_barrier
L_a_recvL:
    v_mov_b32 v14, 69632
    ds_read_b128 v[176:179], v14
    ds_read_b128 v[180:183], v4
    ds_read_b128 v[80:83], v13 offset:0
    ds_read_b128 v[84:87], v13 offset:2048
    ds_read_b128 v[112:115], v13 offset:1024
    ds_read_b128 v[116:119], v13 offset:3072
    ds_read_b128 v[88:91], v13 offset:4096
    ds_read_b128 v[92:95], v13 offset:6144
    ds_read_b128 v[120:123], v13 offset:5120
    ds_read_b128 v[124:127], v13 offset:7168
    ds_read_b128 v[96:99], v13 offset:8192
    ds_read_b128 v[100:103], v13 offset:10240
    ds_read_b128 v[128:131], v13 offset:9216
    ds_read_b128 v[132:135], v13 offset:11264
    ds_read_b128 v[104:107], v13 offset:12288
    s_waitcnt vmcnt(54)
    s_waitcnt lgkmcnt(13)
    v_or3_b32 v176, v176, v177, v178
    v_or_b32 v176, v176, v179
    v_add_f32 v8, v8, v180
    v_add_f32 v9, v9, v181
    s_waitcnt lgkmcnt(12)
    ds_read_b128 v[108:111], v13 offset:14336
    ds_read_b128 v[136:139], v13 offset:13312
    ds_read_b128 v[140:143], v13 offset:15360
    v_readfirstlane_b32 s50, v176
    v_rcp_f32 v8, v8
    v_rcp_f32 v9, v9
    s_cmp_eq_u32 s38, 0
    s_cselect_b32 s50, s50, 0
    s_cmp_lg_u32 s50, 0
    s_cbranch_scc1 L_a_redo
    s_lshl_b32 s50, s27, 20
    s_sub_u32 s50, 33030144, s50
    s_waitcnt lgkmcnt(14)
    v_pk_add_f32 v[16:17], v[16:17], v[80:81]
    v_pk_add_f32 v[18:19], v[18:19], v[82:83]
    v_pk_add_f32 v[20:21], v[20:21], v[84:85]
    v_pk_add_f32 v[22:23], v[22:23], v[86:87]
    v_pk_mul_f32 v[16:17], v[16:17], v[8:9] op_sel:[0,0] op_sel_hi:[1,0]
    v_pk_mul_f32 v[18:19], v[18:19], v[8:9] op_sel:[0,0] op_sel_hi:[1,0]
    v_pk_mul_f32 v[20:21], v[20:21], v[8:9] op_sel:[0,0] op_sel_hi:[1,0]
    v_pk_mul_f32 v[22:23], v[22:23], v[8:9] op_sel:[0,0] op_sel_hi:[1,0]
    v_cvt_pk_bf16_f32 v16, v16, v17
    v_cvt_pk_bf16_f32 v17, v18, v19
    v_cvt_pk_bf16_f32 v18, v20, v21
    v_cvt_pk_bf16_f32 v19, v22, v23
    buffer_store_dwordx4 v[16:19], v6, s[20:23], s50 offen offset:0 sc1
    s_waitcnt lgkmcnt(12)
    v_pk_add_f32 v[48:49], v[48:49], v[112:113]
    v_pk_add_f32 v[50:51], v[50:51], v[114:115]
    v_pk_add_f32 v[52:53], v[52:53], v[116:117]
    v_pk_add_f32 v[54:55], v[54:55], v[118:119]
    v_pk_mul_f32 v[48:49], v[48:49], v[8:9] op_sel:[0,1] op_sel_hi:[1,1]
    v_pk_mul_f32 v[50:51], v[50:51], v[8:9] op_sel:[0,1] op_sel_hi:[1,1]
    v_pk_mul_f32 v[52:53], v[52:53], v[8:9] op_sel:[0,1] op_sel_hi:[1,1]
    v_pk_mul_f32 v[54:55], v[54:55], v[8:9] op_sel:[0,1] op_sel_hi:[1,1]
    v_cvt_pk_bf16_f32 v48, v48, v49
    v_cvt_pk_bf16_f32 v49, v50, v51
    v_cvt_pk_bf16_f32 v50, v52, v53
    v_cvt_pk_bf16_f32 v51, v54, v55
    buffer_store_dwordx4 v[48:51], v6, s[20:23], s50 offen offset:1024 sc1
    s_add_u32 s50, s50, 4096
    s_waitcnt lgkmcnt(10)
    v_pk_add_f32 v[24:25], v[24:25], v[88:89]
    v_pk_add_f32 v[26:27], v[26:27], v[90:91]
    v_pk_add_f32 v[28:29], v[28:29], v[92:93]
    v_pk_add_f32 v[30:31], v[30:31], v[94:95]
    v_pk_mul_f32 v[24:25], v[24:25], v[8:9] op_sel:[0,0] op_sel_hi:[1,0]
    v_pk_mul_f32 v[26:27], v[26:27], v[8:9] op_sel:[0,0] op_sel_hi:[1,0]
    v_pk_mul_f32 v[28:29], v[28:29], v[8:9] op_sel:[0,0] op_sel_hi:[1,0]
    v_pk_mul_f32 v[30:31], v[30:31], v[8:9] op_sel:[0,0] op_sel_hi:[1,0]
    v_cvt_pk_bf16_f32 v24, v24, v25
    v_cvt_pk_bf16_f32 v25, v26, v27
    v_cvt_pk_bf16_f32 v26, v28, v29
    v_cvt_pk_bf16_f32 v27, v30, v31
    buffer_store_dwordx4 v[24:27], v6, s[20:23], s50 offen offset:0 sc1
    s_waitcnt lgkmcnt(8)
    v_pk_add_f32 v[56:57], v[56:57], v[120:121]
    v_pk_add_f32 v[58:59], v[58:59], v[122:123]
    v_pk_add_f32 v[60:61], v[60:61], v[124:125]
    v_pk_add_f32 v[62:63], v[62:63], v[126:127]
    v_pk_mul_f32 v[56:57], v[56:57], v[8:9] op_sel:[0,1] op_sel_hi:[1,1]
    v_pk_mul_f32 v[58:59], v[58:59], v[8:9] op_sel:[0,1] op_sel_hi:[1,1]
    v_pk_mul_f32 v[60:61], v[60:61], v[8:9] op_sel:[0,1] op_sel_hi:[1,1]
    v_pk_mul_f32 v[62:63], v[62:63], v[8:9] op_sel:[0,1] op_sel_hi:[1,1]
    v_cvt_pk_bf16_f32 v56, v56, v57
    v_cvt_pk_bf16_f32 v57, v58, v59
    v_cvt_pk_bf16_f32 v58, v60, v61
    v_cvt_pk_bf16_f32 v59, v62, v63
    buffer_store_dwordx4 v[56:59], v6, s[20:23], s50 offen offset:1024 sc1
    s_add_u32 s50, s50, 4096
    s_waitcnt lgkmcnt(6)
    v_pk_add_f32 v[32:33], v[32:33], v[96:97]
    v_pk_add_f32 v[34:35], v[34:35], v[98:99]
    v_pk_add_f32 v[36:37], v[36:37], v[100:101]
    v_pk_add_f32 v[38:39], v[38:39], v[102:103]
    v_pk_mul_f32 v[32:33], v[32:33], v[8:9] op_sel:[0,0] op_sel_hi:[1,0]
    v_pk_mul_f32 v[34:35], v[34:35], v[8:9] op_sel:[0,0] op_sel_hi:[1,0]
    v_pk_mul_f32 v[36:37], v[36:37], v[8:9] op_sel:[0,0] op_sel_hi:[1,0]
    v_pk_mul_f32 v[38:39], v[38:39], v[8:9] op_sel:[0,0] op_sel_hi:[1,0]
    v_cvt_pk_bf16_f32 v32, v32, v33
    v_cvt_pk_bf16_f32 v33, v34, v35
    v_cvt_pk_bf16_f32 v34, v36, v37
    v_cvt_pk_bf16_f32 v35, v38, v39
    buffer_store_dwordx4 v[32:35], v6, s[20:23], s50 offen offset:0 sc1
    s_waitcnt lgkmcnt(4)
    v_pk_add_f32 v[64:65], v[64:65], v[128:129]
    v_pk_add_f32 v[66:67], v[66:67], v[130:131]
    v_pk_add_f32 v[68:69], v[68:69], v[132:133]
    v_pk_add_f32 v[70:71], v[70:71], v[134:135]
    v_pk_mul_f32 v[64:65], v[64:65], v[8:9] op_sel:[0,1] op_sel_hi:[1,1]
    v_pk_mul_f32 v[66:67], v[66:67], v[8:9] op_sel:[0,1] op_sel_hi:[1,1]
    v_pk_mul_f32 v[68:69], v[68:69], v[8:9] op_sel:[0,1] op_sel_hi:[1,1]
    v_pk_mul_f32 v[70:71], v[70:71], v[8:9] op_sel:[0,1] op_sel_hi:[1,1]
    v_cvt_pk_bf16_f32 v64, v64, v65
    v_cvt_pk_bf16_f32 v65, v66, v67
    v_cvt_pk_bf16_f32 v66, v68, v69
    v_cvt_pk_bf16_f32 v67, v70, v71
    buffer_store_dwordx4 v[64:67], v6, s[20:23], s50 offen offset:1024 sc1
    s_add_u32 s50, s50, 4096
    s_waitcnt lgkmcnt(2)
    v_pk_add_f32 v[40:41], v[40:41], v[104:105]
    v_pk_add_f32 v[42:43], v[42:43], v[106:107]
    v_pk_add_f32 v[44:45], v[44:45], v[108:109]
    v_pk_add_f32 v[46:47], v[46:47], v[110:111]
    v_pk_mul_f32 v[40:41], v[40:41], v[8:9] op_sel:[0,0] op_sel_hi:[1,0]
    v_pk_mul_f32 v[42:43], v[42:43], v[8:9] op_sel:[0,0] op_sel_hi:[1,0]
    v_pk_mul_f32 v[44:45], v[44:45], v[8:9] op_sel:[0,0] op_sel_hi:[1,0]
    v_pk_mul_f32 v[46:47], v[46:47], v[8:9] op_sel:[0,0] op_sel_hi:[1,0]
    v_cvt_pk_bf16_f32 v40, v40, v41
    v_cvt_pk_bf16_f32 v41, v42, v43
    v_cvt_pk_bf16_f32 v42, v44, v45
    v_cvt_pk_bf16_f32 v43, v46, v47
    buffer_store_dwordx4 v[40:43], v6, s[20:23], s50 offen offset:0 sc1
    s_waitcnt lgkmcnt(0)
    v_pk_add_f32 v[72:73], v[72:73], v[136:137]
    v_pk_add_f32 v[74:75], v[74:75], v[138:139]
    v_pk_add_f32 v[76:77], v[76:77], v[140:141]
    v_pk_add_f32 v[78:79], v[78:79], v[142:143]
    v_pk_mul_f32 v[72:73], v[72:73], v[8:9] op_sel:[0,1] op_sel_hi:[1,1]
    v_pk_mul_f32 v[74:75], v[74:75], v[8:9] op_sel:[0,1] op_sel_hi:[1,1]
    v_pk_mul_f32 v[76:77], v[76:77], v[8:9] op_sel:[0,1] op_sel_hi:[1,1]
    v_pk_mul_f32 v[78:79], v[78:79], v[8:9] op_sel:[0,1] op_sel_hi:[1,1]
    v_cvt_pk_bf16_f32 v72, v72, v73
    v_cvt_pk_bf16_f32 v73, v74, v75
    v_cvt_pk_bf16_f32 v74, v76, v77
    v_cvt_pk_bf16_f32 v75, v78, v79
    buffer_store_dwordx4 v[72:75], v6, s[20:23], s50 offen offset:1024 sc1
L_a_done:
    v_add_u32 v184, s70, v1
    s_waitcnt vmcnt(8)
    v_cmp_ne_u32 vcc, 1, v189
    s_nop 4
    s_cbranch_vccnz L_spin12
L_back12:
    v_xor_b32 v185, 1024, v184
    v_xor_b32 v186, 2048, v184
    v_xor_b32 v187, 3072, v184
    s_waitcnt vmcnt(54)
    s_mov_b32 s57, 0
    buffer_load_dwordx4 v[192:195], v184, s[20:23], s57 offen sc1
    buffer_load_dwordx4 v[196:199], v185, s[20:23], s57 offen sc1
    buffer_load_dwordx4 v[200:203], v186, s[20:23], s57 offen sc1
    buffer_load_dwordx4 v[204:207], v187, s[20:23], s57 offen sc1
    s_waitcnt vmcnt(54)
    s_mov_b32 s57, 4096
    buffer_load_dwordx4 v[208:211], v184, s[20:23], s57 offen sc1
    buffer_load_dwordx4 v[212:215], v185, s[20:23], s57 offen sc1
    buffer_load_dwordx4 v[216:219], v186, s[20:23], s57 offen sc1
    buffer_load_dwordx4 v[220:223], v187, s[20:23], s57 offen sc1
    s_waitcnt vmcnt(54)
    s_mov_b32 s57, 8192
    buffer_load_dwordx4 v[224:227], v184, s[20:23], s57 offen sc1
    buffer_load_dwordx4 v[228:231], v185, s[20:23], s57 offen sc1
    buffer_load_dwordx4 v[232:235], v186, s[20:23], s57 offen sc1
    buffer_load_dwordx4 v[236:239], v187, s[20:23], s57 offen sc1
    s_waitcnt vmcnt(54)
    s_mov_b32 s57, 12288
    buffer_load_dwordx4 a[176:179], v184, s[20:23], s57 offen sc1
    buffer_load_dwordx4 a[180:183], v185, s[20:23], s57 offen sc1
    buffer_load_dwordx4 a[184:187], v186, s[20:23], s57 offen sc1
    buffer_load_dwordx4 a[188:191], v187, s[20:23], s57 offen sc1
    s_waitcnt vmcnt(54)
    s_mov_b32 s57, 16384
    buffer_load_dwordx4 a[192:195], v184, s[20:23], s57 offen sc1
    buffer_load_dwordx4 a[196:199], v185, s[20:23], s57 offen sc1
    buffer_load_dwordx4 a[200:203], v186, s[20:23], s57 offen sc1
    buffer_load_dwordx4 a[204:207], v187, s[20:23], s57 offen sc1
    s_waitcnt vmcnt(54)
    s_mov_b32 s57, 20480
    buffer_load_dwordx4 a[208:211], v184, s[20:23], s57 offen sc1
    buffer_load_dwordx4 a[212:215], v185, s[20:23], s57 offen sc1
    buffer_load_dwordx4 a[216:219], v186, s[20:23], s57 offen sc1
    buffer_load_dwordx4 a[220:223], v187, s[20:23], s57 offen sc1
    s_waitcnt vmcnt(54)
    s_mov_b32 s57, 24576
    buffer_load_dwordx4 v[112:115], v184, s[20:23], s57 offen sc1
    buffer_load_dwordx4 v[116:119], v185, s[20:23], s57 offen sc1
    buffer_load_dwordx4 v[120:123], v186, s[20:23], s57 offen sc1
    buffer_load_dwordx4 v[124:127], v187, s[20:23], s57 offen sc1
    s_waitcnt vmcnt(54)
    s_mov_b32 s57, 28672
    buffer_load_dwordx4 v[128:131], v184, s[20:23], s57 offen sc1
    buffer_load_dwordx4 v[132:135], v185, s[20:23], s57 offen sc1
    buffer_load_dwordx4 v[136:139], v186, s[20:23], s57 offen sc1
    buffer_load_dwordx4 v[140:143], v187, s[20:23], s57 offen sc1
    s_lshl_b32 s26, s3, 12
    v_add_u32 v8, s26, v1
    v_add_u32 v9, 0x10000, v8
    ds_read_b128 a[128:131], v9 offset:16384
    ds_read_b128 a[132:135], v9 offset:17408
    ds_read_b128 a[136:139], v9 offset:18432
    ds_read_b128 a[140:143], v9 offset:19456
    ds_read_b128 a[144:147], v8 offset:16384
    ds_read_b128 a[148:151], v8 offset:17408
    ds_read_b128 a[152:155], v8 offset:18432
    ds_read_b128 a[156:159], v8 offset:19456
    ds_read_b128 a[160:163], v8 offset:0
    ds_read_b128 a[164:167], v8 offset:1024
    ds_read_b128 a[168:171], v8 offset:2048
    ds_read_b128 a[172:175], v8 offset:3072
    v_mov_b32 v178, v15
    s_mov_b32 s12, s64
    s_mov_b32 s13, s65
    s_mov_b32 s14, 0x200000
    s_mov_b32 s15, 0x00020000
    v_bfe_u32 v176, v1, 4, 4
    v_lshlrev_b32 v176, 10, v176
    v_bfe_u32 v177, v1, 8, 1
    v_lshl_add_u32 v176, v177, 5, v176
    v_lshrrev_b32 v177, 9, v1
    v_lshl_add_u32 v176, v177, 4, v176
    v_add_u32 v176, s71, v176
    buffer_load_dwordx4 v[24:27], v176, s[12:15], 0 offen offset:0
    buffer_load_dwordx4 v[28:31], v176, s[12:15], 0 offen offset:64
    s_mov_b32 s56, 36864
    buffer_load_dwordx4 a[64:67], v178, s[8:11], s56 offen offset:0 sc1
    s_lshr_b32 s27, s24, 3
    s_lshl_b32 s27, s27, 6
    s_and_b32 s28, s24, 7
    s_add_u32 s27, s27, s28
    s_lshl_b32 s27, s27, 2
    s_lshl_b32 s26, s25, 12
    buffer_load_dwordx4 a[68:71], v178, s[8:11], s56 offen offset:1024 sc1
    s_add_u32 s27, s27, s26
    s_add_u32 s27, s27, 40960
    v_lshl_add_u32 v21, v0, 10, s27
    s_lshl_b32 s29, s24, 8
    s_add_u32 s29, s29, 73728
    s_lshl_b32 s28, s25, 2
    buffer_load_dwordx4 a[72:75], v178, s[8:11], s56 offen offset:2048 sc1
    s_add_u32 s28, s28, s29
    v_writelane_b32 v21, s28, 4
    v_cmp_lt_u32 vcc, 4, v0
    v_mov_b32 v2, 268435456
    v_and_b32 v3, 0x70, v1
    v_cndmask_b32 v21, v21, v2, vcc
    buffer_load_dwordx4 a[76:79], v178, s[8:11], s56 offen offset:3072 sc1
    v_mov_b32 v2, 1
    v_lshrrev_b32 v3, 2, v3
    v_add_u32 v20, s29, v3
    s_and_b32 s28, s24, 1
    s_lshl_b32 s30, s28, 3
    s_add_u32 s30, s30, s25
    s_mov_b32 s56, 40960
    buffer_load_dwordx4 a[80:83], v178, s[8:11], s56 offen offset:0 sc1
    s_lshl_b32 s59, s3, 13
    s_mul_i32 s26, s30, 229376
    s_add_u32 s26, s26, s59
    v_add_u32 v16, s26, v1
    s_and_b32 s28, s24, 1
    s_lshl_b32 s26, s3, 14
    buffer_load_dwordx4 a[84:87], v178, s[8:11], s56 offen offset:1024 sc1
    v_add_u32 v8, s26, v1
    v_xor_b32 v9, 16384, v8
    v_xor_b32 v10, 32768, v8
    v_xor_b32 v11, 49152, v8
    s_add_u32 s40, s78, 0x2000000
    s_addc_u32 s41, s79, 0
    s_mov_b32 s42, 0x2000000
    buffer_load_dwordx4 a[88:91], v178, s[8:11], s56 offen offset:2048 sc1
    s_mov_b32 s43, 0x00020000
    s_lshl_b32 s26, s24, 20
    s_lshl_b32 s27, s25, 16
    s_sub_u32 s26, s26, s27
    s_add_u32 s26, s26, 999424
    s_lshl_b32 s27, s3, 12
    buffer_load_dwordx4 a[92:95], v178, s[8:11], s56 offen offset:3072 sc1
    s_add_u32 s26, s26, s27
    s_xor_b32 s27, s26, 1048576
    v_add_u32 v6, s27, v1
    s_xor_b32 s28, s28, 1
    s_lshl_b32 s29, s28, 28
    s_add_u32 s26, s26, s29
    s_mov_b32 s56, 45056
    buffer_load_dwordx4 a[96:99], v178, s[8:11], s56 offen offset:0 sc1
    v_add_u32 v4, s26, v1
    s_lshl_b32 s26, s24, 8
    s_lshl_b32 s27, s25, 2
    s_add_u32 s26, s26, s27
    s_add_u32 s26, s26, 16416
    s_xor_b32 s27, s26, 256
    buffer_load_dwordx4 a[100:103], v178, s[8:11], s56 offen offset:1024 sc1
    v_mov_b32 v7, s27
    s_lshl_b32 s29, s29, 1
    s_add_u32 s26, s26, s29
    v_min_u32 v5, 1, v0
    v_lshl_add_u32 v5, v5, 28, s26
    s_add_u32 s16, s78, 0x2000000
    s_addc_u32 s17, s79, 0
    buffer_load_dwordx4 a[104:107], v178, s[8:11], s56 offen offset:2048 sc1
    s_mov_b32 s18, 0x2000000
    s_mov_b32 s19, 0x00020000
    s_add_u32 s12, s78, 0x420000
    s_addc_u32 s13, s79, 0
    s_mov_b32 s14, 0xe000
    s_mov_b32 s15, 0x00020000
    s_add_u32 s4, s78, 0x4400000
    s_addc_u32 s5, s79, 0
    buffer_load_dwordx4 a[108:111], v178, s[8:11], s56 offen offset:3072 sc1
    s_mov_b32 s6, 0x1c0000
    s_mov_b32 s7, 0x00020000
    v_lshrrev_b32 v22, 8, v1
    v_bfe_u32 v23, v1, 4, 4
    s_mul_i32 s26, s24, 1048576
    s_lshl_b32 s27, s3, 3
    s_mov_b32 s56, 49152
    buffer_load_dwordx4 a[112:115], v178, s[8:11], s56 offen offset:0 sc1
    s_add_u32 s27, s27, s25
    s_lshl_b32 s28, s27, 11
    s_add_u32 s28, s28, s26
    v_add_u32 v12, s28, v1
    v_lshl_add_u32 v17, v1, 3, s28
    s_lshl_b32 s27, s27, 7
    buffer_load_dwordx4 a[116:119], v178, s[8:11], s56 offen offset:1024 sc1
    s_add_u32 s27, s27, s26
    s_add_u32 s27, s27, 65536
    v_lshlrev_b32 v19, 28, v22
    v_lshl_add_u32 v13, v23, 3, v19
    v_add_u32 v13, s27, v13
    buffer_load_dwordx4 a[120:123], v178, s[8:11], s56 offen offset:2048 sc1
    v_mov_b32 v19, s27
    v_cmp_gt_u32 vcc, 256, v1
    s_mul_i32 s27, s30, 448
    v_lshl_add_u32 v18, v22, 4, s27
    v_cndmask_b32 v17, v19, v17, vcc
    v_and_b32 v19, 1, v23
    buffer_load_dwordx4 a[124:127], v178, s[8:11], s56 offen offset:3072 sc1
    v_mul_u32_u24 v19, 7168, v19
    v_lshrrev_b32 v3, 1, v23
    v_min_u32 v3, 6, v3
    v_lshl_add_u32 v19, v3, 6, v19
    v_add_u32 v18, v18, v19
    s_mul_i32 s26, s25, 229376
    s_mov_b32 s56, 53248
    buffer_load_dwordx4 v[240:243], v178, s[8:11], s56 offen offset:0 sc1
    s_mul_i32 s27, s3, 57344
    s_add_u32 s26, s26, s27
    v_add_u32 v15, s26, v1
    s_lshl_b32 s26, s24, 3
    s_add_u32 s26, s26, s25
    s_and_b32 s27, s26, 7
    buffer_load_dwordx4 v[244:247], v178, s[8:11], s56 offen offset:1024 sc1
    s_lshr_b32 s26, s26, 3
    s_lshl_b32 s26, s26, 6
    s_add_u32 s26, s26, s27
    s_lshl_b32 s26, s26, 2
    s_add_u32 s26, s26, 16384
    v_min_u32 v14, 1, v0
    buffer_load_dwordx4 v[248:251], v178, s[8:11], s56 offen offset:2048 sc1
    v_lshlrev_b32 v14, 28, v14
    v_add_u32 v14, s26, v14
    v_mov_b32 v2, 1
    buffer_load_dwordx4 v[252:255], v178, s[8:11], s56 offen offset:3072 sc1
    s_add_u32 s8, s78, 0x500000
    s_addc_u32 s9, s79, 0
    s_mov_b32 s10, 0x380000
    s_mov_b32 s11, 0x00020000
    s_waitcnt vmcnt(54) lgkmcnt(0)
    s_barrier
    buffer_store_dword v2, v21, s[60:63], 0 offen sc1
    s_waitcnt vmcnt(51)
    v_mfma_f32_16x16x32_bf16 v[96:99], v[144:147], v[192:195], 0
    v_mfma_f32_16x16x32_bf16 v[36:39], v[144:147], v[196:199], 0
    v_mfma_f32_16x16x32_bf16 v[40:43], v[144:147], v[200:203], 0
    v_mfma_f32_16x16x32_bf16 v[44:47], v[144:147], v[204:207], 0
    v_mfma_f32_16x16x32_bf16 v[100:103], v[148:151], v[192:195], 0
    v_mfma_f32_16x16x32_bf16 v[52:55], v[148:151], v[196:199], 0
    v_mfma_f32_16x16x32_bf16 v[56:59], v[148:151], v[200:203], 0
    v_mfma_f32_16x16x32_bf16 v[60:63], v[148:151], v[204:207], 0
    v_mfma_f32_16x16x32_bf16 v[104:107], v[152:155], v[192:195], 0
    v_mfma_f32_16x16x32_bf16 v[68:71], v[152:155], v[196:199], 0
    v_mfma_f32_16x16x32_bf16 v[72:75], v[152:155], v[200:203], 0
    v_mfma_f32_16x16x32_bf16 v[76:79], v[152:155], v[204:207], 0
    v_mfma_f32_16x16x32_bf16 v[108:111], v[156:159], v[192:195], 0
    v_mfma_f32_16x16x32_bf16 v[84:87], v[156:159], v[196:199], 0
    v_mfma_f32_16x16x32_bf16 v[88:91], v[156:159], v[200:203], 0
    v_mfma_f32_16x16x32_bf16 v[92:95], v[156:159], v[204:207], 0
    s_waitcnt vmcnt(47)
    v_mfma_f32_16x16x32_bf16 v[96:99], v[160:163], v[208:211], v[96:99]
    v_mfma_f32_16x16x32_bf16 v[36:39], v[160:163], v[212:215], v[36:39]
    v_mfma_f32_16x16x32_bf16 v[40:43], v[160:163], v[216:219], v[40:43]
    v_mfma_f32_16x16x32_bf16 v[44:47], v[160:163], v[220:223], v[44:47]
    v_mfma_f32_16x16x32_bf16 v[100:103], v[164:167], v[208:211], v[100:103]
    v_mfma_f32_16x16x32_bf16 v[52:55], v[164:167], v[212:215], v[52:55]
    v_mfma_f32_16x16x32_bf16 v[56:59], v[164:167], v[216:219], v[56:59]
    v_mfma_f32_16x16x32_bf16 v[60:63], v[164:167], v[220:223], v[60:63]
    v_mfma_f32_16x16x32_bf16 v[104:107], v[168:171], v[208:211], v[104:107]
    v_mfma_f32_16x16x32_bf16 v[68:71], v[168:171], v[212:215], v[68:71]
    v_mfma_f32_16x16x32_bf16 v[72:75], v[168:171], v[216:219], v[72:75]
    v_mfma_f32_16x16x32_bf16 v[76:79], v[168:171], v[220:223], v[76:79]
    v_mfma_f32_16x16x32_bf16 v[108:111], v[172:175], v[208:211], v[108:111]
    v_mfma_f32_16x16x32_bf16 v[84:87], v[172:175], v[212:215], v[84:87]
    v_mfma_f32_16x16x32_bf16 v[88:91], v[172:175], v[216:219], v[88:91]
    v_mfma_f32_16x16x32_bf16 v[92:95], v[172:175], v[220:223], v[92:95]
    s_waitcnt vmcnt(43)
    v_mfma_f32_16x16x32_bf16 v[96:99], a[224:227], v[224:227], v[96:99]
    v_mfma_f32_16x16x32_bf16 v[36:39], a[224:227], v[228:231], v[36:39]
    v_mfma_f32_16x16x32_bf16 v[40:43], a[224:227], v[232:235], v[40:43]
    v_mfma_f32_16x16x32_bf16 v[44:47], a[224:227], v[236:239], v[44:47]
    v_mfma_f32_16x16x32_bf16 v[100:103], a[228:231], v[224:227], v[100:103]
    v_mfma_f32_16x16x32_bf16 v[52:55], a[228:231], v[228:231], v[52:55]
    v_mfma_f32_16x16x32_bf16 v[56:59], a[228:231], v[232:235], v[56:59]
    v_mfma_f32_16x16x32_bf16 v[60:63], a[228:231], v[236:239], v[60:63]
    v_mfma_f32_16x16x32_bf16 v[104:107], a[232:235], v[224:227], v[104:107]
    v_mfma_f32_16x16x32_bf16 v[68:71], a[232:235], v[228:231], v[68:71]
    v_mfma_f32_16x16x32_bf16 v[72:75], a[232:235], v[232:235], v[72:75]
    v_mfma_f32_16x16x32_bf16 v[76:79], a[232:235], v[236:239], v[76:79]
    v_mfma_f32_16x16x32_bf16 v[108:111], a[236:239], v[224:227], v[108:111]
    v_mfma_f32_16x16x32_bf16 v[84:87], a[236:239], v[228:231], v[84:87]
    v_mfma_f32_16x16x32_bf16 v[88:91], a[236:239], v[232:235], v[88:91]
    v_mfma_f32_16x16x32_bf16 v[92:95], a[236:239], v[236:239], v[92:95]
    s_waitcnt vmcnt(39)
    v_mfma_f32_16x16x32_bf16 v[96:99], a[240:243], a[176:179], v[96:99]
    s_mov_b32 s57, 32768
    v_mfma_f32_16x16x32_bf16 v[36:39], a[240:243], a[180:183], v[36:39]
    buffer_load_dwordx4 v[192:195], v184, s[20:23], s57 offen sc1
    v_mfma_f32_16x16x32_bf16 v[40:43], a[240:243], a[184:187], v[40:43]
    v_mfma_f32_16x16x32_bf16 v[44:47], a[240:243], a[188:191], v[44:47]
    v_mfma_f32_16x16x32_bf16 v[100:103], a[244:247], a[176:179], v[100:103]
    buffer_load_dwordx4 v[196:199], v185, s[20:23], s57 offen sc1
    v_mfma_f32_16x16x32_bf16 v[52:55], a[244:247], a[180:183], v[52:55]
    v_mfma_f32_16x16x32_bf16 v[56:59], a[244:247], a[184:187], v[56:59]
    v_mfma_f32_16x16x32_bf16 v[60:63], a[244:247], a[188:191], v[60:63]
    v_mfma_f32_16x16x32_bf16 v[104:107], a[248:251], a[176:179], v[104:107]
    buffer_load_dwordx4 v[200:203], v186, s[20:23], s57 offen sc1
    v_mfma_f32_16x16x32_bf16 v[68:71], a[248:251], a[180:183], v[68:71]
    v_mfma_f32_16x16x32_bf16 v[72:75], a[248:251], a[184:187], v[72:75]
    v_mfma_f32_16x16x32_bf16 v[76:79], a[248:251], a[188:191], v[76:79]
    v_mfma_f32_16x16x32_bf16 v[108:111], a[252:255], a[176:179], v[108:111]
    buffer_load_dwordx4 v[204:207], v187, s[20:23], s57 offen sc1
    v_mfma_f32_16x16x32_bf16 v[84:87], a[252:255], a[180:183], v[84:87]
    v_mfma_f32_16x16x32_bf16 v[88:91], a[252:255], a[184:187], v[88:91]
    v_mfma_f32_16x16x32_bf16 v[92:95], a[252:255], a[188:191], v[92:95]
    s_waitcnt vmcnt(39)
    v_mfma_f32_16x16x32_bf16 v[96:99], a[0:3], a[192:195], v[96:99]
    s_mov_b32 s57, 36864
    v_mfma_f32_16x16x32_bf16 v[36:39], a[0:3], a[196:199], v[36:39]
    buffer_load_dwordx4 v[208:211], v184, s[20:23], s57 offen sc1
    v_mfma_f32_16x16x32_bf16 v[40:43], a[0:3], a[200:203], v[40:43]
    v_mfma_f32_16x16x32_bf16 v[44:47], a[0:3], a[204:207], v[44:47]
    v_mfma_f32_16x16x32_bf16 v[100:103], a[4:7], a[192:195], v[100:103]
    buffer_load_dwordx4 v[212:215], v185, s[20:23], s57 offen sc1
    v_mfma_f32_16x16x32_bf16 v[52:55], a[4:7], a[196:199], v[52:55]
    v_mfma_f32_16x16x32_bf16 v[56:59], a[4:7], a[200:203], v[56:59]
    v_mfma_f32_16x16x32_bf16 v[60:63], a[4:7], a[204:207], v[60:63]
    v_mfma_f32_16x16x32_bf16 v[104:107], a[8:11], a[192:195], v[104:107]
    buffer_load_dwordx4 v[216:219], v186, s[20:23], s57 offen sc1
    v_mfma_f32_16x16x32_bf16 v[68:71], a[8:11], a[196:199], v[68:71]
    v_mfma_f32_16x16x32_bf16 v[72:75], a[8:11], a[200:203], v[72:75]
    v_mfma_f32_16x16x32_bf16 v[76:79], a[8:11], a[204:207], v[76:79]
    v_mfma_f32_16x16x32_bf16 v[108:111], a[12:15], a[192:195], v[108:111]
    buffer_load_dwordx4 v[220:223], v187, s[20:23], s57 offen sc1
    v_mfma_f32_16x16x32_bf16 v[84:87], a[12:15], a[196:199], v[84:87]
    v_mfma_f32_16x16x32_bf16 v[88:91], a[12:15], a[200:203], v[88:91]
    v_mfma_f32_16x16x32_bf16 v[92:95], a[12:15], a[204:207], v[92:95]
    s_waitcnt vmcnt(39)
    v_mfma_f32_16x16x32_bf16 v[96:99], a[16:19], a[208:211], v[96:99]
    s_mov_b32 s57, 40960
    v_mfma_f32_16x16x32_bf16 v[36:39], a[16:19], a[212:215], v[36:39]
    buffer_load_dwordx4 v[224:227], v184, s[20:23], s57 offen sc1
    v_mfma_f32_16x16x32_bf16 v[40:43], a[16:19], a[216:219], v[40:43]
    v_mfma_f32_16x16x32_bf16 v[44:47], a[16:19], a[220:223], v[44:47]
    v_mfma_f32_16x16x32_bf16 v[100:103], a[20:23], a[208:211], v[100:103]
    buffer_load_dwordx4 v[228:231], v185, s[20:23], s57 offen sc1
    v_mfma_f32_16x16x32_bf16 v[52:55], a[20:23], a[212:215], v[52:55]
    v_mfma_f32_16x16x32_bf16 v[56:59], a[20:23], a[216:219], v[56:59]
    v_mfma_f32_16x16x32_bf16 v[60:63], a[20:23], a[220:223], v[60:63]
    v_mfma_f32_16x16x32_bf16 v[104:107], a[24:27], a[208:211], v[104:107]
    buffer_load_dwordx4 v[232:235], v186, s[20:23], s57 offen sc1
    v_mfma_f32_16x16x32_bf16 v[68:71], a[24:27], a[212:215], v[68:71]
    v_mfma_f32_16x16x32_bf16 v[72:75], a[24:27], a[216:219], v[72:75]
    v_mfma_f32_16x16x32_bf16 v[76:79], a[24:27], a[220:223], v[76:79]
    v_mfma_f32_16x16x32_bf16 v[108:111], a[28:31], a[208:211], v[108:111]
    buffer_load_dwordx4 v[236:239], v187, s[20:23], s57 offen sc1
    v_mfma_f32_16x16x32_bf16 v[84:87], a[28:31], a[212:215], v[84:87]
    v_mfma_f32_16x16x32_bf16 v[88:91], a[28:31], a[216:219], v[88:91]
    v_mfma_f32_16x16x32_bf16 v[92:95], a[28:31], a[220:223], v[92:95]
    s_waitcnt vmcnt(39)
    v_mfma_f32_16x16x32_bf16 v[96:99], a[128:131], v[112:115], v[96:99]
    s_mov_b32 s57, 45056
    v_mfma_f32_16x16x32_bf16 v[36:39], a[128:131], v[116:119], v[36:39]
    buffer_load_dwordx4 a[176:179], v184, s[20:23], s57 offen sc1
    v_mfma_f32_16x16x32_bf16 v[40:43], a[128:131], v[120:123], v[40:43]
    v_mfma_f32_16x16x32_bf16 v[44:47], a[128:131], v[124:127], v[44:47]
    v_mfma_f32_16x16x32_bf16 v[100:103], a[132:135], v[112:115], v[100:103]
    buffer_load_dwordx4 a[180:183], v185, s[20:23], s57 offen sc1
    v_mfma_f32_16x16x32_bf16 v[52:55], a[132:135], v[116:119], v[52:55]
    v_mfma_f32_16x16x32_bf16 v[56:59], a[132:135], v[120:123], v[56:59]
    v_mfma_f32_16x16x32_bf16 v[60:63], a[132:135], v[124:127], v[60:63]
    v_mfma_f32_16x16x32_bf16 v[104:107], a[136:139], v[112:115], v[104:107]
    buffer_load_dwordx4 a[184:187], v186, s[20:23], s57 offen sc1
    v_mfma_f32_16x16x32_bf16 v[68:71], a[136:139], v[116:119], v[68:71]
    v_mfma_f32_16x16x32_bf16 v[72:75], a[136:139], v[120:123], v[72:75]
    v_mfma_f32_16x16x32_bf16 v[76:79], a[136:139], v[124:127], v[76:79]
    v_mfma_f32_16x16x32_bf16 v[108:111], a[140:143], v[112:115], v[108:111]
    buffer_load_dwordx4 a[188:191], v187, s[20:23], s57 offen sc1
    v_mfma_f32_16x16x32_bf16 v[84:87], a[140:143], v[116:119], v[84:87]
    v_mfma_f32_16x16x32_bf16 v[88:91], a[140:143], v[120:123], v[88:91]
    v_mfma_f32_16x16x32_bf16 v[92:95], a[140:143], v[124:127], v[92:95]
    s_waitcnt vmcnt(39)
    v_mfma_f32_16x16x32_bf16 v[96:99], a[32:35], v[128:131], v[96:99]
    s_mov_b32 s57, 49152
    v_mfma_f32_16x16x32_bf16 v[36:39], a[32:35], v[132:135], v[36:39]
    buffer_load_dwordx4 a[192:195], v184, s[20:23], s57 offen sc1
    v_mfma_f32_16x16x32_bf16 v[40:43], a[32:35], v[136:139], v[40:43]
    v_mfma_f32_16x16x32_bf16 v[44:47], a[32:35], v[140:143], v[44:47]
    v_mfma_f32_16x16x32_bf16 v[100:103], a[36:39], v[128:131], v[100:103]
    buffer_load_dwordx4 a[196:199], v185, s[20:23], s57 offen sc1
    v_mfma_f32_16x16x32_bf16 v[52:55], a[36:39], v[132:135], v[52:55]
    v_mfma_f32_16x16x32_bf16 v[56:59], a[36:39], v[136:139], v[56:59]
    v_mfma_f32_16x16x32_bf16 v[60:63], a[36:39], v[140:143], v[60:63]
    v_mfma_f32_16x16x32_bf16 v[104:107], a[40:43], v[128:131], v[104:107]
    buffer_load_dwordx4 a[200:203], v186, s[20:23], s57 offen sc1
    v_mfma_f32_16x16x32_bf16 v[68:71], a[40:43], v[132:135], v[68:71]
    v_mfma_f32_16x16x32_bf16 v[72:75], a[40:43], v[136:139], v[72:75]
    v_mfma_f32_16x16x32_bf16 v[76:79], a[40:43], v[140:143], v[76:79]
    v_mfma_f32_16x16x32_bf16 v[108:111], a[44:47], v[128:131], v[108:111]
    buffer_load_dwordx4 a[204:207], v187, s[20:23], s57 offen sc1
    v_mfma_f32_16x16x32_bf16 v[84:87], a[44:47], v[132:135], v[84:87]
    v_mfma_f32_16x16x32_bf16 v[88:91], a[44:47], v[136:139], v[88:91]
    v_mfma_f32_16x16x32_bf16 v[92:95], a[44:47], v[140:143], v[92:95]
    s_waitcnt vmcnt(16)
    v_mfma_f32_16x16x32_bf16 v[96:99], a[48:51], v[192:195], v[96:99]
    s_mov_b32 s57, 53248
    v_mfma_f32_16x16x32_bf16 v[36:39], a[48:51], v[196:199], v[36:39]
    buffer_load_dwordx4 a[208:211], v184, s[20:23], s57 offen sc1
    v_mfma_f32_16x16x32_bf16 v[40:43], a[48:51], v[200:203], v[40:43]
    v_mfma_f32_16x16x32_bf16 v[44:47], a[48:51], v[204:207], v[44:47]
    buffer_load_dwordx4 a[212:215], v185, s[20:23], s57 offen sc1
    v_mfma_f32_16x16x32_bf16 v[100:103], a[52:55], v[192:195], v[100:103]
    v_mfma_f32_16x16x32_bf16 v[52:55], a[52:55], v[196:199], v[52:55]
    v_mfma_f32_16x16x32_bf16 v[56:59], a[52:55], v[200:203], v[56:59]
    buffer_load_dwordx4 a[216:219], v186, s[20:23], s57 offen sc1
    v_mfma_f32_16x16x32_bf16 v[60:63], a[52:55], v[204:207], v[60:63]
    v_mfma_f32_16x16x32_bf16 v[104:107], a[56:59], v[192:195], v[104:107]
    v_mfma_f32_16x16x32_bf16 v[68:71], a[56:59], v[196:199], v[68:71]
    buffer_load_dwordx4 a[220:223], v187, s[20:23], s57 offen sc1
    v_mfma_f32_16x16x32_bf16 v[72:75], a[56:59], v[200:203], v[72:75]
    v_mfma_f32_16x16x32_bf16 v[76:79], a[56:59], v[204:207], v[76:79]
    v_mfma_f32_16x16x32_bf16 v[108:111], a[60:63], v[192:195], v[108:111]
    s_lshr_b32 s26, s24, 1
    v_mfma_f32_16x16x32_bf16 v[84:87], a[60:63], v[196:199], v[84:87]
    s_lshl_b32 s27, s26, 9
    v_mfma_f32_16x16x32_bf16 v[88:91], a[60:63], v[200:203], v[88:91]
    s_add_u32 s27, s27, 16384
    v_mfma_f32_16x16x32_bf16 v[92:95], a[60:63], v[204:207], v[92:95]
    s_lshl_b32 s26, s26, 10
    s_add_u32 s26, s26, 24064
    v_cmp_gt_u32 vcc, 32, v1
    v_mov_b32 v176, s27
    v_mov_b32 v177, s26
    v_min_u32 v178, 80, v1
    v_cndmask_b32 v176, v177, v176, vcc
    v_lshl_add_u32 v176, v178, 4, v176
    buffer_load_dword v177, v176, s[60:63], 0 offen sc1
    s_waitcnt vmcnt(17)
    v_mfma_f32_16x16x32_bf16 v[96:99], a[64:67], v[208:211], v[96:99]
    s_mov_b32 s57, 57344
    v_mfma_f32_16x16x32_bf16 v[36:39], a[64:67], v[212:215], v[36:39]
    buffer_load_dwordx4 v[112:115], v184, s[20:23], s57 offen sc1
    v_mfma_f32_16x16x32_bf16 v[40:43], a[64:67], v[216:219], v[40:43]
    v_mfma_f32_16x16x32_bf16 v[44:47], a[64:67], v[220:223], v[44:47]
    buffer_load_dwordx4 v[116:119], v185, s[20:23], s57 offen sc1
    v_mfma_f32_16x16x32_bf16 v[100:103], a[68:71], v[208:211], v[100:103]
    v_mfma_f32_16x16x32_bf16 v[52:55], a[68:71], v[212:215], v[52:55]
    v_mfma_f32_16x16x32_bf16 v[56:59], a[68:71], v[216:219], v[56:59]
    buffer_load_dwordx4 v[120:123], v186, s[20:23], s57 offen sc1
    v_mfma_f32_16x16x32_bf16 v[60:63], a[68:71], v[220:223], v[60:63]
    v_mfma_f32_16x16x32_bf16 v[104:107], a[72:75], v[208:211], v[104:107]
    v_mfma_f32_16x16x32_bf16 v[68:71], a[72:75], v[212:215], v[68:71]
    buffer_load_dwordx4 v[124:127], v187, s[20:23], s57 offen sc1
    v_mfma_f32_16x16x32_bf16 v[72:75], a[72:75], v[216:219], v[72:75]
    v_mfma_f32_16x16x32_bf16 v[76:79], a[72:75], v[220:223], v[76:79]
    v_mfma_f32_16x16x32_bf16 v[108:111], a[76:79], v[208:211], v[108:111]
    buffer_load_dword v3, v20, s[60:63], 0 offen sc1
    v_mfma_f32_16x16x32_bf16 v[84:87], a[76:79], v[212:215], v[84:87]
    v_mfma_f32_16x16x32_bf16 v[88:91], a[76:79], v[216:219], v[88:91]
    v_mfma_f32_16x16x32_bf16 v[92:95], a[76:79], v[220:223], v[92:95]
    s_waitcnt vmcnt(18)
    v_mfma_f32_16x16x32_bf16 v[96:99], a[80:83], v[224:227], v[96:99]
    s_mov_b32 s57, 61440
    v_mfma_f32_16x16x32_bf16 v[36:39], a[80:83], v[228:231], v[36:39]
    buffer_load_dwordx4 v[128:131], v184, s[20:23], s57 offen sc1
    v_mfma_f32_16x16x32_bf16 v[40:43], a[80:83], v[232:235], v[40:43]
    v_mfma_f32_16x16x32_bf16 v[44:47], a[80:83], v[236:239], v[44:47]
    v_mfma_f32_16x16x32_bf16 v[100:103], a[84:87], v[224:227], v[100:103]
    buffer_load_dwordx4 v[132:135], v185, s[20:23], s57 offen sc1
    v_mfma_f32_16x16x32_bf16 v[52:55], a[84:87], v[228:231], v[52:55]
    v_mfma_f32_16x16x32_bf16 v[56:59], a[84:87], v[232:235], v[56:59]
    v_mfma_f32_16x16x32_bf16 v[60:63], a[84:87], v[236:239], v[60:63]
    v_mfma_f32_16x16x32_bf16 v[104:107], a[88:91], v[224:227], v[104:107]
    buffer_load_dwordx4 v[136:139], v186, s[20:23], s57 offen sc1
    v_mfma_f32_16x16x32_bf16 v[68:71], a[88:91], v[228:231], v[68:71]
    v_mfma_f32_16x16x32_bf16 v[72:75], a[88:91], v[232:235], v[72:75]
    v_mfma_f32_16x16x32_bf16 v[76:79], a[88:91], v[236:239], v[76:79]
    v_mfma_f32_16x16x32_bf16 v[108:111], a[92:95], v[224:227], v[108:111]
    buffer_load_dwordx4 v[140:143], v187, s[20:23], s57 offen sc1
    v_mfma_f32_16x16x32_bf16 v[84:87], a[92:95], v[228:231], v[84:87]
    v_mfma_f32_16x16x32_bf16 v[88:91], a[92:95], v[232:235], v[88:91]
    v_mfma_f32_16x16x32_bf16 v[92:95], a[92:95], v[236:239], v[92:95]
    s_waitcnt vmcnt(18)
    v_mfma_f32_16x16x32_bf16 v[96:99], a[96:99], a[176:179], v[96:99]
    buffer_load_dword v189, v188, s[60:63], 0 offen offset:1024 sc1
    v_mfma_f32_16x16x32_bf16 v[36:39], a[96:99], a[180:183], v[36:39]
    v_mfma_f32_16x16x32_bf16 v[40:43], a[96:99], a[184:187], v[40:43]
    v_mfma_f32_16x16x32_bf16 v[44:47], a[96:99], a[188:191], v[44:47]
    s_add_u32 m0, s59, 65536
    v_mfma_f32_16x16x32_bf16 v[100:103], a[100:103], a[176:179], v[100:103]
    s_mov_b32 s58, 0
    v_mfma_f32_16x16x32_bf16 v[52:55], a[100:103], a[180:183], v[52:55]
    buffer_load_dwordx4 v16, s[8:11], s58 offen offset:0 sc1 lds
    v_mfma_f32_16x16x32_bf16 v[56:59], a[100:103], a[184:187], v[56:59]
    buffer_load_dwordx4 v16, s[8:11], s58 offen offset:1024 sc1 lds
    v_mfma_f32_16x16x32_bf16 v[60:63], a[100:103], a[188:191], v[60:63]
    v_mfma_f32_16x16x32_bf16 v[104:107], a[104:107], a[176:179], v[104:107]
    v_mfma_f32_16x16x32_bf16 v[68:71], a[104:107], a[180:183], v[68:71]
    buffer_load_dwordx4 v16, s[8:11], s58 offen offset:2048 sc1 lds
    v_mfma_f32_16x16x32_bf16 v[72:75], a[104:107], a[184:187], v[72:75]
    v_mfma_f32_16x16x32_bf16 v[76:79], a[104:107], a[188:191], v[76:79]
    v_mfma_f32_16x16x32_bf16 v[108:111], a[108:111], a[176:179], v[108:111]
    buffer_load_dwordx4 v16, s[8:11], s58 offen offset:3072 sc1 lds
    v_mfma_f32_16x16x32_bf16 v[84:87], a[108:111], a[180:183], v[84:87]
    v_mfma_f32_16x16x32_bf16 v[88:91], a[108:111], a[184:187], v[88:91]
    v_mfma_f32_16x16x32_bf16 v[92:95], a[108:111], a[188:191], v[92:95]
    s_waitcnt vmcnt(9)
    v_cmp_ne_u32 vcc, 1, v3
    s_nop 4
    s_cbranch_vccnz L_spin7
L_back7:
    s_waitcnt vmcnt(19)
    v_mfma_f32_16x16x32_bf16 v[96:99], a[112:115], a[192:195], v[96:99]
    s_add_u32 m0, s59, 69632
    v_mfma_f32_16x16x32_bf16 v[36:39], a[112:115], a[196:199], v[36:39]
    s_mov_b32 s58, 4096
    v_mfma_f32_16x16x32_bf16 v[40:43], a[112:115], a[200:203], v[40:43]
    buffer_load_dwordx4 v16, s[8:11], s58 offen offset:0 sc1 lds
    v_mfma_f32_16x16x32_bf16 v[44:47], a[112:115], a[204:207], v[44:47]
    v_mfma_f32_16x16x32_bf16 v[100:103], a[116:119], a[192:195], v[100:103]
    buffer_load_dwordx4 v16, s[8:11], s58 offen offset:1024 sc1 lds
    v_mfma_f32_16x16x32_bf16 v[52:55], a[116:119], a[196:199], v[52:55]
    v_mfma_f32_16x16x32_bf16 v[56:59], a[116:119], a[200:203], v[56:59]
    v_mfma_f32_16x16x32_bf16 v[60:63], a[116:119], a[204:207], v[60:63]
    v_mfma_f32_16x16x32_bf16 v[104:107], a[120:123], a[192:195], v[104:107]
    buffer_load_dwordx4 v16, s[8:11], s58 offen offset:2048 sc1 lds
    v_mfma_f32_16x16x32_bf16 v[68:71], a[120:123], a[196:199], v[68:71]
    v_mfma_f32_16x16x32_bf16 v[72:75], a[120:123], a[200:203], v[72:75]
    v_mfma_f32_16x16x32_bf16 v[76:79], a[120:123], a[204:207], v[76:79]
    v_mfma_f32_16x16x32_bf16 v[108:111], a[124:127], a[192:195], v[108:111]
    buffer_load_dwordx4 v16, s[8:11], s58 offen offset:3072 sc1 lds
    v_mfma_f32_16x16x32_bf16 v[84:87], a[124:127], a[196:199], v[84:87]
    v_mfma_f32_16x16x32_bf16 v[88:91], a[124:127], a[200:203], v[88:91]
    v_mfma_f32_16x16x32_bf16 v[92:95], a[124:127], a[204:207], v[92:95]
    s_waitcnt vmcnt(19)
    v_mfma_f32_16x16x32_bf16 v[96:99], v[240:243], a[208:211], v[96:99]
    s_add_u32 m0, s59, 98304
    v_mfma_f32_16x16x32_bf16 v[36:39], v[240:243], a[212:215], v[36:39]
    s_mov_b32 s58, 32768
    v_mfma_f32_16x16x32_bf16 v[40:43], v[240:243], a[216:219], v[40:43]
    buffer_load_dwordx4 v16, s[8:11], s58 offen offset:0 sc1 lds
    v_mfma_f32_16x16x32_bf16 v[44:47], v[240:243], a[220:223], v[44:47]
    v_mfma_f32_16x16x32_bf16 v[100:103], v[244:247], a[208:211], v[100:103]
    buffer_load_dwordx4 v16, s[8:11], s58 offen offset:1024 sc1 lds
    v_mfma_f32_16x16x32_bf16 v[52:55], v[244:247], a[212:215], v[52:55]
    v_mfma_f32_16x16x32_bf16 v[56:59], v[244:247], a[216:219], v[56:59]
    v_mfma_f32_16x16x32_bf16 v[60:63], v[244:247], a[220:223], v[60:63]
    v_mfma_f32_16x16x32_bf16 v[104:107], v[248:251], a[208:211], v[104:107]
    buffer_load_dwordx4 v16, s[8:11], s58 offen offset:2048 sc1 lds
    v_mfma_f32_16x16x32_bf16 v[68:71], v[248:251], a[212:215], v[68:71]
    v_mfma_f32_16x16x32_bf16 v[72:75], v[248:251], a[216:219], v[72:75]
    v_mfma_f32_16x16x32_bf16 v[76:79], v[248:251], a[220:223], v[76:79]
    v_mfma_f32_16x16x32_bf16 v[108:111], v[252:255], a[208:211], v[108:111]
    buffer_load_dwordx4 v16, s[8:11], s58 offen offset:3072 sc1 lds
    v_mfma_f32_16x16x32_bf16 v[84:87], v[252:255], a[212:215], v[84:87]
    v_mfma_f32_16x16x32_bf16 v[88:91], v[252:255], a[216:219], v[88:91]
    v_mfma_f32_16x16x32_bf16 v[92:95], v[252:255], a[220:223], v[92:95]
    s_waitcnt vmcnt(12)
    v_cmp_ne_u32 vcc, 1, v189
    s_nop 4
    s_cbranch_vccnz L_spin4
L_back4:
    s_mov_b32 s57, 524288
    buffer_load_dwordx4 v[192:195], v184, s[20:23], s57 offen sc1
    buffer_load_dwordx4 v[196:199], v185, s[20:23], s57 offen sc1
    buffer_load_dwordx4 v[200:203], v186, s[20:23], s57 offen sc1
    buffer_load_dwordx4 v[204:207], v187, s[20:23], s57 offen sc1
    s_mov_b32 s57, 528384
    buffer_load_dwordx4 v[208:211], v184, s[20:23], s57 offen sc1
    buffer_load_dwordx4 v[212:215], v185, s[20:23], s57 offen sc1
    buffer_load_dwordx4 v[216:219], v186, s[20:23], s57 offen sc1
    buffer_load_dwordx4 v[220:223], v187, s[20:23], s57 offen sc1
    s_waitcnt vmcnt(21)
    v_mfma_f32_16x16x32_bf16 v[36:39], a[144:147], v[116:119], v[36:39]
    s_mov_b32 s57, 532480
    v_mfma_f32_16x16x32_bf16 v[52:55], a[148:151], v[116:119], v[52:55]
    buffer_load_dwordx4 v[224:227], v184, s[20:23], s57 offen sc1
    v_mfma_f32_16x16x32_bf16 v[68:71], a[152:155], v[116:119], v[68:71]
    v_mfma_f32_16x16x32_bf16 v[84:87], a[156:159], v[116:119], v[84:87]
    buffer_load_dwordx4 v[228:231], v185, s[20:23], s57 offen sc1
    v_mfma_f32_16x16x32_bf16 v[36:39], a[160:163], v[132:135], v[36:39]
    v_mfma_f32_16x16x32_bf16 v[52:55], a[164:167], v[132:135], v[52:55]
    buffer_load_dwordx4 v[232:235], v186, s[20:23], s57 offen sc1
    v_mfma_f32_16x16x32_bf16 v[68:71], a[168:171], v[132:135], v[68:71]
    v_mfma_f32_16x16x32_bf16 v[84:87], a[172:175], v[132:135], v[84:87]
    buffer_load_dwordx4 v[236:239], v187, s[20:23], s57 offen sc1
    v_mfma_f32_16x16x32_bf16 v[40:43], a[144:147], v[120:123], v[40:43]
    v_mfma_f32_16x16x32_bf16 v[56:59], a[148:151], v[120:123], v[56:59]
    s_mov_b32 s57, 536576
    v_mfma_f32_16x16x32_bf16 v[72:75], a[152:155], v[120:123], v[72:75]
    v_mfma_f32_16x16x32_bf16 v[88:91], a[156:159], v[120:123], v[88:91]
    buffer_load_dwordx4 a[176:179], v184, s[20:23], s57 offen sc1
    v_mfma_f32_16x16x32_bf16 v[40:43], a[160:163], v[136:139], v[40:43]
    ds_write_b128 v8, v[36:39] offset:0
    v_mfma_f32_16x16x32_bf16 v[56:59], a[164:167], v[136:139], v[56:59]
    ds_write_b128 v8, v[52:55] offset:1024
    v_mfma_f32_16x16x32_bf16 v[72:75], a[168:171], v[136:139], v[72:75]
    ds_write_b128 v8, v[68:71] offset:2048
    v_mfma_f32_16x16x32_bf16 v[88:91], a[172:175], v[136:139], v[88:91]
    ds_write_b128 v8, v[84:87] offset:3072
    v_mfma_f32_16x16x32_bf16 v[44:47], a[144:147], v[124:127], v[44:47]
    buffer_load_dwordx4 a[180:183], v185, s[20:23], s57 offen sc1
    v_mfma_f32_16x16x32_bf16 v[60:63], a[148:151], v[124:127], v[60:63]
    buffer_load_dwordx4 a[184:187], v186, s[20:23], s57 offen sc1
    v_mfma_f32_16x16x32_bf16 v[76:79], a[152:155], v[124:127], v[76:79]
    buffer_load_dwordx4 a[188:191], v187, s[20:23], s57 offen sc1
    v_mfma_f32_16x16x32_bf16 v[92:95], a[156:159], v[124:127], v[92:95]
    s_mov_b32 s57, 540672
    v_mfma_f32_16x16x32_bf16 v[44:47], a[160:163], v[140:143], v[44:47]
    ds_write_b128 v8, v[40:43] offset:4096
    v_mfma_f32_16x16x32_bf16 v[60:63], a[164:167], v[140:143], v[60:63]
    ds_write_b128 v8, v[56:59] offset:5120
    v_mfma_f32_16x16x32_bf16 v[76:79], a[168:171], v[140:143], v[76:79]
    ds_write_b128 v8, v[72:75] offset:6144
    v_mfma_f32_16x16x32_bf16 v[92:95], a[172:175], v[140:143], v[92:95]
    buffer_load_dwordx4 a[192:195], v184, s[20:23], s57 offen sc1
    v_mfma_f32_16x16x32_bf16 v[96:99], a[144:147], v[112:115], v[96:99]
    ds_write_b128 v8, v[88:91] offset:7168
    v_mfma_f32_16x16x32_bf16 v[100:103], a[148:151], v[112:115], v[100:103]
    buffer_load_dwordx4 a[196:199], v185, s[20:23], s57 offen sc1
    v_mfma_f32_16x16x32_bf16 v[104:107], a[152:155], v[112:115], v[104:107]
    buffer_load_dwordx4 a[200:203], v186, s[20:23], s57 offen sc1
    v_mfma_f32_16x16x32_bf16 v[108:111], a[156:159], v[112:115], v[108:111]
    buffer_load_dwordx4 a[204:207], v187, s[20:23], s57 offen sc1
    v_mfma_f32_16x16x32_bf16 v[96:99], a[160:163], v[128:131], v[96:99]
    ds_write_b128 v8, v[44:47] offset:8192
    v_mfma_f32_16x16x32_bf16 v[100:103], a[164:167], v[128:131], v[100:103]
    ds_write_b128 v8, v[60:63] offset:9216
    v_mfma_f32_16x16x32_bf16 v[104:107], a[168:171], v[128:131], v[104:107]
    ds_write_b128 v8, v[76:79] offset:10240
    v_mfma_f32_16x16x32_bf16 v[108:111], a[172:175], v[128:131], v[108:111]
    ds_write_b128 v8, v[92:95] offset:11264
    s_waitcnt lgkmcnt(0)
    s_barrier
    ds_read_b128 v[36:39], v9 offset:0
    ds_read_b128 v[52:55], v9 offset:1024
    ds_read_b128 v[68:71], v9 offset:2048
    ds_read_b128 v[84:87], v9 offset:3072
    ds_read_b128 v[40:43], v10 offset:4096
    ds_read_b128 v[56:59], v10 offset:5120
    ds_read_b128 v[72:75], v10 offset:6144
    ds_read_b128 v[88:91], v10 offset:7168
    ds_read_b128 v[44:47], v11 offset:8192
    ds_read_b128 v[60:63], v11 offset:9216
    ds_read_b128 v[76:79], v11 offset:10240
    ds_read_b128 v[92:95], v11 offset:11264
    s_waitcnt lgkmcnt(10)
    v_pk_add_f32 v[96:97], v[96:97], v[36:37]
    v_pk_add_f32 v[98:99], v[98:99], v[38:39]
    v_pk_add_f32 v[100:101], v[100:101], v[52:53]
    v_pk_add_f32 v[102:103], v[102:103], v[54:55]
    s_waitcnt lgkmcnt(8)
    v_pk_add_f32 v[104:105], v[104:105], v[68:69]
    v_pk_add_f32 v[106:107], v[106:107], v[70:71]
    v_pk_add_f32 v[108:109], v[108:109], v[84:85]
    v_pk_add_f32 v[110:111], v[110:111], v[86:87]
    s_waitcnt lgkmcnt(6)
    v_pk_add_f32 v[96:97], v[96:97], v[40:41]
    v_pk_add_f32 v[98:99], v[98:99], v[42:43]
    v_pk_add_f32 v[100:101], v[100:101], v[56:57]
    v_pk_add_f32 v[102:103], v[102:103], v[58:59]
    s_waitcnt lgkmcnt(4)
    v_pk_add_f32 v[104:105], v[104:105], v[72:73]
    v_pk_add_f32 v[106:107], v[106:107], v[74:75]
    v_pk_add_f32 v[108:109], v[108:109], v[88:89]
    v_pk_add_f32 v[110:111], v[110:111], v[90:91]
    s_waitcnt lgkmcnt(2)
    v_pk_add_f32 v[96:97], v[96:97], v[44:45]
    v_pk_add_f32 v[98:99], v[98:99], v[46:47]
    v_pk_add_f32 v[100:101], v[100:101], v[60:61]
    v_pk_add_f32 v[102:103], v[102:103], v[62:63]
    s_waitcnt lgkmcnt(0)
    v_pk_add_f32 v[104:105], v[104:105], v[76:77]
    v_pk_add_f32 v[106:107], v[106:107], v[78:79]
    v_pk_add_f32 v[108:109], v[108:109], v[92:93]
    v_pk_add_f32 v[110:111], v[110:111], v[94:95]
    buffer_store_dwordx4 v[96:99], v4, s[40:43], 0 offen offset:0
    buffer_store_dwordx4 v[100:103], v4, s[40:43], 0 offen offset:1024
    buffer_store_dwordx4 v[104:107], v4, s[40:43], 0 offen offset:2048
    buffer_store_dwordx4 v[108:111], v4, s[40:43], 0 offen offset:3072
    s_waitcnt vmcnt(20)
    v_mfma_f32_16x16x32_bf16 v[32:35], v[144:147], v[192:195], 0
    s_mov_b32 s57, 544768
    v_mfma_f32_16x16x32_bf16 v[36:39], v[144:147], v[196:199], 0
    buffer_load_dwordx4 a[208:211], v184, s[20:23], s57 offen sc1
    v_mfma_f32_16x16x32_bf16 v[40:43], v[144:147], v[200:203], 0
    v_mfma_f32_16x16x32_bf16 v[44:47], v[144:147], v[204:207], 0
    v_mfma_f32_16x16x32_bf16 v[48:51], v[148:151], v[192:195], 0
    buffer_load_dwordx4 a[212:215], v185, s[20:23], s57 offen sc1
    v_mfma_f32_16x16x32_bf16 v[52:55], v[148:151], v[196:199], 0
    v_mfma_f32_16x16x32_bf16 v[56:59], v[148:151], v[200:203], 0
    v_mfma_f32_16x16x32_bf16 v[60:63], v[148:151], v[204:207], 0
    v_mfma_f32_16x16x32_bf16 v[64:67], v[152:155], v[192:195], 0
    buffer_load_dwordx4 a[216:219], v186, s[20:23], s57 offen sc1
    v_mfma_f32_16x16x32_bf16 v[68:71], v[152:155], v[196:199], 0
    v_mfma_f32_16x16x32_bf16 v[72:75], v[152:155], v[200:203], 0
    v_mfma_f32_16x16x32_bf16 v[76:79], v[152:155], v[204:207], 0
    v_mfma_f32_16x16x32_bf16 v[80:83], v[156:159], v[192:195], 0
    buffer_load_dwordx4 a[220:223], v187, s[20:23], s57 offen sc1
    v_mfma_f32_16x16x32_bf16 v[84:87], v[156:159], v[196:199], 0
    v_mfma_f32_16x16x32_bf16 v[88:91], v[156:159], v[200:203], 0
    v_mfma_f32_16x16x32_bf16 v[92:95], v[156:159], v[204:207], 0
    s_waitcnt vmcnt(20)
    v_mfma_f32_16x16x32_bf16 v[32:35], v[160:163], v[208:211], v[32:35]
    s_mov_b32 s57, 548864
    v_mfma_f32_16x16x32_bf16 v[36:39], v[160:163], v[212:215], v[36:39]
    buffer_load_dwordx4 v[112:115], v184, s[20:23], s57 offen sc1
    v_mfma_f32_16x16x32_bf16 v[40:43], v[160:163], v[216:219], v[40:43]
    v_mfma_f32_16x16x32_bf16 v[44:47], v[160:163], v[220:223], v[44:47]
    v_mfma_f32_16x16x32_bf16 v[48:51], v[164:167], v[208:211], v[48:51]
    buffer_load_dwordx4 v[116:119], v185, s[20:23], s57 offen sc1
    v_mfma_f32_16x16x32_bf16 v[52:55], v[164:167], v[212:215], v[52:55]
    v_mfma_f32_16x16x32_bf16 v[56:59], v[164:167], v[216:219], v[56:59]
    v_mfma_f32_16x16x32_bf16 v[60:63], v[164:167], v[220:223], v[60:63]
    v_mfma_f32_16x16x32_bf16 v[64:67], v[168:171], v[208:211], v[64:67]
    buffer_load_dwordx4 v[120:123], v186, s[20:23], s57 offen sc1
    v_mfma_f32_16x16x32_bf16 v[68:71], v[168:171], v[212:215], v[68:71]
    v_mfma_f32_16x16x32_bf16 v[72:75], v[168:171], v[216:219], v[72:75]
    v_mfma_f32_16x16x32_bf16 v[76:79], v[168:171], v[220:223], v[76:79]
    v_mfma_f32_16x16x32_bf16 v[80:83], v[172:175], v[208:211], v[80:83]
    buffer_load_dwordx4 v[124:127], v187, s[20:23], s57 offen sc1
    v_mfma_f32_16x16x32_bf16 v[84:87], v[172:175], v[212:215], v[84:87]
    v_mfma_f32_16x16x32_bf16 v[88:91], v[172:175], v[216:219], v[88:91]
    v_mfma_f32_16x16x32_bf16 v[92:95], v[172:175], v[220:223], v[92:95]
    s_waitcnt vmcnt(8)
    s_barrier
    s_or_b32 s99, s98, s3
    s_cmp_eq_u32 s99, 0
    s_cbranch_scc1 L_wb4
    buffer_store_dword v2, v5, s[60:63], 0 offen
L_wbb4:
    s_waitcnt vmcnt(21)
    v_mfma_f32_16x16x32_bf16 v[32:35], a[224:227], v[224:227], v[32:35]
    s_mov_b32 s57, 552960
    v_mfma_f32_16x16x32_bf16 v[36:39], a[224:227], v[228:231], v[36:39]
    buffer_load_dwordx4 v[128:131], v184, s[20:23], s57 offen sc1
    v_mfma_f32_16x16x32_bf16 v[40:43], a[224:227], v[232:235], v[40:43]
    v_mfma_f32_16x16x32_bf16 v[44:47], a[224:227], v[236:239], v[44:47]
    v_mfma_f32_16x16x32_bf16 v[48:51], a[228:231], v[224:227], v[48:51]
    buffer_load_dwordx4 v[132:135], v185, s[20:23], s57 offen sc1
    v_mfma_f32_16x16x32_bf16 v[52:55], a[228:231], v[228:231], v[52:55]
    v_mfma_f32_16x16x32_bf16 v[56:59], a[228:231], v[232:235], v[56:59]
    v_mfma_f32_16x16x32_bf16 v[60:63], a[228:231], v[236:239], v[60:63]
    v_mfma_f32_16x16x32_bf16 v[64:67], a[232:235], v[224:227], v[64:67]
    buffer_load_dwordx4 v[136:139], v186, s[20:23], s57 offen sc1
    v_mfma_f32_16x16x32_bf16 v[68:71], a[232:235], v[228:231], v[68:71]
    v_mfma_f32_16x16x32_bf16 v[72:75], a[232:235], v[232:235], v[72:75]
    v_mfma_f32_16x16x32_bf16 v[76:79], a[232:235], v[236:239], v[76:79]
    v_mfma_f32_16x16x32_bf16 v[80:83], a[236:239], v[224:227], v[80:83]
    buffer_load_dwordx4 v[140:143], v187, s[20:23], s57 offen sc1
    v_mfma_f32_16x16x32_bf16 v[84:87], a[236:239], v[228:231], v[84:87]
    v_mfma_f32_16x16x32_bf16 v[88:91], a[236:239], v[232:235], v[88:91]
    v_mfma_f32_16x16x32_bf16 v[92:95], a[236:239], v[236:239], v[92:95]
    s_waitcnt vmcnt(21)
    v_mfma_f32_16x16x32_bf16 v[32:35], a[240:243], a[176:179], v[32:35]
    s_mov_b32 s57, 557056
    v_xor_b32 v4, 268435456, v4
    v_mfma_f32_16x16x32_bf16 v[36:39], a[240:243], a[180:183], v[36:39]
    buffer_load_dwordx4 v[192:195], v184, s[20:23], s57 offen sc1
    v_mfma_f32_16x16x32_bf16 v[40:43], a[240:243], a[184:187], v[40:43]
    v_mfma_f32_16x16x32_bf16 v[44:47], a[240:243], a[188:191], v[44:47]
    v_mfma_f32_16x16x32_bf16 v[48:51], a[244:247], a[176:179], v[48:51]
    buffer_load_dwordx4 v[196:199], v185, s[20:23], s57 offen sc1
    v_mfma_f32_16x16x32_bf16 v[52:55], a[244:247], a[180:183], v[52:55]
    v_mfma_f32_16x16x32_bf16 v[56:59], a[244:247], a[184:187], v[56:59]
    v_mfma_f32_16x16x32_bf16 v[60:63], a[244:247], a[188:191], v[60:63]
    v_xor_b32 v5, 536870912, v5
    v_mfma_f32_16x16x32_bf16 v[64:67], a[248:251], a[176:179], v[64:67]
    buffer_load_dwordx4 v[200:203], v186, s[20:23], s57 offen sc1
    v_mfma_f32_16x16x32_bf16 v[68:71], a[248:251], a[180:183], v[68:71]
    v_mfma_f32_16x16x32_bf16 v[72:75], a[248:251], a[184:187], v[72:75]
    v_mfma_f32_16x16x32_bf16 v[76:79], a[248:251], a[188:191], v[76:79]
    v_mfma_f32_16x16x32_bf16 v[80:83], a[252:255], a[176:179], v[80:83]
    buffer_load_dwordx4 v[204:207], v187, s[20:23], s57 offen sc1
    v_mfma_f32_16x16x32_bf16 v[84:87], a[252:255], a[180:183], v[84:87]
    v_mfma_f32_16x16x32_bf16 v[88:91], a[252:255], a[184:187], v[88:91]
    v_mfma_f32_16x16x32_bf16 v[92:95], a[252:255], a[188:191], v[92:95]
    s_waitcnt vmcnt(21)
    v_mfma_f32_16x16x32_bf16 v[32:35], a[0:3], a[192:195], v[32:35]
    s_mov_b32 s57, 561152
    v_mfma_f32_16x16x32_bf16 v[36:39], a[0:3], a[196:199], v[36:39]
    buffer_load_dwordx4 v[208:211], v184, s[20:23], s57 offen sc1
    v_mfma_f32_16x16x32_bf16 v[40:43], a[0:3], a[200:203], v[40:43]
    v_mfma_f32_16x16x32_bf16 v[44:47], a[0:3], a[204:207], v[44:47]
    v_mfma_f32_16x16x32_bf16 v[48:51], a[4:7], a[192:195], v[48:51]
    buffer_load_dwordx4 v[212:215], v185, s[20:23], s57 offen sc1
    v_mfma_f32_16x16x32_bf16 v[52:55], a[4:7], a[196:199], v[52:55]
    v_mfma_f32_16x16x32_bf16 v[56:59], a[4:7], a[200:203], v[56:59]
    v_mfma_f32_16x16x32_bf16 v[60:63], a[4:7], a[204:207], v[60:63]
    v_mfma_f32_16x16x32_bf16 v[64:67], a[8:11], a[192:195], v[64:67]
    buffer_load_dwordx4 v[216:219], v186, s[20:23], s57 offen sc1
    v_mfma_f32_16x16x32_bf16 v[68:71], a[8:11], a[196:199], v[68:71]
    v_mfma_f32_16x16x32_bf16 v[72:75], a[8:11], a[200:203], v[72:75]
    v_mfma_f32_16x16x32_bf16 v[76:79], a[8:11], a[204:207], v[76:79]
    v_mfma_f32_16x16x32_bf16 v[80:83], a[12:15], a[192:195], v[80:83]
    buffer_load_dwordx4 v[220:223], v187, s[20:23], s57 offen sc1
    v_mfma_f32_16x16x32_bf16 v[84:87], a[12:15], a[196:199], v[84:87]
    v_mfma_f32_16x16x32_bf16 v[88:91], a[12:15], a[200:203], v[88:91]
    v_mfma_f32_16x16x32_bf16 v[92:95], a[12:15], a[204:207], v[92:95]
    s_waitcnt vmcnt(17)
    v_mfma_f32_16x16x32_bf16 v[32:35], a[16:19], a[208:211], v[32:35]
    s_mov_b32 s57, 565248
    v_mfma_f32_16x16x32_bf16 v[36:39], a[16:19], a[212:215], v[36:39]
    buffer_load_dwordx4 v[224:227], v184, s[20:23], s57 offen sc1
    v_mfma_f32_16x16x32_bf16 v[40:43], a[16:19], a[216:219], v[40:43]
    v_mfma_f32_16x16x32_bf16 v[44:47], a[16:19], a[220:223], v[44:47]
    v_mfma_f32_16x16x32_bf16 v[48:51], a[20:23], a[208:211], v[48:51]
    buffer_load_dwordx4 v[228:231], v185, s[20:23], s57 offen sc1
    v_mfma_f32_16x16x32_bf16 v[52:55], a[20:23], a[212:215], v[52:55]
    v_mfma_f32_16x16x32_bf16 v[56:59], a[20:23], a[216:219], v[56:59]
    v_mfma_f32_16x16x32_bf16 v[60:63], a[20:23], a[220:223], v[60:63]
    v_mfma_f32_16x16x32_bf16 v[64:67], a[24:27], a[208:211], v[64:67]
    buffer_load_dwordx4 v[232:235], v186, s[20:23], s57 offen sc1
    v_mfma_f32_16x16x32_bf16 v[68:71], a[24:27], a[212:215], v[68:71]
    v_mfma_f32_16x16x32_bf16 v[72:75], a[24:27], a[216:219], v[72:75]
    v_mfma_f32_16x16x32_bf16 v[76:79], a[24:27], a[220:223], v[76:79]
    v_mfma_f32_16x16x32_bf16 v[80:83], a[28:31], a[208:211], v[80:83]
    buffer_load_dwordx4 v[236:239], v187, s[20:23], s57 offen sc1
    v_mfma_f32_16x16x32_bf16 v[84:87], a[28:31], a[212:215], v[84:87]
    v_mfma_f32_16x16x32_bf16 v[88:91], a[28:31], a[216:219], v[88:91]
    v_mfma_f32_16x16x32_bf16 v[92:95], a[28:31], a[220:223], v[92:95]
    s_waitcnt vmcnt(17)
    v_mfma_f32_16x16x32_bf16 v[32:35], a[128:131], v[112:115], v[32:35]
    s_mov_b32 s57, 569344
    v_mfma_f32_16x16x32_bf16 v[36:39], a[128:131], v[116:119], v[36:39]
    buffer_load_dwordx4 a[176:179], v184, s[20:23], s57 offen sc1
    v_mfma_f32_16x16x32_bf16 v[40:43], a[128:131], v[120:123], v[40:43]
    v_mfma_f32_16x16x32_bf16 v[44:47], a[128:131], v[124:127], v[44:47]
    v_mfma_f32_16x16x32_bf16 v[48:51], a[132:135], v[112:115], v[48:51]
    buffer_load_dwordx4 a[180:183], v185, s[20:23], s57 offen sc1
    v_mfma_f32_16x16x32_bf16 v[52:55], a[132:135], v[116:119], v[52:55]
    v_mfma_f32_16x16x32_bf16 v[56:59], a[132:135], v[120:123], v[56:59]
    v_mfma_f32_16x16x32_bf16 v[60:63], a[132:135], v[124:127], v[60:63]
    v_mfma_f32_16x16x32_bf16 v[64:67], a[136:139], v[112:115], v[64:67]
    buffer_load_dwordx4 a[184:187], v186, s[20:23], s57 offen sc1
    v_mfma_f32_16x16x32_bf16 v[68:71], a[136:139], v[116:119], v[68:71]
    v_mfma_f32_16x16x32_bf16 v[72:75], a[136:139], v[120:123], v[72:75]
    v_mfma_f32_16x16x32_bf16 v[76:79], a[136:139], v[124:127], v[76:79]
    v_mfma_f32_16x16x32_bf16 v[80:83], a[140:143], v[112:115], v[80:83]
    buffer_load_dwordx4 a[188:191], v187, s[20:23], s57 offen sc1
    v_mfma_f32_16x16x32_bf16 v[84:87], a[140:143], v[116:119], v[84:87]
    v_mfma_f32_16x16x32_bf16 v[88:91], a[140:143], v[120:123], v[88:91]
    v_mfma_f32_16x16x32_bf16 v[92:95], a[140:143], v[124:127], v[92:95]
    s_waitcnt vmcnt(16)
    v_mfma_f32_16x16x32_bf16 v[32:35], a[32:35], v[128:131], v[32:35]
    s_mov_b32 s57, 573440
    v_mfma_f32_16x16x32_bf16 v[36:39], a[32:35], v[132:135], v[36:39]
    buffer_load_dwordx4 a[192:195], v184, s[20:23], s57 offen sc1
    v_mfma_f32_16x16x32_bf16 v[40:43], a[32:35], v[136:139], v[40:43]
    v_mfma_f32_16x16x32_bf16 v[44:47], a[32:35], v[140:143], v[44:47]
    v_mfma_f32_16x16x32_bf16 v[48:51], a[36:39], v[128:131], v[48:51]
    buffer_load_dwordx4 a[196:199], v185, s[20:23], s57 offen sc1
    v_mfma_f32_16x16x32_bf16 v[52:55], a[36:39], v[132:135], v[52:55]
    v_mfma_f32_16x16x32_bf16 v[56:59], a[36:39], v[136:139], v[56:59]
    v_mfma_f32_16x16x32_bf16 v[60:63], a[36:39], v[140:143], v[60:63]
    v_mfma_f32_16x16x32_bf16 v[64:67], a[40:43], v[128:131], v[64:67]
    buffer_load_dwordx4 a[200:203], v186, s[20:23], s57 offen sc1
    v_mfma_f32_16x16x32_bf16 v[68:71], a[40:43], v[132:135], v[68:71]
    v_mfma_f32_16x16x32_bf16 v[72:75], a[40:43], v[136:139], v[72:75]
    v_mfma_f32_16x16x32_bf16 v[76:79], a[40:43], v[140:143], v[76:79]
    v_mfma_f32_16x16x32_bf16 v[80:83], a[44:47], v[128:131], v[80:83]
    buffer_load_dwordx4 a[204:207], v187, s[20:23], s57 offen sc1
    v_mfma_f32_16x16x32_bf16 v[84:87], a[44:47], v[132:135], v[84:87]
    v_mfma_f32_16x16x32_bf16 v[88:91], a[44:47], v[136:139], v[88:91]
    v_mfma_f32_16x16x32_bf16 v[92:95], a[44:47], v[140:143], v[92:95]
    s_waitcnt vmcnt(16)
    v_mfma_f32_16x16x32_bf16 v[32:35], a[48:51], v[192:195], v[32:35]
    s_mov_b32 s57, 577536
    v_mfma_f32_16x16x32_bf16 v[36:39], a[48:51], v[196:199], v[36:39]
    buffer_load_dwordx4 a[208:211], v184, s[20:23], s57 offen sc1
    v_mfma_f32_16x16x32_bf16 v[40:43], a[48:51], v[200:203], v[40:43]
    v_mfma_f32_16x16x32_bf16 v[44:47], a[48:51], v[204:207], v[44:47]
    v_mfma_f32_16x16x32_bf16 v[48:51], a[52:55], v[192:195], v[48:51]
    buffer_load_dwordx4 a[212:215], v185, s[20:23], s57 offen sc1
    v_mfma_f32_16x16x32_bf16 v[52:55], a[52:55], v[196:199], v[52:55]
    v_mfma_f32_16x16x32_bf16 v[56:59], a[52:55], v[200:203], v[56:59]
    v_mfma_f32_16x16x32_bf16 v[60:63], a[52:55], v[204:207], v[60:63]
    v_mfma_f32_16x16x32_bf16 v[64:67], a[56:59], v[192:195], v[64:67]
    buffer_load_dwordx4 a[216:219], v186, s[20:23], s57 offen sc1
    v_mfma_f32_16x16x32_bf16 v[68:71], a[56:59], v[196:199], v[68:71]
    v_mfma_f32_16x16x32_bf16 v[72:75], a[56:59], v[200:203], v[72:75]
    v_mfma_f32_16x16x32_bf16 v[76:79], a[56:59], v[204:207], v[76:79]
    v_mfma_f32_16x16x32_bf16 v[80:83], a[60:63], v[192:195], v[80:83]
    buffer_load_dwordx4 a[220:223], v187, s[20:23], s57 offen sc1
    v_mfma_f32_16x16x32_bf16 v[84:87], a[60:63], v[196:199], v[84:87]
    v_mfma_f32_16x16x32_bf16 v[88:91], a[60:63], v[200:203], v[88:91]
    v_mfma_f32_16x16x32_bf16 v[92:95], a[60:63], v[204:207], v[92:95]
    s_waitcnt vmcnt(16)
    v_mfma_f32_16x16x32_bf16 v[32:35], a[64:67], v[208:211], v[32:35]
    s_mov_b32 s57, 581632
    v_mfma_f32_16x16x32_bf16 v[36:39], a[64:67], v[212:215], v[36:39]
    buffer_load_dwordx4 v[112:115], v184, s[20:23], s57 offen sc1
    v_mfma_f32_16x16x32_bf16 v[40:43], a[64:67], v[216:219], v[40:43]
    v_mfma_f32_16x16x32_bf16 v[44:47], a[64:67], v[220:223], v[44:47]
    v_mfma_f32_16x16x32_bf16 v[48:51], a[68:71], v[208:211], v[48:51]
    buffer_load_dwordx4 v[116:119], v185, s[20:23], s57 offen sc1
    v_mfma_f32_16x16x32_bf16 v[52:55], a[68:71], v[212:215], v[52:55]
    v_mfma_f32_16x16x32_bf16 v[56:59], a[68:71], v[216:219], v[56:59]
    v_mfma_f32_16x16x32_bf16 v[60:63], a[68:71], v[220:223], v[60:63]
    v_mfma_f32_16x16x32_bf16 v[64:67], a[72:75], v[208:211], v[64:67]
    buffer_load_dwordx4 v[120:123], v186, s[20:23], s57 offen sc1
    v_mfma_f32_16x16x32_bf16 v[68:71], a[72:75], v[212:215], v[68:71]
    v_mfma_f32_16x16x32_bf16 v[72:75], a[72:75], v[216:219], v[72:75]
    v_mfma_f32_16x16x32_bf16 v[76:79], a[72:75], v[220:223], v[76:79]
    v_mfma_f32_16x16x32_bf16 v[80:83], a[76:79], v[208:211], v[80:83]
    buffer_load_dwordx4 v[124:127], v187, s[20:23], s57 offen sc1
    v_mfma_f32_16x16x32_bf16 v[84:87], a[76:79], v[212:215], v[84:87]
    v_mfma_f32_16x16x32_bf16 v[88:91], a[76:79], v[216:219], v[88:91]
    v_mfma_f32_16x16x32_bf16 v[92:95], a[76:79], v[220:223], v[92:95]
    s_waitcnt vmcnt(16)
    v_mfma_f32_16x16x32_bf16 v[32:35], a[80:83], v[224:227], v[32:35]
    s_mov_b32 s57, 585728
    v_mfma_f32_16x16x32_bf16 v[36:39], a[80:83], v[228:231], v[36:39]
    buffer_load_dwordx4 v[128:131], v184, s[20:23], s57 offen sc1
    v_mfma_f32_16x16x32_bf16 v[40:43], a[80:83], v[232:235], v[40:43]
    v_mfma_f32_16x16x32_bf16 v[44:47], a[80:83], v[236:239], v[44:47]
    v_mfma_f32_16x16x32_bf16 v[48:51], a[84:87], v[224:227], v[48:51]
    buffer_load_dwordx4 v[132:135], v185, s[20:23], s57 offen sc1
    v_mfma_f32_16x16x32_bf16 v[52:55], a[84:87], v[228:231], v[52:55]
    v_mfma_f32_16x16x32_bf16 v[56:59], a[84:87], v[232:235], v[56:59]
    v_mfma_f32_16x16x32_bf16 v[60:63], a[84:87], v[236:239], v[60:63]
    v_mfma_f32_16x16x32_bf16 v[64:67], a[88:91], v[224:227], v[64:67]
    buffer_load_dwordx4 v[136:139], v186, s[20:23], s57 offen sc1
    v_mfma_f32_16x16x32_bf16 v[68:71], a[88:91], v[228:231], v[68:71]
    v_mfma_f32_16x16x32_bf16 v[72:75], a[88:91], v[232:235], v[72:75]
    v_mfma_f32_16x16x32_bf16 v[76:79], a[88:91], v[236:239], v[76:79]
    v_mfma_f32_16x16x32_bf16 v[80:83], a[92:95], v[224:227], v[80:83]
    buffer_load_dwordx4 v[140:143], v187, s[20:23], s57 offen sc1
    v_mfma_f32_16x16x32_bf16 v[84:87], a[92:95], v[228:231], v[84:87]
    v_mfma_f32_16x16x32_bf16 v[88:91], a[92:95], v[232:235], v[88:91]
    v_mfma_f32_16x16x32_bf16 v[92:95], a[92:95], v[236:239], v[92:95]
    s_waitcnt vmcnt(16)
    v_mfma_f32_16x16x32_bf16 v[32:35], a[96:99], a[176:179], v[32:35]
    s_add_u32 m0, s59, 102400
    v_mfma_f32_16x16x32_bf16 v[36:39], a[96:99], a[180:183], v[36:39]
    s_mov_b32 s58, 36864
    v_mfma_f32_16x16x32_bf16 v[40:43], a[96:99], a[184:187], v[40:43]
    buffer_load_dwordx4 v16, s[8:11], s58 offen offset:0 sc1 lds
    v_mfma_f32_16x16x32_bf16 v[44:47], a[96:99], a[188:191], v[44:47]
    v_mfma_f32_16x16x32_bf16 v[48:51], a[100:103], a[176:179], v[48:51]
    buffer_load_dwordx4 v16, s[8:11], s58 offen offset:1024 sc1 lds
    v_mfma_f32_16x16x32_bf16 v[52:55], a[100:103], a[180:183], v[52:55]
    v_mfma_f32_16x16x32_bf16 v[56:59], a[100:103], a[184:187], v[56:59]
    v_mfma_f32_16x16x32_bf16 v[60:63], a[100:103], a[188:191], v[60:63]
    v_mfma_f32_16x16x32_bf16 v[64:67], a[104:107], a[176:179], v[64:67]
    buffer_load_dwordx4 v16, s[8:11], s58 offen offset:2048 sc1 lds
    v_mfma_f32_16x16x32_bf16 v[68:71], a[104:107], a[180:183], v[68:71]
    v_mfma_f32_16x16x32_bf16 v[72:75], a[104:107], a[184:187], v[72:75]
    v_mfma_f32_16x16x32_bf16 v[76:79], a[104:107], a[188:191], v[76:79]
    v_mfma_f32_16x16x32_bf16 v[80:83], a[108:111], a[176:179], v[80:83]
    buffer_load_dwordx4 v16, s[8:11], s58 offen offset:3072 sc1 lds
    v_mfma_f32_16x16x32_bf16 v[84:87], a[108:111], a[180:183], v[84:87]
    v_mfma_f32_16x16x32_bf16 v[88:91], a[108:111], a[184:187], v[88:91]
    v_mfma_f32_16x16x32_bf16 v[92:95], a[108:111], a[188:191], v[92:95]
    s_waitcnt vmcnt(16)
    v_mfma_f32_16x16x32_bf16 v[32:35], a[112:115], a[192:195], v[32:35]
    s_add_u32 m0, s59, 131072
    v_mfma_f32_16x16x32_bf16 v[36:39], a[112:115], a[196:199], v[36:39]
    s_mov_b32 s58, 65536
    v_mfma_f32_16x16x32_bf16 v[40:43], a[112:115], a[200:203], v[40:43]
    buffer_load_dwordx4 v16, s[8:11], s58 offen offset:0 sc1 lds
    v_mfma_f32_16x16x32_bf16 v[44:47], a[112:115], a[204:207], v[44:47]
    v_mfma_f32_16x16x32_bf16 v[48:51], a[116:119], a[192:195], v[48:51]
    buffer_load_dwordx4 v16, s[8:11], s58 offen offset:1024 sc1 lds
    v_mfma_f32_16x16x32_bf16 v[52:55], a[116:119], a[196:199], v[52:55]
    v_mfma_f32_16x16x32_bf16 v[56:59], a[116:119], a[200:203], v[56:59]
    v_mfma_f32_16x16x32_bf16 v[60:63], a[116:119], a[204:207], v[60:63]
    v_mfma_f32_16x16x32_bf16 v[64:67], a[120:123], a[192:195], v[64:67]
    buffer_load_dwordx4 v16, s[8:11], s58 offen offset:2048 sc1 lds
    v_mfma_f32_16x16x32_bf16 v[68:71], a[120:123], a[196:199], v[68:71]
    v_mfma_f32_16x16x32_bf16 v[72:75], a[120:123], a[200:203], v[72:75]
    v_mfma_f32_16x16x32_bf16 v[76:79], a[120:123], a[204:207], v[76:79]
    v_mfma_f32_16x16x32_bf16 v[80:83], a[124:127], a[192:195], v[80:83]
    buffer_load_dwordx4 v16, s[8:11], s58 offen offset:3072 sc1 lds
    v_mfma_f32_16x16x32_bf16 v[84:87], a[124:127], a[196:199], v[84:87]
    v_mfma_f32_16x16x32_bf16 v[88:91], a[124:127], a[200:203], v[88:91]
    v_mfma_f32_16x16x32_bf16 v[92:95], a[124:127], a[204:207], v[92:95]
    s_waitcnt vmcnt(16)
    v_mfma_f32_16x16x32_bf16 v[32:35], v[240:243], a[208:211], v[32:35]
    s_add_u32 m0, s59, 135168
    v_mfma_f32_16x16x32_bf16 v[36:39], v[240:243], a[212:215], v[36:39]
    s_mov_b32 s58, 69632
    v_mfma_f32_16x16x32_bf16 v[40:43], v[240:243], a[216:219], v[40:43]
    buffer_load_dwordx4 v16, s[8:11], s58 offen offset:0 sc1 lds
    v_mfma_f32_16x16x32_bf16 v[44:47], v[240:243], a[220:223], v[44:47]
    v_mfma_f32_16x16x32_bf16 v[48:51], v[244:247], a[208:211], v[48:51]
    buffer_load_dwordx4 v16, s[8:11], s58 offen offset:1024 sc1 lds
    v_mfma_f32_16x16x32_bf16 v[52:55], v[244:247], a[212:215], v[52:55]
    v_mfma_f32_16x16x32_bf16 v[56:59], v[244:247], a[216:219], v[56:59]
    v_mfma_f32_16x16x32_bf16 v[60:63], v[244:247], a[220:223], v[60:63]
    v_mfma_f32_16x16x32_bf16 v[64:67], v[248:251], a[208:211], v[64:67]
    buffer_load_dwordx4 v16, s[8:11], s58 offen offset:2048 sc1 lds
    v_mfma_f32_16x16x32_bf16 v[68:71], v[248:251], a[212:215], v[68:71]
    v_mfma_f32_16x16x32_bf16 v[72:75], v[248:251], a[216:219], v[72:75]
    v_mfma_f32_16x16x32_bf16 v[76:79], v[248:251], a[220:223], v[76:79]
    v_mfma_f32_16x16x32_bf16 v[80:83], v[252:255], a[208:211], v[80:83]
    buffer_load_dwordx4 v16, s[8:11], s58 offen offset:3072 sc1 lds
    v_mfma_f32_16x16x32_bf16 v[84:87], v[252:255], a[212:215], v[84:87]
    v_mfma_f32_16x16x32_bf16 v[88:91], v[252:255], a[216:219], v[88:91]
    v_mfma_f32_16x16x32_bf16 v[92:95], v[252:255], a[220:223], v[92:95]
    s_waitcnt vmcnt(12)
    v_mfma_f32_16x16x32_bf16 v[36:39], a[144:147], v[116:119], v[36:39]
    buffer_load_dword v19, v17, s[16:19], 0 offen sc1
    v_mfma_f32_16x16x32_bf16 v[52:55], a[148:151], v[116:119], v[52:55]
    v_mfma_f32_16x16x32_bf16 v[68:71], a[152:155], v[116:119], v[68:71]
    v_mfma_f32_16x16x32_bf16 v[84:87], a[156:159], v[116:119], v[84:87]
    s_mov_b32 s29, 0
    v_mfma_f32_16x16x32_bf16 v[36:39], a[160:163], v[132:135], v[36:39]
    v_mfma_f32_16x16x32_bf16 v[52:55], a[164:167], v[132:135], v[52:55]
    v_mfma_f32_16x16x32_bf16 v[68:71], a[168:171], v[132:135], v[68:71]
    buffer_load_dwordx4 v[160:163], v18, s[12:15], s29 offen sc1
    v_mfma_f32_16x16x32_bf16 v[84:87], a[172:175], v[132:135], v[84:87]
    v_mfma_f32_16x16x32_bf16 v[40:43], a[144:147], v[120:123], v[40:43]
    v_mfma_f32_16x16x32_bf16 v[56:59], a[148:151], v[120:123], v[56:59]
    s_mov_b32 s29, 14336
    v_mfma_f32_16x16x32_bf16 v[72:75], a[152:155], v[120:123], v[72:75]
    v_mfma_f32_16x16x32_bf16 v[88:91], a[156:159], v[120:123], v[88:91]
    v_mfma_f32_16x16x32_bf16 v[40:43], a[160:163], v[136:139], v[40:43]
    ds_write_b128 v8, v[36:39] offset:0
    v_mfma_f32_16x16x32_bf16 v[56:59], a[164:167], v[136:139], v[56:59]
    ds_write_b128 v8, v[52:55] offset:1024
    v_mfma_f32_16x16x32_bf16 v[72:75], a[168:171], v[136:139], v[72:75]
    ds_write_b128 v8, v[68:71] offset:2048
    v_mfma_f32_16x16x32_bf16 v[88:91], a[172:175], v[136:139], v[88:91]
    buffer_load_dwordx4 v[164:167], v18, s[12:15], s29 offen sc1
    v_mfma_f32_16x16x32_bf16 v[44:47], a[144:147], v[124:127], v[44:47]
    ds_write_b128 v8, v[84:87] offset:3072
    v_mfma_f32_16x16x32_bf16 v[60:63], a[148:151], v[124:127], v[60:63]
    s_mov_b32 s29, 28672
    v_mfma_f32_16x16x32_bf16 v[76:79], a[152:155], v[124:127], v[76:79]
    buffer_load_dwordx4 v[168:171], v18, s[12:15], s29 offen sc1
    v_mfma_f32_16x16x32_bf16 v[92:95], a[156:159], v[124:127], v[92:95]
    v_mfma_f32_16x16x32_bf16 v[44:47], a[160:163], v[140:143], v[44:47]
    ds_write_b128 v8, v[40:43] offset:4096
    v_mfma_f32_16x16x32_bf16 v[60:63], a[164:167], v[140:143], v[60:63]
    ds_write_b128 v8, v[56:59] offset:5120
    v_mfma_f32_16x16x32_bf16 v[76:79], a[168:171], v[140:143], v[76:79]
    ds_write_b128 v8, v[72:75] offset:6144
    v_mfma_f32_16x16x32_bf16 v[92:95], a[172:175], v[140:143], v[92:95]
    ds_write_b128 v8, v[88:91] offset:7168
    v_mfma_f32_16x16x32_bf16 v[32:35], a[144:147], v[112:115], v[32:35]
    s_mov_b32 s29, 43008
    v_mfma_f32_16x16x32_bf16 v[48:51], a[148:151], v[112:115], v[48:51]
    buffer_load_dwordx4 v[172:175], v18, s[12:15], s29 offen sc1
    v_mfma_f32_16x16x32_bf16 v[64:67], a[152:155], v[112:115], v[64:67]
    v_mfma_f32_16x16x32_bf16 v[80:83], a[156:159], v[112:115], v[80:83]
    v_mfma_f32_16x16x32_bf16 v[32:35], a[160:163], v[128:131], v[32:35]
    ds_write_b128 v8, v[44:47] offset:8192
    v_mfma_f32_16x16x32_bf16 v[48:51], a[164:167], v[128:131], v[48:51]
    ds_write_b128 v8, v[60:63] offset:9216
    v_mfma_f32_16x16x32_bf16 v[64:67], a[168:171], v[128:131], v[64:67]
    ds_write_b128 v8, v[76:79] offset:10240
    v_mfma_f32_16x16x32_bf16 v[80:83], a[172:175], v[128:131], v[80:83]
    ds_write_b128 v8, v[92:95] offset:11264
    s_waitcnt lgkmcnt(0)
    s_barrier
    ds_read_b128 v[36:39], v9 offset:0
    ds_read_b128 v[52:55], v9 offset:1024
    ds_read_b128 v[68:71], v9 offset:2048
    ds_read_b128 v[84:87], v9 offset:3072
    ds_read_b128 v[40:43], v10 offset:4096
    ds_read_b128 v[56:59], v10 offset:5120
    ds_read_b128 v[72:75], v10 offset:6144
    ds_read_b128 v[88:91], v10 offset:7168
    ds_read_b128 v[44:47], v11 offset:8192
    ds_read_b128 v[60:63], v11 offset:9216
    ds_read_b128 v[76:79], v11 offset:10240
    ds_read_b128 v[92:95], v11 offset:11264
    s_waitcnt lgkmcnt(10)
    v_pk_add_f32 v[32:33], v[32:33], v[36:37]
    v_pk_add_f32 v[34:35], v[34:35], v[38:39]
    v_pk_add_f32 v[48:49], v[48:49], v[52:53]
    v_pk_add_f32 v[50:51], v[50:51], v[54:55]
    s_waitcnt lgkmcnt(8)
    v_pk_add_f32 v[64:65], v[64:65], v[68:69]
    v_pk_add_f32 v[66:67], v[66:67], v[70:71]
    v_pk_add_f32 v[80:81], v[80:81], v[84:85]
    v_pk_add_f32 v[82:83], v[82:83], v[86:87]
    s_waitcnt lgkmcnt(6)
    v_pk_add_f32 v[32:33], v[32:33], v[40:41]
    v_pk_add_f32 v[34:35], v[34:35], v[42:43]
    v_pk_add_f32 v[48:49], v[48:49], v[56:57]
    v_pk_add_f32 v[50:51], v[50:51], v[58:59]
    s_waitcnt lgkmcnt(4)
    v_pk_add_f32 v[64:65], v[64:65], v[72:73]
    v_pk_add_f32 v[66:67], v[66:67], v[74:75]
    v_pk_add_f32 v[80:81], v[80:81], v[88:89]
    v_pk_add_f32 v[82:83], v[82:83], v[90:91]
    s_waitcnt lgkmcnt(2)
    v_pk_add_f32 v[32:33], v[32:33], v[44:45]
    v_pk_add_f32 v[34:35], v[34:35], v[46:47]
    v_pk_add_f32 v[48:49], v[48:49], v[60:61]
    v_pk_add_f32 v[50:51], v[50:51], v[62:63]
    s_waitcnt lgkmcnt(0)
    v_pk_add_f32 v[64:65], v[64:65], v[76:77]
    v_pk_add_f32 v[66:67], v[66:67], v[78:79]
    v_pk_add_f32 v[80:81], v[80:81], v[92:93]
    v_pk_add_f32 v[82:83], v[82:83], v[94:95]
    buffer_store_dwordx4 v[32:35], v4, s[40:43], 0 offen offset:0
    buffer_store_dwordx4 v[48:51], v4, s[40:43], 0 offen offset:1024
    buffer_store_dwordx4 v[64:67], v4, s[40:43], 0 offen offset:2048
    buffer_store_dwordx4 v[80:83], v4, s[40:43], 0 offen offset:3072
    v_permlane16_swap_b32 v24, v26
    v_permlane16_swap_b32 v25, v27
    v_permlane16_swap_b32 v28, v30
    v_permlane16_swap_b32 v29, v31
    s_nop 0
    v_lshlrev_b32 v36, 16, v24
    v_and_b32 v37, 0xffff0000, v24
    v_lshlrev_b32 v38, 16, v25
    v_and_b32 v39, 0xffff0000, v25
    v_lshlrev_b32 v52, 16, v26
    v_and_b32 v53, 0xffff0000, v26
    v_lshlrev_b32 v54, 16, v27
    v_and_b32 v55, 0xffff0000, v27
    v_lshlrev_b32 v68, 16, v28
    v_and_b32 v69, 0xffff0000, v28
    v_lshlrev_b32 v70, 16, v29
    v_and_b32 v71, 0xffff0000, v29
    v_lshlrev_b32 v84, 16, v30
    v_and_b32 v85, 0xffff0000, v30
    v_lshlrev_b32 v86, 16, v31
    v_and_b32 v87, 0xffff0000, v31
    s_waitcnt vmcnt(0)
    s_barrier
    s_or_b32 s99, s98, s3
    s_cmp_eq_u32 s99, 0
    s_cbranch_scc1 L_wb5
    buffer_store_dword v2, v5, s[60:63], 0 offen
L_wbb5:
    buffer_load_dword v3, v7, s[60:63], 0 offen sc1
    s_bitcmp1_b32 s24, 0
    s_cbranch_scc1 L_long
    v_mov_b64 v[32:33], v[96:97]
    v_mov_b64 v[34:35], v[98:99]
    v_mov_b64 v[48:49], v[100:101]
    v_mov_b64 v[50:51], v[102:103]
    v_mov_b64 v[64:65], v[104:105]
    v_mov_b64 v[66:67], v[106:107]
    v_mov_b64 v[80:81], v[108:109]
    v_mov_b64 v[82:83], v[110:111]
L_long:
    v_pk_add_f32 v[32:33], v[32:33], v[36:37]
    v_pk_add_f32 v[34:35], v[34:35], v[38:39]
    v_pk_add_f32 v[48:49], v[48:49], v[52:53]
    v_pk_add_f32 v[50:51], v[50:51], v[54:55]
    v_pk_add_f32 v[64:65], v[64:65], v[68:69]
    v_pk_add_f32 v[66:67], v[66:67], v[70:71]
    v_pk_add_f32 v[80:81], v[80:81], v[84:85]
    v_pk_add_f32 v[82:83], v[82:83], v[86:87]
    s_waitcnt vmcnt(0)
    v_cmp_ne_u32 vcc, 1, v3
    s_nop 4
    s_cbranch_vccnz L_spin8
L_back8:
    buffer_load_dwordx4 v[36:39], v6, s[40:43], 0 offen offset:0 sc1
    buffer_load_dwordx4 v[52:55], v6, s[40:43], 0 offen offset:1024 sc1
    buffer_load_dwordx4 v[68:71], v6, s[40:43], 0 offen offset:2048 sc1
    buffer_load_dwordx4 v[84:87], v6, s[40:43], 0 offen offset:3072 sc1
    s_waitcnt vmcnt(3)
    v_pk_add_f32 v[32:33], v[32:33], v[36:37]
    v_pk_add_f32 v[34:35], v[34:35], v[38:39]
    s_waitcnt vmcnt(2)
    v_pk_add_f32 v[48:49], v[48:49], v[52:53]
    v_pk_add_f32 v[50:51], v[50:51], v[54:55]
    s_waitcnt vmcnt(1)
    v_pk_add_f32 v[64:65], v[64:65], v[68:69]
    v_pk_add_f32 v[66:67], v[66:67], v[70:71]
    s_waitcnt vmcnt(0)
    v_pk_add_f32 v[80:81], v[80:81], v[84:85]
    v_pk_add_f32 v[82:83], v[82:83], v[86:87]
    v_cvt_pk_bf16_f32 v240, v32, v33
    v_cvt_pk_bf16_f32 v241, v34, v35
    v_cvt_pk_bf16_f32 v242, v48, v49
    v_cvt_pk_bf16_f32 v243, v50, v51
    v_cvt_pk_bf16_f32 v244, v64, v65
    v_cvt_pk_bf16_f32 v245, v66, v67
    v_cvt_pk_bf16_f32 v246, v80, v81
    v_cvt_pk_bf16_f32 v247, v82, v83
    buffer_store_dwordx4 v[240:243], v12, s[16:19], 0 offen offset:0
    buffer_store_dwordx4 v[244:247], v12, s[16:19], 0 offen offset:1024
    v_lshlrev_b32 v32, 16, v240
    v_and_b32 v33, 0xffff0000, v240
    v_lshlrev_b32 v34, 16, v241
    v_and_b32 v35, 0xffff0000, v241
    v_lshlrev_b32 v48, 16, v242
    v_and_b32 v49, 0xffff0000, v242
    v_lshlrev_b32 v50, 16, v243
    v_and_b32 v51, 0xffff0000, v243
    v_lshlrev_b32 v64, 16, v244
    v_and_b32 v65, 0xffff0000, v244
    v_lshlrev_b32 v66, 16, v245
    v_and_b32 v67, 0xffff0000, v245
    v_lshlrev_b32 v80, 16, v246
    v_and_b32 v81, 0xffff0000, v246
    v_lshlrev_b32 v82, 16, v247
    v_and_b32 v83, 0xffff0000, v247
    v_pk_add_f32 v[36:37], v[32:33], v[34:35]
    v_pk_add_f32 v[38:39], v[48:49], v[50:51]
    v_pk_add_f32 v[36:37], v[36:37], v[64:65]
    v_pk_add_f32 v[38:39], v[38:39], v[66:67]
    v_pk_add_f32 v[36:37], v[36:37], v[80:81]
    v_pk_add_f32 v[38:39], v[38:39], v[82:83]
    v_pk_add_f32 v[36:37], v[36:37], v[38:39]
    v_add_f32 v40, v36, v37
    v_mov_b32 v38, v40
    s_nop 1
    v_permlane32_swap_b32 v40, v38
    v_add_f32 v40, v40, v38
    v_mov_b32 v38, v40
    s_nop 1
    v_permlane16_swap_b32 v40, v38
    v_add_f32 v40, v40, v38
    v_mul_f32 v40, 0x3c800000, v40
    v_pk_add_f32 v[32:33], v[32:33], v[40:41] op_sel_hi:[1,0] neg_lo:[0,1] neg_hi:[0,1]
    v_pk_add_f32 v[34:35], v[34:35], v[40:41] op_sel_hi:[1,0] neg_lo:[0,1] neg_hi:[0,1]
    v_pk_add_f32 v[48:49], v[48:49], v[40:41] op_sel_hi:[1,0] neg_lo:[0,1] neg_hi:[0,1]
    v_pk_add_f32 v[50:51], v[50:51], v[40:41] op_sel_hi:[1,0] neg_lo:[0,1] neg_hi:[0,1]
    v_pk_add_f32 v[64:65], v[64:65], v[40:41] op_sel_hi:[1,0] neg_lo:[0,1] neg_hi:[0,1]
    v_pk_add_f32 v[66:67], v[66:67], v[40:41] op_sel_hi:[1,0] neg_lo:[0,1] neg_hi:[0,1]
    v_pk_add_f32 v[80:81], v[80:81], v[40:41] op_sel_hi:[1,0] neg_lo:[0,1] neg_hi:[0,1]
    v_pk_add_f32 v[82:83], v[82:83], v[40:41] op_sel_hi:[1,0] neg_lo:[0,1] neg_hi:[0,1]
    v_pk_mul_f32 v[36:37], v[32:33], v[32:33]
    v_pk_mul_f32 v[38:39], v[34:35], v[34:35]
    v_pk_fma_f32 v[36:37], v[48:49], v[48:49], v[36:37]
    v_pk_fma_f32 v[38:39], v[50:51], v[50:51], v[38:39]
    v_pk_fma_f32 v[36:37], v[64:65], v[64:65], v[36:37]
    v_pk_fma_f32 v[38:39], v[66:67], v[66:67], v[38:39]
    v_pk_fma_f32 v[36:37], v[80:81], v[80:81], v[36:37]
    v_pk_fma_f32 v[38:39], v[82:83], v[82:83], v[38:39]
    v_pk_add_f32 v[36:37], v[36:37], v[38:39]
    v_add_f32 v41, v36, v37
    v_mov_b32 v38, v41
    s_nop 1
    v_permlane32_swap_b32 v41, v38
    v_add_f32 v41, v41, v38
    v_mov_b32 v38, v41
    s_nop 1
    v_permlane16_swap_b32 v41, v38
    v_add_f32 v41, v41, v38
    buffer_store_dwordx2 v[40:41], v13, s[16:19], 0 offen
    s_lshr_b32 s26, s24, 1
    s_lshl_b32 s26, s26, 1
    s_lshr_b32 s27, s3, 1
    s_add_u32 s26, s26, s27
    s_lshl_b32 s27, s26, 8
    s_add_u32 s27, s27, 16384
    v_and_b32 v8, 0x70, v1
    v_lshrrev_b32 v8, 2, v8
    v_add_u32 v8, s27, v8
    s_mul_i32 s27, s26, 524288
    s_lshr_b32 s28, s30, 2
    s_mul_i32 s28, s28, 73728
    s_add_u32 s27, s27, s28
    s_lshr_b32 s28, s30, 1
    s_mul_i32 s28, s28, 28672
    s_add_u32 s27, s27, s28
    s_add_u32 s27, s27, 73728
    s_and_b32 s28, s3, 1
    s_lshl_b32 s29, s28, 11
    s_add_u32 s27, s27, s29
    v_add_u32 v7, s27, v1
    s_mul_i32 s26, s26, 1048576
    s_lshl_b32 s27, s28, 15
    s_add_u32 s27, s27, s26
    v_add_u32 v3, s27, v1
    s_add_u32 s27, s29, s26
    s_add_u32 s27, s27, 65536
    v_lshlrev_b32 v9, 3, v23
    v_lshl_add_u32 v9, v22, 8, v9
    v_add_u32 v9, s27, v9
    v_mov_b32 v4, v1
    v_add_u32 v5, 0x10000, v1
    v_add_u32 v6, 0x20000, v1
    s_and_b32 s31, s30, 1
    s_waitcnt vmcnt(0)
    s_barrier
    s_or_b32 s99, s98, s3
    s_cmp_eq_u32 s99, 0
    s_cbranch_scc1 L_wb1
    buffer_store_dword v2, v14, s[60:63], 0 offen
L_wbb1:
    buffer_load_dword v2, v8, s[60:63], 0 offen sc1
    ds_read_b128 a[128:131], v5 offset:0
    ds_read_b128 a[132:135], v5 offset:1024
    ds_read_b128 a[136:139], v5 offset:2048
    ds_read_b128 a[140:143], v5 offset:3072
    ds_read_b128 a[144:147], v5 offset:4096
    ds_read_b128 a[148:151], v5 offset:5120
    ds_read_b128 a[152:155], v5 offset:6144
    ds_read_b128 a[156:159], v5 offset:7168
    ds_read_b128 a[160:163], v5 offset:8192
    ds_read_b128 a[164:167], v5 offset:9216
    ds_read_b128 a[168:171], v5 offset:10240
    ds_read_b128 a[172:175], v5 offset:11264
    ds_read_b128 a[176:179], v5 offset:12288
    ds_read_b128 a[180:183], v5 offset:13312
    ds_read_b128 a[184:187], v5 offset:14336
    ds_read_b128 a[188:191], v5 offset:15360
    v_pk_add_f32 v[160:161], v[160:161], v[164:165]
    v_pk_add_f32 v[162:163], v[162:163], v[166:167]
    v_pk_add_f32 v[168:169], v[168:169], v[172:173]
    v_pk_add_f32 v[170:171], v[170:171], v[174:175]
    v_pk_add_f32 v[88:89], v[160:161], v[168:169]
    v_pk_add_f32 v[90:91], v[162:163], v[170:171]
    s_waitcnt vmcnt(0)
    v_cmp_ne_u32 vcc, 1, v2
    s_nop 4
    s_cbranch_vccnz L_spin5
L_back5:
    s_mov_b32 s29, 0
    buffer_load_dwordx4 a[0:3], v3, s[16:19], s29 offen offset:0 sc1
    buffer_load_dwordx4 a[4:7], v3, s[16:19], s29 offen offset:1024 sc1
    buffer_load_dwordx4 a[8:11], v3, s[16:19], s29 offen offset:2048 sc1
    buffer_load_dwordx4 a[12:15], v3, s[16:19], s29 offen offset:3072 sc1
    s_mov_b32 s29, 16384
    buffer_load_dwordx4 a[64:67], v3, s[16:19], s29 offen offset:0 sc1
    buffer_load_dwordx4 a[68:71], v3, s[16:19], s29 offen offset:1024 sc1
    buffer_load_dwordx4 a[72:75], v3, s[16:19], s29 offen offset:2048 sc1
    buffer_load_dwordx4 a[76:79], v3, s[16:19], s29 offen offset:3072 sc1
    s_mov_b32 s29, 4096
    buffer_load_dwordx4 a[16:19], v3, s[16:19], s29 offen offset:0 sc1
    buffer_load_dwordx4 a[20:23], v3, s[16:19], s29 offen offset:1024 sc1
    buffer_load_dwordx4 a[24:27], v3, s[16:19], s29 offen offset:2048 sc1
    buffer_load_dwordx4 a[28:31], v3, s[16:19], s29 offen offset:3072 sc1
    buffer_load_dwordx2 v[24:25], v9, s[16:19], 0 offen offset:0 sc1
    buffer_load_dwordx2 v[26:27], v9, s[16:19], 0 offen offset:128 sc1
    buffer_load_dwordx2 v[28:29], v9, s[16:19], 0 offen offset:1024 sc1
    buffer_load_dwordx2 v[30:31], v9, s[16:19], 0 offen offset:1152 sc1
    s_waitcnt vmcnt(12) lgkmcnt(0)
    v_mfma_f32_16x16x32_bf16 v[32:35], a[128:131], a[0:3], 0
    ds_read_b128 a[192:195], v5 offset:16384
    v_mfma_f32_16x16x32_bf16 v[32:35], a[136:139], a[4:7], v[32:35]
    ds_read_b128 a[196:199], v5 offset:17408
    v_mfma_f32_16x16x32_bf16 v[32:35], a[144:147], a[8:11], v[32:35]
    s_mov_b32 s29, 20480
    v_mfma_f32_16x16x32_bf16 v[32:35], a[152:155], a[12:15], v[32:35]
    ds_read_b128 a[200:203], v5 offset:18432
    v_mfma_f32_16x16x32_bf16 v[36:39], a[132:135], a[0:3], 0
    buffer_load_dwordx4 a[80:83], v3, s[16:19], s29 offen offset:0 sc1
    v_mfma_f32_16x16x32_bf16 v[36:39], a[140:143], a[4:7], v[36:39]
    ds_read_b128 a[204:207], v5 offset:19456
    v_mfma_f32_16x16x32_bf16 v[36:39], a[148:151], a[8:11], v[36:39]
    buffer_load_dwordx4 a[84:87], v3, s[16:19], s29 offen offset:1024 sc1
    v_mfma_f32_16x16x32_bf16 v[36:39], a[156:159], a[12:15], v[36:39]
    buffer_load_dwordx4 a[88:91], v3, s[16:19], s29 offen offset:2048 sc1
    buffer_load_dwordx4 a[92:95], v3, s[16:19], s29 offen offset:3072 sc1
    s_waitcnt vmcnt(12)
    v_mfma_f32_16x16x32_bf16 v[40:43], a[128:131], a[64:67], 0
    ds_read_b128 a[208:211], v5 offset:20480
    v_mfma_f32_16x16x32_bf16 v[40:43], a[136:139], a[68:71], v[40:43]
    ds_read_b128 a[212:215], v5 offset:21504
    v_mfma_f32_16x16x32_bf16 v[40:43], a[144:147], a[72:75], v[40:43]
    ds_read_b128 a[216:219], v5 offset:22528
    v_mfma_f32_16x16x32_bf16 v[40:43], a[152:155], a[76:79], v[40:43]
    ds_read_b128 a[220:223], v5 offset:23552
    v_mfma_f32_16x16x32_bf16 v[44:47], a[132:135], a[64:67], 0
    s_mov_b32 s29, 8192
    v_mfma_f32_16x16x32_bf16 v[44:47], a[140:143], a[68:71], v[44:47]
    ds_read_b128 a[224:227], v5 offset:24576
    v_mfma_f32_16x16x32_bf16 v[44:47], a[148:151], a[72:75], v[44:47]
    buffer_load_dwordx4 a[32:35], v3, s[16:19], s29 offen offset:0 sc1
    v_mfma_f32_16x16x32_bf16 v[44:47], a[156:159], a[76:79], v[44:47]
    buffer_load_dwordx4 a[36:39], v3, s[16:19], s29 offen offset:1024 sc1
    buffer_load_dwordx4 a[40:43], v3, s[16:19], s29 offen offset:2048 sc1
    buffer_load_dwordx4 a[44:47], v3, s[16:19], s29 offen offset:3072 sc1
    s_waitcnt vmcnt(8)
    v_mfma_f32_16x16x32_bf16 v[32:35], a[160:163], a[16:19], v[32:35]
    ds_read_b128 a[228:231], v5 offset:25600
    v_add_f32 v10, v24, v26
    v_mfma_f32_16x16x32_bf16 v[32:35], a[168:171], a[20:23], v[32:35]
    ds_read_b128 a[232:235], v5 offset:26624
    v_mov_b32 v22, v10
    v_mfma_f32_16x16x32_bf16 v[32:35], a[176:179], a[24:27], v[32:35]
    ds_read_b128 a[236:239], v5 offset:27648
    v_add_f32 v11, v28, v30
    v_mfma_f32_16x16x32_bf16 v[32:35], a[184:187], a[28:31], v[32:35]
    s_mov_b32 s29, 24576
    v_permlane32_swap_b32 v10, v22
    v_add_f32 v10, v10, v22
    v_mfma_f32_16x16x32_bf16 v[36:39], a[164:167], a[16:19], v[36:39]
    ds_read_b128 a[240:243], v5 offset:28672
    v_mov_b32 v22, v10
    v_mfma_f32_16x16x32_bf16 v[36:39], a[172:175], a[20:23], v[36:39]
    buffer_load_dwordx4 a[96:99], v3, s[16:19], s29 offen offset:0 sc1
    v_mfma_f32_16x16x32_bf16 v[36:39], a[180:183], a[24:27], v[36:39]
    buffer_load_dwordx4 a[100:103], v3, s[16:19], s29 offen offset:1024 sc1
    v_mfma_f32_16x16x32_bf16 v[36:39], a[188:191], a[28:31], v[36:39]
    buffer_load_dwordx4 a[104:107], v3, s[16:19], s29 offen offset:2048 sc1
    buffer_load_dwordx4 a[108:111], v3, s[16:19], s29 offen offset:3072 sc1
    s_waitcnt vmcnt(8)
    v_mfma_f32_16x16x32_bf16 v[40:43], a[160:163], a[80:83], v[40:43]
    ds_read_b128 a[244:247], v5 offset:29696
    v_permlane16_swap_b32 v10, v22
    v_mfma_f32_16x16x32_bf16 v[40:43], a[168:171], a[84:87], v[40:43]
    ds_read_b128 a[248:251], v5 offset:30720
    v_add_f32 v10, v10, v22
    v_mfma_f32_16x16x32_bf16 v[40:43], a[176:179], a[88:91], v[40:43]
    ds_read_b128 a[252:255], v5 offset:31744
    v_mul_f32 v10, 0xbe000000, v10
    v_mfma_f32_16x16x32_bf16 v[40:43], a[184:187], a[92:95], v[40:43]
    s_mov_b32 s29, 12288
    v_add_f32 v24, v24, v10
    v_add_f32 v26, v26, v10
    v_mfma_f32_16x16x32_bf16 v[44:47], a[164:167], a[80:83], v[44:47]
    buffer_load_dwordx4 a[48:51], v3, s[16:19], s29 offen offset:0 sc1
    v_mfma_f32_16x16x32_bf16 v[44:47], a[172:175], a[84:87], v[44:47]
    buffer_load_dwordx4 a[52:55], v3, s[16:19], s29 offen offset:1024 sc1
    v_mfma_f32_16x16x32_bf16 v[44:47], a[180:183], a[88:91], v[44:47]
    buffer_load_dwordx4 a[56:59], v3, s[16:19], s29 offen offset:2048 sc1
    v_mfma_f32_16x16x32_bf16 v[44:47], a[188:191], a[92:95], v[44:47]
    s_waitcnt vmcnt(7) lgkmcnt(0)
    s_barrier
    buffer_load_dwordx4 a[60:63], v3, s[16:19], s29 offen offset:3072 sc1
    v_mfma_f32_16x16x32_bf16 v[32:35], a[192:195], a[32:35], v[32:35]
    ds_read_b128 a[128:131], v5 offset:32768
    v_mul_f32 v24, v24, v24
    v_mfma_f32_16x16x32_bf16 v[32:35], a[200:203], a[36:39], v[32:35]
    ds_read_b128 a[132:135], v5 offset:33792
    v_fmac_f32 v24, v26, v26
    v_mfma_f32_16x16x32_bf16 v[32:35], a[208:211], a[40:43], v[32:35]
    s_mov_b32 s29, 28672
    v_add_f32 v25, v25, v27
    v_fmac_f32 v25, 0x42800000, v24
    v_mfma_f32_16x16x32_bf16 v[32:35], a[216:219], a[44:47], v[32:35]
    ds_read_b128 a[136:139], v5 offset:34816
    v_mov_b32 v22, v25
    v_mfma_f32_16x16x32_bf16 v[36:39], a[196:199], a[32:35], v[36:39]
    buffer_load_dwordx4 a[112:115], v3, s[16:19], s29 offen offset:0 sc1
    v_mfma_f32_16x16x32_bf16 v[36:39], a[204:207], a[36:39], v[36:39]
    ds_read_b128 a[140:143], v5 offset:35840
    v_permlane32_swap_b32 v25, v22
    v_mfma_f32_16x16x32_bf16 v[36:39], a[212:215], a[40:43], v[36:39]
    buffer_load_dwordx4 a[116:119], v3, s[16:19], s29 offen offset:1024 sc1
    v_mfma_f32_16x16x32_bf16 v[36:39], a[220:223], a[44:47], v[36:39]
    buffer_load_dwordx4 a[120:123], v3, s[16:19], s29 offen offset:2048 sc1
    buffer_load_dwordx4 a[124:127], v3, s[16:19], s29 offen offset:3072 sc1
    s_waitcnt vmcnt(8)
    v_mfma_f32_16x16x32_bf16 v[40:43], a[192:195], a[96:99], v[40:43]
    ds_read_b128 a[144:147], v5 offset:36864
    v_add_f32 v25, v25, v22
    v_mfma_f32_16x16x32_bf16 v[40:43], a[200:203], a[100:103], v[40:43]
    ds_read_b128 a[148:151], v5 offset:37888
    v_mov_b32 v22, v25
    v_mfma_f32_16x16x32_bf16 v[40:43], a[208:211], a[104:107], v[40:43]
    ds_read_b128 a[152:155], v5 offset:38912
    v_mov_b32 v23, v11
    v_mfma_f32_16x16x32_bf16 v[40:43], a[216:219], a[108:111], v[40:43]
    ds_read_b128 a[156:159], v5 offset:39936
    v_permlane16_swap_b32 v25, v22
    v_mfma_f32_16x16x32_bf16 v[44:47], a[196:199], a[96:99], v[44:47]
    v_add_f32 v25, v25, v22
    v_mov_b32 v20, 0x3727c5ac
    v_mfma_f32_16x16x32_bf16 v[44:47], a[204:207], a[100:103], v[44:47]
    ds_read_b128 a[160:163], v5 offset:40960
    v_fmac_f32 v20, 0x3b000000, v25
    v_mfma_f32_16x16x32_bf16 v[44:47], a[212:215], a[104:107], v[44:47]
    v_rsq_f32 v24, v20
    v_mfma_f32_16x16x32_bf16 v[44:47], a[220:223], a[108:111], v[44:47]
    s_waitcnt vmcnt(4)
    v_permlane32_swap_b32 v11, v23
    v_add_f32 v11, v11, v23
    v_mfma_f32_16x16x32_bf16 v[32:35], a[224:227], a[48:51], v[32:35]
    ds_read_b128 a[164:167], v5 offset:41984
    v_mul_f32 v12, 0xc0135761, v24
    v_mfma_f32_16x16x32_bf16 v[32:35], a[232:235], a[52:55], v[32:35]
    v_mul_f32 v26, v24, v24
    v_mul_f32 v26, v26, v24
    v_mfma_f32_16x16x32_bf16 v[32:35], a[240:243], a[56:59], v[32:35]
    v_mul_f32 v18, 0xbdd2d3e8, v26
    v_mov_b32 v23, v11
    v_mfma_f32_16x16x32_bf16 v[32:35], a[248:251], a[60:63], v[32:35]
    ds_read_b128 a[168:171], v5 offset:43008
    v_mfma_f32_16x16x32_bf16 v[36:39], a[228:231], a[48:51], v[36:39]
    ds_read_b128 a[172:175], v5 offset:44032
    v_permlane16_swap_b32 v11, v23
    v_add_f32 v11, v11, v23
    v_mul_f32 v11, 0xbe000000, v11
    v_add_f32 v28, v28, v11
    v_add_f32 v30, v30, v11
    v_mul_f32 v28, v28, v28
    v_fmac_f32 v28, v30, v30
    v_add_f32 v29, v29, v31
    v_fmac_f32 v29, 0x42800000, v28
    v_mov_b32 v23, v29
    v_mfma_f32_16x16x32_bf16 v[36:39], a[236:239], a[52:55], v[36:39]
    ds_read_b128 a[176:179], v5 offset:45056
    v_mul_f32_dpp v48, v88, v10 row_newbcast:2 row_mask:0xf bank_mask:0xf
    v_mfma_f32_16x16x32_bf16 v[36:39], a[244:247], a[56:59], v[36:39]
    v_permlane32_swap_b32 v29, v23
    v_add_f32 v29, v29, v23
    v_mov_b32 v23, v29
    v_mfma_f32_16x16x32_bf16 v[36:39], a[252:255], a[60:63], v[36:39]
    s_waitcnt vmcnt(0)
    v_mul_f32_dpp v49, v89, v10 row_newbcast:2 row_mask:0xf bank_mask:0xf
    v_mul_f32_dpp v50, v90, v10 row_newbcast:2 row_mask:0xf bank_mask:0xf
    v_mfma_f32_16x16x32_bf16 v[40:43], a[224:227], a[112:115], v[40:43]
    ds_read_b128 a[180:183], v5 offset:46080
    v_permlane16_swap_b32 v29, v23
    v_add_f32 v29, v29, v23
    v_mov_b32 v21, 0x3727c5ac
    v_fmac_f32 v21, 0x3b000000, v29
    v_rsq_f32 v28, v21
    v_mfma_f32_16x16x32_bf16 v[40:43], a[232:235], a[116:119], v[40:43]
    ds_read_b128 a[184:187], v5 offset:47104
    v_mul_f32_dpp v51, v91, v10 row_newbcast:2 row_mask:0xf bank_mask:0xf
    v_mfma_f32_16x16x32_bf16 v[40:43], a[240:243], a[120:123], v[40:43]
    v_mul_f32 v13, 0xc0135761, v28
    v_mul_f32 v30, v28, v28
    v_mul_f32 v30, v30, v28
    v_mul_f32 v19, 0xbdd2d3e8, v30
    v_mfma_f32_16x16x32_bf16 v[40:43], a[248:251], a[124:127], v[40:43]
    ds_read_b128 a[188:191], v5 offset:48128
    v_mul_f32_dpp v52, v88, v10 row_newbcast:3 row_mask:0xf bank_mask:0xf
    v_mfma_f32_16x16x32_bf16 v[44:47], a[228:231], a[112:115], v[44:47]
    v_mul_f32_dpp v53, v89, v10 row_newbcast:3 row_mask:0xf bank_mask:0xf
    v_mul_f32_dpp v54, v90, v10 row_newbcast:3 row_mask:0xf bank_mask:0xf
    v_mfma_f32_16x16x32_bf16 v[44:47], a[236:239], a[116:119], v[44:47]
    v_mul_f32_dpp v55, v91, v10 row_newbcast:3 row_mask:0xf bank_mask:0xf
    v_mul_f32_dpp v56, v88, v11 row_newbcast:2 row_mask:0xf bank_mask:0xf
    v_mul_f32_dpp v57, v89, v11 row_newbcast:2 row_mask:0xf bank_mask:0xf
    v_mul_f32_dpp v58, v90, v11 row_newbcast:2 row_mask:0xf bank_mask:0xf
    v_mul_f32_dpp v59, v91, v11 row_newbcast:2 row_mask:0xf bank_mask:0xf
    v_mul_f32_dpp v60, v88, v11 row_newbcast:3 row_mask:0xf bank_mask:0xf
    v_mul_f32_dpp v61, v89, v11 row_newbcast:3 row_mask:0xf bank_mask:0xf
    v_mul_f32_dpp v62, v90, v11 row_newbcast:3 row_mask:0xf bank_mask:0xf
    v_mul_f32_dpp v63, v91, v11 row_newbcast:3 row_mask:0xf bank_mask:0xf
    v_mfma_f32_16x16x32_bf16 v[44:47], a[244:247], a[120:123], v[44:47]
    v_mfma_f32_16x16x32_bf16 v[44:47], a[252:255], a[124:127], v[44:47]
    s_waitcnt lgkmcnt(0)
    v_mfma_f32_16x16x32_bf16 v[48:51], a[128:131], a[0:3], v[48:51]
    ds_read_b128 a[192:195], v5 offset:49152
    v_mfma_f32_16x16x32_bf16 v[48:51], a[136:139], a[4:7], v[48:51]
    ds_read_b128 a[196:199], v5 offset:50176
    v_mfma_f32_16x16x32_bf16 v[48:51], a[144:147], a[8:11], v[48:51]
    s_add_u32 m0, s59, 0
    v_mfma_f32_16x16x32_bf16 v[48:51], a[152:155], a[12:15], v[48:51]
    ds_read_b128 a[200:203], v5 offset:51200
    v_fmac_f32_dpp v32, v88, v10 row_newbcast:0 row_mask:0xf bank_mask:0xf
    v_fmac_f32_dpp v33, v89, v10 row_newbcast:0 row_mask:0xf bank_mask:0xf
    v_mfma_f32_16x16x32_bf16 v[48:51], a[160:163], a[16:19], v[48:51]
    s_mov_b32 s58, 98304
    v_fmac_f32_dpp v34, v90, v10 row_newbcast:0 row_mask:0xf bank_mask:0xf
    v_fmac_f32_dpp v35, v91, v10 row_newbcast:0 row_mask:0xf bank_mask:0xf
    v_mfma_f32_16x16x32_bf16 v[48:51], a[168:171], a[20:23], v[48:51]
    ds_read_b128 a[204:207], v5 offset:52224
    v_fmac_f32_dpp v36, v88, v10 row_newbcast:1 row_mask:0xf bank_mask:0xf
    v_fmac_f32_dpp v37, v89, v10 row_newbcast:1 row_mask:0xf bank_mask:0xf
    v_mfma_f32_16x16x32_bf16 v[48:51], a[176:179], a[24:27], v[48:51]
    ds_read_b128 a[208:211], v5 offset:53248
    v_fmac_f32_dpp v38, v90, v10 row_newbcast:1 row_mask:0xf bank_mask:0xf
    v_fmac_f32_dpp v39, v91, v10 row_newbcast:1 row_mask:0xf bank_mask:0xf
    v_mfma_f32_16x16x32_bf16 v[48:51], a[184:187], a[28:31], v[48:51]
    buffer_load_dwordx4 v16, s[8:11], s58 offen offset:0 sc1 lds
    v_fmac_f32_dpp v40, v88, v11 row_newbcast:0 row_mask:0xf bank_mask:0xf
    v_mfma_f32_16x16x32_bf16 v[52:55], a[132:135], a[0:3], v[52:55]
    v_fmac_f32_dpp v41, v89, v11 row_newbcast:0 row_mask:0xf bank_mask:0xf
    v_fmac_f32_dpp v42, v90, v11 row_newbcast:0 row_mask:0xf bank_mask:0xf
    v_fmac_f32_dpp v43, v91, v11 row_newbcast:0 row_mask:0xf bank_mask:0xf
    v_mfma_f32_16x16x32_bf16 v[52:55], a[140:143], a[4:7], v[52:55]
    ds_read_b128 a[212:215], v5 offset:54272
    v_fmac_f32_dpp v44, v88, v11 row_newbcast:1 row_mask:0xf bank_mask:0xf
    v_fmac_f32_dpp v45, v89, v11 row_newbcast:1 row_mask:0xf bank_mask:0xf
    v_mfma_f32_16x16x32_bf16 v[52:55], a[148:151], a[8:11], v[52:55]
    buffer_load_dwordx4 v16, s[8:11], s58 offen offset:1024 sc1 lds
    v_fmac_f32_dpp v46, v90, v11 row_newbcast:1 row_mask:0xf bank_mask:0xf
    v_mfma_f32_16x16x32_bf16 v[52:55], a[156:159], a[12:15], v[52:55]
    ds_read_b128 a[216:219], v5 offset:55296
    v_fmac_f32_dpp v47, v91, v11 row_newbcast:1 row_mask:0xf bank_mask:0xf
    v_mul_f32 v64, v32, v32
    v_mfma_f32_16x16x32_bf16 v[52:55], a[164:167], a[16:19], v[52:55]
    ds_read_b128 a[220:223], v5 offset:56320
    v_mul_f32 v65, v33, v33
    v_fma_f32 v64, v64, v18, v12
    v_mfma_f32_16x16x32_bf16 v[52:55], a[172:175], a[20:23], v[52:55]
    buffer_load_dwordx4 v16, s[8:11], s58 offen offset:2048 sc1 lds
    v_fma_f32 v65, v65, v18, v12
    v_mfma_f32_16x16x32_bf16 v[52:55], a[180:183], a[24:27], v[52:55]
    ds_read_b128 a[224:227], v5 offset:57344
    v_mul_f32 v64, v64, v32
    v_mul_f32 v65, v65, v33
    v_mfma_f32_16x16x32_bf16 v[52:55], a[188:191], a[28:31], v[52:55]
    buffer_load_dwordx4 v16, s[8:11], s58 offen offset:3072 sc1 lds
    v_exp_f32 v64, v64
    v_mfma_f32_16x16x32_bf16 v[56:59], a[128:131], a[64:67], v[56:59]
    ds_read_b128 a[228:231], v5 offset:58368
    v_exp_f32 v65, v65
    v_mfma_f32_16x16x32_bf16 v[56:59], a[136:139], a[68:71], v[56:59]
    s_add_u32 m0, s59, 4096
    v_mul_f32 v32, v32, v36
    v_mul_f32 v33, v33, v37
    v_fma_f32 v64, v64, v20, v20
    v_mfma_f32_16x16x32_bf16 v[56:59], a[144:147], a[72:75], v[56:59]
    ds_read_b128 a[232:235], v5 offset:59392
    v_fma_f32 v65, v65, v20, v20
    v_mfma_f32_16x16x32_bf16 v[56:59], a[152:155], a[76:79], v[56:59]
    ds_read_b128 a[236:239], v5 offset:60416
    v_rcp_f32 v64, v64
    v_mfma_f32_16x16x32_bf16 v[56:59], a[160:163], a[80:83], v[56:59]
    s_mov_b32 s58, 102400
    v_rcp_f32 v65, v65
    v_mul_f32 v64, v64, v32
    v_mfma_f32_16x16x32_bf16 v[56:59], a[168:171], a[84:87], v[56:59]
    ds_read_b128 a[240:243], v5 offset:61440
    v_mul_f32 v65, v65, v33
    v_cvt_pk_bf16_f32 v74, v64, v65
    v_mfma_f32_16x16x32_bf16 v[56:59], a[176:179], a[88:91], v[56:59]
    buffer_load_dwordx4 v16, s[8:11], s58 offen offset:0 sc1 lds
    v_mul_f32 v66, v34, v34
    v_mfma_f32_16x16x32_bf16 v[56:59], a[184:187], a[92:95], v[56:59]
    ds_read_b128 a[244:247], v5 offset:62464
    v_mul_f32 v67, v35, v35
    v_fma_f32 v66, v66, v18, v12
    v_mfma_f32_16x16x32_bf16 v[60:63], a[132:135], a[64:67], v[60:63]
    ds_read_b128 a[248:251], v5 offset:63488
    v_fma_f32 v67, v67, v18, v12
    v_mul_f32 v66, v66, v34
    v_mfma_f32_16x16x32_bf16 v[60:63], a[140:143], a[68:71], v[60:63]
    buffer_load_dwordx4 v16, s[8:11], s58 offen offset:1024 sc1 lds
    v_mul_f32 v67, v67, v35
    v_exp_f32 v66, v66
    v_mfma_f32_16x16x32_bf16 v[60:63], a[148:151], a[72:75], v[60:63]
    ds_read_b128 a[252:255], v5 offset:64512
    v_exp_f32 v67, v67
    v_mfma_f32_16x16x32_bf16 v[60:63], a[156:159], a[76:79], v[60:63]
    buffer_load_dwordx4 v16, s[8:11], s58 offen offset:2048 sc1 lds
    v_mul_f32 v34, v34, v38
    v_mfma_f32_16x16x32_bf16 v[60:63], a[164:167], a[80:83], v[60:63]
    v_mul_f32 v35, v35, v39
    v_fma_f32 v66, v66, v20, v20
    v_fma_f32 v67, v67, v20, v20
    v_mfma_f32_16x16x32_bf16 v[60:63], a[172:175], a[84:87], v[60:63]
    buffer_load_dwordx4 v16, s[8:11], s58 offen offset:3072 sc1 lds
    v_rcp_f32 v66, v66
    v_mfma_f32_16x16x32_bf16 v[60:63], a[180:183], a[88:91], v[60:63]
    v_rcp_f32 v67, v67
    v_mul_f32 v66, v66, v34
    v_mfma_f32_16x16x32_bf16 v[60:63], a[188:191], a[92:95], v[60:63]
    s_waitcnt vmcnt(63) lgkmcnt(0)
    s_barrier
    v_mul_f32 v67, v67, v35
    v_cvt_pk_bf16_f32 v75, v66, v67
    v_mfma_f32_16x16x32_bf16 v[48:51], a[192:195], a[32:35], v[48:51]
    ds_read_b128 a[128:131], v6 offset:0
    v_mul_f32 v68, v40, v40
    v_mul_f32 v69, v41, v41
    v_mfma_f32_16x16x32_bf16 v[48:51], a[200:203], a[36:39], v[48:51]
    ds_read_b128 a[132:135], v6 offset:1024
    v_fma_f32 v68, v68, v19, v13
    v_fma_f32 v69, v69, v19, v13
    v_mfma_f32_16x16x32_bf16 v[48:51], a[208:211], a[40:43], v[48:51]
    s_add_u32 m0, s59, 32768
    v_mul_f32 v68, v68, v40
    v_mul_f32 v69, v69, v41
    v_mfma_f32_16x16x32_bf16 v[48:51], a[216:219], a[44:47], v[48:51]
    ds_read_b128 a[136:139], v6 offset:2048
    v_exp_f32 v68, v68
    v_mfma_f32_16x16x32_bf16 v[48:51], a[224:227], a[48:51], v[48:51]
    s_mov_b32 s58, 131072
    v_exp_f32 v69, v69
    v_mfma_f32_16x16x32_bf16 v[48:51], a[232:235], a[52:55], v[48:51]
    ds_read_b128 a[140:143], v6 offset:3072
    v_mul_f32 v40, v40, v44
    v_mul_f32 v41, v41, v45
    v_mfma_f32_16x16x32_bf16 v[48:51], a[240:243], a[56:59], v[48:51]
    ds_read_b128 a[144:147], v6 offset:4096
    v_fma_f32 v68, v68, v21, v21
    v_fma_f32 v69, v69, v21, v21
    v_mfma_f32_16x16x32_bf16 v[48:51], a[248:251], a[60:63], v[48:51]
    buffer_load_dwordx4 v16, s[8:11], s58 offen offset:0 sc1 lds
    v_mfma_f32_16x16x32_bf16 v[52:55], a[196:199], a[32:35], v[52:55]
    ds_read_b128 a[148:151], v6 offset:5120
    v_rcp_f32 v68, v68
    v_mfma_f32_16x16x32_bf16 v[52:55], a[204:207], a[36:39], v[52:55]
    v_rcp_f32 v69, v69
    v_mul_f32 v68, v68, v40
    v_mfma_f32_16x16x32_bf16 v[52:55], a[212:215], a[40:43], v[52:55]
    buffer_load_dwordx4 v16, s[8:11], s58 offen offset:1024 sc1 lds
    v_mul_f32 v69, v69, v41
    v_mfma_f32_16x16x32_bf16 v[52:55], a[220:223], a[44:47], v[52:55]
    ds_read_b128 a[152:155], v6 offset:6144
    v_cvt_pk_bf16_f32 v78, v68, v69
    v_mul_f32 v70, v42, v42
    v_mfma_f32_16x16x32_bf16 v[52:55], a[228:231], a[48:51], v[52:55]
    ds_read_b128 a[156:159], v6 offset:7168
    v_mul_f32 v71, v43, v43
    v_fma_f32 v70, v70, v19, v13
    v_mfma_f32_16x16x32_bf16 v[52:55], a[236:239], a[52:55], v[52:55]
    buffer_load_dwordx4 v16, s[8:11], s58 offen offset:2048 sc1 lds
    v_fma_f32 v71, v71, v19, v13
    v_mul_f32 v70, v70, v42
    v_mfma_f32_16x16x32_bf16 v[52:55], a[244:247], a[56:59], v[52:55]
    v_mul_f32 v71, v71, v43
    v_exp_f32 v70, v70
    v_mfma_f32_16x16x32_bf16 v[52:55], a[252:255], a[60:63], v[52:55]
    ds_read_b128 a[160:163], v6 offset:8192
    buffer_load_dwordx4 v16, s[8:11], s58 offen offset:3072 sc1 lds
    v_exp_f32 v71, v71
    v_mfma_f32_16x16x32_bf16 v[56:59], a[192:195], a[96:99], v[56:59]
    ds_read_b128 a[164:167], v6 offset:9216
    v_mul_f32 v42, v42, v46
    v_mul_f32 v43, v43, v47
    v_mfma_f32_16x16x32_bf16 v[56:59], a[200:203], a[100:103], v[56:59]
    s_add_u32 m0, s59, 36864
    v_fma_f32 v70, v70, v21, v21
    v_fma_f32 v71, v71, v21, v21
    v_mfma_f32_16x16x32_bf16 v[56:59], a[208:211], a[104:107], v[56:59]
    ds_read_b128 a[168:171], v6 offset:10240
    v_rcp_f32 v70, v70
    v_mfma_f32_16x16x32_bf16 v[56:59], a[216:219], a[108:111], v[56:59]
    ds_read_b128 a[172:175], v6 offset:11264
    v_rcp_f32 v71, v71
    v_mfma_f32_16x16x32_bf16 v[56:59], a[224:227], a[112:115], v[56:59]
    s_mov_b32 s58, 135168
    v_mul_f32 v70, v70, v42
    v_mul_f32 v71, v71, v43
    v_cvt_pk_bf16_f32 v79, v70, v71
    v_mfma_f32_16x16x32_bf16 v[56:59], a[232:235], a[116:119], v[56:59]
    ds_read_b128 a[176:179], v6 offset:12288
    v_mfma_f32_16x16x32_bf16 v[56:59], a[240:243], a[120:123], v[56:59]
    buffer_load_dwordx4 v16, s[8:11], s58 offen offset:0 sc1 lds
    s_lshl_b32 s57, s31, 3
    buffer_store_dwordx2 v[74:75], v7, s[20:23], s57 offen offset:0
    buffer_store_dwordx2 v[78:79], v7, s[20:23], s57 offen offset:1024
    v_mul_f32_dpp v32, v88, v10 row_newbcast:4 row_mask:0xf bank_mask:0xf
    v_mul_f32_dpp v33, v89, v10 row_newbcast:4 row_mask:0xf bank_mask:0xf
    v_mfma_f32_16x16x32_bf16 v[56:59], a[248:251], a[124:127], v[56:59]
    ds_read_b128 a[180:183], v6 offset:13312
    v_mul_f32_dpp v34, v90, v10 row_newbcast:4 row_mask:0xf bank_mask:0xf
    v_mul_f32_dpp v35, v91, v10 row_newbcast:4 row_mask:0xf bank_mask:0xf
    v_mfma_f32_16x16x32_bf16 v[60:63], a[196:199], a[96:99], v[60:63]
    ds_read_b128 a[184:187], v6 offset:14336
    v_mul_f32_dpp v36, v88, v10 row_newbcast:5 row_mask:0xf bank_mask:0xf
    v_mul_f32_dpp v37, v89, v10 row_newbcast:5 row_mask:0xf bank_mask:0xf
    v_mfma_f32_16x16x32_bf16 v[60:63], a[204:207], a[100:103], v[60:63]
    buffer_load_dwordx4 v16, s[8:11], s58 offen offset:1024 sc1 lds
    v_mul_f32_dpp v38, v90, v10 row_newbcast:5 row_mask:0xf bank_mask:0xf
    v_mul_f32_dpp v39, v91, v10 row_newbcast:5 row_mask:0xf bank_mask:0xf
    v_mfma_f32_16x16x32_bf16 v[60:63], a[212:215], a[104:107], v[60:63]
    ds_read_b128 a[188:191], v6 offset:15360
    v_mul_f32_dpp v40, v88, v11 row_newbcast:4 row_mask:0xf bank_mask:0xf
    v_mul_f32_dpp v41, v89, v11 row_newbcast:4 row_mask:0xf bank_mask:0xf
    v_mfma_f32_16x16x32_bf16 v[60:63], a[220:223], a[108:111], v[60:63]
    buffer_load_dwordx4 v16, s[8:11], s58 offen offset:2048 sc1 lds
    v_mul_f32_dpp v42, v90, v11 row_newbcast:4 row_mask:0xf bank_mask:0xf
    v_mul_f32_dpp v43, v91, v11 row_newbcast:4 row_mask:0xf bank_mask:0xf
    v_mfma_f32_16x16x32_bf16 v[60:63], a[228:231], a[112:115], v[60:63]
    v_mul_f32_dpp v44, v88, v11 row_newbcast:5 row_mask:0xf bank_mask:0xf
    v_mul_f32_dpp v45, v89, v11 row_newbcast:5 row_mask:0xf bank_mask:0xf
    v_mul_f32_dpp v46, v90, v11 row_newbcast:5 row_mask:0xf bank_mask:0xf
    v_mfma_f32_16x16x32_bf16 v[60:63], a[236:239], a[116:119], v[60:63]
    buffer_load_dwordx4 v16, s[8:11], s58 offen offset:3072 sc1 lds
    v_mul_f32_dpp v47, v91, v11 row_newbcast:5 row_mask:0xf bank_mask:0xf
    v_mfma_f32_16x16x32_bf16 v[60:63], a[244:247], a[120:123], v[60:63]
    v_mfma_f32_16x16x32_bf16 v[60:63], a[252:255], a[124:127], v[60:63]
    s_waitcnt lgkmcnt(0)
    v_mfma_f32_16x16x32_bf16 v[32:35], a[128:131], a[0:3], v[32:35]
    ds_read_b128 a[192:195], v6 offset:16384
    v_mfma_f32_16x16x32_bf16 v[32:35], a[136:139], a[4:7], v[32:35]
    ds_read_b128 a[196:199], v6 offset:17408
    v_mfma_f32_16x16x32_bf16 v[32:35], a[144:147], a[8:11], v[32:35]
    s_add_u32 m0, s59, 65536
    v_mfma_f32_16x16x32_bf16 v[32:35], a[152:155], a[12:15], v[32:35]
    ds_read_b128 a[200:203], v6 offset:18432
    v_mul_f32 v64, v48, v48
    v_mul_f32 v65, v49, v49
    v_mfma_f32_16x16x32_bf16 v[32:35], a[160:163], a[16:19], v[32:35]
    s_mov_b32 s58, 163840
    v_fma_f32 v64, v64, v18, v12
    v_fma_f32 v65, v65, v18, v12
    v_mfma_f32_16x16x32_bf16 v[32:35], a[168:171], a[20:23], v[32:35]
    ds_read_b128 a[204:207], v6 offset:19456
    v_mul_f32 v64, v64, v48
    v_mul_f32 v65, v65, v49
    v_mfma_f32_16x16x32_bf16 v[32:35], a[176:179], a[24:27], v[32:35]
    ds_read_b128 a[208:211], v6 offset:20480
    v_exp_f32 v64, v64
    v_mfma_f32_16x16x32_bf16 v[32:35], a[184:187], a[28:31], v[32:35]
    buffer_load_dwordx4 v16, s[8:11], s58 offen offset:0 sc1 lds
    v_mfma_f32_16x16x32_bf16 v[36:39], a[132:135], a[0:3], v[36:39]
    s_lshl_b32 s26, s24, 3
    v_exp_f32 v65, v65
    v_mul_f32 v48, v48, v52
    v_mfma_f32_16x16x32_bf16 v[36:39], a[140:143], a[4:7], v[36:39]
    ds_read_b128 a[212:215], v6 offset:21504
    v_mul_f32 v49, v49, v53
    v_fma_f32 v64, v64, v20, v20
    v_mfma_f32_16x16x32_bf16 v[36:39], a[148:151], a[8:11], v[36:39]
    buffer_load_dwordx4 v16, s[8:11], s58 offen offset:1024 sc1 lds
    v_fma_f32 v65, v65, v20, v20
    v_mfma_f32_16x16x32_bf16 v[36:39], a[156:159], a[12:15], v[36:39]
    s_add_u32 s26, s26, s25
    v_rcp_f32 v64, v64
    v_mfma_f32_16x16x32_bf16 v[36:39], a[164:167], a[16:19], v[36:39]
    ds_read_b128 a[216:219], v6 offset:22528
    v_rcp_f32 v65, v65
    v_mfma_f32_16x16x32_bf16 v[36:39], a[172:175], a[20:23], v[36:39]
    ds_read_b128 a[220:223], v6 offset:23552
    buffer_load_dwordx4 v16, s[8:11], s58 offen offset:2048 sc1 lds
    s_and_b32 s27, s26, 3
    v_mfma_f32_16x16x32_bf16 v[36:39], a[180:183], a[24:27], v[36:39]
    s_lshr_b32 s26, s26, 2
    v_mul_f32 v64, v64, v48
    v_mul_f32 v65, v65, v49
    v_cvt_pk_bf16_f32 v72, v64, v65
    v_mfma_f32_16x16x32_bf16 v[36:39], a[188:191], a[28:31], v[36:39]
    ds_read_b128 a[224:227], v6 offset:24576
    buffer_load_dwordx4 v16, s[8:11], s58 offen offset:3072 sc1 lds
    v_mfma_f32_16x16x32_bf16 v[40:43], a[128:131], a[64:67], v[40:43]
    s_lshl_b32 s26, s26, 6
    v_mul_f32 v66, v50, v50
    v_mul_f32 v67, v51, v51
    v_fma_f32 v66, v66, v18, v12
    v_mfma_f32_16x16x32_bf16 v[40:43], a[136:139], a[68:71], v[40:43]
    ds_read_b128 a[228:231], v6 offset:25600
    s_add_u32 s26, s26, s27
    v_fma_f32 v67, v67, v18, v12
    v_mfma_f32_16x16x32_bf16 v[40:43], a[144:147], a[72:75], v[40:43]
    s_add_u32 m0, s59, 69632
    v_mul_f32 v66, v66, v50
    v_mul_f32 v67, v67, v51
    v_mfma_f32_16x16x32_bf16 v[40:43], a[152:155], a[76:79], v[40:43]
    ds_read_b128 a[232:235], v6 offset:26624
    s_lshl_b32 s26, s26, 2
    v_exp_f32 v66, v66
    v_mfma_f32_16x16x32_bf16 v[40:43], a[160:163], a[80:83], v[40:43]
    ds_read_b128 a[236:239], v6 offset:27648
    s_mov_b32 s58, 167936
    s_add_u32 s26, s26, 24576
    v_exp_f32 v67, v67
    v_mfma_f32_16x16x32_bf16 v[40:43], a[168:171], a[84:87], v[40:43]
    ds_read_b128 a[240:243], v6 offset:28672
    v_mul_f32 v50, v50, v54
    v_mul_f32 v51, v51, v55
    v_mfma_f32_16x16x32_bf16 v[40:43], a[176:179], a[88:91], v[40:43]
    buffer_load_dwordx4 v16, s[8:11], s58 offen offset:0 sc1 lds
    v_min_u32 v14, 1, v0
    v_mfma_f32_16x16x32_bf16 v[40:43], a[184:187], a[92:95], v[40:43]
    v_fma_f32 v66, v66, v20, v20
    v_fma_f32 v67, v67, v20, v20
    v_lshlrev_b32 v14, 28, v14
    v_mfma_f32_16x16x32_bf16 v[44:47], a[132:135], a[64:67], v[44:47]
    ds_read_b128 a[244:247], v6 offset:29696
    v_rcp_f32 v66, v66
    v_mfma_f32_16x16x32_bf16 v[44:47], a[140:143], a[68:71], v[44:47]
    ds_read_b128 a[248:251], v6 offset:30720
    buffer_load_dwordx4 v16, s[8:11], s58 offen offset:1024 sc1 lds
    v_rcp_f32 v67, v67
    v_add_u32 v14, s26, v14
    v_mfma_f32_16x16x32_bf16 v[44:47], a[148:151], a[72:75], v[44:47]
    ds_read_b128 a[252:255], v6 offset:31744
    v_mul_f32 v66, v66, v50
    v_mov_b32 v2, 1
    v_mfma_f32_16x16x32_bf16 v[44:47], a[156:159], a[76:79], v[44:47]
    buffer_load_dwordx4 v16, s[8:11], s58 offen offset:2048 sc1 lds
    v_mul_f32 v67, v67, v51
    v_cvt_pk_bf16_f32 v73, v66, v67
    v_mfma_f32_16x16x32_bf16 v[44:47], a[164:167], a[80:83], v[44:47]
    s_mul_i32 s26, s24, 524288
    v_mul_f32 v68, v56, v56
    v_mul_f32 v69, v57, v57
    v_fma_f32 v68, v68, v19, v13
    v_mfma_f32_16x16x32_bf16 v[44:47], a[172:175], a[84:87], v[44:47]
    buffer_load_dwordx4 v16, s[8:11], s58 offen offset:3072 sc1 lds
    s_mul_i32 s27, s3, 131072
    v_mfma_f32_16x16x32_bf16 v[44:47], a[180:183], a[88:91], v[44:47]
    s_add_u32 s26, s26, s27
    v_fma_f32 v69, v69, v19, v13
    v_mul_f32 v68, v68, v56
    v_mul_f32 v69, v69, v57
    v_mfma_f32_16x16x32_bf16 v[44:47], a[188:191], a[92:95], v[44:47]
    s_waitcnt vmcnt(18) lgkmcnt(0)
    s_barrier
    v_exp_f32 v68, v68
    v_mfma_f32_16x16x32_bf16 v[32:35], a[192:195], a[32:35], v[32:35]
    s_add_u32 s26, s26, 73728
    v_exp_f32 v69, v69
    v_mfma_f32_16x16x32_bf16 v[32:35], a[200:203], a[36:39], v[32:35]
    ds_read_b128 a[128:131], v4 offset:0
    v_mul_f32 v56, v56, v60
    v_mul_f32 v57, v57, v61
    v_mfma_f32_16x16x32_bf16 v[32:35], a[208:211], a[40:43], v[32:35]
    s_add_u32 s27, s3, 0
    v_fma_f32 v68, v68, v21, v21
    v_fma_f32 v69, v69, v21, v21
    v_mfma_f32_16x16x32_bf16 v[32:35], a[216:219], a[44:47], v[32:35]
    ds_read_b128 a[132:135], v4 offset:1024
    s_and_b32 s27, s27, 3
    v_mfma_f32_16x16x32_bf16 v[32:35], a[224:227], a[48:51], v[32:35]
    s_mov_b32 s56, 49152
    v_rcp_f32 v68, v68
    v_mfma_f32_16x16x32_bf16 v[32:35], a[232:235], a[52:55], v[32:35]
    ds_read_b128 a[136:139], v4 offset:2048
    s_lshl_b32 s27, s27, 10
    v_rcp_f32 v69, v69
    v_mfma_f32_16x16x32_bf16 v[32:35], a[240:243], a[56:59], v[32:35]
    buffer_load_dwordx4 v[112:115], v15, s[4:7], s56 offen offset:0 sc1
    s_add_u32 s27, s27, s26
    v_mul_f32 v68, v68, v56
    v_mfma_f32_16x16x32_bf16 v[32:35], a[248:251], a[60:63], v[32:35]
    ds_read_b128 a[140:143], v4 offset:3072
    v_mul_f32 v69, v69, v57
    v_cvt_pk_bf16_f32 v76, v68, v69
    v_mfma_f32_16x16x32_bf16 v[36:39], a[196:199], a[32:35], v[36:39]
    ds_read_b128 a[144:147], v4 offset:4096
    v_mul_f32 v70, v58, v58
    v_add_u32 v24, s27, v1
    v_mfma_f32_16x16x32_bf16 v[36:39], a[204:207], a[36:39], v[36:39]
    buffer_load_dwordx4 v[116:119], v15, s[4:7], s56 offen offset:1024 sc1
    s_add_u32 s27, s3, 1
    v_mul_f32 v71, v59, v59
    v_fma_f32 v70, v70, v19, v13
    v_mfma_f32_16x16x32_bf16 v[36:39], a[212:215], a[40:43], v[36:39]
    ds_read_b128 a[148:151], v4 offset:5120
    v_fma_f32 v71, v71, v19, v13
    v_mul_f32 v70, v70, v58
    v_mfma_f32_16x16x32_bf16 v[36:39], a[220:223], a[44:47], v[36:39]
    s_and_b32 s27, s27, 3
    v_mul_f32 v71, v71, v59
    v_exp_f32 v70, v70
    v_mfma_f32_16x16x32_bf16 v[36:39], a[228:231], a[48:51], v[36:39]
    ds_read_b128 a[152:155], v4 offset:6144
    buffer_load_dwordx4 v[120:123], v15, s[4:7], s56 offen offset:2048 sc1
    s_lshl_b32 s27, s27, 10
    v_mfma_f32_16x16x32_bf16 v[36:39], a[236:239], a[52:55], v[36:39]
    ds_read_b128 a[156:159], v4 offset:7168
    v_exp_f32 v71, v71
    v_mfma_f32_16x16x32_bf16 v[36:39], a[244:247], a[56:59], v[36:39]
    s_add_u32 s27, s27, s26
    v_mul_f32 v58, v58, v62
    v_mul_f32 v59, v59, v63
    v_fma_f32 v70, v70, v21, v21
    v_mfma_f32_16x16x32_bf16 v[36:39], a[252:255], a[60:63], v[36:39]
    ds_read_b128 a[160:163], v4 offset:8192
    buffer_load_dwordx4 v[124:127], v15, s[4:7], s56 offen offset:3072 sc1
    v_add_u32 v25, s27, v1
    v_mfma_f32_16x16x32_bf16 v[40:43], a[192:195], a[96:99], v[40:43]
    s_add_u32 s27, s3, 2
    v_fma_f32 v71, v71, v21, v21
    v_rcp_f32 v70, v70
    v_mfma_f32_16x16x32_bf16 v[40:43], a[200:203], a[100:103], v[40:43]
    ds_read_b128 a[164:167], v4 offset:9216
    v_rcp_f32 v71, v71
    v_mfma_f32_16x16x32_bf16 v[40:43], a[208:211], a[104:107], v[40:43]
    s_mov_b32 s56, 12288
    s_and_b32 s27, s27, 3
    v_mul_f32 v70, v70, v58
    v_mul_f32 v71, v71, v59
    v_mfma_f32_16x16x32_bf16 v[40:43], a[216:219], a[108:111], v[40:43]
    ds_read_b128 a[168:171], v4 offset:10240
    v_cvt_pk_bf16_f32 v77, v70, v71
    v_mul_f32_dpp v48, v88, v10 row_newbcast:6 row_mask:0xf bank_mask:0xf
    v_mfma_f32_16x16x32_bf16 v[40:43], a[224:227], a[112:115], v[40:43]
    ds_read_b128 a[172:175], v4 offset:11264
    buffer_load_dwordx4 v[128:131], v15, s[4:7], s56 offen offset:0 sc1
    s_lshl_b32 s27, s27, 10
    v_mfma_f32_16x16x32_bf16 v[40:43], a[232:235], a[116:119], v[40:43]
    s_add_u32 s27, s27, s26
    v_mul_f32_dpp v49, v89, v10 row_newbcast:6 row_mask:0xf bank_mask:0xf
    v_mul_f32_dpp v50, v90, v10 row_newbcast:6 row_mask:0xf bank_mask:0xf
    v_mul_f32_dpp v51, v91, v10 row_newbcast:6 row_mask:0xf bank_mask:0xf
    v_mfma_f32_16x16x32_bf16 v[40:43], a[240:243], a[120:123], v[40:43]
    ds_read_b128 a[176:179], v4 offset:12288
    v_mul_f32_dpp v52, v88, v10 row_newbcast:7 row_mask:0xf bank_mask:0xf
    v_mul_f32_dpp v53, v89, v10 row_newbcast:7 row_mask:0xf bank_mask:0xf
    v_mfma_f32_16x16x32_bf16 v[40:43], a[248:251], a[124:127], v[40:43]
    buffer_load_dwordx4 v[132:135], v15, s[4:7], s56 offen offset:1024 sc1
    v_add_u32 v26, s27, v1
    v_mfma_f32_16x16x32_bf16 v[44:47], a[196:199], a[96:99], v[44:47]
    ds_read_b128 a[180:183], v4 offset:13312
    s_add_u32 s27, s3, 3
    v_mul_f32_dpp v54, v90, v10 row_newbcast:7 row_mask:0xf bank_mask:0xf
    v_mul_f32_dpp v55, v91, v10 row_newbcast:7 row_mask:0xf bank_mask:0xf
    v_mfma_f32_16x16x32_bf16 v[44:47], a[204:207], a[100:103], v[44:47]
    ds_read_b128 a[184:187], v4 offset:14336
    v_mul_f32_dpp v56, v88, v11 row_newbcast:6 row_mask:0xf bank_mask:0xf
    v_mul_f32_dpp v57, v89, v11 row_newbcast:6 row_mask:0xf bank_mask:0xf
    v_mfma_f32_16x16x32_bf16 v[44:47], a[212:215], a[104:107], v[44:47]
    buffer_load_dwordx4 v[136:139], v15, s[4:7], s56 offen offset:2048 sc1
    s_and_b32 s27, s27, 3
    v_mul_f32_dpp v58, v90, v11 row_newbcast:6 row_mask:0xf bank_mask:0xf
    v_mfma_f32_16x16x32_bf16 v[44:47], a[220:223], a[108:111], v[44:47]
    ds_read_b128 a[188:191], v4 offset:15360
    s_lshl_b32 s27, s27, 10
    v_mul_f32_dpp v59, v91, v11 row_newbcast:6 row_mask:0xf bank_mask:0xf
    v_mul_f32_dpp v60, v88, v11 row_newbcast:7 row_mask:0xf bank_mask:0xf
    v_mfma_f32_16x16x32_bf16 v[44:47], a[228:231], a[112:115], v[44:47]
    s_add_u32 s27, s27, s26
    v_mul_f32_dpp v61, v89, v11 row_newbcast:7 row_mask:0xf bank_mask:0xf
    v_mul_f32_dpp v62, v90, v11 row_newbcast:7 row_mask:0xf bank_mask:0xf
    v_add_u32 v27, s27, v1
    s_lshr_b32 s26, s24, 1
    s_lshl_b32 s26, s26, 10
    s_lshl_b32 s27, s3, 8
    s_add_u32 s26, s26, s27
    s_add_u32 s26, s26, 24576
    v_and_b32 v28, 0x30, v1
    v_lshrrev_b32 v28, 2, v28
    v_add_u32 v28, s26, v28
    v_mfma_f32_16x16x32_bf16 v[44:47], a[236:239], a[116:119], v[44:47]
    buffer_load_dwordx4 v[140:143], v15, s[4:7], s56 offen offset:3072 sc1
    v_mul_f32_dpp v63, v91, v11 row_newbcast:7 row_mask:0xf bank_mask:0xf
    v_mfma_f32_16x16x32_bf16 v[44:47], a[244:247], a[120:123], v[44:47]
    v_mfma_f32_16x16x32_bf16 v[44:47], a[252:255], a[124:127], v[44:47]
    s_waitcnt lgkmcnt(0)
    v_mfma_f32_16x16x32_bf16 v[48:51], a[128:131], a[0:3], v[48:51]
    ds_read_b128 a[192:195], v4 offset:16384
    v_mfma_f32_16x16x32_bf16 v[48:51], a[136:139], a[4:7], v[48:51]
    ds_read_b128 a[196:199], v4 offset:17408
    v_mfma_f32_16x16x32_bf16 v[48:51], a[144:147], a[8:11], v[48:51]
    s_add_u32 m0, s59, 98304
    v_mfma_f32_16x16x32_bf16 v[48:51], a[152:155], a[12:15], v[48:51]
    ds_read_b128 a[200:203], v4 offset:18432
    v_mul_f32 v64, v32, v32
    v_mul_f32 v65, v33, v33
    v_mfma_f32_16x16x32_bf16 v[48:51], a[160:163], a[16:19], v[48:51]
    s_mov_b32 s58, 196608
    v_fma_f32 v64, v64, v18, v12
    v_fma_f32 v65, v65, v18, v12
    v_mfma_f32_16x16x32_bf16 v[48:51], a[168:171], a[20:23], v[48:51]
    ds_read_b128 a[204:207], v4 offset:19456
    v_mul_f32 v64, v64, v32
    v_mul_f32 v65, v65, v33
    v_mfma_f32_16x16x32_bf16 v[48:51], a[176:179], a[24:27], v[48:51]
    ds_read_b128 a[208:211], v4 offset:20480
    v_exp_f32 v64, v64
    v_mfma_f32_16x16x32_bf16 v[48:51], a[184:187], a[28:31], v[48:51]
    buffer_load_dwordx4 v16, s[8:11], s58 offen offset:0 sc1 lds
    v_mfma_f32_16x16x32_bf16 v[52:55], a[132:135], a[0:3], v[52:55]
    v_exp_f32 v65, v65
    v_mul_f32 v32, v32, v36
    v_mfma_f32_16x16x32_bf16 v[52:55], a[140:143], a[4:7], v[52:55]
    ds_read_b128 a[212:215], v4 offset:21504
    v_mul_f32 v33, v33, v37
    v_fma_f32 v64, v64, v20, v20
    v_mfma_f32_16x16x32_bf16 v[52:55], a[148:151], a[8:11], v[52:55]
    buffer_load_dwordx4 v16, s[8:11], s58 offen offset:1024 sc1 lds
    v_fma_f32 v65, v65, v20, v20
    v_mfma_f32_16x16x32_bf16 v[52:55], a[156:159], a[12:15], v[52:55]
    ds_read_b128 a[216:219], v4 offset:22528
    v_rcp_f32 v64, v64
    v_mfma_f32_16x16x32_bf16 v[52:55], a[164:167], a[16:19], v[52:55]
    ds_read_b128 a[220:223], v4 offset:23552
    v_rcp_f32 v65, v65
    v_mfma_f32_16x16x32_bf16 v[52:55], a[172:175], a[20:23], v[52:55]
    buffer_load_dwordx4 v16, s[8:11], s58 offen offset:2048 sc1 lds
    v_mul_f32 v64, v64, v32
    v_mfma_f32_16x16x32_bf16 v[52:55], a[180:183], a[24:27], v[52:55]
    ds_read_b128 a[224:227], v4 offset:24576
    v_mul_f32 v65, v65, v33
    v_cvt_pk_bf16_f32 v74, v64, v65
    v_mfma_f32_16x16x32_bf16 v[52:55], a[188:191], a[28:31], v[52:55]
    buffer_load_dwordx4 v16, s[8:11], s58 offen offset:3072 sc1 lds
    v_mul_f32 v66, v34, v34
    v_mfma_f32_16x16x32_bf16 v[56:59], a[128:131], a[64:67], v[56:59]
    ds_read_b128 a[228:231], v4 offset:25600
    v_mul_f32 v67, v35, v35
    v_fma_f32 v66, v66, v18, v12
    v_mfma_f32_16x16x32_bf16 v[56:59], a[136:139], a[68:71], v[56:59]
    s_add_u32 m0, s59, 102400
    v_fma_f32 v67, v67, v18, v12
    v_mul_f32 v66, v66, v34
    v_mfma_f32_16x16x32_bf16 v[56:59], a[144:147], a[72:75], v[56:59]
    ds_read_b128 a[232:235], v4 offset:26624
    v_mul_f32 v67, v67, v35
    v_mfma_f32_16x16x32_bf16 v[56:59], a[152:155], a[76:79], v[56:59]
    ds_read_b128 a[236:239], v4 offset:27648
    v_exp_f32 v66, v66
    v_mfma_f32_16x16x32_bf16 v[56:59], a[160:163], a[80:83], v[56:59]
    s_mov_b32 s58, 200704
    v_exp_f32 v67, v67
    v_mul_f32 v34, v34, v38
    v_mfma_f32_16x16x32_bf16 v[56:59], a[168:171], a[84:87], v[56:59]
    ds_read_b128 a[240:243], v4 offset:28672
    v_mul_f32 v35, v35, v39
    v_mfma_f32_16x16x32_bf16 v[56:59], a[176:179], a[88:91], v[56:59]
    buffer_load_dwordx4 v16, s[8:11], s58 offen offset:0 sc1 lds
    v_fma_f32 v66, v66, v20, v20
    v_mfma_f32_16x16x32_bf16 v[56:59], a[184:187], a[92:95], v[56:59]
    ds_read_b128 a[244:247], v4 offset:29696
    v_fma_f32 v67, v67, v20, v20
    v_mfma_f32_16x16x32_bf16 v[60:63], a[132:135], a[64:67], v[60:63]
    ds_read_b128 a[248:251], v4 offset:30720
    v_rcp_f32 v66, v66
    v_mfma_f32_16x16x32_bf16 v[60:63], a[140:143], a[68:71], v[60:63]
    buffer_load_dwordx4 v16, s[8:11], s58 offen offset:1024 sc1 lds
    v_rcp_f32 v67, v67
    v_mfma_f32_16x16x32_bf16 v[60:63], a[148:151], a[72:75], v[60:63]
    ds_read_b128 a[252:255], v4 offset:31744
    v_mul_f32 v66, v66, v34
    v_mul_f32 v67, v67, v35
    v_mfma_f32_16x16x32_bf16 v[60:63], a[156:159], a[76:79], v[60:63]
    buffer_load_dwordx4 v16, s[8:11], s58 offen offset:2048 sc1 lds
    v_cvt_pk_bf16_f32 v75, v66, v67
    v_mfma_f32_16x16x32_bf16 v[60:63], a[164:167], a[80:83], v[60:63]
    v_mul_f32 v68, v40, v40
    v_mul_f32 v69, v41, v41
    v_fma_f32 v68, v68, v19, v13
    v_mfma_f32_16x16x32_bf16 v[60:63], a[172:175], a[84:87], v[60:63]
    buffer_load_dwordx4 v16, s[8:11], s58 offen offset:3072 sc1 lds
    v_fma_f32 v69, v69, v19, v13
    v_mfma_f32_16x16x32_bf16 v[60:63], a[180:183], a[88:91], v[60:63]
    v_mul_f32 v68, v68, v40
    v_mul_f32 v69, v69, v41
    v_mfma_f32_16x16x32_bf16 v[60:63], a[188:191], a[92:95], v[60:63]
    s_waitcnt vmcnt(24) lgkmcnt(0)
    s_barrier
    v_exp_f32 v68, v68
    v_mfma_f32_16x16x32_bf16 v[48:51], a[192:195], a[32:35], v[48:51]
    ds_read_b128 a[128:131], v4 offset:32768
    v_exp_f32 v69, v69
    v_mfma_f32_16x16x32_bf16 v[48:51], a[200:203], a[36:39], v[48:51]
    ds_read_b128 a[132:135], v4 offset:33792
    v_mul_f32 v40, v40, v44
    v_mul_f32 v41, v41, v45
    v_mfma_f32_16x16x32_bf16 v[48:51], a[208:211], a[40:43], v[48:51]
    s_mov_b32 s56, 24576
    v_fma_f32 v68, v68, v21, v21
    v_fma_f32 v69, v69, v21, v21
    v_mfma_f32_16x16x32_bf16 v[48:51], a[216:219], a[44:47], v[48:51]
    ds_read_b128 a[136:139], v4 offset:34816
    v_rcp_f32 v68, v68
    v_mfma_f32_16x16x32_bf16 v[48:51], a[224:227], a[48:51], v[48:51]
    v_rcp_f32 v69, v69
    v_mfma_f32_16x16x32_bf16 v[48:51], a[232:235], a[52:55], v[48:51]
    buffer_load_dwordx4 v[144:147], v15, s[4:7], s56 offen offset:0 sc1
    v_mul_f32 v68, v68, v40
    v_mfma_f32_16x16x32_bf16 v[48:51], a[240:243], a[56:59], v[48:51]
    ds_read_b128 a[140:143], v4 offset:35840
    v_mul_f32 v69, v69, v41
    v_cvt_pk_bf16_f32 v78, v68, v69
    v_mfma_f32_16x16x32_bf16 v[48:51], a[248:251], a[60:63], v[48:51]
    ds_read_b128 a[144:147], v4 offset:36864
    v_mul_f32 v70, v42, v42
    v_mfma_f32_16x16x32_bf16 v[52:55], a[196:199], a[32:35], v[52:55]
    buffer_load_dwordx4 v[148:151], v15, s[4:7], s56 offen offset:1024 sc1
    v_mul_f32 v71, v43, v43
    v_mfma_f32_16x16x32_bf16 v[52:55], a[204:207], a[36:39], v[52:55]
    ds_read_b128 a[148:151], v4 offset:37888
    v_fma_f32 v70, v70, v19, v13
    v_fma_f32 v71, v71, v19, v13
    v_mfma_f32_16x16x32_bf16 v[52:55], a[212:215], a[40:43], v[52:55]
    ds_read_b128 a[152:155], v4 offset:38912
    v_mul_f32 v70, v70, v42
    v_mul_f32 v71, v71, v43
    v_mfma_f32_16x16x32_bf16 v[52:55], a[220:223], a[44:47], v[52:55]
    buffer_load_dwordx4 v[152:155], v15, s[4:7], s56 offen offset:2048 sc1
    v_mfma_f32_16x16x32_bf16 v[52:55], a[228:231], a[48:51], v[52:55]
    ds_read_b128 a[156:159], v4 offset:39936
    v_exp_f32 v70, v70
    v_mfma_f32_16x16x32_bf16 v[52:55], a[236:239], a[52:55], v[52:55]
    v_exp_f32 v71, v71
    v_mul_f32 v42, v42, v46
    v_mfma_f32_16x16x32_bf16 v[52:55], a[244:247], a[56:59], v[52:55]
    ds_read_b128 a[160:163], v4 offset:40960
    v_mul_f32 v43, v43, v47
    v_fma_f32 v70, v70, v21, v21
    v_mfma_f32_16x16x32_bf16 v[52:55], a[252:255], a[60:63], v[52:55]
    buffer_load_dwordx4 v[156:159], v15, s[4:7], s56 offen offset:3072 sc1
    v_fma_f32 v71, v71, v21, v21
    v_mfma_f32_16x16x32_bf16 v[56:59], a[192:195], a[96:99], v[56:59]
    ds_read_b128 a[164:167], v4 offset:41984
    v_rcp_f32 v70, v70
    v_mfma_f32_16x16x32_bf16 v[56:59], a[200:203], a[100:103], v[56:59]
    s_mov_b32 s56, 36864
    v_rcp_f32 v71, v71
    v_mul_f32 v70, v70, v42
    v_mfma_f32_16x16x32_bf16 v[56:59], a[208:211], a[104:107], v[56:59]
    ds_read_b128 a[168:171], v4 offset:43008
    v_mul_f32 v71, v71, v43
    v_mfma_f32_16x16x32_bf16 v[56:59], a[216:219], a[108:111], v[56:59]
    ds_read_b128 a[172:175], v4 offset:44032
    v_cvt_pk_bf16_f32 v79, v70, v71
    v_mfma_f32_16x16x32_bf16 v[56:59], a[224:227], a[112:115], v[56:59]
    buffer_load_dwordx4 v[96:99], v15, s[4:7], s56 offen offset:0 sc1
    s_mul_i32 s57, s31, 12288
    s_add_u32 s57, s57, 4096
    buffer_store_dwordx4 v[72:75], v7, s[20:23], s57 offen offset:0
    buffer_store_dwordx4 v[76:79], v7, s[20:23], s57 offen offset:1024
    v_mul_f32_dpp v32, v88, v10 row_newbcast:8 row_mask:0xf bank_mask:0xf
    v_mfma_f32_16x16x32_bf16 v[56:59], a[232:235], a[116:119], v[56:59]
    ds_read_b128 a[176:179], v4 offset:45056
    v_mul_f32_dpp v33, v89, v10 row_newbcast:8 row_mask:0xf bank_mask:0xf
    v_mul_f32_dpp v34, v90, v10 row_newbcast:8 row_mask:0xf bank_mask:0xf
    v_mfma_f32_16x16x32_bf16 v[56:59], a[240:243], a[120:123], v[56:59]
    buffer_load_dwordx4 v[100:103], v15, s[4:7], s56 offen offset:1024 sc1
    v_mul_f32_dpp v35, v91, v10 row_newbcast:8 row_mask:0xf bank_mask:0xf
    v_mfma_f32_16x16x32_bf16 v[56:59], a[248:251], a[124:127], v[56:59]
    ds_read_b128 a[180:183], v4 offset:46080
    v_mul_f32_dpp v36, v88, v10 row_newbcast:9 row_mask:0xf bank_mask:0xf
    v_mul_f32_dpp v37, v89, v10 row_newbcast:9 row_mask:0xf bank_mask:0xf
    v_mfma_f32_16x16x32_bf16 v[60:63], a[196:199], a[96:99], v[60:63]
    ds_read_b128 a[184:187], v4 offset:47104
    v_mul_f32_dpp v38, v90, v10 row_newbcast:9 row_mask:0xf bank_mask:0xf
    v_mul_f32_dpp v39, v91, v10 row_newbcast:9 row_mask:0xf bank_mask:0xf
    v_mfma_f32_16x16x32_bf16 v[60:63], a[204:207], a[100:103], v[60:63]
    v_mul_f32_dpp v40, v88, v11 row_newbcast:8 row_mask:0xf bank_mask:0xf
    v_mul_f32_dpp v41, v89, v11 row_newbcast:8 row_mask:0xf bank_mask:0xf
    v_mul_f32_dpp v42, v90, v11 row_newbcast:8 row_mask:0xf bank_mask:0xf
    v_mfma_f32_16x16x32_bf16 v[60:63], a[212:215], a[104:107], v[60:63]
    buffer_load_dwordx4 v[104:107], v15, s[4:7], s56 offen offset:2048 sc1
    v_mul_f32_dpp v43, v91, v11 row_newbcast:8 row_mask:0xf bank_mask:0xf
    v_mfma_f32_16x16x32_bf16 v[60:63], a[220:223], a[108:111], v[60:63]
    ds_read_b128 a[188:191], v4 offset:48128
    v_mul_f32_dpp v44, v88, v11 row_newbcast:9 row_mask:0xf bank_mask:0xf
    v_mul_f32_dpp v45, v89, v11 row_newbcast:9 row_mask:0xf bank_mask:0xf
    v_mfma_f32_16x16x32_bf16 v[60:63], a[228:231], a[112:115], v[60:63]
    buffer_load_dwordx4 v[108:111], v15, s[4:7], s56 offen offset:3072 sc1
    v_mul_f32_dpp v46, v90, v11 row_newbcast:9 row_mask:0xf bank_mask:0xf
    v_mfma_f32_16x16x32_bf16 v[60:63], a[236:239], a[116:119], v[60:63]
    v_mul_f32_dpp v47, v91, v11 row_newbcast:9 row_mask:0xf bank_mask:0xf
    v_mfma_f32_16x16x32_bf16 v[60:63], a[244:247], a[120:123], v[60:63]
    v_mfma_f32_16x16x32_bf16 v[60:63], a[252:255], a[124:127], v[60:63]
    s_waitcnt lgkmcnt(0)
    v_mfma_f32_16x16x32_bf16 v[32:35], a[128:131], a[0:3], v[32:35]
    ds_read_b128 a[192:195], v4 offset:49152
    v_mfma_f32_16x16x32_bf16 v[32:35], a[136:139], a[4:7], v[32:35]
    ds_read_b128 a[196:199], v4 offset:50176
    v_mfma_f32_16x16x32_bf16 v[32:35], a[144:147], a[8:11], v[32:35]
    s_mov_b32 s56, 53248
    v_mfma_f32_16x16x32_bf16 v[32:35], a[152:155], a[12:15], v[32:35]
    ds_read_b128 a[200:203], v4 offset:51200
    v_mul_f32 v64, v48, v48
    v_mul_f32 v65, v49, v49
    v_mfma_f32_16x16x32_bf16 v[32:35], a[160:163], a[16:19], v[32:35]
    v_fma_f32 v64, v64, v18, v12
    v_fma_f32 v65, v65, v18, v12
    v_mfma_f32_16x16x32_bf16 v[32:35], a[168:171], a[20:23], v[32:35]
    buffer_load_dwordx4 v[176:179], v15, s[4:7], s56 offen offset:0 sc1
    v_mul_f32 v64, v64, v48
    v_mfma_f32_16x16x32_bf16 v[32:35], a[176:179], a[24:27], v[32:35]
    ds_read_b128 a[204:207], v4 offset:52224
    v_mul_f32 v65, v65, v49
    v_mfma_f32_16x16x32_bf16 v[32:35], a[184:187], a[28:31], v[32:35]
    ds_read_b128 a[208:211], v4 offset:53248
    v_exp_f32 v64, v64
    v_mfma_f32_16x16x32_bf16 v[36:39], a[132:135], a[0:3], v[36:39]
    v_exp_f32 v65, v65
    v_mul_f32 v48, v48, v52
    v_mfma_f32_16x16x32_bf16 v[36:39], a[140:143], a[4:7], v[36:39]
    buffer_load_dwordx4 v[180:183], v15, s[4:7], s56 offen offset:1024 sc1
    v_mul_f32 v49, v49, v53
    v_mfma_f32_16x16x32_bf16 v[36:39], a[148:151], a[8:11], v[36:39]
    ds_read_b128 a[212:215], v4 offset:54272
    v_fma_f32 v64, v64, v20, v20
    v_fma_f32 v65, v65, v20, v20
    v_mfma_f32_16x16x32_bf16 v[36:39], a[156:159], a[12:15], v[36:39]
    ds_read_b128 a[216:219], v4 offset:55296
    v_rcp_f32 v64, v64
    v_mfma_f32_16x16x32_bf16 v[36:39], a[164:167], a[16:19], v[36:39]
    buffer_load_dwordx4 v[184:187], v15, s[4:7], s56 offen offset:2048 sc1
    v_mfma_f32_16x16x32_bf16 v[36:39], a[172:175], a[20:23], v[36:39]
    ds_read_b128 a[220:223], v4 offset:56320
    v_rcp_f32 v65, v65
    v_mfma_f32_16x16x32_bf16 v[36:39], a[180:183], a[24:27], v[36:39]
    ds_read_b128 a[224:227], v4 offset:57344
    v_mul_f32 v64, v64, v48
    v_mul_f32 v65, v65, v49
    v_mfma_f32_16x16x32_bf16 v[36:39], a[188:191], a[28:31], v[36:39]
    buffer_load_dwordx4 v[188:191], v15, s[4:7], s56 offen offset:3072 sc1
    v_cvt_pk_bf16_f32 v72, v64, v65
    v_mfma_f32_16x16x32_bf16 v[40:43], a[128:131], a[64:67], v[40:43]
    ds_read_b128 a[228:231], v4 offset:58368
    v_mul_f32 v66, v50, v50
    v_mul_f32 v67, v51, v51
    v_mfma_f32_16x16x32_bf16 v[40:43], a[136:139], a[68:71], v[40:43]
    s_mov_b32 s56, 40960
    v_fma_f32 v66, v66, v18, v12
    v_fma_f32 v67, v67, v18, v12
    v_mul_f32 v66, v66, v50
    v_mfma_f32_16x16x32_bf16 v[40:43], a[144:147], a[72:75], v[40:43]
    ds_read_b128 a[232:235], v4 offset:59392
    v_mul_f32 v67, v67, v51
    v_mfma_f32_16x16x32_bf16 v[40:43], a[152:155], a[76:79], v[40:43]
    ds_read_b128 a[236:239], v4 offset:60416
    v_exp_f32 v66, v66
    v_mfma_f32_16x16x32_bf16 v[40:43], a[160:163], a[80:83], v[40:43]
    buffer_load_dwordx4 v[160:163], v15, s[4:7], s56 offen offset:0 sc1
    v_exp_f32 v67, v67
    v_mfma_f32_16x16x32_bf16 v[40:43], a[168:171], a[84:87], v[40:43]
    ds_read_b128 a[240:243], v4 offset:61440
    v_mul_f32 v50, v50, v54
    v_mul_f32 v51, v51, v55
    v_mfma_f32_16x16x32_bf16 v[40:43], a[176:179], a[88:91], v[40:43]
    buffer_load_dwordx4 v[164:167], v15, s[4:7], s56 offen offset:1024 sc1
    v_fma_f32 v66, v66, v20, v20
    v_mfma_f32_16x16x32_bf16 v[40:43], a[184:187], a[92:95], v[40:43]
    ds_read_b128 a[244:247], v4 offset:62464
    v_fma_f32 v67, v67, v20, v20
    v_mfma_f32_16x16x32_bf16 v[44:47], a[132:135], a[64:67], v[44:47]
    ds_read_b128 a[248:251], v4 offset:63488
    v_rcp_f32 v66, v66
    v_mfma_f32_16x16x32_bf16 v[44:47], a[140:143], a[68:71], v[44:47]
    v_rcp_f32 v67, v67
    v_mul_f32 v66, v66, v50
    v_mfma_f32_16x16x32_bf16 v[44:47], a[148:151], a[72:75], v[44:47]
    buffer_load_dwordx4 v[168:171], v15, s[4:7], s56 offen offset:2048 sc1
    v_mul_f32 v67, v67, v51
    v_mfma_f32_16x16x32_bf16 v[44:47], a[156:159], a[76:79], v[44:47]
    ds_read_b128 a[252:255], v4 offset:64512
    v_cvt_pk_bf16_f32 v73, v66, v67
    v_mul_f32 v68, v56, v56
    v_mfma_f32_16x16x32_bf16 v[44:47], a[164:167], a[80:83], v[44:47]
    buffer_load_dwordx4 v[172:175], v15, s[4:7], s56 offen offset:3072 sc1
    v_mul_f32 v69, v57, v57
    v_mfma_f32_16x16x32_bf16 v[44:47], a[172:175], a[84:87], v[44:47]
    v_fma_f32 v68, v68, v19, v13
    v_fma_f32 v69, v69, v19, v13
    v_mul_f32 v68, v68, v56
    v_mfma_f32_16x16x32_bf16 v[44:47], a[180:183], a[88:91], v[44:47]
    v_mul_f32 v69, v69, v57
    v_exp_f32 v68, v68
    v_mfma_f32_16x16x32_bf16 v[44:47], a[188:191], a[92:95], v[44:47]
    s_waitcnt vmcnt(11) lgkmcnt(0)
    s_barrier
    s_or_b32 s99, s98, s3
    s_cmp_eq_u32 s99, 0
    s_cbranch_scc1 L_wb3
    buffer_store_dword v2, v14, s[60:63], 0 offen offset:16
L_wbb3:
    v_mfma_f32_16x16x32_bf16 v[32:35], a[192:195], a[32:35], v[32:35]
    ds_read_b128 a[128:131], v5 offset:0
    v_exp_f32 v69, v69
    v_mfma_f32_16x16x32_bf16 v[32:35], a[200:203], a[36:39], v[32:35]
    ds_read_b128 a[132:135], v5 offset:1024
    v_mul_f32 v56, v56, v60
    v_mul_f32 v57, v57, v61
    v_mfma_f32_16x16x32_bf16 v[32:35], a[208:211], a[40:43], v[32:35]
    s_add_u32 m0, s59, 131072
    v_fma_f32 v68, v68, v21, v21
    v_fma_f32 v69, v69, v21, v21
    v_mfma_f32_16x16x32_bf16 v[32:35], a[216:219], a[44:47], v[32:35]
    ds_read_b128 a[136:139], v5 offset:2048
    v_rcp_f32 v68, v68
    v_mfma_f32_16x16x32_bf16 v[32:35], a[224:227], a[48:51], v[32:35]
    s_mov_b32 s56, 0
    v_rcp_f32 v69, v69
    v_mfma_f32_16x16x32_bf16 v[32:35], a[232:235], a[52:55], v[32:35]
    ds_read_b128 a[140:143], v5 offset:3072
    v_mul_f32 v68, v68, v56
    v_mfma_f32_16x16x32_bf16 v[32:35], a[240:243], a[56:59], v[32:35]
    ds_read_b128 a[144:147], v5 offset:4096
    v_mul_f32 v69, v69, v57
    v_cvt_pk_bf16_f32 v76, v68, v69
    v_mfma_f32_16x16x32_bf16 v[32:35], a[248:251], a[60:63], v[32:35]
    buffer_load_dwordx4 v15, s[4:7], s56 offen offset:0 sc1 lds
    v_mul_f32 v70, v58, v58
    v_mfma_f32_16x16x32_bf16 v[36:39], a[196:199], a[32:35], v[36:39]
    ds_read_b128 a[148:151], v5 offset:5120
    v_mul_f32 v71, v59, v59
    v_fma_f32 v70, v70, v19, v13
    v_mfma_f32_16x16x32_bf16 v[36:39], a[204:207], a[36:39], v[36:39]
    v_fma_f32 v71, v71, v19, v13
    v_mul_f32 v70, v70, v58
    v_mfma_f32_16x16x32_bf16 v[36:39], a[212:215], a[40:43], v[36:39]
    buffer_load_dwordx4 v15, s[4:7], s56 offen offset:1024 sc1 lds
    v_mul_f32 v71, v71, v59
    v_mfma_f32_16x16x32_bf16 v[36:39], a[220:223], a[44:47], v[36:39]
    ds_read_b128 a[152:155], v5 offset:6144
    v_exp_f32 v70, v70
    v_mfma_f32_16x16x32_bf16 v[36:39], a[228:231], a[48:51], v[36:39]
    ds_read_b128 a[156:159], v5 offset:7168
    v_exp_f32 v71, v71
    v_mfma_f32_16x16x32_bf16 v[36:39], a[236:239], a[52:55], v[36:39]
    buffer_load_dwordx4 v15, s[4:7], s56 offen offset:2048 sc1 lds
    v_mul_f32 v58, v58, v62
    v_mfma_f32_16x16x32_bf16 v[36:39], a[244:247], a[56:59], v[36:39]
    ds_read_b128 a[160:163], v5 offset:8192
    v_mul_f32 v59, v59, v63
    v_fma_f32 v70, v70, v21, v21
    v_mfma_f32_16x16x32_bf16 v[36:39], a[252:255], a[60:63], v[36:39]
    buffer_load_dwordx4 v15, s[4:7], s56 offen offset:3072 sc1 lds
    v_fma_f32 v71, v71, v21, v21
    v_mfma_f32_16x16x32_bf16 v[40:43], a[192:195], a[96:99], v[40:43]
    ds_read_b128 a[164:167], v5 offset:9216
    v_rcp_f32 v70, v70
    v_mfma_f32_16x16x32_bf16 v[40:43], a[200:203], a[100:103], v[40:43]
    s_add_u32 m0, s59, 135168
    v_rcp_f32 v71, v71
    v_mul_f32 v70, v70, v58
    v_mfma_f32_16x16x32_bf16 v[40:43], a[208:211], a[104:107], v[40:43]
    ds_read_b128 a[168:171], v5 offset:10240
    v_mul_f32 v71, v71, v59
    v_mfma_f32_16x16x32_bf16 v[40:43], a[216:219], a[108:111], v[40:43]
    ds_read_b128 a[172:175], v5 offset:11264
    v_cvt_pk_bf16_f32 v77, v70, v71
    v_mul_f32_dpp v48, v88, v10 row_newbcast:10 row_mask:0xf bank_mask:0xf
    v_mfma_f32_16x16x32_bf16 v[40:43], a[224:227], a[112:115], v[40:43]
    s_mov_b32 s56, 4096
    v_mul_f32_dpp v49, v89, v10 row_newbcast:10 row_mask:0xf bank_mask:0xf
    v_mul_f32_dpp v50, v90, v10 row_newbcast:10 row_mask:0xf bank_mask:0xf
    v_mfma_f32_16x16x32_bf16 v[40:43], a[232:235], a[116:119], v[40:43]
    ds_read_b128 a[176:179], v5 offset:12288
    v_mul_f32_dpp v51, v91, v10 row_newbcast:10 row_mask:0xf bank_mask:0xf
    v_mfma_f32_16x16x32_bf16 v[40:43], a[240:243], a[120:123], v[40:43]
    buffer_load_dwordx4 v15, s[4:7], s56 offen offset:0 sc1 lds
    v_mul_f32_dpp v52, v88, v10 row_newbcast:11 row_mask:0xf bank_mask:0xf
    v_mfma_f32_16x16x32_bf16 v[40:43], a[248:251], a[124:127], v[40:43]
    ds_read_b128 a[180:183], v5 offset:13312
    v_mul_f32_dpp v53, v89, v10 row_newbcast:11 row_mask:0xf bank_mask:0xf
    v_mul_f32_dpp v54, v90, v10 row_newbcast:11 row_mask:0xf bank_mask:0xf
    v_mfma_f32_16x16x32_bf16 v[44:47], a[196:199], a[96:99], v[44:47]
    ds_read_b128 a[184:187], v5 offset:14336
    v_mul_f32_dpp v55, v91, v10 row_newbcast:11 row_mask:0xf bank_mask:0xf
    v_mul_f32_dpp v56, v88, v11 row_newbcast:10 row_mask:0xf bank_mask:0xf
    v_mfma_f32_16x16x32_bf16 v[44:47], a[204:207], a[100:103], v[44:47]
    buffer_load_dwordx4 v15, s[4:7], s56 offen offset:1024 sc1 lds
    v_mul_f32_dpp v57, v89, v11 row_newbcast:10 row_mask:0xf bank_mask:0xf
    v_mfma_f32_16x16x32_bf16 v[44:47], a[212:215], a[104:107], v[44:47]
    ds_read_b128 a[188:191], v5 offset:15360
    v_mul_f32_dpp v58, v90, v11 row_newbcast:10 row_mask:0xf bank_mask:0xf
    v_mul_f32_dpp v59, v91, v11 row_newbcast:10 row_mask:0xf bank_mask:0xf
    v_mfma_f32_16x16x32_bf16 v[44:47], a[220:223], a[108:111], v[44:47]
    buffer_load_dwordx4 v15, s[4:7], s56 offen offset:2048 sc1 lds
    v_mul_f32_dpp v60, v88, v11 row_newbcast:11 row_mask:0xf bank_mask:0xf
    v_mfma_f32_16x16x32_bf16 v[44:47], a[228:231], a[112:115], v[44:47]
    v_mul_f32_dpp v61, v89, v11 row_newbcast:11 row_mask:0xf bank_mask:0xf
    v_mul_f32_dpp v62, v90, v11 row_newbcast:11 row_mask:0xf bank_mask:0xf
    v_mul_f32_dpp v63, v91, v11 row_newbcast:11 row_mask:0xf bank_mask:0xf
    v_mfma_f32_16x16x32_bf16 v[44:47], a[236:239], a[116:119], v[44:47]
    buffer_load_dwordx4 v15, s[4:7], s56 offen offset:3072 sc1 lds
    v_mfma_f32_16x16x32_bf16 v[44:47], a[244:247], a[120:123], v[44:47]
    v_mfma_f32_16x16x32_bf16 v[44:47], a[252:255], a[124:127], v[44:47]
    s_waitcnt lgkmcnt(0)
    v_mfma_f32_16x16x32_bf16 v[48:51], a[128:131], a[0:3], v[48:51]
    ds_read_b128 a[192:195], v5 offset:16384
    v_mfma_f32_16x16x32_bf16 v[48:51], a[136:139], a[4:7], v[48:51]
    ds_read_b128 a[196:199], v5 offset:17408
    v_mfma_f32_16x16x32_bf16 v[48:51], a[144:147], a[8:11], v[48:51]
    s_add_u32 m0, s59, 0
    v_mfma_f32_16x16x32_bf16 v[48:51], a[152:155], a[12:15], v[48:51]
    ds_read_b128 a[200:203], v5 offset:18432
    v_mul_f32 v64, v32, v32
    v_mul_f32 v65, v33, v33
    v_mfma_f32_16x16x32_bf16 v[48:51], a[160:163], a[16:19], v[48:51]
    s_mov_b32 s56, 16384
    v_fma_f32 v64, v64, v18, v12
    v_fma_f32 v65, v65, v18, v12
    v_mfma_f32_16x16x32_bf16 v[48:51], a[168:171], a[20:23], v[48:51]
    ds_read_b128 a[204:207], v5 offset:19456
    v_mul_f32 v64, v64, v32
    v_mul_f32 v65, v65, v33
    v_mfma_f32_16x16x32_bf16 v[48:51], a[176:179], a[24:27], v[48:51]
    ds_read_b128 a[208:211], v5 offset:20480
    v_exp_f32 v64, v64
    v_mfma_f32_16x16x32_bf16 v[48:51], a[184:187], a[28:31], v[48:51]
    buffer_load_dwordx4 v15, s[4:7], s56 offen offset:0 sc1 lds
    v_mfma_f32_16x16x32_bf16 v[52:55], a[132:135], a[0:3], v[52:55]
    v_exp_f32 v65, v65
    v_mul_f32 v32, v32, v36
    v_mfma_f32_16x16x32_bf16 v[52:55], a[140:143], a[4:7], v[52:55]
    ds_read_b128 a[212:215], v5 offset:21504
    v_mul_f32 v33, v33, v37
    v_fma_f32 v64, v64, v20, v20
    v_mfma_f32_16x16x32_bf16 v[52:55], a[148:151], a[8:11], v[52:55]
    buffer_load_dwordx4 v15, s[4:7], s56 offen offset:1024 sc1 lds
    v_fma_f32 v65, v65, v20, v20
    v_mfma_f32_16x16x32_bf16 v[52:55], a[156:159], a[12:15], v[52:55]
    ds_read_b128 a[216:219], v5 offset:22528
    v_rcp_f32 v64, v64
    v_mfma_f32_16x16x32_bf16 v[52:55], a[164:167], a[16:19], v[52:55]
    ds_read_b128 a[220:223], v5 offset:23552
    v_rcp_f32 v65, v65
    v_mfma_f32_16x16x32_bf16 v[52:55], a[172:175], a[20:23], v[52:55]
    buffer_load_dwordx4 v15, s[4:7], s56 offen offset:2048 sc1 lds
    v_mul_f32 v64, v64, v32
    v_mfma_f32_16x16x32_bf16 v[52:55], a[180:183], a[24:27], v[52:55]
    ds_read_b128 a[224:227], v5 offset:24576
    v_mul_f32 v65, v65, v33
    v_cvt_pk_bf16_f32 v74, v64, v65
    v_mfma_f32_16x16x32_bf16 v[52:55], a[188:191], a[28:31], v[52:55]
    buffer_load_dwordx4 v15, s[4:7], s56 offen offset:3072 sc1 lds
    v_mul_f32 v66, v34, v34
    v_mfma_f32_16x16x32_bf16 v[56:59], a[128:131], a[64:67], v[56:59]
    ds_read_b128 a[228:231], v5 offset:25600
    v_mul_f32 v67, v35, v35
    v_fma_f32 v66, v66, v18, v12
    v_mfma_f32_16x16x32_bf16 v[56:59], a[136:139], a[68:71], v[56:59]
    s_add_u32 m0, s59, 4096
    v_fma_f32 v67, v67, v18, v12
    v_mul_f32 v66, v66, v34
    v_mfma_f32_16x16x32_bf16 v[56:59], a[144:147], a[72:75], v[56:59]
    ds_read_b128 a[232:235], v5 offset:26624
    v_mul_f32 v67, v67, v35
    v_mfma_f32_16x16x32_bf16 v[56:59], a[152:155], a[76:79], v[56:59]
    ds_read_b128 a[236:239], v5 offset:27648
    v_exp_f32 v66, v66
    v_mfma_f32_16x16x32_bf16 v[56:59], a[160:163], a[80:83], v[56:59]
    s_mov_b32 s56, 28672
    v_exp_f32 v67, v67
    v_mul_f32 v34, v34, v38
    v_mfma_f32_16x16x32_bf16 v[56:59], a[168:171], a[84:87], v[56:59]
    ds_read_b128 a[240:243], v5 offset:28672
    v_mul_f32 v35, v35, v39
    v_mfma_f32_16x16x32_bf16 v[56:59], a[176:179], a[88:91], v[56:59]
    buffer_load_dwordx4 v15, s[4:7], s56 offen offset:0 sc1 lds
    v_fma_f32 v66, v66, v20, v20
    v_mfma_f32_16x16x32_bf16 v[56:59], a[184:187], a[92:95], v[56:59]
    ds_read_b128 a[244:247], v5 offset:29696
    v_fma_f32 v67, v67, v20, v20
    v_mfma_f32_16x16x32_bf16 v[60:63], a[132:135], a[64:67], v[60:63]
    ds_read_b128 a[248:251], v5 offset:30720
    v_rcp_f32 v66, v66
    v_mfma_f32_16x16x32_bf16 v[60:63], a[140:143], a[68:71], v[60:63]
    buffer_load_dwordx4 v15, s[4:7], s56 offen offset:1024 sc1 lds
    v_rcp_f32 v67, v67
    v_mfma_f32_16x16x32_bf16 v[60:63], a[148:151], a[72:75], v[60:63]
    ds_read_b128 a[252:255], v5 offset:31744
    v_mul_f32 v66, v66, v34
    v_mul_f32 v67, v67, v35
    v_mfma_f32_16x16x32_bf16 v[60:63], a[156:159], a[76:79], v[60:63]
    buffer_load_dwordx4 v15, s[4:7], s56 offen offset:2048 sc1 lds
    v_cvt_pk_bf16_f32 v75, v66, v67
    v_mfma_f32_16x16x32_bf16 v[60:63], a[164:167], a[80:83], v[60:63]
    buffer_load_dwordx4 v15, s[4:7], s56 offen offset:3072 sc1 lds
    buffer_load_dword v29, v28, s[60:63], 0 offen offset:16 sc1
    v_mul_f32 v68, v40, v40
    v_mul_f32 v69, v41, v41
    v_mfma_f32_16x16x32_bf16 v[60:63], a[172:175], a[84:87], v[60:63]
    v_fma_f32 v68, v68, v19, v13
    v_fma_f32 v69, v69, v19, v13
    v_mul_f32 v68, v68, v40
    v_mfma_f32_16x16x32_bf16 v[60:63], a[180:183], a[88:91], v[60:63]
    v_mul_f32 v69, v69, v41
    v_exp_f32 v68, v68
    v_mfma_f32_16x16x32_bf16 v[60:63], a[188:191], a[92:95], v[60:63]
    s_waitcnt vmcnt(36) lgkmcnt(0)
    s_barrier
    v_mfma_f32_16x16x32_bf16 v[48:51], a[192:195], a[32:35], v[48:51]
    ds_read_b128 a[128:131], v5 offset:32768
    v_exp_f32 v69, v69
    v_mfma_f32_16x16x32_bf16 v[48:51], a[200:203], a[36:39], v[48:51]
    ds_read_b128 a[132:135], v5 offset:33792
    v_mul_f32 v40, v40, v44
    v_mul_f32 v41, v41, v45
    v_mfma_f32_16x16x32_bf16 v[48:51], a[208:211], a[40:43], v[48:51]
    s_add_u32 m0, s59, 32768
    v_fma_f32 v68, v68, v21, v21
    v_fma_f32 v69, v69, v21, v21
    v_mfma_f32_16x16x32_bf16 v[48:51], a[216:219], a[44:47], v[48:51]
    ds_read_b128 a[136:139], v5 offset:34816
    v_rcp_f32 v68, v68
    v_mfma_f32_16x16x32_bf16 v[48:51], a[224:227], a[48:51], v[48:51]
    s_mov_b32 s56, 32768
    v_rcp_f32 v69, v69
    v_mfma_f32_16x16x32_bf16 v[48:51], a[232:235], a[52:55], v[48:51]
    ds_read_b128 a[140:143], v5 offset:35840
    v_mul_f32 v68, v68, v40
    v_mfma_f32_16x16x32_bf16 v[48:51], a[240:243], a[56:59], v[48:51]
    ds_read_b128 a[144:147], v5 offset:36864
    v_mul_f32 v69, v69, v41
    v_cvt_pk_bf16_f32 v78, v68, v69
    v_mfma_f32_16x16x32_bf16 v[48:51], a[248:251], a[60:63], v[48:51]
    buffer_load_dwordx4 v15, s[4:7], s56 offen offset:0 sc1 lds
    v_mul_f32 v70, v42, v42
    v_mfma_f32_16x16x32_bf16 v[52:55], a[196:199], a[32:35], v[52:55]
    ds_read_b128 a[148:151], v5 offset:37888
    v_mul_f32 v71, v43, v43
    v_fma_f32 v70, v70, v19, v13
    v_mfma_f32_16x16x32_bf16 v[52:55], a[204:207], a[36:39], v[52:55]
    v_fma_f32 v71, v71, v19, v13
    v_mul_f32 v70, v70, v42
    v_mfma_f32_16x16x32_bf16 v[52:55], a[212:215], a[40:43], v[52:55]
    buffer_load_dwordx4 v15, s[4:7], s56 offen offset:1024 sc1 lds
    v_mul_f32 v71, v71, v43
    v_mfma_f32_16x16x32_bf16 v[52:55], a[220:223], a[44:47], v[52:55]
    ds_read_b128 a[152:155], v5 offset:38912
    v_exp_f32 v70, v70
    v_mfma_f32_16x16x32_bf16 v[52:55], a[228:231], a[48:51], v[52:55]
    ds_read_b128 a[156:159], v5 offset:39936
    v_exp_f32 v71, v71
    v_mfma_f32_16x16x32_bf16 v[52:55], a[236:239], a[52:55], v[52:55]
    buffer_load_dwordx4 v15, s[4:7], s56 offen offset:2048 sc1 lds
    v_mul_f32 v42, v42, v46
    v_mfma_f32_16x16x32_bf16 v[52:55], a[244:247], a[56:59], v[52:55]
    ds_read_b128 a[160:163], v5 offset:40960
    v_mul_f32 v43, v43, v47
    v_fma_f32 v70, v70, v21, v21
    v_mfma_f32_16x16x32_bf16 v[52:55], a[252:255], a[60:63], v[52:55]
    buffer_load_dwordx4 v15, s[4:7], s56 offen offset:3072 sc1 lds
    v_fma_f32 v71, v71, v21, v21
    v_mfma_f32_16x16x32_bf16 v[56:59], a[192:195], a[96:99], v[56:59]
    ds_read_b128 a[164:167], v5 offset:41984
    v_rcp_f32 v70, v70
    v_mfma_f32_16x16x32_bf16 v[56:59], a[200:203], a[100:103], v[56:59]
    s_add_u32 m0, s59, 36864
    v_rcp_f32 v71, v71
    v_mul_f32 v70, v70, v42
    v_mfma_f32_16x16x32_bf16 v[56:59], a[208:211], a[104:107], v[56:59]
    ds_read_b128 a[168:171], v5 offset:43008
    v_mul_f32 v71, v71, v43
    v_mfma_f32_16x16x32_bf16 v[56:59], a[216:219], a[108:111], v[56:59]
    ds_read_b128 a[172:175], v5 offset:44032
    v_cvt_pk_bf16_f32 v79, v70, v71
    v_mfma_f32_16x16x32_bf16 v[56:59], a[224:227], a[112:115], v[56:59]
    s_mov_b32 s56, 45056
    s_mul_i32 s57, s31, 12288
    s_add_u32 s57, s57, 8192
    buffer_store_dwordx4 v[72:75], v7, s[20:23], s57 offen offset:0
    buffer_store_dwordx4 v[76:79], v7, s[20:23], s57 offen offset:1024
    v_mul_f32_dpp v32, v88, v10 row_newbcast:12 row_mask:0xf bank_mask:0xf
    v_mfma_f32_16x16x32_bf16 v[56:59], a[232:235], a[116:119], v[56:59]
    ds_read_b128 a[176:179], v5 offset:45056
    v_mul_f32_dpp v33, v89, v10 row_newbcast:12 row_mask:0xf bank_mask:0xf
    v_mul_f32_dpp v34, v90, v10 row_newbcast:12 row_mask:0xf bank_mask:0xf
    v_mfma_f32_16x16x32_bf16 v[56:59], a[240:243], a[120:123], v[56:59]
    buffer_load_dwordx4 v15, s[4:7], s56 offen offset:0 sc1 lds
    v_mul_f32_dpp v35, v91, v10 row_newbcast:12 row_mask:0xf bank_mask:0xf
    v_mfma_f32_16x16x32_bf16 v[56:59], a[248:251], a[124:127], v[56:59]
    ds_read_b128 a[180:183], v5 offset:46080
    v_mul_f32_dpp v36, v88, v10 row_newbcast:13 row_mask:0xf bank_mask:0xf
    v_mul_f32_dpp v37, v89, v10 row_newbcast:13 row_mask:0xf bank_mask:0xf
    v_mfma_f32_16x16x32_bf16 v[60:63], a[196:199], a[96:99], v[60:63]
    buffer_load_dwordx4 v15, s[4:7], s56 offen offset:1024 sc1 lds
    buffer_load_dwordx4 v15, s[4:7], s56 offen offset:2048 sc1 lds
    s_waitcnt vmcnt(9)
    v_cmp_ne_u32 vcc, 1, v29
    v_mul_f32_dpp v38, v90, v10 row_newbcast:13 row_mask:0xf bank_mask:0xf
    v_mul_f32_dpp v39, v91, v10 row_newbcast:13 row_mask:0xf bank_mask:0xf
    v_mfma_f32_16x16x32_bf16 v[60:63], a[204:207], a[100:103], v[60:63]
    ds_read_b128 a[184:187], v5 offset:47104
    v_mul_f32_dpp v40, v88, v11 row_newbcast:12 row_mask:0xf bank_mask:0xf
    v_mul_f32_dpp v41, v89, v11 row_newbcast:12 row_mask:0xf bank_mask:0xf
    v_mfma_f32_16x16x32_bf16 v[60:63], a[212:215], a[104:107], v[60:63]
    buffer_load_dwordx4 v15, s[4:7], s56 offen offset:3072 sc1 lds
    s_cbranch_vccnz L_spin9
L_back9:
    v_mul_f32_dpp v42, v90, v11 row_newbcast:12 row_mask:0xf bank_mask:0xf
    v_mfma_f32_16x16x32_bf16 v[60:63], a[220:223], a[108:111], v[60:63]
    ds_read_b128 a[188:191], v5 offset:48128
    v_mul_f32_dpp v43, v91, v11 row_newbcast:12 row_mask:0xf bank_mask:0xf
    v_mul_f32_dpp v44, v88, v11 row_newbcast:13 row_mask:0xf bank_mask:0xf
    v_mfma_f32_16x16x32_bf16 v[60:63], a[228:231], a[112:115], v[60:63]
    v_mul_f32_dpp v45, v89, v11 row_newbcast:13 row_mask:0xf bank_mask:0xf
    v_mul_f32_dpp v46, v90, v11 row_newbcast:13 row_mask:0xf bank_mask:0xf
    v_mul_f32_dpp v47, v91, v11 row_newbcast:13 row_mask:0xf bank_mask:0xf
    v_mfma_f32_16x16x32_bf16 v[60:63], a[236:239], a[116:119], v[60:63]
    v_mfma_f32_16x16x32_bf16 v[60:63], a[244:247], a[120:123], v[60:63]
    v_mfma_f32_16x16x32_bf16 v[60:63], a[252:255], a[124:127], v[60:63]
    s_waitcnt lgkmcnt(0)
    v_mfma_f32_16x16x32_bf16 v[32:35], a[128:131], a[0:3], v[32:35]
    ds_read_b128 a[192:195], v5 offset:49152
    v_mfma_f32_16x16x32_bf16 v[32:35], a[136:139], a[4:7], v[32:35]
    ds_read_b128 a[196:199], v5 offset:50176
    v_mfma_f32_16x16x32_bf16 v[32:35], a[144:147], a[8:11], v[32:35]
    s_mov_b32 s40, 0
    v_mfma_f32_16x16x32_bf16 v[32:35], a[152:155], a[12:15], v[32:35]
    ds_read_b128 a[200:203], v5 offset:51200
    v_mul_f32 v64, v48, v48
    v_mul_f32 v65, v49, v49
    v_mfma_f32_16x16x32_bf16 v[32:35], a[160:163], a[16:19], v[32:35]
    buffer_load_dwordx4 v[192:195], v24, s[20:23], s40 offen sc1
    v_fma_f32 v64, v64, v18, v12
    v_mfma_f32_16x16x32_bf16 v[32:35], a[168:171], a[20:23], v[32:35]
    ds_read_b128 a[204:207], v5 offset:52224
    v_fma_f32 v65, v65, v18, v12
    v_mul_f32 v64, v64, v48
    v_mfma_f32_16x16x32_bf16 v[32:35], a[176:179], a[24:27], v[32:35]
    buffer_load_dwordx4 v[196:199], v25, s[20:23], s40 offen sc1
    v_mul_f32 v65, v65, v49
    v_mfma_f32_16x16x32_bf16 v[32:35], a[184:187], a[28:31], v[32:35]
    ds_read_b128 a[208:211], v5 offset:53248
    v_exp_f32 v64, v64
    v_mfma_f32_16x16x32_bf16 v[36:39], a[132:135], a[0:3], v[36:39]
    buffer_load_dwordx4 v[200:203], v26, s[20:23], s40 offen sc1
    v_mfma_f32_16x16x32_bf16 v[36:39], a[140:143], a[4:7], v[36:39]
    ds_read_b128 a[212:215], v5 offset:54272
    v_exp_f32 v65, v65
    v_mfma_f32_16x16x32_bf16 v[36:39], a[148:151], a[8:11], v[36:39]
    buffer_load_dwordx4 v[204:207], v27, s[20:23], s40 offen sc1
    v_mul_f32 v48, v48, v52
    v_mfma_f32_16x16x32_bf16 v[36:39], a[156:159], a[12:15], v[36:39]
    ds_read_b128 a[216:219], v5 offset:55296
    v_mul_f32 v49, v49, v53
    v_fma_f32 v64, v64, v20, v20
    v_mfma_f32_16x16x32_bf16 v[36:39], a[164:167], a[16:19], v[36:39]
    ds_read_b128 a[220:223], v5 offset:56320
    v_fma_f32 v65, v65, v20, v20
    v_mfma_f32_16x16x32_bf16 v[36:39], a[172:175], a[20:23], v[36:39]
    s_mov_b32 s40, 4096
    v_rcp_f32 v64, v64
    v_mfma_f32_16x16x32_bf16 v[36:39], a[180:183], a[24:27], v[36:39]
    ds_read_b128 a[224:227], v5 offset:57344
    v_rcp_f32 v65, v65
    v_mfma_f32_16x16x32_bf16 v[36:39], a[188:191], a[28:31], v[36:39]
    buffer_load_dwordx4 v[208:211], v24, s[20:23], s40 offen sc1
    v_mul_f32 v64, v64, v48
    v_mfma_f32_16x16x32_bf16 v[40:43], a[128:131], a[64:67], v[40:43]
    ds_read_b128 a[228:231], v5 offset:58368
    v_mul_f32 v65, v65, v49
    v_cvt_pk_bf16_f32 v72, v64, v65
    v_mfma_f32_16x16x32_bf16 v[40:43], a[136:139], a[68:71], v[40:43]
    buffer_load_dwordx4 v[212:215], v25, s[20:23], s40 offen sc1
    v_mul_f32 v66, v50, v50
    v_mfma_f32_16x16x32_bf16 v[40:43], a[144:147], a[72:75], v[40:43]
    buffer_load_dwordx4 v[216:219], v26, s[20:23], s40 offen sc1
    v_mul_f32 v67, v51, v51
    v_mfma_f32_16x16x32_bf16 v[40:43], a[152:155], a[76:79], v[40:43]
    ds_read_b128 a[232:235], v5 offset:59392
    v_fma_f32 v66, v66, v18, v12
    v_fma_f32 v67, v67, v18, v12
    v_mfma_f32_16x16x32_bf16 v[40:43], a[160:163], a[80:83], v[40:43]
    ds_read_b128 a[236:239], v5 offset:60416
    buffer_load_dwordx4 v[220:223], v27, s[20:23], s40 offen sc1
    v_mfma_f32_16x16x32_bf16 v[40:43], a[168:171], a[84:87], v[40:43]
    ds_read_b128 a[240:243], v5 offset:61440
    v_mul_f32 v66, v66, v50
    v_mul_f32 v67, v67, v51
    v_mfma_f32_16x16x32_bf16 v[40:43], a[176:179], a[88:91], v[40:43]
    s_mov_b32 s40, 16384
    v_exp_f32 v66, v66
    v_mfma_f32_16x16x32_bf16 v[40:43], a[184:187], a[92:95], v[40:43]
    ds_read_b128 a[244:247], v5 offset:62464
    v_exp_f32 v67, v67
    v_mfma_f32_16x16x32_bf16 v[44:47], a[132:135], a[64:67], v[44:47]
    buffer_load_dwordx4 v[224:227], v24, s[20:23], s40 offen sc1
    v_mul_f32 v50, v50, v54
    v_mfma_f32_16x16x32_bf16 v[44:47], a[140:143], a[68:71], v[44:47]
    ds_read_b128 a[248:251], v5 offset:63488
    v_mul_f32 v51, v51, v55
    v_fma_f32 v66, v66, v20, v20
    v_mfma_f32_16x16x32_bf16 v[44:47], a[148:151], a[72:75], v[44:47]
    buffer_load_dwordx4 v[228:231], v25, s[20:23], s40 offen sc1
    v_fma_f32 v67, v67, v20, v20
    v_mfma_f32_16x16x32_bf16 v[44:47], a[156:159], a[76:79], v[44:47]
    ds_read_b128 a[252:255], v5 offset:64512
    v_rcp_f32 v66, v66
    v_mfma_f32_16x16x32_bf16 v[44:47], a[164:167], a[80:83], v[44:47]
    buffer_load_dwordx4 v[232:235], v26, s[20:23], s40 offen sc1
    v_mfma_f32_16x16x32_bf16 v[44:47], a[172:175], a[84:87], v[44:47]
    v_rcp_f32 v67, v67
    v_mul_f32 v66, v66, v50
    v_mfma_f32_16x16x32_bf16 v[44:47], a[180:183], a[88:91], v[44:47]
    buffer_load_dwordx4 v[236:239], v27, s[20:23], s40 offen sc1
    v_mul_f32 v67, v67, v51
    v_mfma_f32_16x16x32_bf16 v[44:47], a[188:191], a[92:95], v[44:47]
    s_waitcnt lgkmcnt(0)
    v_cvt_pk_bf16_f32 v73, v66, v67
    v_mfma_f32_16x16x32_bf16 v[32:35], a[192:195], a[32:35], v[32:35]
    v_mul_f32 v68, v56, v56
    v_mul_f32 v69, v57, v57
    v_mfma_f32_16x16x32_bf16 v[32:35], a[200:203], a[36:39], v[32:35]
    v_fma_f32 v68, v68, v19, v13
    v_mfma_f32_16x16x32_bf16 v[32:35], a[208:211], a[40:43], v[32:35]
    s_mov_b32 s40, 28672
    v_fma_f32 v69, v69, v19, v13
    v_mul_f32 v68, v68, v56
    v_mfma_f32_16x16x32_bf16 v[32:35], a[216:219], a[44:47], v[32:35]
    v_mul_f32 v69, v69, v57
    v_mfma_f32_16x16x32_bf16 v[32:35], a[224:227], a[48:51], v[32:35]
    v_exp_f32 v68, v68
    v_mfma_f32_16x16x32_bf16 v[32:35], a[232:235], a[52:55], v[32:35]
    v_exp_f32 v69, v69
    v_mfma_f32_16x16x32_bf16 v[32:35], a[240:243], a[56:59], v[32:35]
    v_mul_f32 v56, v56, v60
    v_mfma_f32_16x16x32_bf16 v[32:35], a[248:251], a[60:63], v[32:35]
    buffer_load_dwordx4 a[128:131], v24, s[20:23], s40 offen sc1
    v_mul_f32 v57, v57, v61
    v_mfma_f32_16x16x32_bf16 v[36:39], a[196:199], a[32:35], v[36:39]
    v_fma_f32 v68, v68, v21, v21
    v_fma_f32 v69, v69, v21, v21
    v_mfma_f32_16x16x32_bf16 v[36:39], a[204:207], a[36:39], v[36:39]
    v_rcp_f32 v68, v68
    v_mfma_f32_16x16x32_bf16 v[36:39], a[212:215], a[40:43], v[36:39]
    v_mfma_f32_16x16x32_bf16 v[36:39], a[220:223], a[44:47], v[36:39]
    v_rcp_f32 v69, v69
    v_mfma_f32_16x16x32_bf16 v[36:39], a[228:231], a[48:51], v[36:39]
    buffer_load_dwordx4 a[132:135], v25, s[20:23], s40 offen sc1
    v_mul_f32 v68, v68, v56
    v_mfma_f32_16x16x32_bf16 v[36:39], a[236:239], a[52:55], v[36:39]
    v_mul_f32 v69, v69, v57
    v_cvt_pk_bf16_f32 v76, v68, v69
    v_mfma_f32_16x16x32_bf16 v[36:39], a[244:247], a[56:59], v[36:39]
    v_mul_f32 v70, v58, v58
    v_mfma_f32_16x16x32_bf16 v[36:39], a[252:255], a[60:63], v[36:39]
    v_mul_f32 v71, v59, v59
    v_fma_f32 v70, v70, v19, v13
    v_mfma_f32_16x16x32_bf16 v[40:43], a[192:195], a[96:99], v[40:43]
    v_fma_f32 v71, v71, v19, v13
    v_mfma_f32_16x16x32_bf16 v[40:43], a[200:203], a[100:103], v[40:43]
    v_mul_f32 v70, v70, v58
    v_mul_f32 v71, v71, v59
    v_mfma_f32_16x16x32_bf16 v[40:43], a[208:211], a[104:107], v[40:43]
    v_exp_f32 v70, v70
    v_mfma_f32_16x16x32_bf16 v[40:43], a[216:219], a[108:111], v[40:43]
    buffer_load_dwordx4 a[136:139], v26, s[20:23], s40 offen sc1
    v_mfma_f32_16x16x32_bf16 v[40:43], a[224:227], a[112:115], v[40:43]
    v_exp_f32 v71, v71
    v_mfma_f32_16x16x32_bf16 v[40:43], a[232:235], a[116:119], v[40:43]
    v_mul_f32 v58, v58, v62
    v_mfma_f32_16x16x32_bf16 v[40:43], a[240:243], a[120:123], v[40:43]
    v_mul_f32 v59, v59, v63
    v_fma_f32 v70, v70, v21, v21
    v_mfma_f32_16x16x32_bf16 v[40:43], a[248:251], a[124:127], v[40:43]
    buffer_load_dwordx4 a[140:143], v27, s[20:23], s40 offen sc1
    v_fma_f32 v71, v71, v21, v21
    v_mfma_f32_16x16x32_bf16 v[44:47], a[196:199], a[96:99], v[44:47]
    v_rcp_f32 v70, v70
    v_mfma_f32_16x16x32_bf16 v[44:47], a[204:207], a[100:103], v[44:47]
    v_rcp_f32 v71, v71
    v_mfma_f32_16x16x32_bf16 v[44:47], a[212:215], a[104:107], v[44:47]
    v_mul_f32 v70, v70, v58
    v_mfma_f32_16x16x32_bf16 v[44:47], a[220:223], a[108:111], v[44:47]
    v_mul_f32 v71, v71, v59
    v_mfma_f32_16x16x32_bf16 v[44:47], a[228:231], a[112:115], v[44:47]
    v_cvt_pk_bf16_f32 v77, v70, v71
    v_mfma_f32_16x16x32_bf16 v[44:47], a[236:239], a[116:119], v[44:47]
    v_mfma_f32_16x16x32_bf16 v[44:47], a[244:247], a[120:123], v[44:47]
    v_mfma_f32_16x16x32_bf16 v[44:47], a[252:255], a[124:127], v[44:47]
    s_load_dwordx2 s[12:13], s[0:1], 80
    s_nop 5
    v_pk_mul_f32 v[64:65], v[32:33], v[32:33]
    v_pk_mul_f32 v[66:67], v[34:35], v[34:35]
    v_pk_mul_f32 v[68:69], v[40:41], v[40:41]
    v_pk_mul_f32 v[70:71], v[42:43], v[42:43]
    v_pk_fma_f32 v[64:65], v[64:65], v[18:19], v[12:13] op_sel:[0,0,0] op_sel_hi:[1,0,0]
    v_pk_fma_f32 v[66:67], v[66:67], v[18:19], v[12:13] op_sel:[0,0,0] op_sel_hi:[1,0,0]
    v_pk_fma_f32 v[68:69], v[68:69], v[18:19], v[12:13] op_sel:[0,1,1] op_sel_hi:[1,1,1]
    v_pk_fma_f32 v[70:71], v[70:71], v[18:19], v[12:13] op_sel:[0,1,1] op_sel_hi:[1,1,1]
    v_pk_mul_f32 v[64:65], v[64:65], v[32:33]
    v_pk_mul_f32 v[66:67], v[66:67], v[34:35]
    v_pk_mul_f32 v[68:69], v[68:69], v[40:41]
    v_pk_mul_f32 v[70:71], v[70:71], v[42:43]
    v_exp_f32 v64, v64
    v_exp_f32 v65, v65
    v_exp_f32 v66, v66
    v_exp_f32 v67, v67
    v_exp_f32 v68, v68
    v_exp_f32 v69, v69
    v_exp_f32 v70, v70
    v_exp_f32 v71, v71
    v_pk_mul_f32 v[32:33], v[32:33], v[36:37]
    v_pk_mul_f32 v[34:35], v[34:35], v[38:39]
    v_pk_mul_f32 v[40:41], v[40:41], v[44:45]
    v_pk_mul_f32 v[42:43], v[42:43], v[46:47]
    v_pk_fma_f32 v[64:65], v[64:65], v[20:21], v[20:21] op_sel:[0,0,0] op_sel_hi:[1,0,0]
    v_pk_fma_f32 v[66:67], v[66:67], v[20:21], v[20:21] op_sel:[0,0,0] op_sel_hi:[1,0,0]
    v_pk_fma_f32 v[68:69], v[68:69], v[20:21], v[20:21] op_sel:[0,1,1] op_sel_hi:[1,1,1]
    v_pk_fma_f32 v[70:71], v[70:71], v[20:21], v[20:21] op_sel:[0,1,1] op_sel_hi:[1,1,1]
    v_rcp_f32 v64, v64
    v_rcp_f32 v65, v65
    v_rcp_f32 v66, v66
    v_rcp_f32 v67, v67
    v_rcp_f32 v68, v68
    v_rcp_f32 v69, v69
    v_rcp_f32 v70, v70
    v_rcp_f32 v71, v71
    v_pk_mul_f32 v[64:65], v[64:65], v[32:33]
    v_pk_mul_f32 v[66:67], v[66:67], v[34:35]
    v_pk_mul_f32 v[68:69], v[68:69], v[40:41]
    v_pk_mul_f32 v[70:71], v[70:71], v[42:43]
    v_cvt_pk_bf16_f32 v74, v64, v65
    v_cvt_pk_bf16_f32 v75, v66, v67
    v_cvt_pk_bf16_f32 v78, v68, v69
    v_cvt_pk_bf16_f32 v79, v70, v71
    s_mul_i32 s57, s31, 12288
    s_add_u32 s57, s57, 12288
    buffer_store_dwordx4 v[72:75], v7, s[20:23], s57 offen offset:0
    buffer_store_dwordx4 v[76:79], v7, s[20:23], s57 offen offset:1024
    s_lshl_b32 s26, s3, 13
    v_add_u32 v16, s26, v1
    s_sub_u32 s26, s3, 1
    s_and_b32 s26, s26, 3
    s_lshl_b32 s26, s26, 13
    v_add_u32 v9, s26, v1
    s_sub_u32 s26, s3, 2
    s_and_b32 s26, s26, 3
    s_lshl_b32 s26, s26, 13
    v_add_u32 v10, s26, v1
    s_sub_u32 s26, s3, 3
    s_and_b32 s26, s26, 3
    s_lshl_b32 s26, s26, 13
    v_add_u32 v11, s26, v1
    v_add_u32 v17, 0x10000, v16
    v_add_u32 v18, 0x20000, v16
    s_waitcnt vmcnt(18)
    ds_read_b128 a[240:243], v18 offset:0
    ds_read_b128 a[244:247], v18 offset:1024
    ds_read_b128 a[248:251], v18 offset:2048
    ds_read_b128 a[252:255], v18 offset:3072
    v_lshlrev_b32 v32, 16, v240
    v_and_b32 v33, 0xffff0000, v240
    v_lshlrev_b32 v34, 16, v241
    v_and_b32 v35, 0xffff0000, v241
    v_lshlrev_b32 v48, 16, v242
    v_and_b32 v49, 0xffff0000, v242
    v_lshlrev_b32 v50, 16, v243
    v_and_b32 v51, 0xffff0000, v243
    v_lshlrev_b32 v64, 16, v244
    v_and_b32 v65, 0xffff0000, v244
    v_lshlrev_b32 v66, 16, v245
    v_and_b32 v67, 0xffff0000, v245
    v_lshlrev_b32 v80, 16, v246
    v_and_b32 v81, 0xffff0000, v246
    v_lshlrev_b32 v82, 16, v247
    v_and_b32 v83, 0xffff0000, v247
    v_bfe_u32 v20, v1, 4, 4
    v_lshlrev_b32 v20, 10, v20
    v_bfe_u32 v21, v1, 8, 1
    v_lshl_add_u32 v20, v21, 5, v20
    v_lshrrev_b32 v21, 9, v1
    v_lshl_add_u32 v20, v21, 4, v20
    v_add_u32 v20, s71, v20
    s_mov_b32 s14, 2097152
    s_waitcnt lgkmcnt(0)
    s_waitcnt vmcnt(0)
    s_barrier
    s_or_b32 s99, s98, s3
    s_cmp_eq_u32 s99, 0
    s_cbranch_scc1 L_wb2
    buffer_store_dword v2, v14, s[60:63], 0 offen
L_wbb2:
    s_waitcnt vmcnt(15)
    v_mfma_f32_16x16x32_bf16 v[32:35], a[240:243], v[192:195], v[32:35]
    s_add_u32 m0, s59, 65536
    v_mfma_f32_16x16x32_bf16 v[36:39], a[240:243], v[196:199], 0
    s_mov_b32 s56, 8192
    v_mfma_f32_16x16x32_bf16 v[40:43], a[240:243], v[200:203], 0
    buffer_load_dwordx4 v15, s[4:7], s56 offen offset:0 sc1 lds
    v_mfma_f32_16x16x32_bf16 v[44:47], a[240:243], v[204:207], 0
    ds_read_b128 a[240:243], v18 offset:4096
    v_mfma_f32_16x16x32_bf16 v[48:51], a[244:247], v[192:195], v[48:51]
    buffer_load_dwordx4 v15, s[4:7], s56 offen offset:1024 sc1 lds
    v_mfma_f32_16x16x32_bf16 v[52:55], a[244:247], v[196:199], 0
    v_mfma_f32_16x16x32_bf16 v[56:59], a[244:247], v[200:203], 0
    v_mfma_f32_16x16x32_bf16 v[60:63], a[244:247], v[204:207], 0
    ds_read_b128 a[244:247], v18 offset:5120
    v_mfma_f32_16x16x32_bf16 v[64:67], a[248:251], v[192:195], v[64:67]
    buffer_load_dwordx4 v15, s[4:7], s56 offen offset:2048 sc1 lds
    v_mfma_f32_16x16x32_bf16 v[68:71], a[248:251], v[196:199], 0
    v_mfma_f32_16x16x32_bf16 v[72:75], a[248:251], v[200:203], 0
    v_mfma_f32_16x16x32_bf16 v[76:79], a[248:251], v[204:207], 0
    ds_read_b128 a[248:251], v18 offset:6144
    v_mfma_f32_16x16x32_bf16 v[80:83], a[252:255], v[192:195], v[80:83]
    buffer_load_dwordx4 v15, s[4:7], s56 offen offset:3072 sc1 lds
    v_mfma_f32_16x16x32_bf16 v[84:87], a[252:255], v[196:199], 0
    v_mfma_f32_16x16x32_bf16 v[88:91], a[252:255], v[200:203], 0
    v_mfma_f32_16x16x32_bf16 v[92:95], a[252:255], v[204:207], 0
    ds_read_b128 a[252:255], v18 offset:7168
    buffer_load_dword v29, v28, s[60:63], 0 offen sc1
    s_waitcnt vmcnt(16) lgkmcnt(3)
    v_mfma_f32_16x16x32_bf16 v[32:35], a[240:243], v[208:211], v[32:35]
    s_add_u32 m0, s59, 69632
    v_mfma_f32_16x16x32_bf16 v[36:39], a[240:243], v[212:215], v[36:39]
    s_mov_b32 s56, 20480
    v_mfma_f32_16x16x32_bf16 v[40:43], a[240:243], v[216:219], v[40:43]
    buffer_load_dwordx4 v15, s[4:7], s56 offen offset:0 sc1 lds
    v_mfma_f32_16x16x32_bf16 v[44:47], a[240:243], v[220:223], v[44:47]
    ds_read_b128 a[240:243], v16 offset:0
    s_waitcnt lgkmcnt(3)
    v_mfma_f32_16x16x32_bf16 v[48:51], a[244:247], v[208:211], v[48:51]
    buffer_load_dwordx4 v15, s[4:7], s56 offen offset:1024 sc1 lds
    v_mfma_f32_16x16x32_bf16 v[52:55], a[244:247], v[212:215], v[52:55]
    v_mfma_f32_16x16x32_bf16 v[56:59], a[244:247], v[216:219], v[56:59]
    v_mfma_f32_16x16x32_bf16 v[60:63], a[244:247], v[220:223], v[60:63]
    ds_read_b128 a[244:247], v16 offset:1024
    s_waitcnt lgkmcnt(3)
    v_mfma_f32_16x16x32_bf16 v[64:67], a[248:251], v[208:211], v[64:67]
    buffer_load_dwordx4 v15, s[4:7], s56 offen offset:2048 sc1 lds
    v_mfma_f32_16x16x32_bf16 v[68:71], a[248:251], v[212:215], v[68:71]
    v_mfma_f32_16x16x32_bf16 v[72:75], a[248:251], v[216:219], v[72:75]
    v_mfma_f32_16x16x32_bf16 v[76:79], a[248:251], v[220:223], v[76:79]
    ds_read_b128 a[248:251], v16 offset:2048
    s_waitcnt lgkmcnt(3)
    v_mfma_f32_16x16x32_bf16 v[80:83], a[252:255], v[208:211], v[80:83]
    buffer_load_dwordx4 v15, s[4:7], s56 offen offset:3072 sc1 lds
    v_mfma_f32_16x16x32_bf16 v[84:87], a[252:255], v[212:215], v[84:87]
    v_mfma_f32_16x16x32_bf16 v[88:91], a[252:255], v[216:219], v[88:91]
    v_mfma_f32_16x16x32_bf16 v[92:95], a[252:255], v[220:223], v[92:95]
    ds_read_b128 a[252:255], v16 offset:3072
    s_waitcnt vmcnt(16) lgkmcnt(3)
    v_mfma_f32_16x16x32_bf16 v[32:35], a[240:243], v[224:227], v[32:35]
    v_mfma_f32_16x16x32_bf16 v[36:39], a[240:243], v[228:231], v[36:39]
    v_mfma_f32_16x16x32_bf16 v[40:43], a[240:243], v[232:235], v[40:43]
    v_mfma_f32_16x16x32_bf16 v[44:47], a[240:243], v[236:239], v[44:47]
    ds_read_b128 a[240:243], v16 offset:4096
    s_waitcnt lgkmcnt(3)
    v_mfma_f32_16x16x32_bf16 v[48:51], a[244:247], v[224:227], v[48:51]
    v_mfma_f32_16x16x32_bf16 v[52:55], a[244:247], v[228:231], v[52:55]
    v_mfma_f32_16x16x32_bf16 v[56:59], a[244:247], v[232:235], v[56:59]
    v_mfma_f32_16x16x32_bf16 v[60:63], a[244:247], v[236:239], v[60:63]
    ds_read_b128 a[244:247], v16 offset:5120
    s_waitcnt lgkmcnt(3)
    v_mfma_f32_16x16x32_bf16 v[64:67], a[248:251], v[224:227], v[64:67]
    v_mfma_f32_16x16x32_bf16 v[68:71], a[248:251], v[228:231], v[68:71]
    v_mfma_f32_16x16x32_bf16 v[72:75], a[248:251], v[232:235], v[72:75]
    v_mfma_f32_16x16x32_bf16 v[76:79], a[248:251], v[236:239], v[76:79]
    ds_read_b128 a[248:251], v16 offset:6144
    s_waitcnt lgkmcnt(3)
    v_mfma_f32_16x16x32_bf16 v[80:83], a[252:255], v[224:227], v[80:83]
    v_mfma_f32_16x16x32_bf16 v[84:87], a[252:255], v[228:231], v[84:87]
    v_mfma_f32_16x16x32_bf16 v[88:91], a[252:255], v[232:235], v[88:91]
    v_mfma_f32_16x16x32_bf16 v[92:95], a[252:255], v[236:239], v[92:95]
    ds_read_b128 a[252:255], v16 offset:7168
    s_waitcnt vmcnt(4)
    v_cmp_ne_u32 vcc, 1, v29
    s_nop 4
    s_cbranch_vccnz L_spin6
L_back6:
    s_mov_b32 s40, 32768
    buffer_load_dwordx4 a[144:147], v24, s[20:23], s40 offen sc1
    buffer_load_dwordx4 a[148:151], v25, s[20:23], s40 offen sc1
    buffer_load_dwordx4 a[152:155], v26, s[20:23], s40 offen sc1
    buffer_load_dwordx4 a[156:159], v27, s[20:23], s40 offen sc1
    s_mov_b32 s40, 45056
    buffer_load_dwordx4 a[160:163], v24, s[20:23], s40 offen sc1
    buffer_load_dwordx4 a[164:167], v25, s[20:23], s40 offen sc1
    buffer_load_dwordx4 a[168:171], v26, s[20:23], s40 offen sc1
    buffer_load_dwordx4 a[172:175], v27, s[20:23], s40 offen sc1
    s_waitcnt vmcnt(20) lgkmcnt(3)
    v_mfma_f32_16x16x32_bf16 v[32:35], a[240:243], a[128:131], v[32:35]
    s_mov_b32 s40, 8192
    v_mfma_f32_16x16x32_bf16 v[36:39], a[240:243], a[132:135], v[36:39]
    buffer_load_dwordx4 a[176:179], v24, s[20:23], s40 offen sc1
    v_mfma_f32_16x16x32_bf16 v[40:43], a[240:243], a[136:139], v[40:43]
    v_mfma_f32_16x16x32_bf16 v[44:47], a[240:243], a[140:143], v[44:47]
    ds_read_b128 a[240:243], v16 offset:32768
    s_waitcnt lgkmcnt(3)
    v_mfma_f32_16x16x32_bf16 v[48:51], a[244:247], a[128:131], v[48:51]
    buffer_load_dwordx4 a[180:183], v25, s[20:23], s40 offen sc1
    v_mfma_f32_16x16x32_bf16 v[52:55], a[244:247], a[132:135], v[52:55]
    v_mfma_f32_16x16x32_bf16 v[56:59], a[244:247], a[136:139], v[56:59]
    v_mfma_f32_16x16x32_bf16 v[60:63], a[244:247], a[140:143], v[60:63]
    ds_read_b128 a[244:247], v16 offset:33792
    s_waitcnt lgkmcnt(3)
    v_mfma_f32_16x16x32_bf16 v[64:67], a[248:251], a[128:131], v[64:67]
    buffer_load_dwordx4 a[184:187], v26, s[20:23], s40 offen sc1
    v_mfma_f32_16x16x32_bf16 v[68:71], a[248:251], a[132:135], v[68:71]
    v_mfma_f32_16x16x32_bf16 v[72:75], a[248:251], a[136:139], v[72:75]
    v_mfma_f32_16x16x32_bf16 v[76:79], a[248:251], a[140:143], v[76:79]
    ds_read_b128 a[248:251], v16 offset:34816
    s_waitcnt lgkmcnt(3)
    v_mfma_f32_16x16x32_bf16 v[80:83], a[252:255], a[128:131], v[80:83]
    buffer_load_dwordx4 a[188:191], v27, s[20:23], s40 offen sc1
    v_mfma_f32_16x16x32_bf16 v[84:87], a[252:255], a[132:135], v[84:87]
    v_mfma_f32_16x16x32_bf16 v[88:91], a[252:255], a[136:139], v[88:91]
    v_mfma_f32_16x16x32_bf16 v[92:95], a[252:255], a[140:143], v[92:95]
    ds_read_b128 a[252:255], v16 offset:35840
    s_waitcnt vmcnt(8) lgkmcnt(3)
    v_mfma_f32_16x16x32_bf16 v[32:35], a[240:243], a[144:147], v[32:35]
    s_mov_b32 s40, 20480
    v_mfma_f32_16x16x32_bf16 v[36:39], a[240:243], a[148:151], v[36:39]
    buffer_load_dwordx4 a[0:3], v24, s[20:23], s40 offen sc1
    v_mfma_f32_16x16x32_bf16 v[40:43], a[240:243], a[152:155], v[40:43]
    v_mfma_f32_16x16x32_bf16 v[44:47], a[240:243], a[156:159], v[44:47]
    ds_read_b128 a[240:243], v16 offset:36864
    s_waitcnt lgkmcnt(3)
    v_mfma_f32_16x16x32_bf16 v[48:51], a[244:247], a[144:147], v[48:51]
    buffer_load_dwordx4 a[4:7], v25, s[20:23], s40 offen sc1
    v_mfma_f32_16x16x32_bf16 v[52:55], a[244:247], a[148:151], v[52:55]
    v_mfma_f32_16x16x32_bf16 v[56:59], a[244:247], a[152:155], v[56:59]
    v_mfma_f32_16x16x32_bf16 v[60:63], a[244:247], a[156:159], v[60:63]
    ds_read_b128 a[244:247], v16 offset:37888
    s_waitcnt lgkmcnt(3)
    v_mfma_f32_16x16x32_bf16 v[64:67], a[248:251], a[144:147], v[64:67]
    buffer_load_dwordx4 a[8:11], v26, s[20:23], s40 offen sc1
    v_mfma_f32_16x16x32_bf16 v[68:71], a[248:251], a[148:151], v[68:71]
    v_mfma_f32_16x16x32_bf16 v[72:75], a[248:251], a[152:155], v[72:75]
    v_mfma_f32_16x16x32_bf16 v[76:79], a[248:251], a[156:159], v[76:79]
    ds_read_b128 a[248:251], v16 offset:38912
    s_waitcnt lgkmcnt(3)
    v_mfma_f32_16x16x32_bf16 v[80:83], a[252:255], a[144:147], v[80:83]
    buffer_load_dwordx4 a[12:15], v27, s[20:23], s40 offen sc1
    v_mfma_f32_16x16x32_bf16 v[84:87], a[252:255], a[148:151], v[84:87]
    v_mfma_f32_16x16x32_bf16 v[88:91], a[252:255], a[152:155], v[88:91]
    v_mfma_f32_16x16x32_bf16 v[92:95], a[252:255], a[156:159], v[92:95]
    ds_read_b128 a[252:255], v16 offset:39936
    s_waitcnt vmcnt(8) lgkmcnt(3)
    v_mfma_f32_16x16x32_bf16 v[32:35], a[240:243], a[160:163], v[32:35]
    s_mov_b32 s40, 36864
    v_mfma_f32_16x16x32_bf16 v[36:39], a[240:243], a[164:167], v[36:39]
    buffer_load_dwordx4 a[16:19], v24, s[20:23], s40 offen sc1
    v_mfma_f32_16x16x32_bf16 v[40:43], a[240:243], a[168:171], v[40:43]
    v_mfma_f32_16x16x32_bf16 v[44:47], a[240:243], a[172:175], v[44:47]
    ds_read_b128 a[240:243], v17 offset:0
    s_waitcnt lgkmcnt(3)
    v_mfma_f32_16x16x32_bf16 v[48:51], a[244:247], a[160:163], v[48:51]
    buffer_load_dwordx4 a[20:23], v25, s[20:23], s40 offen sc1
    v_mfma_f32_16x16x32_bf16 v[52:55], a[244:247], a[164:167], v[52:55]
    v_mfma_f32_16x16x32_bf16 v[56:59], a[244:247], a[168:171], v[56:59]
    v_mfma_f32_16x16x32_bf16 v[60:63], a[244:247], a[172:175], v[60:63]
    ds_read_b128 a[244:247], v17 offset:1024
    s_waitcnt lgkmcnt(3)
    v_mfma_f32_16x16x32_bf16 v[64:67], a[248:251], a[160:163], v[64:67]
    buffer_load_dwordx4 a[24:27], v26, s[20:23], s40 offen sc1
    v_mfma_f32_16x16x32_bf16 v[68:71], a[248:251], a[164:167], v[68:71]
    v_mfma_f32_16x16x32_bf16 v[72:75], a[248:251], a[168:171], v[72:75]
    v_mfma_f32_16x16x32_bf16 v[76:79], a[248:251], a[172:175], v[76:79]
    ds_read_b128 a[248:251], v17 offset:2048
    s_waitcnt lgkmcnt(3)
    v_mfma_f32_16x16x32_bf16 v[80:83], a[252:255], a[160:163], v[80:83]
    buffer_load_dwordx4 a[28:31], v27, s[20:23], s40 offen sc1
    v_mfma_f32_16x16x32_bf16 v[84:87], a[252:255], a[164:167], v[84:87]
    v_mfma_f32_16x16x32_bf16 v[88:91], a[252:255], a[168:171], v[88:91]
    v_mfma_f32_16x16x32_bf16 v[92:95], a[252:255], a[172:175], v[92:95]
    ds_read_b128 a[252:255], v17 offset:3072
    s_waitcnt vmcnt(8) lgkmcnt(3)
    v_mfma_f32_16x16x32_bf16 v[32:35], a[240:243], a[176:179], v[32:35]
    s_mov_b32 s40, 49152
    v_mfma_f32_16x16x32_bf16 v[36:39], a[240:243], a[180:183], v[36:39]
    buffer_load_dwordx4 a[32:35], v24, s[20:23], s40 offen sc1
    v_mfma_f32_16x16x32_bf16 v[40:43], a[240:243], a[184:187], v[40:43]
    v_mfma_f32_16x16x32_bf16 v[44:47], a[240:243], a[188:191], v[44:47]
    ds_read_b128 a[240:243], v17 offset:4096
    s_waitcnt lgkmcnt(3)
    v_mfma_f32_16x16x32_bf16 v[48:51], a[244:247], a[176:179], v[48:51]
    buffer_load_dwordx4 a[36:39], v25, s[20:23], s40 offen sc1
    v_mfma_f32_16x16x32_bf16 v[52:55], a[244:247], a[180:183], v[52:55]
    v_mfma_f32_16x16x32_bf16 v[56:59], a[244:247], a[184:187], v[56:59]
    v_mfma_f32_16x16x32_bf16 v[60:63], a[244:247], a[188:191], v[60:63]
    ds_read_b128 a[244:247], v17 offset:5120
    s_waitcnt lgkmcnt(3)
    v_mfma_f32_16x16x32_bf16 v[64:67], a[248:251], a[176:179], v[64:67]
    buffer_load_dwordx4 a[40:43], v26, s[20:23], s40 offen sc1
    v_mfma_f32_16x16x32_bf16 v[68:71], a[248:251], a[180:183], v[68:71]
    v_mfma_f32_16x16x32_bf16 v[72:75], a[248:251], a[184:187], v[72:75]
    v_mfma_f32_16x16x32_bf16 v[76:79], a[248:251], a[188:191], v[76:79]
    ds_read_b128 a[248:251], v17 offset:6144
    s_waitcnt lgkmcnt(3)
    v_mfma_f32_16x16x32_bf16 v[80:83], a[252:255], a[176:179], v[80:83]
    buffer_load_dwordx4 a[44:47], v27, s[20:23], s40 offen sc1
    v_mfma_f32_16x16x32_bf16 v[84:87], a[252:255], a[180:183], v[84:87]
    v_mfma_f32_16x16x32_bf16 v[88:91], a[252:255], a[184:187], v[88:91]
    v_mfma_f32_16x16x32_bf16 v[92:95], a[252:255], a[188:191], v[92:95]
    ds_read_b128 a[252:255], v17 offset:7168
    s_waitcnt vmcnt(8) lgkmcnt(3)
    v_mfma_f32_16x16x32_bf16 v[32:35], a[240:243], a[0:3], v[32:35]
    s_mov_b32 s40, 12288
    v_mfma_f32_16x16x32_bf16 v[36:39], a[240:243], a[4:7], v[36:39]
    buffer_load_dwordx4 a[48:51], v24, s[20:23], s40 offen sc1
    v_mfma_f32_16x16x32_bf16 v[40:43], a[240:243], a[8:11], v[40:43]
    v_mfma_f32_16x16x32_bf16 v[44:47], a[240:243], a[12:15], v[44:47]
    s_waitcnt lgkmcnt(2)
    v_mfma_f32_16x16x32_bf16 v[48:51], a[244:247], a[0:3], v[48:51]
    buffer_load_dwordx4 a[52:55], v25, s[20:23], s40 offen sc1
    v_mfma_f32_16x16x32_bf16 v[52:55], a[244:247], a[4:7], v[52:55]
    v_mfma_f32_16x16x32_bf16 v[56:59], a[244:247], a[8:11], v[56:59]
    v_mfma_f32_16x16x32_bf16 v[60:63], a[244:247], a[12:15], v[60:63]
    s_waitcnt lgkmcnt(1)
    v_mfma_f32_16x16x32_bf16 v[64:67], a[248:251], a[0:3], v[64:67]
    buffer_load_dwordx4 a[56:59], v26, s[20:23], s40 offen sc1
    v_mfma_f32_16x16x32_bf16 v[68:71], a[248:251], a[4:7], v[68:71]
    v_mfma_f32_16x16x32_bf16 v[72:75], a[248:251], a[8:11], v[72:75]
    v_mfma_f32_16x16x32_bf16 v[76:79], a[248:251], a[12:15], v[76:79]
    s_waitcnt lgkmcnt(0)
    v_mfma_f32_16x16x32_bf16 v[80:83], a[252:255], a[0:3], v[80:83]
    buffer_load_dwordx4 a[60:63], v27, s[20:23], s40 offen sc1
    v_mfma_f32_16x16x32_bf16 v[84:87], a[252:255], a[4:7], v[84:87]
    v_mfma_f32_16x16x32_bf16 v[88:91], a[252:255], a[8:11], v[88:91]
    v_mfma_f32_16x16x32_bf16 v[92:95], a[252:255], a[12:15], v[92:95]
    s_waitcnt vmcnt(8)
    v_mfma_f32_16x16x32_bf16 v[32:35], v[96:99], a[16:19], v[32:35]
    s_mov_b32 s40, 24576
    v_mfma_f32_16x16x32_bf16 v[36:39], v[96:99], a[20:23], v[36:39]
    buffer_load_dwordx4 a[64:67], v24, s[20:23], s40 offen sc1
    v_mfma_f32_16x16x32_bf16 v[40:43], v[96:99], a[24:27], v[40:43]
    v_mfma_f32_16x16x32_bf16 v[44:47], v[96:99], a[28:31], v[44:47]
    v_mfma_f32_16x16x32_bf16 v[48:51], v[100:103], a[16:19], v[48:51]
    buffer_load_dwordx4 a[68:71], v25, s[20:23], s40 offen sc1
    v_mfma_f32_16x16x32_bf16 v[52:55], v[100:103], a[20:23], v[52:55]
    v_mfma_f32_16x16x32_bf16 v[56:59], v[100:103], a[24:27], v[56:59]
    v_mfma_f32_16x16x32_bf16 v[60:63], v[100:103], a[28:31], v[60:63]
    v_mfma_f32_16x16x32_bf16 v[64:67], v[104:107], a[16:19], v[64:67]
    buffer_load_dwordx4 a[72:75], v26, s[20:23], s40 offen sc1
    v_mfma_f32_16x16x32_bf16 v[68:71], v[104:107], a[20:23], v[68:71]
    v_mfma_f32_16x16x32_bf16 v[72:75], v[104:107], a[24:27], v[72:75]
    v_mfma_f32_16x16x32_bf16 v[76:79], v[104:107], a[28:31], v[76:79]
    v_mfma_f32_16x16x32_bf16 v[80:83], v[108:111], a[16:19], v[80:83]
    buffer_load_dwordx4 a[76:79], v27, s[20:23], s40 offen sc1
    v_mfma_f32_16x16x32_bf16 v[84:87], v[108:111], a[20:23], v[84:87]
    v_mfma_f32_16x16x32_bf16 v[88:91], v[108:111], a[24:27], v[88:91]
    v_mfma_f32_16x16x32_bf16 v[92:95], v[108:111], a[28:31], v[92:95]
    s_waitcnt vmcnt(8)
    v_mfma_f32_16x16x32_bf16 v[32:35], v[112:115], a[32:35], v[32:35]
    s_mov_b32 s40, 40960
    v_mfma_f32_16x16x32_bf16 v[36:39], v[112:115], a[36:39], v[36:39]
    buffer_load_dwordx4 a[80:83], v24, s[20:23], s40 offen sc1
    v_mfma_f32_16x16x32_bf16 v[40:43], v[112:115], a[40:43], v[40:43]
    v_mfma_f32_16x16x32_bf16 v[44:47], v[112:115], a[44:47], v[44:47]
    v_mfma_f32_16x16x32_bf16 v[48:51], v[116:119], a[32:35], v[48:51]
    buffer_load_dwordx4 a[84:87], v25, s[20:23], s40 offen sc1
    v_mfma_f32_16x16x32_bf16 v[52:55], v[116:119], a[36:39], v[52:55]
    v_mfma_f32_16x16x32_bf16 v[56:59], v[116:119], a[40:43], v[56:59]
    v_mfma_f32_16x16x32_bf16 v[60:63], v[116:119], a[44:47], v[60:63]
    v_mfma_f32_16x16x32_bf16 v[64:67], v[120:123], a[32:35], v[64:67]
    buffer_load_dwordx4 a[88:91], v26, s[20:23], s40 offen sc1
    v_mfma_f32_16x16x32_bf16 v[68:71], v[120:123], a[36:39], v[68:71]
    v_mfma_f32_16x16x32_bf16 v[72:75], v[120:123], a[40:43], v[72:75]
    v_mfma_f32_16x16x32_bf16 v[76:79], v[120:123], a[44:47], v[76:79]
    v_mfma_f32_16x16x32_bf16 v[80:83], v[124:127], a[32:35], v[80:83]
    buffer_load_dwordx4 a[92:95], v27, s[20:23], s40 offen sc1
    v_mfma_f32_16x16x32_bf16 v[84:87], v[124:127], a[36:39], v[84:87]
    v_mfma_f32_16x16x32_bf16 v[88:91], v[124:127], a[40:43], v[88:91]
    v_mfma_f32_16x16x32_bf16 v[92:95], v[124:127], a[44:47], v[92:95]
    s_waitcnt vmcnt(8)
    v_mfma_f32_16x16x32_bf16 v[32:35], v[128:131], a[48:51], v[32:35]
    s_mov_b32 s40, 53248
    v_mfma_f32_16x16x32_bf16 v[36:39], v[128:131], a[52:55], v[36:39]
    buffer_load_dwordx4 a[96:99], v24, s[20:23], s40 offen sc1
    v_mfma_f32_16x16x32_bf16 v[40:43], v[128:131], a[56:59], v[40:43]
    v_mfma_f32_16x16x32_bf16 v[44:47], v[128:131], a[60:63], v[44:47]
    v_mfma_f32_16x16x32_bf16 v[48:51], v[132:135], a[48:51], v[48:51]
    buffer_load_dwordx4 a[100:103], v25, s[20:23], s40 offen sc1
    v_mfma_f32_16x16x32_bf16 v[52:55], v[132:135], a[52:55], v[52:55]
    v_mfma_f32_16x16x32_bf16 v[56:59], v[132:135], a[56:59], v[56:59]
    v_mfma_f32_16x16x32_bf16 v[60:63], v[132:135], a[60:63], v[60:63]
    v_mfma_f32_16x16x32_bf16 v[64:67], v[136:139], a[48:51], v[64:67]
    buffer_load_dwordx4 a[104:107], v26, s[20:23], s40 offen sc1
    v_mfma_f32_16x16x32_bf16 v[68:71], v[136:139], a[52:55], v[68:71]
    v_mfma_f32_16x16x32_bf16 v[72:75], v[136:139], a[56:59], v[72:75]
    v_mfma_f32_16x16x32_bf16 v[76:79], v[136:139], a[60:63], v[76:79]
    v_mfma_f32_16x16x32_bf16 v[80:83], v[140:143], a[48:51], v[80:83]
    buffer_load_dwordx4 a[108:111], v27, s[20:23], s40 offen sc1
    v_mfma_f32_16x16x32_bf16 v[84:87], v[140:143], a[52:55], v[84:87]
    v_mfma_f32_16x16x32_bf16 v[88:91], v[140:143], a[56:59], v[88:91]
    v_mfma_f32_16x16x32_bf16 v[92:95], v[140:143], a[60:63], v[92:95]
    s_waitcnt vmcnt(8)
    v_mfma_f32_16x16x32_bf16 v[32:35], v[144:147], a[64:67], v[32:35]
    v_mfma_f32_16x16x32_bf16 v[36:39], v[144:147], a[68:71], v[36:39]
    v_mfma_f32_16x16x32_bf16 v[40:43], v[144:147], a[72:75], v[40:43]
    v_mfma_f32_16x16x32_bf16 v[44:47], v[144:147], a[76:79], v[44:47]
    v_mfma_f32_16x16x32_bf16 v[48:51], v[148:151], a[64:67], v[48:51]
    v_mfma_f32_16x16x32_bf16 v[52:55], v[148:151], a[68:71], v[52:55]
    v_mfma_f32_16x16x32_bf16 v[56:59], v[148:151], a[72:75], v[56:59]
    v_mfma_f32_16x16x32_bf16 v[60:63], v[148:151], a[76:79], v[60:63]
    v_mfma_f32_16x16x32_bf16 v[64:67], v[152:155], a[64:67], v[64:67]
    v_mfma_f32_16x16x32_bf16 v[68:71], v[152:155], a[68:71], v[68:71]
    v_mfma_f32_16x16x32_bf16 v[72:75], v[152:155], a[72:75], v[72:75]
    v_mfma_f32_16x16x32_bf16 v[76:79], v[152:155], a[76:79], v[76:79]
    v_mfma_f32_16x16x32_bf16 v[80:83], v[156:159], a[64:67], v[80:83]
    v_mfma_f32_16x16x32_bf16 v[84:87], v[156:159], a[68:71], v[84:87]
    v_mfma_f32_16x16x32_bf16 v[88:91], v[156:159], a[72:75], v[88:91]
    v_mfma_f32_16x16x32_bf16 v[92:95], v[156:159], a[76:79], v[92:95]
    s_waitcnt vmcnt(0)
    s_lshr_b32 s26, s2, 3
    s_and_b32 s26, s26, 31
    s_or_b32 s26, s26, s3
    s_cmp_eq_u32 s26, 0
    s_cbranch_scc0 L_nowb
    buffer_wbl2 sc1
L_nowb:
    v_mfma_f32_16x16x32_bf16 v[36:39], v[160:163], a[84:87], v[36:39]
    v_mfma_f32_16x16x32_bf16 v[52:55], v[164:167], a[84:87], v[52:55]
    v_mfma_f32_16x16x32_bf16 v[68:71], v[168:171], a[84:87], v[68:71]
    v_mfma_f32_16x16x32_bf16 v[84:87], v[172:175], a[84:87], v[84:87]
    v_mfma_f32_16x16x32_bf16 v[36:39], v[176:179], a[100:103], v[36:39]
    v_mfma_f32_16x16x32_bf16 v[52:55], v[180:183], a[100:103], v[52:55]
    v_mfma_f32_16x16x32_bf16 v[68:71], v[184:187], a[100:103], v[68:71]
    v_mfma_f32_16x16x32_bf16 v[84:87], v[188:191], a[100:103], v[84:87]
    v_mfma_f32_16x16x32_bf16 v[40:43], v[160:163], a[88:91], v[40:43]
    v_mfma_f32_16x16x32_bf16 v[56:59], v[164:167], a[88:91], v[56:59]
    v_mfma_f32_16x16x32_bf16 v[72:75], v[168:171], a[88:91], v[72:75]
    v_mfma_f32_16x16x32_bf16 v[88:91], v[172:175], a[88:91], v[88:91]
    v_mfma_f32_16x16x32_bf16 v[40:43], v[176:179], a[104:107], v[40:43]
    ds_write_b128 v16, v[36:39] offset:0
    v_mfma_f32_16x16x32_bf16 v[56:59], v[180:183], a[104:107], v[56:59]
    ds_write_b128 v16, v[52:55] offset:1024
    v_mfma_f32_16x16x32_bf16 v[72:75], v[184:187], a[104:107], v[72:75]
    ds_write_b128 v16, v[68:71] offset:2048
    v_mfma_f32_16x16x32_bf16 v[88:91], v[188:191], a[104:107], v[88:91]
    ds_write_b128 v16, v[84:87] offset:3072
    v_mfma_f32_16x16x32_bf16 v[44:47], v[160:163], a[92:95], v[44:47]
    v_mfma_f32_16x16x32_bf16 v[60:63], v[164:167], a[92:95], v[60:63]
    v_mfma_f32_16x16x32_bf16 v[76:79], v[168:171], a[92:95], v[76:79]
    v_mfma_f32_16x16x32_bf16 v[92:95], v[172:175], a[92:95], v[92:95]
    v_mfma_f32_16x16x32_bf16 v[44:47], v[176:179], a[108:111], v[44:47]
    ds_write_b128 v16, v[40:43] offset:4096
    v_mfma_f32_16x16x32_bf16 v[60:63], v[180:183], a[108:111], v[60:63]
    ds_write_b128 v16, v[56:59] offset:5120
    v_mfma_f32_16x16x32_bf16 v[76:79], v[184:187], a[108:111], v[76:79]
    ds_write_b128 v16, v[72:75] offset:6144
    v_mfma_f32_16x16x32_bf16 v[92:95], v[188:191], a[108:111], v[92:95]
    ds_write_b128 v16, v[88:91] offset:7168
    v_mfma_f32_16x16x32_bf16 v[32:35], v[160:163], a[80:83], v[32:35]
    v_mfma_f32_16x16x32_bf16 v[48:51], v[164:167], a[80:83], v[48:51]
    v_mfma_f32_16x16x32_bf16 v[64:67], v[168:171], a[80:83], v[64:67]
    v_mfma_f32_16x16x32_bf16 v[80:83], v[172:175], a[80:83], v[80:83]
    v_mfma_f32_16x16x32_bf16 v[32:35], v[176:179], a[96:99], v[32:35]
    ds_write_b128 v16, v[44:47] offset:32768
    v_mfma_f32_16x16x32_bf16 v[48:51], v[180:183], a[96:99], v[48:51]
    ds_write_b128 v16, v[60:63] offset:33792
    v_mfma_f32_16x16x32_bf16 v[64:67], v[184:187], a[96:99], v[64:67]
    ds_write_b128 v16, v[76:79] offset:34816
    v_mfma_f32_16x16x32_bf16 v[80:83], v[188:191], a[96:99], v[80:83]
    ds_write_b128 v16, v[92:95] offset:35840
    s_waitcnt lgkmcnt(0)
    s_barrier
    ds_read_b128 v[36:39], v9 offset:0
    ds_read_b128 v[52:55], v9 offset:1024
    ds_read_b128 v[68:71], v9 offset:2048
    ds_read_b128 v[84:87], v9 offset:3072
    ds_read_b128 v[40:43], v10 offset:4096
    ds_read_b128 v[56:59], v10 offset:5120
    ds_read_b128 v[72:75], v10 offset:6144
    ds_read_b128 v[88:91], v10 offset:7168
    ds_read_b128 v[44:47], v11 offset:32768
    ds_read_b128 v[60:63], v11 offset:33792
    ds_read_b128 v[76:79], v11 offset:34816
    ds_read_b128 v[92:95], v11 offset:35840
    s_waitcnt lgkmcnt(10)
    v_pk_add_f32 v[32:33], v[32:33], v[36:37]
    v_pk_add_f32 v[34:35], v[34:35], v[38:39]
    v_pk_add_f32 v[48:49], v[48:49], v[52:53]
    v_pk_add_f32 v[50:51], v[50:51], v[54:55]
    s_waitcnt lgkmcnt(8)
    v_pk_add_f32 v[64:65], v[64:65], v[68:69]
    v_pk_add_f32 v[66:67], v[66:67], v[70:71]
    v_pk_add_f32 v[80:81], v[80:81], v[84:85]
    v_pk_add_f32 v[82:83], v[82:83], v[86:87]
    s_waitcnt lgkmcnt(6)
    v_pk_add_f32 v[32:33], v[32:33], v[40:41]
    v_pk_add_f32 v[34:35], v[34:35], v[42:43]
    v_pk_add_f32 v[48:49], v[48:49], v[56:57]
    v_pk_add_f32 v[50:51], v[50:51], v[58:59]
    s_waitcnt lgkmcnt(4)
    v_pk_add_f32 v[64:65], v[64:65], v[72:73]
    v_pk_add_f32 v[66:67], v[66:67], v[74:75]
    v_pk_add_f32 v[80:81], v[80:81], v[88:89]
    v_pk_add_f32 v[82:83], v[82:83], v[90:91]
    s_waitcnt lgkmcnt(2)
    v_pk_add_f32 v[32:33], v[32:33], v[44:45]
    v_pk_add_f32 v[34:35], v[34:35], v[46:47]
    v_pk_add_f32 v[48:49], v[48:49], v[60:61]
    v_pk_add_f32 v[50:51], v[50:51], v[62:63]
    s_waitcnt lgkmcnt(0)
    v_pk_add_f32 v[64:65], v[64:65], v[76:77]
    v_pk_add_f32 v[66:67], v[66:67], v[78:79]
    v_pk_add_f32 v[80:81], v[80:81], v[92:93]
    v_pk_add_f32 v[82:83], v[82:83], v[94:95]
    v_cvt_pk_bf16_f32 v96, v32, v33
    v_cvt_pk_bf16_f32 v97, v34, v35
    v_cvt_pk_bf16_f32 v98, v48, v49
    v_cvt_pk_bf16_f32 v99, v50, v51
    v_cvt_pk_bf16_f32 v100, v64, v65
    v_cvt_pk_bf16_f32 v101, v66, v67
    v_cvt_pk_bf16_f32 v102, v80, v81
    v_cvt_pk_bf16_f32 v103, v82, v83
    v_permlane16_swap_b32 v96, v98
    v_permlane16_swap_b32 v97, v99
    v_permlane16_swap_b32 v100, v102
    v_permlane16_swap_b32 v101, v103
    buffer_store_dwordx4 v[96:99], v20, s[12:15], 0 offen offset:0
    buffer_store_dwordx4 v[100:103], v20, s[12:15], 0 offen offset:64
L_end:
    s_endpgm
L_wb0:
    buffer_wbl2 sc1
    s_waitcnt vmcnt(0)
    buffer_store_dword v254, v12, s[60:63], s59 offen sc1
    s_branch L_wbb0
L_spin10:
    s_mov_b32 s99, 0
L_spinl10:
    s_add_u32 s99, s99, 1
    s_cmp_gt_u32 s99, 0x20000
    s_cbranch_scc1 L_back10
    s_sleep 1
    buffer_load_dword a232, v11, s[60:63], 0 offen sc1
    s_waitcnt vmcnt(0)
    v_accvgpr_read_b32 v8, a232
    s_nop 0
    v_cmp_ne_u32 vcc, 1, v8
    s_nop 4
    s_cbranch_vccnz L_spinl10
    s_branch L_back10
L_spin11:
    s_mov_b32 s99, 0
L_spinl11:
    s_add_u32 s99, s99, 1
    s_cmp_gt_u32 s99, 0x20000
    s_cbranch_scc1 L_back11
    s_sleep 1
    buffer_load_dword a232, v11, s[60:63], 0 offen sc1
    s_waitcnt vmcnt(0)
    v_accvgpr_read_b32 v8, a232
    s_nop 0
    v_cmp_ne_u32 vcc, 1, v8
    s_nop 4
    s_cbranch_vccnz L_spinl11
    s_branch L_back11
L_nmx1:
    v_mov_b32 v160, v5
    v_mov_b32 v161, v5
    v_mov_b32 v162, v5
    v_mov_b32 v163, v5
    v_lshrrev_b32 v10, 8, v1
    v_lshlrev_b32 v10, 2, v10
    v_bfe_u32 v9, v1, 4, 4
    v_sub_u32 v10, v10, v9
    s_lshl_b32 s52, s27, 6
    s_mov_b32 s50, 0
    s_lshl_b32 s51, s24, 20
    v_add_u32 v8, s51, v1
L_nmx1loop:
    s_lshr_b32 s54, s50, 2
    s_lshl_b32 s54, s54, 15
    s_and_b32 s55, s50, 3
    s_lshl_b32 s55, s55, 12
    s_add_u32 s54, s54, s55
    buffer_load_dwordx4 a[128:131], v8, s[12:15], s54 offen offset:0 sc1
    buffer_load_dwordx4 a[132:135], v8, s[12:15], s54 offen offset:1024 sc1
    buffer_load_dwordx4 a[136:139], v8, s[12:15], s54 offen offset:2048 sc1
    buffer_load_dwordx4 a[140:143], v8, s[12:15], s54 offen offset:3072 sc1
    s_waitcnt vmcnt(0)
    v_mfma_f32_16x16x32_bf16 v[144:147], a[128:131], a[0:3], 0
    v_mfma_f32_16x16x32_bf16 v[144:147], a[132:135], a[4:7], v[144:147]
    v_mfma_f32_16x16x32_bf16 v[144:147], a[136:139], a[8:11], v[144:147]
    v_mfma_f32_16x16x32_bf16 v[144:147], a[140:143], a[12:15], v[144:147]
    v_mfma_f32_16x16x32_bf16 v[148:151], a[128:131], a[16:19], 0
    v_mfma_f32_16x16x32_bf16 v[148:151], a[132:135], a[20:23], v[148:151]
    v_mfma_f32_16x16x32_bf16 v[148:151], a[136:139], a[24:27], v[148:151]
    v_mfma_f32_16x16x32_bf16 v[148:151], a[140:143], a[28:31], v[148:151]
    v_mfma_f32_16x16x32_bf16 v[152:155], a[128:131], a[32:35], 0
    v_mfma_f32_16x16x32_bf16 v[152:155], a[132:135], a[36:39], v[152:155]
    v_mfma_f32_16x16x32_bf16 v[152:155], a[136:139], a[40:43], v[152:155]
    v_mfma_f32_16x16x32_bf16 v[152:155], a[140:143], a[44:47], v[152:155]
    v_mfma_f32_16x16x32_bf16 v[156:159], a[128:131], a[48:51], 0
    v_mfma_f32_16x16x32_bf16 v[156:159], a[132:135], a[52:55], v[156:159]
    v_mfma_f32_16x16x32_bf16 v[156:159], a[136:139], a[56:59], v[156:159]
    v_mfma_f32_16x16x32_bf16 v[156:159], a[140:143], a[60:63], v[156:159]
    s_nop 7
    s_add_i32 s54, s52, 0
    v_cmp_ge_i32 vcc, s54, v10
    s_nop 1
    v_cndmask_b32 v9, v5, v144, vcc
    v_max_f32 v160, v160, v9
    s_add_i32 s54, s52, -1
    v_cmp_ge_i32 vcc, s54, v10
    s_nop 1
    v_cndmask_b32 v9, v5, v145, vcc
    v_max_f32 v160, v160, v9
    s_add_i32 s54, s52, -2
    v_cmp_ge_i32 vcc, s54, v10
    s_nop 1
    v_cndmask_b32 v9, v5, v146, vcc
    v_max_f32 v160, v160, v9
    s_add_i32 s54, s52, -3
    v_cmp_ge_i32 vcc, s54, v10
    s_nop 1
    v_cndmask_b32 v9, v5, v147, vcc
    v_max_f32 v160, v160, v9
    s_add_i32 s54, s52, 16
    v_cmp_ge_i32 vcc, s54, v10
    s_nop 1
    v_cndmask_b32 v9, v5, v148, vcc
    v_max_f32 v161, v161, v9
    s_add_i32 s54, s52, 15
    v_cmp_ge_i32 vcc, s54, v10
    s_nop 1
    v_cndmask_b32 v9, v5, v149, vcc
    v_max_f32 v161, v161, v9
    s_add_i32 s54, s52, 14
    v_cmp_ge_i32 vcc, s54, v10
    s_nop 1
    v_cndmask_b32 v9, v5, v150, vcc
    v_max_f32 v161, v161, v9
    s_add_i32 s54, s52, 13
    v_cmp_ge_i32 vcc, s54, v10
    s_nop 1
    v_cndmask_b32 v9, v5, v151, vcc
    v_max_f32 v161, v161, v9
    s_add_i32 s54, s52, 32
    v_cmp_ge_i32 vcc, s54, v10
    s_nop 1
    v_cndmask_b32 v9, v5, v152, vcc
    v_max_f32 v162, v162, v9
    s_add_i32 s54, s52, 31
    v_cmp_ge_i32 vcc, s54, v10
    s_nop 1
    v_cndmask_b32 v9, v5, v153, vcc
    v_max_f32 v162, v162, v9
    s_add_i32 s54, s52, 30
    v_cmp_ge_i32 vcc, s54, v10
    s_nop 1
    v_cndmask_b32 v9, v5, v154, vcc
    v_max_f32 v162, v162, v9
    s_add_i32 s54, s52, 29
    v_cmp_ge_i32 vcc, s54, v10
    s_nop 1
    v_cndmask_b32 v9, v5, v155, vcc
    v_max_f32 v162, v162, v9
    s_add_i32 s54, s52, 48
    v_cmp_ge_i32 vcc, s54, v10
    s_nop 1
    v_cndmask_b32 v9, v5, v156, vcc
    v_max_f32 v163, v163, v9
    s_add_i32 s54, s52, 47
    v_cmp_ge_i32 vcc, s54, v10
    s_nop 1
    v_cndmask_b32 v9, v5, v157, vcc
    v_max_f32 v163, v163, v9
    s_add_i32 s54, s52, 46
    v_cmp_ge_i32 vcc, s54, v10
    s_nop 1
    v_cndmask_b32 v9, v5, v158, vcc
    v_max_f32 v163, v163, v9
    s_add_i32 s54, s52, 45
    v_cmp_ge_i32 vcc, s54, v10
    s_nop 1
    v_cndmask_b32 v9, v5, v159, vcc
    v_max_f32 v163, v163, v9
    s_sub_i32 s52, s52, 16
    s_add_u32 s50, s50, 1
    s_cmp_ge_i32 s52, -48
    s_cbranch_scc1 L_nmx1loop
    v_mov_b32 v9, v160
    s_nop 1
    v_permlane32_swap_b32 v160, v9
    v_max_f32 v160, v160, v9
    v_mov_b32 v9, v160
    s_nop 1
    v_permlane16_swap_b32 v160, v9
    v_max_f32 v160, v160, v9
    v_sub_f32 v240, 0, v160
    v_sub_f32 v241, 0, v160
    v_sub_f32 v242, 0, v160
    v_sub_f32 v243, 0, v160
    v_mov_b32 v9, v161
    s_nop 1
    v_permlane32_swap_b32 v161, v9
    v_max_f32 v161, v161, v9
    v_mov_b32 v9, v161
    s_nop 1
    v_permlane16_swap_b32 v161, v9
    v_max_f32 v161, v161, v9
    v_sub_f32 v244, 0, v161
    v_sub_f32 v245, 0, v161
    v_sub_f32 v246, 0, v161
    v_sub_f32 v247, 0, v161
    v_mov_b32 v9, v162
    s_nop 1
    v_permlane32_swap_b32 v162, v9
    v_max_f32 v162, v162, v9
    v_mov_b32 v9, v162
    s_nop 1
    v_permlane16_swap_b32 v162, v9
    v_max_f32 v162, v162, v9
    v_sub_f32 v248, 0, v162
    v_sub_f32 v249, 0, v162
    v_sub_f32 v250, 0, v162
    v_sub_f32 v251, 0, v162
    v_mov_b32 v9, v163
    s_nop 1
    v_permlane32_swap_b32 v163, v9
    v_max_f32 v163, v163, v9
    v_mov_b32 v9, v163
    s_nop 1
    v_permlane16_swap_b32 v163, v9
    v_max_f32 v163, v163, v9
    v_sub_f32 v252, 0, v163
    v_sub_f32 v253, 0, v163
    v_sub_f32 v254, 0, v163
    v_sub_f32 v255, 0, v163
    s_branch L_go
L_spin0:
    s_mov_b32 s99, 0
L_spinl0:
    s_add_u32 s99, s99, 1
    s_cmp_gt_u32 s99, 0x20000
    s_cbranch_scc1 L_back0
    s_sleep 1
    buffer_load_dword v254, v255, s[28:31], 0 offen sc1
    s_waitcnt vmcnt(0)
    v_cmp_ne_u32 vcc, v229, v254
    s_nop 4
    s_cbranch_vccnz L_spinl0
    s_branch L_back0
L_spin1:
    s_mov_b32 s99, 0
L_spinl1:
    s_add_u32 s99, s99, 1
    s_cmp_gt_u32 s99, 0x20000
    s_cbranch_scc1 L_back1
    s_sleep 1
    buffer_load_dword v254, v255, s[60:63], 0 offen sc1
    s_waitcnt vmcnt(0)
    v_or_b32 v224, v254, v225
    v_cmp_eq_u32 vcc, 0, v224
    s_nop 4
    s_cbranch_vccnz L_spinl1
    s_branch L_back1
L_spin2:
    s_mov_b32 s99, 0
L_spinl2:
    s_add_u32 s99, s99, 1
    s_cmp_gt_u32 s99, 0x20000
    s_cbranch_scc1 L_back2
    s_sleep 1
    buffer_load_dword v254, v252, s[60:63], 0 offen sc1
    s_waitcnt vmcnt(0)
    v_cmp_ne_u32 vcc, 1, v254
    s_nop 4
    s_cbranch_vccnz L_spinl2
    s_branch L_back2
L_spin3:
    s_mov_b32 s99, 0
L_spinl3:
    s_add_u32 s99, s99, 1
    s_cmp_gt_u32 s99, 0x20000
    s_cbranch_scc1 L_back3
    s_sleep 1
    buffer_load_dwordx4 a[228:231], v14, s[60:63], 0 offen sc1
    s_waitcnt vmcnt(0)
    v_accvgpr_read_b32 v8, a228
    v_accvgpr_read_b32 v9, a229
    v_accvgpr_read_b32 v10, a230
    v_accvgpr_read_b32 v11, a231
    v_and_b32 v8, v8, v9
    v_and_b32 v10, v10, v11
    v_and_b32 v8, v8, v10
    v_cmp_ne_u32 vcc, 1, v8
    s_nop 4
    s_cbranch_vccnz L_spinl3
    s_branch L_back3
L_spin12:
    s_mov_b32 s99, 0
L_spinl12:
    s_add_u32 s99, s99, 1
    s_cmp_gt_u32 s99, 0x20000
    s_cbranch_scc1 L_back12
    s_sleep 1
    buffer_load_dword v189, v188, s[60:63], 0 offen offset:0 sc1
    s_waitcnt vmcnt(0)
    v_cmp_ne_u32 vcc, 1, v189
    s_nop 4
    s_cbranch_vccnz L_spinl12
    s_branch L_back12
L_spin4:
    s_mov_b32 s99, 0
L_spinl4:
    s_add_u32 s99, s99, 1
    s_cmp_gt_u32 s99, 0x20000
    s_cbranch_scc1 L_back4
    s_sleep 1
    buffer_load_dword v189, v188, s[60:63], 0 offen offset:1024 sc1
    s_waitcnt vmcnt(0)
    v_cmp_ne_u32 vcc, 1, v189
    s_nop 4
    s_cbranch_vccnz L_spinl4
    s_branch L_back4
L_spin7:
    s_mov_b32 s99, 0
L_spinl7:
    s_add_u32 s99, s99, 1
    s_cmp_gt_u32 s99, 0x20000
    s_cbranch_scc1 L_back7
    s_sleep 1
    buffer_load_dword v3, v20, s[60:63], 0 offen sc1
    s_waitcnt vmcnt(0)
    v_cmp_ne_u32 vcc, 1, v3
    s_nop 4
    s_cbranch_vccnz L_spinl7
    s_branch L_back7
L_wb4:
    buffer_wbl2 sc1
    s_waitcnt vmcnt(0)
    buffer_store_dword v2, v5, s[60:63], 0 offen sc1
    s_branch L_wbb4
L_wb5:
    buffer_wbl2 sc1
    s_waitcnt vmcnt(0)
    buffer_store_dword v2, v5, s[60:63], 0 offen sc1
    s_branch L_wbb5
L_spin8:
    s_mov_b32 s99, 0
L_spinl8:
    s_add_u32 s99, s99, 1
    s_cmp_gt_u32 s99, 0x20000
    s_cbranch_scc1 L_back8
    s_sleep 1
    buffer_load_dword v3, v7, s[60:63], 0 offen sc1
    s_waitcnt vmcnt(0)
    v_cmp_ne_u32 vcc, 1, v3
    s_nop 4
    s_cbranch_vccnz L_spinl8
    s_branch L_back8
L_wb1:
    buffer_wbl2 sc1
    s_waitcnt vmcnt(0)
    buffer_store_dword v2, v14, s[60:63], 0 offen sc1
    s_branch L_wbb1
L_spin5:
    s_mov_b32 s99, 0
L_spinl5:
    s_add_u32 s99, s99, 1
    s_cmp_gt_u32 s99, 0x20000
    s_cbranch_scc1 L_back5
    s_sleep 1
    buffer_load_dword v2, v8, s[60:63], 0 offen sc1
    s_waitcnt vmcnt(0)
    v_cmp_ne_u32 vcc, 1, v2
    s_nop 4
    s_cbranch_vccnz L_spinl5
    s_branch L_back5
L_wb3:
    buffer_wbl2 sc1
    s_waitcnt vmcnt(0)
    buffer_store_dword v2, v14, s[60:63], 0 offen offset:16 sc1
    s_branch L_wbb3
L_spin9:
    s_mov_b32 s99, 0
L_spinl9:
    s_add_u32 s99, s99, 1
    s_cmp_gt_u32 s99, 0x20000
    s_cbranch_scc1 L_back9
    s_sleep 1
    buffer_load_dword v29, v28, s[60:63], 0 offen offset:16 sc1
    s_waitcnt vmcnt(0)
    v_cmp_ne_u32 vcc, 1, v29
    s_nop 4
    s_cbranch_vccnz L_spinl9
    s_branch L_back9
L_spin6:
    s_mov_b32 s99, 0
L_spinl6:
    s_add_u32 s99, s99, 1
    s_cmp_gt_u32 s99, 0x20000
    s_cbranch_scc1 L_back6
    s_sleep 1
    buffer_load_dword v29, v28, s[60:63], 0 offen sc1
    s_waitcnt vmcnt(0)
    v_cmp_ne_u32 vcc, 1, v29
    s_nop 4
    s_cbranch_vccnz L_spinl6
    s_branch L_back6
L_wb2:
    buffer_wbl2 sc1
    s_waitcnt vmcnt(0)
    buffer_store_dword v2, v14, s[60:63], 0 offen sc1
    s_branch L_wbb2
L_text_end:
.section .rodata,"a"
.p2align 6
.amdhsa_kernel sequential_preLN__compressed_kv_cla__geglu_ffn__prompt_kernel
  .amdhsa_next_free_vgpr 512
  .amdhsa_next_free_sgpr 102
  .amdhsa_accum_offset 256
  .amdhsa_group_segment_fixed_size 0
  .amdhsa_kernarg_size 104
  .amdhsa_user_sgpr_count 2
  .amdhsa_user_sgpr_kernarg_segment_ptr 1
  .amdhsa_system_sgpr_workgroup_id_x 1
.end_amdhsa_kernel
```
